```python
import torch

def _softmax(x, axis=-1):
    return torch.softmax(x, dim=axis)
def _gelu(x):
    return torch.nn.functional.gelu(x, approximate="tanh")
def _silu(x):
    return torch.nn.functional.silu(x)
def _sigmoid(x):
    return torch.sigmoid(x)
def _layernorm(x, axis=-1, eps=1e-5):
    m = x.mean(dim=axis, keepdim=True)
    v = x.var(dim=axis, keepdim=True, unbiased=False)
    return (x - m) / torch.sqrt(v + eps)
def _scatter_add(tgt, idx, src, axis=0):
    return tgt.clone().index_add_(axis, idx, src)
def _segment_sum(src, seg, n):
    out = torch.zeros((n,) + src.shape[1:], dtype=src.dtype)
    return out.index_add_(0, seg, src)
def _pad(x, pw):
    flat = tuple(v for pair in reversed(pw) for v in pair)
    return torch.nn.functional.pad(x, flat)

kernel_name = 'concat_heads__sliding_block__softmax_full_mha__prompt'

def setup_inputs():

    _w = (lambda a: (lambda t: t.to(torch.bfloat16) if t.is_floating_point() else t)(torch.as_tensor(a)))
    def _A_setup():
        B, S, D = 1, 2048, 1024
        return {
            "x": _w((lambda *s: torch.randn(*s, dtype=torch.bfloat16) * 0.2)(B, S, D)),
            "wqkv": _w((lambda *s: torch.randn(*s, dtype=torch.bfloat16) * 0.8)(D, 3 * D)),
            "wo": _w((lambda *s: torch.randn(*s, dtype=torch.bfloat16) * 0.8)(D, D)),
        }
    _A_in = _A_setup()

    def _B_setup():
        B, S, D = 1, 2048, 1024
        return {
            "x": _w((lambda *s: torch.randn(*s, dtype=torch.bfloat16) * 0.2)(B, S, D)),
            "wqkv": _w((lambda *s: torch.randn(*s, dtype=torch.bfloat16) * 0.8)(D, 3 * D)),
            "wo": _w((lambda *s: torch.randn(*s, dtype=torch.bfloat16) * 0.8)(D, D)),
        }
    _B_in = _B_setup()

    return {
        "A_x": _A_in["x"],
        "A_wqkv": _A_in["wqkv"],
        "A_wo": _A_in["wo"],
        "B_x": _B_in["x"],
        "B_wqkv": _B_in["wqkv"],
        "B_wo": _B_in["wo"],
    }

def reference(A_x, A_wqkv, A_wo, B_x, B_wqkv, B_wo):
    def _A_ref(x, wqkv, wo):
        B, S, D = x.shape
        H = 32; Dh = D // H; W = 256
        qkv = (lambda x, *d: x.permute(*d))((x @ wqkv).reshape(B, S, 3, H, Dh), 2, 0, 3, 1, 4)
        q, k, v = qkv[0], qkv[1], qkv[2]
        scores = torch.einsum("bhqd,bhkd->bhqk", q, k) * (Dh ** -0.5)
        idx = torch.arange(S)
        mask = (idx[:, None] - idx[None, :] >= 0) & (idx[:, None] - idx[None, :] < W)
        scores = torch.where(mask[None, None], scores, -1e9)
        p = _softmax(scores, axis=-1)
        o = torch.einsum("bhqk,bhkd->bhqd", p, v)
        return (lambda x, *d: x.permute(*d))(o, 0, 2, 1, 3).reshape(B, S, D) @ wo

    def _B_ref(x, wqkv, wo):
        B, S, D = x.shape
        H = 32; Dh = D // H
        qkv = (lambda x, *d: x.permute(*d))((x @ wqkv).reshape(B, S, 3, H, Dh), 2, 0, 3, 1, 4)
        q, k, v = qkv[0], qkv[1], qkv[2]
        scale = Dh ** -0.5
        scores = torch.einsum("bhqd,bhkd->bhqk", q, k) * scale
        p = _softmax(scores, axis=-1)
        o = torch.einsum("bhqk,bhkd->bhqd", p, v)
        return (lambda x, *d: x.permute(*d))(o, 0, 2, 1, 3).reshape(B, S, D) @ wo

    a = _A_ref(A_x, A_wqkv, A_wo)
    b = _B_ref(B_x, B_wqkv, B_wo)
    return torch.concatenate([a, b], axis=-1)
```

```asm
; @launch grid=(256,1,1) block=(256,1,1) lds=163840
.amdgcn_target "amdgcn-amd-amdhsa--gfx950"
.text
.globl concat_heads__sliding_block__softmax_full_mha__prompt_kernel
.p2align 8
.type concat_heads__sliding_block__softmax_full_mha__prompt_kernel,@function
concat_heads__sliding_block__softmax_full_mha__prompt_kernel:
    s_cmp_ge_u32 s2, 256
    s_cbranch_scc1 fz_end
    s_load_dwordx4 s[16:19], s[0:1], 24
    s_load_dwordx4 s[36:39], s[0:1], 0
    s_load_dwordx4 s[4:7], s[0:1], 56
    s_load_dwordx2 s[42:43], s[0:1], 16
    s_load_dwordx2 s[44:45], s[0:1], 40
    s_load_dwordx2 s[40:41], s[0:1], 48
    s_getpc_b64 s[98:99]
fz_pc:
    s_lshr_b32 s33, s2, 3
    s_lshl_b32 s33, s33, 14
    v_lshl_add_u32 v44, v0, 6, s33
    v_min_u32 v44, fz_code_end-fz_pc-4, v44
    global_load_dword v45, v44, s[98:99]
    v_lshrrev_b32 v3, 6, v0
    v_and_b32 v2, 63, v0
    v_readfirstlane_b32 s24, v3
    v_lshlrev_b32 v1, 4, v2
    s_and_b32 s33, s2, 3
    s_lshl_b32 s33, s33, 2
    s_lshr_b32 s34, s2, 6
    s_add_u32 s26, s33, s34
    s_bfe_u32 s27, s2, 0x30003
    s_bfe_u32 s62, s2, 0x10002
    v_lshrrev_b32 v6, 3, v2
    v_lshrrev_b32 v21, 4, v2
    v_and_b32 v22, 7, v2
    s_bfe_u32 s10, s27, 0x10001
    s_bfe_u32 s11, s26, 0x10001
    s_lshl_b32 s33, s24, 1
    s_add_u32 s25, s33, s10
    s_lshl_b32 s33, s25, 3
    v_add_u32 v20, s33, v6
    v_xor_b32 v7, 8, v20
    v_mul_u32_u24 v20, 6144, v20
    v_mul_u32_u24 v7, 6144, v7
    v_and_b32 v23, 1, v21
    v_lshlrev_b32 v23, 1, v23
    v_xor_b32 v23, v23, v22
    s_lshl_b32 s33, s10, 2
    v_xor_b32 v23, s33, v23
    s_lshl_b32 s33, s26, 7
    v_lshl_add_u32 v23, v23, 4, s33
    v_add_u32 v36, v23, v20
    v_xor_b32 v23, 64, v23
    v_add_u32 v39, v23, v7
    v_add_u32 v37, 1024, v36
    v_add_u32 v40, 1024, v39
    v_add_u32 v38, 2048, v36
    v_add_u32 v41, 2048, v39
    s_lshl_b32 s33, s27, 8
    s_lshl_b32 s34, s24, 6
    s_add_u32 s33, s33, s34
    s_lshl_b32 s34, s11, 5
    s_add_u32 s33, s33, s34
    s_lshl_b32 s34, s11, 17
    s_sub_u32 s34, 0x10000, s34
    v_add_u32 v20, s33, v6
    v_lshlrev_b32 v20, 11, v20
    v_xor_b32 v23, v22, v21
    v_lshl_add_u32 v28, v23, 4, v20
    v_xor_b32 v29, 64, v28
    v_add_u32 v29, 15360, v29
    v_add_u32 v30, 30720, v28
    v_add_u32 v31, 30720, v29
    v_add_u32 v32, s34, v28
    v_add_u32 v33, s34, v29
    v_add_u32 v34, s34, v30
    v_add_u32 v35, s34, v31
    s_lshl_b32 s30, s24, 13
    s_lshl_b32 s33, s11, 12
    s_add_u32 s46, s30, s33
    s_xor_b32 s47, s46, 4096
    s_mul_i32 s31, s25, 3072
    s_add_u32 s31, s31, 98304
    s_xor_b32 s25, s25, 1
    s_mul_i32 s30, s25, 3072
    s_add_u32 s30, s30, 98304
    s_xor_b32 s53, s26, s27
    s_and_b32 s53, s53, 1
    s_lshl_b32 s53, s53, 7
    s_cmp_eq_u32 s62, 0
    s_waitcnt lgkmcnt(0)
    s_cselect_b64 s[16:17], s[36:37], s[16:17]
    s_cselect_b64 s[18:19], s[38:39], s[18:19]
    s_xor_b32 s28, s53, 0
    s_mul_i32 s29, s28, 3072
    s_add_u32 s14, s18, s29
    s_addc_u32 s15, s19, 0
    s_add_u32 m0, s31, 0
    s_nop 0
    global_load_lds_dwordx4 v36, s[14:15] offset:0
    s_add_u32 s12, s16, s28
    s_addc_u32 s13, s17, 0
    global_load_lds_dwordx4 v37, s[14:15] offset:1024
    global_load_lds_dwordx4 v38, s[14:15] offset:2048
    s_add_u32 m0, s46, 0
    s_nop 0
    global_load_lds_dwordx4 v28, s[12:13] offset:0
    global_load_lds_dwordx4 v29, s[12:13] offset:1024
    global_load_lds_dwordx4 v30, s[12:13] offset:2048
    global_load_lds_dwordx4 v31, s[12:13] offset:3072
    s_add_u32 m0, s30, 0
    s_nop 0
    global_load_lds_dwordx4 v39, s[14:15] offset:0
    global_load_lds_dwordx4 v40, s[14:15] offset:1024
    global_load_lds_dwordx4 v41, s[14:15] offset:2048
    s_add_u32 m0, s47, 0
    s_nop 0
    global_load_lds_dwordx4 v32, s[12:13] offset:0
    global_load_lds_dwordx4 v33, s[12:13] offset:1024
    global_load_lds_dwordx4 v34, s[12:13] offset:2048
    global_load_lds_dwordx4 v35, s[12:13] offset:3072
    s_lshr_b32 s36, s24, 1
    s_and_b32 s37, s24, 1
    v_and_b32 v17, 15, v2
    v_and_b32 v7, 1, v21
    v_lshrrev_b32 v8, 5, v2
    s_lshl_b32 s33, s36, 7
    v_add_u32 v20, s33, v17
    v_lshlrev_b32 v20, 7, v20
    v_lshrrev_b32 v23, 1, v17
    v_xor_b32 v23, v23, v21
    v_lshl_add_u32 v48, v23, 4, v20
    v_xor_b32 v49, 64, v48
    v_add_u32 v50, 0x10000, v48
    v_add_u32 v51, 0x10000, v49
    v_mul_u32_u24 v20, 3072, v21
    v_lshrrev_b32 v12, 2, v17
    v_lshl_add_u32 v20, v12, 7, v20
    v_lshrrev_b32 v13, 1, v12
    v_xor_b32 v23, s37, v7
    v_lshl_add_u32 v23, v23, 1, v13
    v_lshl_add_u32 v20, v23, 5, v20
    v_and_b32 v14, 3, v2
    v_lshl_add_u32 v20, v14, 3, v20
    v_add_u32 v42, 98304, v20
    v_xor_b32 v43, 32, v42
    s_lshl_b32 s33, s62, 2
    s_add_u32 s33, s33, s24
    s_mov_b64 exec, 0
    s_cmp_eq_u32 s33, 1
    s_cbranch_scc1 hook12
    s_cmp_eq_u32 s33, 2
    s_cbranch_scc1 hook11
    s_cmp_eq_u32 s33, 3
    s_cbranch_scc1 hook10
    s_cmp_eq_u32 s33, 4
    s_cbranch_scc1 hook9
    s_cmp_eq_u32 s33, 5
    s_cbranch_scc1 hook8
    s_cmp_eq_u32 s33, 6
    s_cbranch_scc1 hook7
    s_cmp_eq_u32 s33, 7
    s_cbranch_scc1 hook6
    s_branch hook13
hook_end:
    s_mov_b64 exec, -1
    s_branch fz_main
pinit_spin:
    s_mov_b32 s25, 65536
pinit_spin1:
    buffer_load_dword v5, v4, s[4:7], 0 offen sc1
    s_waitcnt vmcnt(0)
    v_cmp_gt_u32 vcc, 32, v5
    s_cbranch_vccz pinit_ok
    s_sleep 4
    s_sub_u32 s25, s25, 1
    s_cmp_lg_u32 s25, 0
    s_cbranch_scc1 pinit_spin1
    s_branch pinit_ok
a_set2:
    s_nop 7
    v_mov_b32 v224, v11
    v_mov_b32 v225, v11
    v_mov_b64 v[226:227], v[224:225]
    v_mov_b64 v[228:229], v[224:225]
    v_mov_b64 v[230:231], v[224:225]
    v_mov_b64 v[232:233], v[224:225]
    v_mov_b64 v[234:235], v[224:225]
    v_mov_b64 v[236:237], v[224:225]
    v_mov_b64 v[238:239], v[224:225]
    v_mov_b64 v[240:241], v[224:225]
    v_mov_b64 v[242:243], v[224:225]
    v_mov_b64 v[244:245], v[224:225]
    v_mov_b64 v[246:247], v[224:225]
    v_mov_b64 v[248:249], v[224:225]
    v_mov_b64 v[250:251], v[224:225]
    v_mov_b64 v[252:253], v[224:225]
    v_mov_b64 v[254:255], v[224:225]
    s_branch a_set2b
a_set4:
    s_nop 7
    v_mov_b32 v224, v11
    v_mov_b32 v225, v11
    v_mov_b64 v[226:227], v[224:225]
    v_mov_b64 v[228:229], v[224:225]
    v_mov_b64 v[230:231], v[224:225]
    v_mov_b64 v[232:233], v[224:225]
    v_mov_b64 v[234:235], v[224:225]
    v_mov_b64 v[236:237], v[224:225]
    v_mov_b64 v[238:239], v[224:225]
    v_mov_b64 v[240:241], v[224:225]
    v_mov_b64 v[242:243], v[224:225]
    v_mov_b64 v[244:245], v[224:225]
    v_mov_b64 v[246:247], v[224:225]
    v_mov_b64 v[248:249], v[224:225]
    v_mov_b64 v[250:251], v[224:225]
    v_mov_b64 v[252:253], v[224:225]
    v_mov_b64 v[254:255], v[224:225]
    s_branch a_set4b
b_set6:
    s_nop 7
    v_mov_b32 v128, v12
    v_mov_b32 v129, v12
    v_mov_b64 v[130:131], v[128:129]
    v_mov_b64 v[132:133], v[128:129]
    v_mov_b64 v[134:135], v[128:129]
    v_mov_b64 v[136:137], v[128:129]
    v_mov_b64 v[138:139], v[128:129]
    v_mov_b64 v[140:141], v[128:129]
    v_mov_b64 v[142:143], v[128:129]
    v_mov_b32 v144, v13
    v_mov_b32 v145, v13
    v_mov_b64 v[146:147], v[144:145]
    v_mov_b64 v[148:149], v[144:145]
    v_mov_b64 v[150:151], v[144:145]
    v_mov_b64 v[152:153], v[144:145]
    v_mov_b64 v[154:155], v[144:145]
    v_mov_b64 v[156:157], v[144:145]
    v_mov_b64 v[158:159], v[144:145]
    s_branch b_set6b
b_set8:
    s_nop 7
    v_mov_b32 v128, v12
    v_mov_b32 v129, v12
    v_mov_b64 v[130:131], v[128:129]
    v_mov_b64 v[132:133], v[128:129]
    v_mov_b64 v[134:135], v[128:129]
    v_mov_b64 v[136:137], v[128:129]
    v_mov_b64 v[138:139], v[128:129]
    v_mov_b64 v[140:141], v[128:129]
    v_mov_b64 v[142:143], v[128:129]
    v_mov_b32 v144, v13
    v_mov_b32 v145, v13
    v_mov_b64 v[146:147], v[144:145]
    v_mov_b64 v[148:149], v[144:145]
    v_mov_b64 v[150:151], v[144:145]
    v_mov_b64 v[152:153], v[144:145]
    v_mov_b64 v[154:155], v[144:145]
    v_mov_b64 v[156:157], v[144:145]
    v_mov_b64 v[158:159], v[144:145]
    s_branch b_set8b
b_diag:
    v_cndmask_b32 v112, v11, v112, s[64:65]
    v_cndmask_b32 v113, v11, v113, s[66:67]
    v_cndmask_b32 v114, v11, v114, s[68:69]
    v_cndmask_b32 v115, v11, v115, s[70:71]
    v_cndmask_b32 v116, v11, v116, s[72:73]
    v_cndmask_b32 v117, v11, v117, s[74:75]
    v_cndmask_b32 v118, v11, v118, s[76:77]
    v_cndmask_b32 v119, v11, v119, s[78:79]
    v_cndmask_b32 v120, v11, v120, s[80:81]
    v_cndmask_b32 v121, v11, v121, s[82:83]
    v_cndmask_b32 v122, v11, v122, s[84:85]
    v_cndmask_b32 v123, v11, v123, s[86:87]
    v_cndmask_b32 v124, v11, v124, s[88:89]
    v_cndmask_b32 v125, v11, v125, s[90:91]
    v_cndmask_b32 v126, v11, v126, s[92:93]
    v_cndmask_b32 v127, v11, v127, s[94:95]
    s_branch b_diagb
bpb0_spin:
    s_mov_b32 s25, 65536
bpb0_spin1:
    buffer_load_dword v5, v19, s[20:23], 0 offen offset:0 sc1
    s_waitcnt vmcnt(0)
    v_cmp_gt_u32 vcc, 1, v5
    s_cbranch_vccz bpb0_ok
    s_sleep 4
    s_sub_u32 s25, s25, 1
    s_cmp_lg_u32 s25, 0
    s_cbranch_scc1 bpb0_spin1
    s_branch bpb0_ok
bpb1_spin:
    s_mov_b32 s25, 65536
bpb1_spin1:
    buffer_load_dword v5, v19, s[20:23], 0 offen offset:128 sc1
    s_waitcnt vmcnt(0)
    v_cmp_gt_u32 vcc, 1, v5
    s_cbranch_vccz bpb1_ok
    s_sleep 4
    s_sub_u32 s25, s25, 1
    s_cmp_lg_u32 s25, 0
    s_cbranch_scc1 bpb1_spin1
    s_branch bpb1_ok
bpa_spin:
    s_mov_b32 s25, 65536
bpa_spin1:
    buffer_load_dword v5, v18, s[20:23], 0 offen offset:256 sc1
    s_waitcnt vmcnt(0)
    v_cmp_gt_u32 vcc, 1, v5
    s_cbranch_vccz bpa_ok
    s_sleep 4
    s_sub_u32 s25, s25, 1
    s_cmp_lg_u32 s25, 0
    s_cbranch_scc1 bpa_spin1
    s_branch bpa_ok
bpb2_spin:
    s_mov_b32 s25, 65536
bpb2_spin1:
    buffer_load_dword v5, v19, s[20:23], 0 offen offset:256 sc1
    s_waitcnt vmcnt(0)
    v_cmp_gt_u32 vcc, 1, v5
    s_cbranch_vccz bpb2_ok
    s_sleep 4
    s_sub_u32 s25, s25, 1
    s_cmp_lg_u32 s25, 0
    s_cbranch_scc1 bpb2_spin1
    s_branch bpb2_ok
apa_spin:
    s_mov_b32 s25, 65536
apa_spin1:
    buffer_load_dword v5, v4, s[20:23], 0 offen offset:0 sc1
    s_waitcnt vmcnt(0)
    v_cmp_gt_u32 vcc, 1, v5
    s_cbranch_vccz apa_ok
    s_sleep 4
    s_sub_u32 s25, s25, 1
    s_cmp_lg_u32 s25, 0
    s_cbranch_scc1 apa_spin1
    s_branch apa_ok
apb0_spin:
    s_mov_b32 s25, 65536
apb0_spin1:
    buffer_load_dword v5, v19, s[20:23], 0 offen offset:0 sc1
    s_waitcnt vmcnt(0)
    v_cmp_gt_u32 vcc, 1, v5
    s_cbranch_vccz apb0_ok
    s_sleep 4
    s_sub_u32 s25, s25, 1
    s_cmp_lg_u32 s25, 0
    s_cbranch_scc1 apb0_spin1
    s_branch apb0_ok
apb1_spin:
    s_mov_b32 s25, 65536
apb1_spin1:
    buffer_load_dword v5, v19, s[20:23], 0 offen offset:128 sc1
    s_waitcnt vmcnt(0)
    v_cmp_gt_u32 vcc, 1, v5
    s_cbranch_vccz apb1_ok
    s_sleep 4
    s_sub_u32 s25, s25, 1
    s_cmp_lg_u32 s25, 0
    s_cbranch_scc1 apb1_spin1
    s_branch apb1_ok
apb2_spin:
    s_mov_b32 s25, 65536
apb2_spin1:
    buffer_load_dword v5, v19, s[20:23], 0 offen offset:256 sc1
    s_waitcnt vmcnt(0)
    v_cmp_gt_u32 vcc, 1, v5
    s_cbranch_vccz apb2_ok
    s_sleep 4
    s_sub_u32 s25, s25, 1
    s_cmp_lg_u32 s25, 0
    s_cbranch_scc1 apb2_spin1
    s_branch apb2_ok
poa_spin:
    s_mov_b32 s25, 65536
poa_spin1:
    buffer_load_dword v5, v46, s[20:23], 0 offen offset:384 sc1
    s_waitcnt vmcnt(0)
    v_cmp_gt_u32 vcc, 1, v5
    s_cbranch_vccz poa_ok
    s_sleep 4
    s_sub_u32 s25, s25, 1
    s_cmp_lg_u32 s25, 0
    s_cbranch_scc1 poa_spin1
    s_branch poa_ok
.p2align 12
fz_main:
hook0:
    s_cbranch_execz hook4
    s_xor_b32 s28, s53, 128
    s_mul_i32 s29, s28, 3072
    s_add_u32 s14, s18, s29
    s_addc_u32 s15, s19, 0
    s_add_u32 m0, s31, 24576
    s_nop 0
    global_load_lds_dwordx4 v36, s[14:15] offset:0
    s_add_u32 s12, s16, s28
    s_addc_u32 s13, s17, 0
    global_load_lds_dwordx4 v37, s[14:15] offset:1024
    global_load_lds_dwordx4 v38, s[14:15] offset:2048
    s_add_u32 m0, s46, 32768
    s_nop 0
    global_load_lds_dwordx4 v28, s[12:13] offset:0
    global_load_lds_dwordx4 v29, s[12:13] offset:1024
    global_load_lds_dwordx4 v30, s[12:13] offset:2048
    global_load_lds_dwordx4 v31, s[12:13] offset:3072
    s_add_u32 m0, s30, 24576
    s_nop 0
    global_load_lds_dwordx4 v39, s[14:15] offset:0
    global_load_lds_dwordx4 v40, s[14:15] offset:1024
    global_load_lds_dwordx4 v41, s[14:15] offset:2048
    s_add_u32 m0, s47, 32768
    s_nop 0
    global_load_lds_dwordx4 v32, s[12:13] offset:0
    global_load_lds_dwordx4 v33, s[12:13] offset:1024
    global_load_lds_dwordx4 v34, s[12:13] offset:2048
    global_load_lds_dwordx4 v35, s[12:13] offset:3072
    s_waitcnt vmcnt(14)
    s_barrier
    ds_read_b128 a[96:99], v48 offset:0
    ds_read_b128 a[100:103], v49 offset:0
    ds_read_b64_tr_b16 a[0:1], v42 offset:0
    ds_read_b64_tr_b16 a[2:3], v42 offset:512
    ds_read_b64_tr_b16 a[24:25], v42 offset:12288
    ds_read_b64_tr_b16 a[26:27], v42 offset:12800
    ds_read_b64_tr_b16 a[4:5], v43 offset:0
    ds_read_b64_tr_b16 a[6:7], v43 offset:512
    ds_read_b64_tr_b16 a[28:29], v43 offset:12288
    ds_read_b64_tr_b16 a[30:31], v43 offset:12800
    ds_read_b64_tr_b16 a[8:9], v42 offset:1024
    ds_read_b64_tr_b16 a[10:11], v42 offset:1536
    ds_read_b64_tr_b16 a[32:33], v42 offset:13312
    ds_read_b64_tr_b16 a[34:35], v42 offset:13824
    ds_read_b64_tr_b16 a[12:13], v43 offset:1024
    ds_read_b64_tr_b16 a[14:15], v43 offset:1536
    ds_read_b64_tr_b16 a[36:37], v43 offset:13312
    ds_read_b64_tr_b16 a[38:39], v43 offset:13824
    ds_read_b64_tr_b16 a[16:17], v42 offset:2048
    ds_read_b64_tr_b16 a[18:19], v42 offset:2560
    ds_read_b64_tr_b16 a[40:41], v42 offset:14336
    ds_read_b64_tr_b16 a[42:43], v42 offset:14848
    ds_read_b64_tr_b16 a[20:21], v43 offset:2048
    ds_read_b64_tr_b16 a[22:23], v43 offset:2560
    ds_read_b64_tr_b16 a[44:45], v43 offset:14336
    ds_read_b64_tr_b16 a[46:47], v43 offset:14848
    ds_read_b128 a[104:107], v48 offset:2048
    ds_read_b128 a[108:111], v49 offset:2048
    s_xor_b32 s28, s53, 256
    s_mul_i32 s29, s28, 3072
    s_add_u32 s14, s18, s29
    s_addc_u32 s15, s19, 0
    s_add_u32 m0, s31, 0
    s_waitcnt lgkmcnt(0)
    s_barrier
    v_mfma_f32_16x16x32_bf16 v[192:195], a[0:3], a[96:99], 0
    ds_read_b128 a[112:115], v48 offset:4096
    v_mfma_f32_16x16x32_bf16 v[192:195], a[24:27], a[100:103], v[192:195]
    ds_read_b128 a[116:119], v49 offset:4096
    v_mfma_f32_16x16x32_bf16 v[196:199], a[4:7], a[96:99], 0
    global_load_lds_dwordx4 v36, s[14:15] offset:0
    v_mfma_f32_16x16x32_bf16 v[196:199], a[28:31], a[100:103], v[196:199]
    v_mfma_f32_16x16x32_bf16 v[64:67], a[8:11], a[96:99], 0
    v_mfma_f32_16x16x32_bf16 v[64:67], a[32:35], a[100:103], v[64:67]
    v_mfma_f32_16x16x32_bf16 v[68:71], a[12:15], a[96:99], 0
    s_add_u32 s12, s16, s28
    v_mfma_f32_16x16x32_bf16 v[68:71], a[36:39], a[100:103], v[68:71]
    s_addc_u32 s13, s17, 0
    v_mfma_f32_16x16x32_bf16 v[128:131], a[96:99], a[16:19], 0
    global_load_lds_dwordx4 v37, s[14:15] offset:1024
    v_mfma_f32_16x16x32_bf16 v[128:131], a[100:103], a[40:43], v[128:131]
    v_mfma_f32_16x16x32_bf16 v[136:139], a[96:99], a[20:23], 0
    v_mfma_f32_16x16x32_bf16 v[136:139], a[100:103], a[44:47], v[136:139]
    v_mfma_f32_16x16x32_bf16 v[200:203], a[0:3], a[104:107], 0
    ds_read_b128 a[120:123], v48 offset:6144
    v_mfma_f32_16x16x32_bf16 v[200:203], a[24:27], a[108:111], v[200:203]
    ds_read_b128 a[124:127], v49 offset:6144
    v_mfma_f32_16x16x32_bf16 v[204:207], a[4:7], a[104:107], 0
    global_load_lds_dwordx4 v38, s[14:15] offset:2048
    v_mfma_f32_16x16x32_bf16 v[204:207], a[28:31], a[108:111], v[204:207]
    v_mfma_f32_16x16x32_bf16 v[72:75], a[8:11], a[104:107], 0
    v_mfma_f32_16x16x32_bf16 v[72:75], a[32:35], a[108:111], v[72:75]
    v_mfma_f32_16x16x32_bf16 v[76:79], a[12:15], a[104:107], 0
    v_mfma_f32_16x16x32_bf16 v[76:79], a[36:39], a[108:111], v[76:79]
    v_mfma_f32_16x16x32_bf16 v[132:135], a[104:107], a[16:19], 0
    s_add_u32 m0, s46, 65536
    v_mfma_f32_16x16x32_bf16 v[132:135], a[108:111], a[40:43], v[132:135]
    global_load_lds_dwordx4 v28, s[12:13] offset:0
    v_mfma_f32_16x16x32_bf16 v[140:143], a[104:107], a[20:23], 0
    v_mfma_f32_16x16x32_bf16 v[140:143], a[108:111], a[44:47], v[140:143]
    s_waitcnt lgkmcnt(2)
    v_mfma_f32_16x16x32_bf16 v[208:211], a[0:3], a[112:115], 0
    ds_read_b128 a[96:99], v48 offset:8192
    v_mfma_f32_16x16x32_bf16 v[208:211], a[24:27], a[116:119], v[208:211]
    ds_read_b128 a[100:103], v49 offset:8192
    v_mfma_f32_16x16x32_bf16 v[212:215], a[4:7], a[112:115], 0
    v_mfma_f32_16x16x32_bf16 v[212:215], a[28:31], a[116:119], v[212:215]
    global_load_lds_dwordx4 v29, s[12:13] offset:1024
    v_mfma_f32_16x16x32_bf16 v[80:83], a[8:11], a[112:115], 0
    v_mfma_f32_16x16x32_bf16 v[80:83], a[32:35], a[116:119], v[80:83]
    v_mfma_f32_16x16x32_bf16 v[84:87], a[12:15], a[112:115], 0
    v_mfma_f32_16x16x32_bf16 v[84:87], a[36:39], a[116:119], v[84:87]
    v_mfma_f32_16x16x32_bf16 v[144:147], a[112:115], a[16:19], 0
    v_mfma_f32_16x16x32_bf16 v[144:147], a[116:119], a[40:43], v[144:147]
    v_mfma_f32_16x16x32_bf16 v[152:155], a[112:115], a[20:23], 0
    global_load_lds_dwordx4 v30, s[12:13] offset:2048
    v_mfma_f32_16x16x32_bf16 v[152:155], a[116:119], a[44:47], v[152:155]
    s_waitcnt lgkmcnt(2)
    v_mfma_f32_16x16x32_bf16 v[216:219], a[0:3], a[120:123], 0
    ds_read_b128 a[104:107], v48 offset:10240
    v_mfma_f32_16x16x32_bf16 v[216:219], a[24:27], a[124:127], v[216:219]
    ds_read_b128 a[108:111], v49 offset:10240
    v_mfma_f32_16x16x32_bf16 v[220:223], a[4:7], a[120:123], 0
    v_mfma_f32_16x16x32_bf16 v[220:223], a[28:31], a[124:127], v[220:223]
    v_mfma_f32_16x16x32_bf16 v[88:91], a[8:11], a[120:123], 0
    global_load_lds_dwordx4 v31, s[12:13] offset:3072
    v_mfma_f32_16x16x32_bf16 v[88:91], a[32:35], a[124:127], v[88:91]
    v_mfma_f32_16x16x32_bf16 v[92:95], a[12:15], a[120:123], 0
    v_mfma_f32_16x16x32_bf16 v[92:95], a[36:39], a[124:127], v[92:95]
    v_mfma_f32_16x16x32_bf16 v[148:151], a[120:123], a[16:19], 0
    v_mfma_f32_16x16x32_bf16 v[148:151], a[124:127], a[40:43], v[148:151]
    v_mfma_f32_16x16x32_bf16 v[156:159], a[120:123], a[20:23], 0
    s_add_u32 m0, s30, 0
    v_mfma_f32_16x16x32_bf16 v[156:159], a[124:127], a[44:47], v[156:159]
    s_waitcnt lgkmcnt(2)
    global_load_lds_dwordx4 v39, s[14:15] offset:0
    v_mfma_f32_16x16x32_bf16 v[224:227], a[0:3], a[96:99], 0
    ds_read_b128 a[112:115], v48 offset:12288
    v_mfma_f32_16x16x32_bf16 v[224:227], a[24:27], a[100:103], v[224:227]
    ds_read_b128 a[116:119], v49 offset:12288
    v_mfma_f32_16x16x32_bf16 v[228:231], a[4:7], a[96:99], 0
    v_mfma_f32_16x16x32_bf16 v[228:231], a[28:31], a[100:103], v[228:231]
    v_mfma_f32_16x16x32_bf16 v[96:99], a[8:11], a[96:99], 0
    v_mfma_f32_16x16x32_bf16 v[96:99], a[32:35], a[100:103], v[96:99]
    global_load_lds_dwordx4 v40, s[14:15] offset:1024
    v_mfma_f32_16x16x32_bf16 v[100:103], a[12:15], a[96:99], 0
    v_mfma_f32_16x16x32_bf16 v[100:103], a[36:39], a[100:103], v[100:103]
    v_mfma_f32_16x16x32_bf16 v[160:163], a[96:99], a[16:19], 0
    v_mfma_f32_16x16x32_bf16 v[160:163], a[100:103], a[40:43], v[160:163]
    v_mfma_f32_16x16x32_bf16 v[168:171], a[96:99], a[20:23], 0
    v_mfma_f32_16x16x32_bf16 v[168:171], a[100:103], a[44:47], v[168:171]
    s_waitcnt lgkmcnt(2)
    global_load_lds_dwordx4 v41, s[14:15] offset:2048
    v_mfma_f32_16x16x32_bf16 v[232:235], a[0:3], a[104:107], 0
    ds_read_b128 a[120:123], v48 offset:14336
    v_mfma_f32_16x16x32_bf16 v[232:235], a[24:27], a[108:111], v[232:235]
    ds_read_b128 a[124:127], v49 offset:14336
    v_mfma_f32_16x16x32_bf16 v[236:239], a[4:7], a[104:107], 0
    v_mfma_f32_16x16x32_bf16 v[236:239], a[28:31], a[108:111], v[236:239]
    v_mfma_f32_16x16x32_bf16 v[104:107], a[8:11], a[104:107], 0
    v_mfma_f32_16x16x32_bf16 v[104:107], a[32:35], a[108:111], v[104:107]
    s_add_u32 m0, s47, 65536
    s_waitcnt vmcnt(10)
    s_barrier
    v_mfma_f32_16x16x32_bf16 v[108:111], a[12:15], a[104:107], 0
    ds_read_b64_tr_b16 a[48:49], v42 offset:24576
    global_load_lds_dwordx4 v32, s[12:13] offset:0
    v_mfma_f32_16x16x32_bf16 v[108:111], a[36:39], a[108:111], v[108:111]
    ds_read_b64_tr_b16 a[50:51], v42 offset:25088
    v_mfma_f32_16x16x32_bf16 v[164:167], a[104:107], a[16:19], 0
    ds_read_b64_tr_b16 a[72:73], v42 offset:36864
    v_mfma_f32_16x16x32_bf16 v[164:167], a[108:111], a[40:43], v[164:167]
    ds_read_b64_tr_b16 a[74:75], v42 offset:37376
    v_mfma_f32_16x16x32_bf16 v[172:175], a[104:107], a[20:23], 0
    ds_read_b64_tr_b16 a[52:53], v43 offset:24576
    v_mfma_f32_16x16x32_bf16 v[172:175], a[108:111], a[44:47], v[172:175]
    s_waitcnt lgkmcnt(7)
    ds_read_b64_tr_b16 a[54:55], v43 offset:25088
    v_mfma_f32_16x16x32_bf16 v[240:243], a[0:3], a[112:115], 0
    ds_read_b128 a[96:99], v48 offset:32768
    global_load_lds_dwordx4 v33, s[12:13] offset:1024
    v_mfma_f32_16x16x32_bf16 v[240:243], a[24:27], a[116:119], v[240:243]
    ds_read_b128 a[100:103], v49 offset:32768
    v_mfma_f32_16x16x32_bf16 v[244:247], a[4:7], a[112:115], 0
    ds_read_b64_tr_b16 a[76:77], v43 offset:36864
    v_mfma_f32_16x16x32_bf16 v[244:247], a[28:31], a[116:119], v[244:247]
    ds_read_b64_tr_b16 a[78:79], v43 offset:37376
    v_mfma_f32_16x16x32_bf16 v[112:115], a[8:11], a[112:115], 0
    ds_read_b64_tr_b16 a[56:57], v42 offset:25600
    v_mfma_f32_16x16x32_bf16 v[112:115], a[32:35], a[116:119], v[112:115]
    ds_read_b64_tr_b16 a[58:59], v42 offset:26112
    v_mfma_f32_16x16x32_bf16 v[116:119], a[12:15], a[112:115], 0
    ds_read_b64_tr_b16 a[80:81], v42 offset:37888
    v_mfma_f32_16x16x32_bf16 v[116:119], a[36:39], a[116:119], v[116:119]
    ds_read_b64_tr_b16 a[82:83], v42 offset:38400
    global_load_lds_dwordx4 v34, s[12:13] offset:2048
    v_mfma_f32_16x16x32_bf16 v[176:179], a[112:115], a[16:19], 0
    ds_read_b64_tr_b16 a[60:61], v43 offset:25600
    v_mfma_f32_16x16x32_bf16 v[176:179], a[116:119], a[40:43], v[176:179]
    ds_read_b64_tr_b16 a[62:63], v43 offset:26112
    v_mfma_f32_16x16x32_bf16 v[184:187], a[112:115], a[20:23], 0
    ds_read_b64_tr_b16 a[84:85], v43 offset:37888
    v_mfma_f32_16x16x32_bf16 v[184:187], a[116:119], a[44:47], v[184:187]
    s_waitcnt lgkmcnt(14)
    ds_read_b64_tr_b16 a[86:87], v43 offset:38400
    v_mfma_f32_16x16x32_bf16 v[248:251], a[0:3], a[120:123], 0
    ds_read_b128 a[104:107], v48 offset:34816
    v_mfma_f32_16x16x32_bf16 v[248:251], a[24:27], a[124:127], v[248:251]
    ds_read_b128 a[108:111], v49 offset:34816
    global_load_lds_dwordx4 v35, s[12:13] offset:3072
    v_mfma_f32_16x16x32_bf16 v[252:255], a[4:7], a[120:123], 0
    ds_read_b64_tr_b16 a[64:65], v42 offset:26624
    v_mfma_f32_16x16x32_bf16 v[252:255], a[28:31], a[124:127], v[252:255]
    ds_read_b64_tr_b16 a[66:67], v42 offset:27136
    v_mfma_f32_16x16x32_bf16 v[120:123], a[8:11], a[120:123], 0
    ds_read_b64_tr_b16 a[88:89], v42 offset:38912
    v_mfma_f32_16x16x32_bf16 v[120:123], a[32:35], a[124:127], v[120:123]
    ds_read_b64_tr_b16 a[90:91], v42 offset:39424
    v_mfma_f32_16x16x32_bf16 v[124:127], a[12:15], a[120:123], 0
    ds_read_b64_tr_b16 a[68:69], v43 offset:26624
    v_mfma_f32_16x16x32_bf16 v[124:127], a[36:39], a[124:127], v[124:127]
    ds_read_b64_tr_b16 a[70:71], v43 offset:27136
    v_mfma_f32_16x16x32_bf16 v[180:183], a[120:123], a[16:19], 0
    ds_read_b64_tr_b16 a[92:93], v43 offset:38912
    v_mfma_f32_16x16x32_bf16 v[180:183], a[124:127], a[40:43], v[180:183]
    s_xor_b32 s28, s53, 384
    ds_read_b64_tr_b16 a[94:95], v43 offset:39424
    v_mfma_f32_16x16x32_bf16 v[188:191], a[120:123], a[20:23], 0
    s_mul_i32 s29, s28, 3072
    v_mfma_f32_16x16x32_bf16 v[188:191], a[124:127], a[44:47], v[188:191]
    s_add_u32 s14, s18, s29
    s_waitcnt lgkmcnt(0)
    s_barrier
    v_mfma_f32_16x16x32_bf16 v[192:195], a[48:51], a[96:99], v[192:195]
    s_addc_u32 s15, s19, 0
    ds_read_b128 a[112:115], v48 offset:36864
    v_mfma_f32_16x16x32_bf16 v[192:195], a[72:75], a[100:103], v[192:195]
    s_add_u32 m0, s31, 24576
    ds_read_b128 a[116:119], v49 offset:36864
    v_mfma_f32_16x16x32_bf16 v[196:199], a[52:55], a[96:99], v[196:199]
    global_load_lds_dwordx4 v36, s[14:15] offset:0
    v_mfma_f32_16x16x32_bf16 v[196:199], a[76:79], a[100:103], v[196:199]
    v_mfma_f32_16x16x32_bf16 v[64:67], a[56:59], a[96:99], v[64:67]
    s_mov_b64 s[8:9], s[6:7]
    s_mov_b32 s20, s8
    v_mfma_f32_16x16x32_bf16 v[64:67], a[80:83], a[100:103], v[64:67]
    s_mov_b32 s21, s9
    s_mov_b32 s22, 0x3000000
    v_mfma_f32_16x16x32_bf16 v[68:71], a[60:63], a[96:99], v[68:71]
    s_add_u32 s12, s16, s28
    v_mfma_f32_16x16x32_bf16 v[68:71], a[84:87], a[100:103], v[68:71]
    s_addc_u32 s13, s17, 0
    s_mov_b32 s23, 0x00020000
    s_mov_b32 s6, 256
    v_mfma_f32_16x16x32_bf16 v[128:131], a[96:99], a[64:67], v[128:131]
    global_load_lds_dwordx4 v37, s[14:15] offset:1024
    s_mov_b32 s7, 0x00020000
    v_mfma_f32_16x16x32_bf16 v[128:131], a[100:103], a[88:91], v[128:131]
    s_lshl_b32 s33, s62, 7
    s_lshl_b32 s34, s26, 3
    v_mfma_f32_16x16x32_bf16 v[136:139], a[96:99], a[68:71], v[136:139]
    s_add_u32 s33, s33, s34
    s_add_u32 s33, s33, s27
    v_mfma_f32_16x16x32_bf16 v[136:139], a[100:103], a[92:95], v[136:139]
    s_lshl_b32 s33, s33, 2
    s_add_u32 s33, s33, s24
    v_mfma_f32_16x16x32_bf16 v[200:203], a[48:51], a[104:107], v[200:203]
    ds_read_b128 a[120:123], v48 offset:38912
    s_lshl_b32 s33, s33, 10
    v_mfma_f32_16x16x32_bf16 v[200:203], a[72:75], a[108:111], v[200:203]
    ds_read_b128 a[124:127], v49 offset:38912
    s_add_u32 s54, s33, 0x2000000
    v_mfma_f32_16x16x32_bf16 v[204:207], a[52:55], a[104:107], v[204:207]
    global_load_lds_dwordx4 v38, s[14:15] offset:2048
    v_mov_b64 v[56:57], 0
    v_mfma_f32_16x16x32_bf16 v[204:207], a[76:79], a[108:111], v[204:207]
    v_mov_b64 v[58:59], 0
    v_mfma_f32_16x16x32_bf16 v[72:75], a[56:59], a[104:107], v[72:75]
    buffer_store_dwordx4 v[56:59], v1, s[20:23], s54 offen sc1
    v_lshl_add_u32 v20, v8, 2, v12
    v_mfma_f32_16x16x32_bf16 v[72:75], a[80:83], a[108:111], v[72:75]
    v_lshl_add_u32 v20, v7, 4, v20
    v_lshlrev_b32 v20, 7, v20
    v_mfma_f32_16x16x32_bf16 v[76:79], a[60:63], a[104:107], v[76:79]
    v_lshl_add_u32 v23, v7, 1, v13
    v_lshl_add_u32 v20, v23, 5, v20
    v_mfma_f32_16x16x32_bf16 v[76:79], a[84:87], a[108:111], v[76:79]
    v_lshl_add_u32 v47, v14, 3, v20
    v_lshlrev_b32 v20, 10, v7
    v_mfma_f32_16x16x32_bf16 v[132:135], a[104:107], a[64:67], v[132:135]
    s_add_u32 m0, s46, 0
    v_lshl_add_u32 v20, v8, 9, v20
    v_lshl_add_u32 v3, v17, 4, v20
    v_mfma_f32_16x16x32_bf16 v[132:135], a[108:111], a[88:91], v[132:135]
    global_load_lds_dwordx4 v28, s[12:13] offset:0
    v_and_b32 v20, 0x2b, v2
    v_mfma_f32_16x16x32_bf16 v[140:143], a[104:107], a[68:71], v[140:143]
    v_and_b32 v23, 1, v12
    v_lshl_or_b32 v20, v23, 4, v20
    v_mfma_f32_16x16x32_bf16 v[140:143], a[108:111], a[92:95], v[140:143]
    s_waitcnt lgkmcnt(2)
    v_lshl_or_b32 v20, v7, 2, v20
    v_lshlrev_b32 v52, 4, v20
    v_mfma_f32_16x16x32_bf16 v[208:211], a[48:51], a[112:115], v[208:211]
    ds_read_b128 a[96:99], v48 offset:40960
    s_lshl_b32 s38, s36, 15
    v_mfma_f32_16x16x32_bf16 v[208:211], a[72:75], a[116:119], v[208:211]
    ds_read_b128 a[100:103], v49 offset:40960
    s_lshl_b32 s39, s37, 12
    v_mfma_f32_16x16x32_bf16 v[212:215], a[52:55], a[112:115], v[212:215]
    s_add_u32 s33, s38, s39
    s_add_u32 s33, s33, 98304
    v_mfma_f32_16x16x32_bf16 v[212:215], a[76:79], a[116:119], v[212:215]
    global_load_lds_dwordx4 v29, s[12:13] offset:1024
    v_add_u32 v53, s33, v3
    v_mfma_f32_16x16x32_bf16 v[80:83], a[56:59], a[112:115], v[80:83]
    s_lshl_b32 s33, s37, 14
    s_lshl_b32 s34, s36, 13
    v_mfma_f32_16x16x32_bf16 v[80:83], a[80:83], a[116:119], v[80:83]
    s_add_u32 s34, s34, s33
    s_add_u32 s34, s34, 32768
    v_mfma_f32_16x16x32_bf16 v[84:87], a[60:63], a[112:115], v[84:87]
    v_add_u32 v54, s34, v3
    s_lshl_b32 s10, s36, 1
    v_mfma_f32_16x16x32_bf16 v[84:87], a[84:87], a[116:119], v[84:87]
    s_lshl_b32 s11, s36, 2
    s_add_u32 s25, s10, 4
    v_mfma_f32_16x16x32_bf16 v[144:147], a[112:115], a[64:67], v[144:147]
    s_cmp_eq_u32 s62, 0
    s_cselect_b32 s56, s36, s11
    s_cselect_b32 s57, s25, s10
    v_mfma_f32_16x16x32_bf16 v[144:147], a[116:119], a[88:91], v[144:147]
    s_lshl_b32 s34, s56, 13
    s_add_u32 s34, s34, s39
    v_mfma_f32_16x16x32_bf16 v[152:155], a[112:115], a[68:71], v[152:155]
    global_load_lds_dwordx4 v30, s[12:13] offset:2048
    s_add_u32 s34, s34, 98304
    v_mfma_f32_16x16x32_bf16 v[152:155], a[116:119], a[92:95], v[152:155]
    s_waitcnt lgkmcnt(2)
    v_add_u32 v60, s34, v1
    s_lshl_b32 s34, s25, 13
    v_mfma_f32_16x16x32_bf16 v[216:219], a[48:51], a[120:123], v[216:219]
    ds_read_b128 a[104:107], v48 offset:43008
    s_add_u32 s34, s34, s39
    v_mfma_f32_16x16x32_bf16 v[216:219], a[72:75], a[124:127], v[216:219]
    ds_read_b128 a[108:111], v49 offset:43008
    s_add_u32 s34, s34, 98304
    v_mfma_f32_16x16x32_bf16 v[220:223], a[52:55], a[120:123], v[220:223]
    s_sub_u32 s10, s34, 65536
    s_sub_u32 s11, s34, 8192
    v_mfma_f32_16x16x32_bf16 v[220:223], a[76:79], a[124:127], v[220:223]
    s_add_u32 s25, s38, 98304
    v_mfma_f32_16x16x32_bf16 v[88:91], a[56:59], a[120:123], v[88:91]
    global_load_lds_dwordx4 v31, s[12:13] offset:3072
    v_mfma_f32_16x16x32_bf16 v[88:91], a[80:83], a[124:127], v[88:91]
    s_cmp_eq_u32 s62, 0
    s_cselect_b32 s10, s10, s25
    s_cselect_b32 s11, s11, s25
    v_mfma_f32_16x16x32_bf16 v[92:95], a[60:63], a[120:123], v[92:95]
    v_add_u32 v61, s10, v1
    v_add_u32 v55, s11, v1
    v_mfma_f32_16x16x32_bf16 v[92:95], a[84:87], a[124:127], v[92:95]
    s_lshl_b32 s34, s36, 12
    s_add_u32 s10, s33, s34
    v_mfma_f32_16x16x32_bf16 v[148:151], a[120:123], a[64:67], v[148:151]
    s_lshl_b32 s11, s24, 12
    s_add_u32 s11, s11, 16384
    v_mfma_f32_16x16x32_bf16 v[148:151], a[124:127], a[88:91], v[148:151]
    s_lshl_b32 s25, s37, 13
    s_add_u32 s25, s25, s34
    v_mfma_f32_16x16x32_bf16 v[156:159], a[120:123], a[68:71], v[156:159]
    s_add_u32 m0, s30, 24576
    s_add_u32 s34, s10, 8192
    v_mfma_f32_16x16x32_bf16 v[156:159], a[124:127], a[92:95], v[156:159]
    s_waitcnt lgkmcnt(2)
    global_load_lds_dwordx4 v39, s[14:15] offset:0
    v_mfma_f32_16x16x32_bf16 v[224:227], a[48:51], a[96:99], v[224:227]
    ds_read_b128 a[112:115], v48 offset:45056
    v_mfma_f32_16x16x32_bf16 v[224:227], a[72:75], a[100:103], v[224:227]
    ds_read_b128 a[116:119], v49 offset:45056
    v_mfma_f32_16x16x32_bf16 v[228:231], a[52:55], a[96:99], v[228:231]
    s_cmp_eq_u32 s62, 0
    s_cselect_b32 s10, s10, s11
    s_cselect_b32 s11, s34, s25
    v_mfma_f32_16x16x32_bf16 v[228:231], a[76:79], a[100:103], v[228:231]
    s_add_u32 s10, s10, 32768
    s_add_u32 s11, s11, 32768
    v_mfma_f32_16x16x32_bf16 v[96:99], a[56:59], a[96:99], v[96:99]
    v_add_u32 v16, s10, v1
    v_add_u32 v63, s11, v1
    v_mfma_f32_16x16x32_bf16 v[96:99], a[80:83], a[100:103], v[96:99]
    global_load_lds_dwordx4 v40, s[14:15] offset:1024
    s_lshl_b32 s33, s26, 1
    v_mfma_f32_16x16x32_bf16 v[100:103], a[60:63], a[96:99], v[100:103]
    s_add_u32 s51, s33, s37
    s_lshl_b32 s33, s27, 3
    v_mfma_f32_16x16x32_bf16 v[100:103], a[84:87], a[100:103], v[100:103]
    s_add_u32 s50, s33, s57
    s_lshr_b32 s25, s25, 11
    v_mfma_f32_16x16x32_bf16 v[160:163], a[96:99], a[64:67], v[160:163]
    s_add_u32 s63, s33, s25
    s_add_u32 s33, s33, s56
    v_mfma_f32_16x16x32_bf16 v[160:163], a[100:103], a[88:91], v[160:163]
    s_lshl_b32 s33, s33, 12
    s_lshl_b32 s34, s51, 18
    v_mfma_f32_16x16x32_bf16 v[168:171], a[96:99], a[68:71], v[168:171]
    s_add_u32 s33, s33, s34
    s_lshl_b32 s10, s62, 23
    v_mfma_f32_16x16x32_bf16 v[168:171], a[100:103], a[92:95], v[168:171]
    s_waitcnt lgkmcnt(2)
    global_load_lds_dwordx4 v41, s[14:15] offset:2048
    s_add_u32 s48, s33, s10
    v_mfma_f32_16x16x32_bf16 v[232:235], a[48:51], a[104:107], v[232:235]
    ds_read_b128 a[120:123], v48 offset:47104
    s_add_u32 s34, s34, 4096
    v_mfma_f32_16x16x32_bf16 v[232:235], a[72:75], a[108:111], v[232:235]
    ds_read_b128 a[124:127], v49 offset:47104
    v_mfma_f32_16x16x32_bf16 v[236:239], a[52:55], a[104:107], v[236:239]
    s_add_u32 s58, s8, s34
    s_addc_u32 s59, s9, 0
    v_mfma_f32_16x16x32_bf16 v[236:239], a[76:79], a[108:111], v[236:239]
    s_lshl_b32 s33, s50, 12
    s_sub_u32 s3, s33, 32768
    v_mfma_f32_16x16x32_bf16 v[104:107], a[56:59], a[104:107], v[104:107]
    s_sub_i32 s52, 8, s50
    s_max_i32 s52, s52, 0
    v_mfma_f32_16x16x32_bf16 v[104:107], a[80:83], a[108:111], v[104:107]
    s_add_u32 m0, s47, 0
    s_lshl_b32 s33, s50, 16
    s_lshl_b32 s34, s51, 11
    s_waitcnt vmcnt(11)
    s_barrier
    v_mfma_f32_16x16x32_bf16 v[108:111], a[60:63], a[104:107], v[108:111]
    ds_read_b64_tr_b16 a[0:1], v42 offset:0
    global_load_lds_dwordx4 v32, s[12:13] offset:0
    v_mfma_f32_16x16x32_bf16 v[108:111], a[84:87], a[108:111], v[108:111]
    ds_read_b64_tr_b16 a[2:3], v42 offset:512
    s_add_u32 s33, s33, s34
    v_mfma_f32_16x16x32_bf16 v[164:167], a[104:107], a[64:67], v[164:167]
    ds_read_b64_tr_b16 a[24:25], v42 offset:12288
    s_add_u32 s55, s33, 0x1800000
    v_mfma_f32_16x16x32_bf16 v[164:167], a[108:111], a[88:91], v[164:167]
    ds_read_b64_tr_b16 a[26:27], v42 offset:12800
    s_sub_u32 s33, s54, 0x2000000
    v_mfma_f32_16x16x32_bf16 v[172:175], a[104:107], a[68:71], v[172:175]
    ds_read_b64_tr_b16 a[4:5], v43 offset:0
    s_lshl_b32 s33, s33, 2
    v_mfma_f32_16x16x32_bf16 v[172:175], a[108:111], a[92:95], v[172:175]
    s_waitcnt lgkmcnt(7)
    ds_read_b64_tr_b16 a[6:7], v43 offset:512
    s_add_u32 s49, s33, 0x1000000
    v_mfma_f32_16x16x32_bf16 v[240:243], a[48:51], a[112:115], v[240:243]
    ds_read_b128 a[96:99], v50 offset:0
    global_load_lds_dwordx4 v33, s[12:13] offset:1024
    v_mfma_f32_16x16x32_bf16 v[240:243], a[72:75], a[116:119], v[240:243]
    ds_read_b128 a[100:103], v51 offset:0
    s_lshl_b32 s38, s62, 3
    v_mfma_f32_16x16x32_bf16 v[244:247], a[52:55], a[112:115], v[244:247]
    ds_read_b64_tr_b16 a[28:29], v43 offset:12288
    s_add_u32 s38, s38, s27
    v_mfma_f32_16x16x32_bf16 v[244:247], a[76:79], a[116:119], v[244:247]
    ds_read_b64_tr_b16 a[30:31], v43 offset:12800
    s_lshl_b32 s38, s38, 7
    v_mfma_f32_16x16x32_bf16 v[112:115], a[56:59], a[112:115], v[112:115]
    ds_read_b64_tr_b16 a[8:9], v42 offset:1024
    s_lshl_b32 s33, s26, 2
    v_mfma_f32_16x16x32_bf16 v[112:115], a[80:83], a[116:119], v[112:115]
    ds_read_b64_tr_b16 a[10:11], v42 offset:1536
    s_add_u32 s33, s33, s24
    v_mfma_f32_16x16x32_bf16 v[116:119], a[60:63], a[112:115], v[116:119]
    ds_read_b64_tr_b16 a[32:33], v42 offset:13312
    s_lshl_b32 s34, s33, 16
    v_mfma_f32_16x16x32_bf16 v[116:119], a[84:87], a[116:119], v[116:119]
    ds_read_b64_tr_b16 a[34:35], v42 offset:13824
    global_load_lds_dwordx4 v34, s[12:13] offset:2048
    v_mfma_f32_16x16x32_bf16 v[176:179], a[112:115], a[64:67], v[176:179]
    ds_read_b64_tr_b16 a[12:13], v43 offset:1024
    s_add_u32 s34, s34, 0x1801000
    v_mfma_f32_16x16x32_bf16 v[176:179], a[116:119], a[88:91], v[176:179]
    ds_read_b64_tr_b16 a[14:15], v43 offset:1536
    v_mfma_f32_16x16x32_bf16 v[184:187], a[112:115], a[68:71], v[184:187]
    ds_read_b64_tr_b16 a[36:37], v43 offset:13312
    v_mfma_f32_16x16x32_bf16 v[184:187], a[116:119], a[92:95], v[184:187]
    s_waitcnt lgkmcnt(14)
    ds_read_b64_tr_b16 a[38:39], v43 offset:13824
    v_mfma_f32_16x16x32_bf16 v[248:251], a[48:51], a[120:123], v[248:251]
    ds_read_b128 a[104:107], v50 offset:2048
    v_mfma_f32_16x16x32_bf16 v[248:251], a[72:75], a[124:127], v[248:251]
    ds_read_b128 a[108:111], v51 offset:2048
    global_load_lds_dwordx4 v35, s[12:13] offset:3072
    v_mfma_f32_16x16x32_bf16 v[252:255], a[52:55], a[120:123], v[252:255]
    ds_read_b64_tr_b16 a[16:17], v42 offset:2048
    v_mfma_f32_16x16x32_bf16 v[252:255], a[76:79], a[124:127], v[252:255]
    ds_read_b64_tr_b16 a[18:19], v42 offset:2560
    v_mfma_f32_16x16x32_bf16 v[120:123], a[56:59], a[120:123], v[120:123]
    ds_read_b64_tr_b16 a[40:41], v42 offset:14336
    v_mfma_f32_16x16x32_bf16 v[120:123], a[80:83], a[124:127], v[120:123]
    ds_read_b64_tr_b16 a[42:43], v42 offset:14848
    v_mfma_f32_16x16x32_bf16 v[124:127], a[60:63], a[120:123], v[124:127]
    ds_read_b64_tr_b16 a[20:21], v43 offset:2048
    v_mfma_f32_16x16x32_bf16 v[124:127], a[84:87], a[124:127], v[124:127]
    ds_read_b64_tr_b16 a[22:23], v43 offset:2560
    v_mfma_f32_16x16x32_bf16 v[180:183], a[120:123], a[64:67], v[180:183]
    ds_read_b64_tr_b16 a[44:45], v43 offset:14336
    v_mfma_f32_16x16x32_bf16 v[180:183], a[124:127], a[88:91], v[180:183]
    s_xor_b32 s28, s53, 512
    ds_read_b64_tr_b16 a[46:47], v43 offset:14848
    v_mfma_f32_16x16x32_bf16 v[188:191], a[120:123], a[68:71], v[188:191]
    s_mul_i32 s29, s28, 3072
    s_add_u32 s60, s8, s34
    s_addc_u32 s61, s9, 0
    v_mfma_f32_16x16x32_bf16 v[188:191], a[124:127], a[92:95], v[188:191]
    s_add_u32 s14, s18, s29
    s_waitcnt lgkmcnt(0)
    s_barrier
    v_mfma_f32_16x16x32_bf16 v[192:195], a[0:3], a[96:99], v[192:195]
    s_addc_u32 s15, s19, 0
    ds_read_b128 a[112:115], v50 offset:4096
    s_lshl_b32 s33, s33, 17
    v_mfma_f32_16x16x32_bf16 v[192:195], a[24:27], a[100:103], v[192:195]
    s_add_u32 m0, s31, 0
    ds_read_b128 a[116:119], v51 offset:4096
    s_add_u32 s35, s33, s38
    v_mfma_f32_16x16x32_bf16 v[196:199], a[4:7], a[96:99], v[196:199]
    global_load_lds_dwordx4 v36, s[14:15] offset:0
    s_lshl_b32 s33, s24, 3
    v_mfma_f32_16x16x32_bf16 v[196:199], a[28:31], a[100:103], v[196:199]
    v_add_u32 v20, s33, v6
    v_lshlrev_b32 v20, 11, v20
    v_mfma_f32_16x16x32_bf16 v[64:67], a[8:11], a[96:99], v[64:67]
    s_and_b32 s39, s24, 2
    v_or_b32 v23, s39, v7
    v_mfma_f32_16x16x32_bf16 v[64:67], a[32:35], a[100:103], v[64:67]
    v_lshlrev_b32 v23, 1, v23
    v_xor_b32 v23, v23, v22
    v_mfma_f32_16x16x32_bf16 v[68:71], a[12:15], a[96:99], v[68:71]
    s_add_u32 s12, s16, s28
    v_mfma_f32_16x16x32_bf16 v[68:71], a[36:39], a[100:103], v[68:71]
    s_addc_u32 s13, s17, 0
    v_lshl_add_u32 v20, v23, 4, v20
    v_add_u32 v9, s38, v20
    v_mfma_f32_16x16x32_bf16 v[128:131], a[96:99], a[16:19], v[128:131]
    global_load_lds_dwordx4 v37, s[14:15] offset:1024
    s_lshl_b32 s33, s26, 15
    v_mfma_f32_16x16x32_bf16 v[128:131], a[100:103], a[40:43], v[128:131]
    s_add_u32 s34, s33, 0x2080000
    s_add_u32 s10, s39, 1
    v_mfma_f32_16x16x32_bf16 v[136:139], a[96:99], a[20:23], v[136:139]
    s_sub_u32 s10, s10, s62
    s_lshl_b32 s10, s10, 10
    v_mfma_f32_16x16x32_bf16 v[136:139], a[100:103], a[44:47], v[136:139]
    s_add_u32 s10, s10, s34
    v_lshl_add_u32 v20, v22, 12, s10
    v_mfma_f32_16x16x32_bf16 v[200:203], a[0:3], a[104:107], v[200:203]
    ds_read_b128 a[120:123], v50 offset:6144
    s_lshl_b32 s10, s27, 12
    v_mfma_f32_16x16x32_bf16 v[200:203], a[24:27], a[108:111], v[200:203]
    ds_read_b128 a[124:127], v51 offset:6144
    s_lshl_b32 s11, s37, 11
    v_mfma_f32_16x16x32_bf16 v[204:207], a[4:7], a[104:107], v[204:207]
    global_load_lds_dwordx4 v38, s[14:15] offset:2048
    s_add_u32 s10, s10, s11
    v_mfma_f32_16x16x32_bf16 v[204:207], a[28:31], a[108:111], v[204:207]
    s_add_u32 s10, s10, s34
    s_add_u32 s10, s10, 1024
    v_mfma_f32_16x16x32_bf16 v[72:75], a[8:11], a[104:107], v[72:75]
    v_mov_b32 v23, s10
    v_mfma_f32_16x16x32_bf16 v[72:75], a[32:35], a[108:111], v[72:75]
    s_cmp_eq_u32 s62, 0
    s_cselect_b32 s10, 0xff00, 0
    v_mfma_f32_16x16x32_bf16 v[76:79], a[12:15], a[104:107], v[76:79]
    s_mov_b32 s11, 0
    v_cndmask_b32 v19, v20, v23, s[10:11]
    v_mfma_f32_16x16x32_bf16 v[76:79], a[36:39], a[108:111], v[76:79]
    s_sub_i32 s34, s27, 1
    s_max_i32 s34, s34, 0
    v_mfma_f32_16x16x32_bf16 v[132:135], a[104:107], a[16:19], v[132:135]
    s_add_u32 m0, s46, 32768
    s_lshl_b32 s34, s34, 12
    s_add_u32 s33, s33, s34
    v_mfma_f32_16x16x32_bf16 v[132:135], a[108:111], a[40:43], v[132:135]
    global_load_lds_dwordx4 v28, s[12:13] offset:0
    s_add_u32 s33, s33, 0x2000000
    v_mfma_f32_16x16x32_bf16 v[140:143], a[104:107], a[20:23], v[140:143]
    s_min_u32 s34, s27, 1
    s_lshl_b32 s34, s34, 2
    v_mfma_f32_16x16x32_bf16 v[140:143], a[108:111], a[44:47], v[140:143]
    s_waitcnt lgkmcnt(2)
    s_or_b32 s34, s34, 3
    v_and_b32 v23, s34, v2
    v_mfma_f32_16x16x32_bf16 v[208:211], a[0:3], a[112:115], v[208:211]
    ds_read_b128 a[96:99], v50 offset:8192
    v_lshl_add_u32 v18, v23, 10, s33
    v_mfma_f32_16x16x32_bf16 v[208:211], a[24:27], a[116:119], v[208:211]
hook1:
    s_cbranch_execz hook5
    ds_read_b128 a[100:103], v51 offset:8192
    v_bfe_u32 v20, v2, 1, 4
    v_mfma_f32_16x16x32_bf16 v[212:215], a[4:7], a[112:115], v[212:215]
    v_lshlrev_b32 v20, 15, v20
    v_and_b32 v23, 1, v2
    v_mfma_f32_16x16x32_bf16 v[212:215], a[28:31], a[116:119], v[212:215]
    global_load_lds_dwordx4 v29, s[12:13] offset:1024
    s_lshr_b32 s33, s26, 1
    v_mfma_f32_16x16x32_bf16 v[80:83], a[8:11], a[112:115], v[80:83]
    s_lshl_b32 s33, s33, 12
    s_lshl_b32 s34, s39, 10
    v_mfma_f32_16x16x32_bf16 v[80:83], a[32:35], a[116:119], v[80:83]
    s_add_u32 s33, s33, s34
    s_add_u32 s33, s33, 0x2000000
    v_mfma_f32_16x16x32_bf16 v[84:87], a[12:15], a[112:115], v[84:87]
    s_and_b32 s34, s26, 1
    s_xor_b32 s10, s34, 1
    v_mfma_f32_16x16x32_bf16 v[84:87], a[36:39], a[116:119], v[84:87]
    s_lshl_b32 s10, s10, 19
    s_add_u32 s10, s10, s33
    v_mfma_f32_16x16x32_bf16 v[144:147], a[112:115], a[16:19], v[144:147]
    s_lshl_b32 s34, s34, 10
    s_add_u32 s11, s34, s33
    v_mfma_f32_16x16x32_bf16 v[144:147], a[116:119], a[40:43], v[144:147]
    v_lshl_add_u32 v12, v23, 10, v20
    v_add_u32 v46, s10, v12
    v_mfma_f32_16x16x32_bf16 v[152:155], a[112:115], a[20:23], v[152:155]
    global_load_lds_dwordx4 v30, s[12:13] offset:2048
    v_lshl_add_u32 v12, v23, 19, v20
    v_mfma_f32_16x16x32_bf16 v[152:155], a[116:119], a[44:47], v[152:155]
    s_waitcnt lgkmcnt(2)
    v_add_u32 v62, s11, v12
    v_min_u32 v20, 1, v0
    v_mfma_f32_16x16x32_bf16 v[216:219], a[0:3], a[120:123], v[216:219]
    ds_read_b128 a[104:107], v50 offset:10240
    s_and_b32 s33, s2, 7
    v_mfma_f32_16x16x32_bf16 v[216:219], a[24:27], a[124:127], v[216:219]
    ds_read_b128 a[108:111], v51 offset:10240
    s_lshl_b32 s33, s33, 5
    v_mfma_f32_16x16x32_bf16 v[220:223], a[4:7], a[120:123], v[220:223]
    v_lshl_add_u32 v14, v20, 30, s33
    v_min_u32 v20, 1, v2
    v_mfma_f32_16x16x32_bf16 v[220:223], a[28:31], a[124:127], v[220:223]
    v_lshlrev_b32 v25, 30, v20
    v_lshlrev_b32 v4, 5, v22
    v_mfma_f32_16x16x32_bf16 v[88:91], a[8:11], a[120:123], v[88:91]
    global_load_lds_dwordx4 v31, s[12:13] offset:3072
    v_mov_b32 v15, 1
    v_mfma_f32_16x16x32_bf16 v[88:91], a[32:35], a[124:127], v[88:91]
    s_lshl_b32 s33, s24, 9
    v_lshl_add_u32 v58, v2, 3, s33
    v_mfma_f32_16x16x32_bf16 v[92:95], a[12:15], a[120:123], v[92:95]
    v_xor_b32 v59, 0x400, v58
    s_lshl_b32 s33, s24, 13
    v_mfma_f32_16x16x32_bf16 v[92:95], a[36:39], a[124:127], v[92:95]
    s_add_u32 s33, s33, 131072
    v_add_u32 v56, s33, v1
    v_mfma_f32_16x16x32_bf16 v[148:151], a[120:123], a[16:19], v[148:151]
    v_xor_b32 v57, 0x4000, v56
    s_lshl_b32 s34, s24, 12
    v_mfma_f32_16x16x32_bf16 v[148:151], a[124:127], a[40:43], v[148:151]
    s_add_u32 s33, s34, 102400
    v_xor_b32 v20, v8, v22
    v_mfma_f32_16x16x32_bf16 v[156:159], a[120:123], a[20:23], v[156:159]
    s_add_u32 m0, s30, 0
    v_lshl_add_u32 v20, v20, 4, s33
    v_lshl_add_u32 v20, v7, 3, v20
    v_mfma_f32_16x16x32_bf16 v[156:159], a[124:127], a[44:47], v[156:159]
    s_waitcnt lgkmcnt(2)
    global_load_lds_dwordx4 v39, s[14:15] offset:0
    v_lshl_add_u32 v10, v17, 7, v20
    v_mfma_f32_16x16x32_bf16 v[224:227], a[0:3], a[96:99], v[224:227]
    ds_read_b128 a[112:115], v50 offset:12288
    v_xor_b32 v20, v6, v22
    v_mfma_f32_16x16x32_bf16 v[224:227], a[24:27], a[100:103], v[224:227]
    ds_read_b128 a[116:119], v51 offset:12288
    v_lshl_add_u32 v20, v20, 4, s33
    v_mfma_f32_16x16x32_bf16 v[228:231], a[4:7], a[96:99], v[228:231]
    v_lshl_add_u32 v0, v6, 7, v20
    s_and_b32 s33, s2, 127
    v_mfma_f32_16x16x32_bf16 v[228:231], a[28:31], a[100:103], v[228:231]
    s_lshl_b32 s33, s33, 14
    s_add_u32 s33, s33, s34
    v_mfma_f32_16x16x32_bf16 v[96:99], a[8:11], a[96:99], v[96:99]
    s_bitcmp1_b32 s2, 7
    s_cselect_b64 s[100:101], s[44:45], s[42:43]
    v_mfma_f32_16x16x32_bf16 v[96:99], a[32:35], a[100:103], v[96:99]
    global_load_lds_dwordx4 v40, s[14:15] offset:1024
    v_mfma_f32_16x16x32_bf16 v[100:103], a[12:15], a[96:99], v[100:103]
    s_add_u32 s100, s100, s33
    s_addc_u32 s101, s101, 0
    v_mfma_f32_16x16x32_bf16 v[100:103], a[36:39], a[100:103], v[100:103]
    v_lshlrev_b32 v13, 6, v2
    v_bfe_u32 v17, v2, 2, 1
    v_mfma_f32_16x16x32_bf16 v[160:163], a[96:99], a[16:19], v[160:163]
    v_cmp_eq_u32 s[10:11], 0, v17
    v_mfma_f32_16x16x32_bf16 v[160:163], a[100:103], a[40:43], v[160:163]
    v_mov_b32 v6, 0x3f803f80
    v_mov_b32 v24, 0xdddddddd
    v_mfma_f32_16x16x32_bf16 v[168:171], a[96:99], a[20:23], v[168:171]
    v_cndmask_b32 v20, 0, v6, s[10:11]
    v_cndmask_b32 v21, 0, v6, s[10:11]
    v_mfma_f32_16x16x32_bf16 v[168:171], a[100:103], a[44:47], v[168:171]
    s_waitcnt lgkmcnt(2)
    global_load_lds_dwordx4 v41, s[14:15] offset:2048
    v_cndmask_b32 v22, v6, 0, s[10:11]
    v_mfma_f32_16x16x32_bf16 v[232:235], a[0:3], a[104:107], v[232:235]
    ds_read_b128 a[120:123], v50 offset:14336
    v_cndmask_b32 v23, v6, 0, s[10:11]
    v_mfma_f32_16x16x32_bf16 v[232:235], a[24:27], a[108:111], v[232:235]
    ds_read_b128 a[124:127], v51 offset:14336
    v_and_b32 v17, 31, v2
    v_mfma_f32_16x16x32_bf16 v[236:239], a[4:7], a[104:107], v[236:239]
    v_lshlrev_b32 v8, 4, v8
    v_sub_u32 v17, v17, v8
    v_mfma_f32_16x16x32_bf16 v[236:239], a[28:31], a[108:111], v[236:239]
    v_cmp_le_i32 s[64:65], 0, v17
    v_cmp_le_i32 s[66:67], 1, v17
    v_mfma_f32_16x16x32_bf16 v[104:107], a[8:11], a[104:107], v[104:107]
    v_cmp_le_i32 s[68:69], 2, v17
    v_cmp_le_i32 s[70:71], 3, v17
    v_mfma_f32_16x16x32_bf16 v[104:107], a[32:35], a[108:111], v[104:107]
    s_add_u32 m0, s47, 32768
    v_cmp_le_i32 s[72:73], 8, v17
    v_cmp_le_i32 s[74:75], 9, v17
    s_waitcnt vmcnt(10)
    s_barrier
    v_mfma_f32_16x16x32_bf16 v[108:111], a[12:15], a[104:107], v[108:111]
    ds_read_b64_tr_b16 a[48:49], v42 offset:24576
    global_load_lds_dwordx4 v32, s[12:13] offset:0
    v_mfma_f32_16x16x32_bf16 v[108:111], a[36:39], a[108:111], v[108:111]
    ds_read_b64_tr_b16 a[50:51], v42 offset:25088
    v_cmp_le_i32 s[76:77], 10, v17
    v_mfma_f32_16x16x32_bf16 v[164:167], a[104:107], a[16:19], v[164:167]
    ds_read_b64_tr_b16 a[72:73], v42 offset:36864
    v_cmp_le_i32 s[78:79], 11, v17
    v_mfma_f32_16x16x32_bf16 v[164:167], a[108:111], a[40:43], v[164:167]
    ds_read_b64_tr_b16 a[74:75], v42 offset:37376
    v_cmp_le_i32 s[80:81], 4, v17
    v_mfma_f32_16x16x32_bf16 v[172:175], a[104:107], a[20:23], v[172:175]
    ds_read_b64_tr_b16 a[52:53], v43 offset:24576
    v_cmp_le_i32 s[82:83], 5, v17
    v_mfma_f32_16x16x32_bf16 v[172:175], a[108:111], a[44:47], v[172:175]
    s_waitcnt lgkmcnt(7)
    ds_read_b64_tr_b16 a[54:55], v43 offset:25088
    v_cmp_le_i32 s[84:85], 6, v17
    v_mfma_f32_16x16x32_bf16 v[240:243], a[0:3], a[112:115], v[240:243]
    ds_read_b128 a[96:99], v48 offset:0
    global_load_lds_dwordx4 v33, s[12:13] offset:1024
    v_mfma_f32_16x16x32_bf16 v[240:243], a[24:27], a[116:119], v[240:243]
    ds_read_b128 a[100:103], v49 offset:0
    v_cmp_le_i32 s[86:87], 7, v17
    v_mfma_f32_16x16x32_bf16 v[244:247], a[4:7], a[112:115], v[244:247]
    ds_read_b64_tr_b16 a[76:77], v43 offset:36864
    v_cmp_le_i32 s[88:89], 12, v17
    v_mfma_f32_16x16x32_bf16 v[244:247], a[28:31], a[116:119], v[244:247]
    ds_read_b64_tr_b16 a[78:79], v43 offset:37376
    v_cmp_le_i32 s[90:91], 13, v17
    v_mfma_f32_16x16x32_bf16 v[112:115], a[8:11], a[112:115], v[112:115]
    ds_read_b64_tr_b16 a[56:57], v42 offset:25600
    v_cmp_le_i32 s[92:93], 14, v17
    v_mfma_f32_16x16x32_bf16 v[112:115], a[32:35], a[116:119], v[112:115]
    ds_read_b64_tr_b16 a[58:59], v42 offset:26112
    v_cmp_le_i32 s[94:95], 15, v17
    v_mfma_f32_16x16x32_bf16 v[116:119], a[12:15], a[112:115], v[116:119]
    ds_read_b64_tr_b16 a[80:81], v42 offset:37888
    v_mov_b32 v11, 0xf149f2ca
    v_mfma_f32_16x16x32_bf16 v[116:119], a[36:39], a[116:119], v[116:119]
    ds_read_b64_tr_b16 a[82:83], v42 offset:38400
    global_load_lds_dwordx4 v34, s[12:13] offset:2048
    v_mfma_f32_16x16x32_bf16 v[176:179], a[112:115], a[16:19], v[176:179]
    ds_read_b64_tr_b16 a[60:61], v43 offset:25600
    s_and_b32 s33, s26, 3
    v_mfma_f32_16x16x32_bf16 v[176:179], a[116:119], a[40:43], v[176:179]
    ds_read_b64_tr_b16 a[62:63], v43 offset:26112
    s_lshl_b32 s33, s33, 3
    v_mfma_f32_16x16x32_bf16 v[184:187], a[112:115], a[20:23], v[184:187]
    ds_read_b64_tr_b16 a[84:85], v43 offset:37888
    s_lshl_b32 s34, s27, 2
    v_mfma_f32_16x16x32_bf16 v[184:187], a[116:119], a[44:47], v[184:187]
    s_waitcnt lgkmcnt(14)
    ds_read_b64_tr_b16 a[86:87], v43 offset:38400
    s_xor_b32 s33, s33, s34
    v_mfma_f32_16x16x32_bf16 v[248:251], a[0:3], a[120:123], v[248:251]
    ds_read_b128 a[104:107], v48 offset:2048
    s_lshl_b32 s0, s33, 11
    v_mfma_f32_16x16x32_bf16 v[248:251], a[24:27], a[124:127], v[248:251]
    ds_read_b128 a[108:111], v49 offset:2048
    global_load_lds_dwordx4 v35, s[12:13] offset:3072
    v_mfma_f32_16x16x32_bf16 v[252:255], a[4:7], a[120:123], v[252:255]
    ds_read_b64_tr_b16 a[64:65], v42 offset:26624
    s_lshl_b32 s1, s33, 16
    v_mfma_f32_16x16x32_bf16 v[252:255], a[28:31], a[124:127], v[252:255]
    ds_read_b64_tr_b16 a[66:67], v42 offset:27136
    s_mov_b32 s32, 0x3e8293ee
    v_mfma_f32_16x16x32_bf16 v[120:123], a[8:11], a[120:123], v[120:123]
    ds_read_b64_tr_b16 a[88:89], v42 offset:38912
    v_mfma_f32_16x16x32_bf16 v[120:123], a[32:35], a[124:127], v[120:123]
    ds_read_b64_tr_b16 a[90:91], v42 offset:39424
    v_mfma_f32_16x16x32_bf16 v[124:127], a[12:15], a[120:123], v[124:127]
    ds_read_b64_tr_b16 a[68:69], v43 offset:26624
    v_mfma_f32_16x16x32_bf16 v[124:127], a[36:39], a[124:127], v[124:127]
    ds_read_b64_tr_b16 a[70:71], v43 offset:27136
    v_mfma_f32_16x16x32_bf16 v[180:183], a[120:123], a[16:19], v[180:183]
    ds_read_b64_tr_b16 a[92:93], v43 offset:38912
    v_mfma_f32_16x16x32_bf16 v[180:183], a[124:127], a[40:43], v[180:183]
    s_xor_b32 s28, s53, 640
    ds_read_b64_tr_b16 a[94:95], v43 offset:39424
    v_mfma_f32_16x16x32_bf16 v[188:191], a[120:123], a[20:23], v[188:191]
    s_mul_i32 s29, s28, 3072
    v_mfma_f32_16x16x32_bf16 v[188:191], a[124:127], a[44:47], v[188:191]
    s_add_u32 s14, s18, s29
    s_waitcnt lgkmcnt(0)
    s_barrier
    v_mfma_f32_16x16x32_bf16 v[192:195], a[48:51], a[96:99], v[192:195]
    s_addc_u32 s15, s19, 0
    ds_read_b128 a[112:115], v48 offset:4096
    v_mfma_f32_16x16x32_bf16 v[192:195], a[72:75], a[100:103], v[192:195]
    s_add_u32 m0, s31, 24576
    ds_read_b128 a[116:119], v49 offset:4096
    v_mfma_f32_16x16x32_bf16 v[196:199], a[52:55], a[96:99], v[196:199]
    global_load_lds_dwordx4 v36, s[14:15] offset:0
    v_mfma_f32_16x16x32_bf16 v[196:199], a[76:79], a[100:103], v[196:199]
    v_mfma_f32_16x16x32_bf16 v[64:67], a[56:59], a[96:99], v[64:67]
    v_mfma_f32_16x16x32_bf16 v[64:67], a[80:83], a[100:103], v[64:67]
    v_mfma_f32_16x16x32_bf16 v[68:71], a[60:63], a[96:99], v[68:71]
    s_add_u32 s12, s16, s28
    v_mfma_f32_16x16x32_bf16 v[68:71], a[84:87], a[100:103], v[68:71]
    s_addc_u32 s13, s17, 0
    v_mfma_f32_16x16x32_bf16 v[128:131], a[96:99], a[64:67], v[128:131]
    global_load_lds_dwordx4 v37, s[14:15] offset:1024
    v_mfma_f32_16x16x32_bf16 v[128:131], a[100:103], a[88:91], v[128:131]
    v_mfma_f32_16x16x32_bf16 v[136:139], a[96:99], a[68:71], v[136:139]
    v_mfma_f32_16x16x32_bf16 v[136:139], a[100:103], a[92:95], v[136:139]
    v_mfma_f32_16x16x32_bf16 v[200:203], a[48:51], a[104:107], v[200:203]
    ds_read_b128 a[120:123], v48 offset:6144
    v_mfma_f32_16x16x32_bf16 v[200:203], a[72:75], a[108:111], v[200:203]
    ds_read_b128 a[124:127], v49 offset:6144
    v_mfma_f32_16x16x32_bf16 v[204:207], a[52:55], a[104:107], v[204:207]
    global_load_lds_dwordx4 v38, s[14:15] offset:2048
    v_mfma_f32_16x16x32_bf16 v[204:207], a[76:79], a[108:111], v[204:207]
    v_mfma_f32_16x16x32_bf16 v[72:75], a[56:59], a[104:107], v[72:75]
    v_mfma_f32_16x16x32_bf16 v[72:75], a[80:83], a[108:111], v[72:75]
    v_mfma_f32_16x16x32_bf16 v[76:79], a[60:63], a[104:107], v[76:79]
    v_mfma_f32_16x16x32_bf16 v[76:79], a[84:87], a[108:111], v[76:79]
    v_mfma_f32_16x16x32_bf16 v[132:135], a[104:107], a[64:67], v[132:135]
    s_add_u32 m0, s46, 65536
    v_mfma_f32_16x16x32_bf16 v[132:135], a[108:111], a[88:91], v[132:135]
    global_load_lds_dwordx4 v28, s[12:13] offset:0
    v_mfma_f32_16x16x32_bf16 v[140:143], a[104:107], a[68:71], v[140:143]
    v_mfma_f32_16x16x32_bf16 v[140:143], a[108:111], a[92:95], v[140:143]
    s_waitcnt lgkmcnt(2)
    v_mfma_f32_16x16x32_bf16 v[208:211], a[48:51], a[112:115], v[208:211]
    ds_read_b128 a[96:99], v48 offset:8192
    v_mfma_f32_16x16x32_bf16 v[208:211], a[72:75], a[116:119], v[208:211]
    ds_read_b128 a[100:103], v49 offset:8192
    v_mfma_f32_16x16x32_bf16 v[212:215], a[52:55], a[112:115], v[212:215]
    v_mfma_f32_16x16x32_bf16 v[212:215], a[76:79], a[116:119], v[212:215]
    global_load_lds_dwordx4 v29, s[12:13] offset:1024
    v_mfma_f32_16x16x32_bf16 v[80:83], a[56:59], a[112:115], v[80:83]
    v_mfma_f32_16x16x32_bf16 v[80:83], a[80:83], a[116:119], v[80:83]
    v_mfma_f32_16x16x32_bf16 v[84:87], a[60:63], a[112:115], v[84:87]
    v_mfma_f32_16x16x32_bf16 v[84:87], a[84:87], a[116:119], v[84:87]
    v_mfma_f32_16x16x32_bf16 v[144:147], a[112:115], a[64:67], v[144:147]
    v_mfma_f32_16x16x32_bf16 v[144:147], a[116:119], a[88:91], v[144:147]
    v_mfma_f32_16x16x32_bf16 v[152:155], a[112:115], a[68:71], v[152:155]
    global_load_lds_dwordx4 v30, s[12:13] offset:2048
    v_mfma_f32_16x16x32_bf16 v[152:155], a[116:119], a[92:95], v[152:155]
    s_waitcnt lgkmcnt(2)
    v_mfma_f32_16x16x32_bf16 v[216:219], a[48:51], a[120:123], v[216:219]
    ds_read_b128 a[104:107], v48 offset:10240
    v_mfma_f32_16x16x32_bf16 v[216:219], a[72:75], a[124:127], v[216:219]
    ds_read_b128 a[108:111], v49 offset:10240
    v_mfma_f32_16x16x32_bf16 v[220:223], a[52:55], a[120:123], v[220:223]
    v_mfma_f32_16x16x32_bf16 v[220:223], a[76:79], a[124:127], v[220:223]
    v_mfma_f32_16x16x32_bf16 v[88:91], a[56:59], a[120:123], v[88:91]
    global_load_lds_dwordx4 v31, s[12:13] offset:3072
    v_mfma_f32_16x16x32_bf16 v[88:91], a[80:83], a[124:127], v[88:91]
    v_mfma_f32_16x16x32_bf16 v[92:95], a[60:63], a[120:123], v[92:95]
    v_mfma_f32_16x16x32_bf16 v[92:95], a[84:87], a[124:127], v[92:95]
    v_mfma_f32_16x16x32_bf16 v[148:151], a[120:123], a[64:67], v[148:151]
    v_mfma_f32_16x16x32_bf16 v[148:151], a[124:127], a[88:91], v[148:151]
    v_mfma_f32_16x16x32_bf16 v[156:159], a[120:123], a[68:71], v[156:159]
    s_add_u32 m0, s30, 24576
    v_mfma_f32_16x16x32_bf16 v[156:159], a[124:127], a[92:95], v[156:159]
    s_waitcnt lgkmcnt(2)
    global_load_lds_dwordx4 v39, s[14:15] offset:0
    v_mfma_f32_16x16x32_bf16 v[224:227], a[48:51], a[96:99], v[224:227]
    ds_read_b128 a[112:115], v48 offset:12288
    v_mfma_f32_16x16x32_bf16 v[224:227], a[72:75], a[100:103], v[224:227]
    ds_read_b128 a[116:119], v49 offset:12288
    v_mfma_f32_16x16x32_bf16 v[228:231], a[52:55], a[96:99], v[228:231]
    v_mfma_f32_16x16x32_bf16 v[228:231], a[76:79], a[100:103], v[228:231]
    v_mfma_f32_16x16x32_bf16 v[96:99], a[56:59], a[96:99], v[96:99]
    v_mfma_f32_16x16x32_bf16 v[96:99], a[80:83], a[100:103], v[96:99]
    global_load_lds_dwordx4 v40, s[14:15] offset:1024
    v_mfma_f32_16x16x32_bf16 v[100:103], a[60:63], a[96:99], v[100:103]
    v_mfma_f32_16x16x32_bf16 v[100:103], a[84:87], a[100:103], v[100:103]
    v_mfma_f32_16x16x32_bf16 v[160:163], a[96:99], a[64:67], v[160:163]
    v_mfma_f32_16x16x32_bf16 v[160:163], a[100:103], a[88:91], v[160:163]
    v_mfma_f32_16x16x32_bf16 v[168:171], a[96:99], a[68:71], v[168:171]
    v_mfma_f32_16x16x32_bf16 v[168:171], a[100:103], a[92:95], v[168:171]
    s_waitcnt lgkmcnt(2)
    global_load_lds_dwordx4 v41, s[14:15] offset:2048
    v_mfma_f32_16x16x32_bf16 v[232:235], a[48:51], a[104:107], v[232:235]
    ds_read_b128 a[120:123], v48 offset:14336
    v_mfma_f32_16x16x32_bf16 v[232:235], a[72:75], a[108:111], v[232:235]
    ds_read_b128 a[124:127], v49 offset:14336
    v_mfma_f32_16x16x32_bf16 v[236:239], a[52:55], a[104:107], v[236:239]
    v_mfma_f32_16x16x32_bf16 v[236:239], a[76:79], a[108:111], v[236:239]
    v_mfma_f32_16x16x32_bf16 v[104:107], a[56:59], a[104:107], v[104:107]
    v_mfma_f32_16x16x32_bf16 v[104:107], a[80:83], a[108:111], v[104:107]
    s_add_u32 m0, s47, 65536
    s_waitcnt vmcnt(10)
    s_barrier
    v_mfma_f32_16x16x32_bf16 v[108:111], a[60:63], a[104:107], v[108:111]
    ds_read_b64_tr_b16 a[0:1], v42 offset:0
    global_load_lds_dwordx4 v32, s[12:13] offset:0
    v_mfma_f32_16x16x32_bf16 v[108:111], a[84:87], a[108:111], v[108:111]
    ds_read_b64_tr_b16 a[2:3], v42 offset:512
    v_mfma_f32_16x16x32_bf16 v[164:167], a[104:107], a[64:67], v[164:167]
    ds_read_b64_tr_b16 a[24:25], v42 offset:12288
    v_mfma_f32_16x16x32_bf16 v[164:167], a[108:111], a[88:91], v[164:167]
    ds_read_b64_tr_b16 a[26:27], v42 offset:12800
    v_mfma_f32_16x16x32_bf16 v[172:175], a[104:107], a[68:71], v[172:175]
    ds_read_b64_tr_b16 a[4:5], v43 offset:0
    v_mfma_f32_16x16x32_bf16 v[172:175], a[108:111], a[92:95], v[172:175]
    s_waitcnt lgkmcnt(7)
    ds_read_b64_tr_b16 a[6:7], v43 offset:512
    v_mfma_f32_16x16x32_bf16 v[240:243], a[48:51], a[112:115], v[240:243]
    ds_read_b128 a[96:99], v48 offset:32768
    global_load_lds_dwordx4 v33, s[12:13] offset:1024
    v_mfma_f32_16x16x32_bf16 v[240:243], a[72:75], a[116:119], v[240:243]
    ds_read_b128 a[100:103], v49 offset:32768
    v_mfma_f32_16x16x32_bf16 v[244:247], a[52:55], a[112:115], v[244:247]
    ds_read_b64_tr_b16 a[28:29], v43 offset:12288
    v_mfma_f32_16x16x32_bf16 v[244:247], a[76:79], a[116:119], v[244:247]
    ds_read_b64_tr_b16 a[30:31], v43 offset:12800
    v_mfma_f32_16x16x32_bf16 v[112:115], a[56:59], a[112:115], v[112:115]
    ds_read_b64_tr_b16 a[8:9], v42 offset:1024
    v_mfma_f32_16x16x32_bf16 v[112:115], a[80:83], a[116:119], v[112:115]
    ds_read_b64_tr_b16 a[10:11], v42 offset:1536
    v_mfma_f32_16x16x32_bf16 v[116:119], a[60:63], a[112:115], v[116:119]
    ds_read_b64_tr_b16 a[32:33], v42 offset:13312
    v_mfma_f32_16x16x32_bf16 v[116:119], a[84:87], a[116:119], v[116:119]
    ds_read_b64_tr_b16 a[34:35], v42 offset:13824
    global_load_lds_dwordx4 v34, s[12:13] offset:2048
    v_mfma_f32_16x16x32_bf16 v[176:179], a[112:115], a[64:67], v[176:179]
    ds_read_b64_tr_b16 a[12:13], v43 offset:1024
    v_mfma_f32_16x16x32_bf16 v[176:179], a[116:119], a[88:91], v[176:179]
    ds_read_b64_tr_b16 a[14:15], v43 offset:1536
    v_mfma_f32_16x16x32_bf16 v[184:187], a[112:115], a[68:71], v[184:187]
    ds_read_b64_tr_b16 a[36:37], v43 offset:13312
    v_mfma_f32_16x16x32_bf16 v[184:187], a[116:119], a[92:95], v[184:187]
    s_waitcnt lgkmcnt(14)
    ds_read_b64_tr_b16 a[38:39], v43 offset:13824
    v_mfma_f32_16x16x32_bf16 v[248:251], a[48:51], a[120:123], v[248:251]
    ds_read_b128 a[104:107], v48 offset:34816
    v_mfma_f32_16x16x32_bf16 v[248:251], a[72:75], a[124:127], v[248:251]
    ds_read_b128 a[108:111], v49 offset:34816
    global_load_lds_dwordx4 v35, s[12:13] offset:3072
    v_mfma_f32_16x16x32_bf16 v[252:255], a[52:55], a[120:123], v[252:255]
    ds_read_b64_tr_b16 a[16:17], v42 offset:2048
    v_mfma_f32_16x16x32_bf16 v[252:255], a[76:79], a[124:127], v[252:255]
    ds_read_b64_tr_b16 a[18:19], v42 offset:2560
    v_mfma_f32_16x16x32_bf16 v[120:123], a[56:59], a[120:123], v[120:123]
    ds_read_b64_tr_b16 a[40:41], v42 offset:14336
    v_mfma_f32_16x16x32_bf16 v[120:123], a[80:83], a[124:127], v[120:123]
    ds_read_b64_tr_b16 a[42:43], v42 offset:14848
    v_mfma_f32_16x16x32_bf16 v[124:127], a[60:63], a[120:123], v[124:127]
    ds_read_b64_tr_b16 a[20:21], v43 offset:2048
    v_mfma_f32_16x16x32_bf16 v[124:127], a[84:87], a[124:127], v[124:127]
    ds_read_b64_tr_b16 a[22:23], v43 offset:2560
    v_mfma_f32_16x16x32_bf16 v[180:183], a[120:123], a[64:67], v[180:183]
    ds_read_b64_tr_b16 a[44:45], v43 offset:14336
    v_mfma_f32_16x16x32_bf16 v[180:183], a[124:127], a[88:91], v[180:183]
    s_xor_b32 s28, s53, 768
    ds_read_b64_tr_b16 a[46:47], v43 offset:14848
    v_mfma_f32_16x16x32_bf16 v[188:191], a[120:123], a[68:71], v[188:191]
    s_mul_i32 s29, s28, 3072
    v_mfma_f32_16x16x32_bf16 v[188:191], a[124:127], a[92:95], v[188:191]
    s_add_u32 s14, s18, s29
    s_waitcnt lgkmcnt(0)
    s_barrier
    v_mfma_f32_16x16x32_bf16 v[192:195], a[0:3], a[96:99], v[192:195]
    s_addc_u32 s15, s19, 0
    ds_read_b128 a[112:115], v48 offset:36864
    v_mfma_f32_16x16x32_bf16 v[192:195], a[24:27], a[100:103], v[192:195]
    s_add_u32 m0, s31, 0
    ds_read_b128 a[116:119], v49 offset:36864
    v_mfma_f32_16x16x32_bf16 v[196:199], a[4:7], a[96:99], v[196:199]
    global_load_lds_dwordx4 v36, s[14:15] offset:0
    v_mfma_f32_16x16x32_bf16 v[196:199], a[28:31], a[100:103], v[196:199]
    v_mfma_f32_16x16x32_bf16 v[64:67], a[8:11], a[96:99], v[64:67]
    v_mfma_f32_16x16x32_bf16 v[64:67], a[32:35], a[100:103], v[64:67]
    v_mfma_f32_16x16x32_bf16 v[68:71], a[12:15], a[96:99], v[68:71]
    s_add_u32 s12, s16, s28
    v_mfma_f32_16x16x32_bf16 v[68:71], a[36:39], a[100:103], v[68:71]
    s_addc_u32 s13, s17, 0
    v_mfma_f32_16x16x32_bf16 v[128:131], a[96:99], a[16:19], v[128:131]
    global_load_lds_dwordx4 v37, s[14:15] offset:1024
    v_mfma_f32_16x16x32_bf16 v[128:131], a[100:103], a[40:43], v[128:131]
    v_mfma_f32_16x16x32_bf16 v[136:139], a[96:99], a[20:23], v[136:139]
    v_mfma_f32_16x16x32_bf16 v[136:139], a[100:103], a[44:47], v[136:139]
    v_mfma_f32_16x16x32_bf16 v[200:203], a[0:3], a[104:107], v[200:203]
    ds_read_b128 a[120:123], v48 offset:38912
    v_mfma_f32_16x16x32_bf16 v[200:203], a[24:27], a[108:111], v[200:203]
    ds_read_b128 a[124:127], v49 offset:38912
    v_mfma_f32_16x16x32_bf16 v[204:207], a[4:7], a[104:107], v[204:207]
    global_load_lds_dwordx4 v38, s[14:15] offset:2048
    v_mfma_f32_16x16x32_bf16 v[204:207], a[28:31], a[108:111], v[204:207]
    v_mfma_f32_16x16x32_bf16 v[72:75], a[8:11], a[104:107], v[72:75]
    v_mfma_f32_16x16x32_bf16 v[72:75], a[32:35], a[108:111], v[72:75]
    v_mfma_f32_16x16x32_bf16 v[76:79], a[12:15], a[104:107], v[76:79]
    v_mfma_f32_16x16x32_bf16 v[76:79], a[36:39], a[108:111], v[76:79]
    v_mfma_f32_16x16x32_bf16 v[132:135], a[104:107], a[16:19], v[132:135]
    s_add_u32 m0, s46, 0
    buffer_atomic_add v15, v14, s[4:7], 0 offen sc1
    v_mfma_f32_16x16x32_bf16 v[132:135], a[108:111], a[40:43], v[132:135]
    global_load_lds_dwordx4 v28, s[12:13] offset:0
    v_mfma_f32_16x16x32_bf16 v[140:143], a[104:107], a[20:23], v[140:143]
    v_mfma_f32_16x16x32_bf16 v[140:143], a[108:111], a[44:47], v[140:143]
    s_waitcnt lgkmcnt(2)
    v_mfma_f32_16x16x32_bf16 v[208:211], a[0:3], a[112:115], v[208:211]
    ds_read_b128 a[96:99], v48 offset:40960
    v_mfma_f32_16x16x32_bf16 v[208:211], a[24:27], a[116:119], v[208:211]
    ds_read_b128 a[100:103], v49 offset:40960
    v_mfma_f32_16x16x32_bf16 v[212:215], a[4:7], a[112:115], v[212:215]
    v_mfma_f32_16x16x32_bf16 v[212:215], a[28:31], a[116:119], v[212:215]
    global_load_lds_dwordx4 v29, s[12:13] offset:1024
    v_mfma_f32_16x16x32_bf16 v[80:83], a[8:11], a[112:115], v[80:83]
    v_mfma_f32_16x16x32_bf16 v[80:83], a[32:35], a[116:119], v[80:83]
    v_mfma_f32_16x16x32_bf16 v[84:87], a[12:15], a[112:115], v[84:87]
    v_mfma_f32_16x16x32_bf16 v[84:87], a[36:39], a[116:119], v[84:87]
    v_mfma_f32_16x16x32_bf16 v[144:147], a[112:115], a[16:19], v[144:147]
    v_mfma_f32_16x16x32_bf16 v[144:147], a[116:119], a[40:43], v[144:147]
    v_mfma_f32_16x16x32_bf16 v[152:155], a[112:115], a[20:23], v[152:155]
    global_load_lds_dwordx4 v30, s[12:13] offset:2048
    v_mfma_f32_16x16x32_bf16 v[152:155], a[116:119], a[44:47], v[152:155]
    s_waitcnt lgkmcnt(2)
    v_mfma_f32_16x16x32_bf16 v[216:219], a[0:3], a[120:123], v[216:219]
    ds_read_b128 a[104:107], v48 offset:43008
    v_mfma_f32_16x16x32_bf16 v[216:219], a[24:27], a[124:127], v[216:219]
    ds_read_b128 a[108:111], v49 offset:43008
    v_mfma_f32_16x16x32_bf16 v[220:223], a[4:7], a[120:123], v[220:223]
    v_mfma_f32_16x16x32_bf16 v[220:223], a[28:31], a[124:127], v[220:223]
    v_mfma_f32_16x16x32_bf16 v[88:91], a[8:11], a[120:123], v[88:91]
    global_load_lds_dwordx4 v31, s[12:13] offset:3072
    v_mfma_f32_16x16x32_bf16 v[88:91], a[32:35], a[124:127], v[88:91]
    v_mfma_f32_16x16x32_bf16 v[92:95], a[12:15], a[120:123], v[92:95]
    v_mfma_f32_16x16x32_bf16 v[92:95], a[36:39], a[124:127], v[92:95]
    v_mfma_f32_16x16x32_bf16 v[148:151], a[120:123], a[16:19], v[148:151]
    v_mfma_f32_16x16x32_bf16 v[148:151], a[124:127], a[40:43], v[148:151]
    v_mfma_f32_16x16x32_bf16 v[156:159], a[120:123], a[20:23], v[156:159]
    s_add_u32 m0, s30, 0
    v_mfma_f32_16x16x32_bf16 v[156:159], a[124:127], a[44:47], v[156:159]
    s_waitcnt lgkmcnt(2)
    global_load_lds_dwordx4 v39, s[14:15] offset:0
    v_mfma_f32_16x16x32_bf16 v[224:227], a[0:3], a[96:99], v[224:227]
    ds_read_b128 a[112:115], v48 offset:45056
    v_mfma_f32_16x16x32_bf16 v[224:227], a[24:27], a[100:103], v[224:227]
    ds_read_b128 a[116:119], v49 offset:45056
    v_mfma_f32_16x16x32_bf16 v[228:231], a[4:7], a[96:99], v[228:231]
    v_mfma_f32_16x16x32_bf16 v[228:231], a[28:31], a[100:103], v[228:231]
    v_mfma_f32_16x16x32_bf16 v[96:99], a[8:11], a[96:99], v[96:99]
    v_mfma_f32_16x16x32_bf16 v[96:99], a[32:35], a[100:103], v[96:99]
    global_load_lds_dwordx4 v40, s[14:15] offset:1024
    v_mfma_f32_16x16x32_bf16 v[100:103], a[12:15], a[96:99], v[100:103]
    v_mfma_f32_16x16x32_bf16 v[100:103], a[36:39], a[100:103], v[100:103]
    v_mfma_f32_16x16x32_bf16 v[160:163], a[96:99], a[16:19], v[160:163]
    v_mfma_f32_16x16x32_bf16 v[160:163], a[100:103], a[40:43], v[160:163]
    v_mfma_f32_16x16x32_bf16 v[168:171], a[96:99], a[20:23], v[168:171]
    v_mfma_f32_16x16x32_bf16 v[168:171], a[100:103], a[44:47], v[168:171]
    s_waitcnt lgkmcnt(2)
    global_load_lds_dwordx4 v41, s[14:15] offset:2048
    v_mfma_f32_16x16x32_bf16 v[232:235], a[0:3], a[104:107], v[232:235]
    ds_read_b128 a[120:123], v48 offset:47104
    v_mfma_f32_16x16x32_bf16 v[232:235], a[24:27], a[108:111], v[232:235]
    ds_read_b128 a[124:127], v49 offset:47104
    v_mfma_f32_16x16x32_bf16 v[236:239], a[4:7], a[104:107], v[236:239]
    v_mfma_f32_16x16x32_bf16 v[236:239], a[28:31], a[108:111], v[236:239]
    v_mfma_f32_16x16x32_bf16 v[104:107], a[8:11], a[104:107], v[104:107]
    v_mfma_f32_16x16x32_bf16 v[104:107], a[32:35], a[108:111], v[104:107]
    s_add_u32 m0, s47, 0
    s_waitcnt vmcnt(11)
    s_barrier
    v_mfma_f32_16x16x32_bf16 v[108:111], a[12:15], a[104:107], v[108:111]
    ds_read_b64_tr_b16 a[48:49], v42 offset:24576
    global_load_lds_dwordx4 v32, s[12:13] offset:0
    v_mfma_f32_16x16x32_bf16 v[108:111], a[36:39], a[108:111], v[108:111]
    ds_read_b64_tr_b16 a[50:51], v42 offset:25088
    v_mfma_f32_16x16x32_bf16 v[164:167], a[104:107], a[16:19], v[164:167]
    ds_read_b64_tr_b16 a[72:73], v42 offset:36864
    v_mfma_f32_16x16x32_bf16 v[164:167], a[108:111], a[40:43], v[164:167]
    ds_read_b64_tr_b16 a[74:75], v42 offset:37376
    v_mfma_f32_16x16x32_bf16 v[172:175], a[104:107], a[20:23], v[172:175]
    ds_read_b64_tr_b16 a[52:53], v43 offset:24576
    v_mfma_f32_16x16x32_bf16 v[172:175], a[108:111], a[44:47], v[172:175]
    s_waitcnt lgkmcnt(7)
    ds_read_b64_tr_b16 a[54:55], v43 offset:25088
    v_mfma_f32_16x16x32_bf16 v[240:243], a[0:3], a[112:115], v[240:243]
    ds_read_b128 a[96:99], v50 offset:0
    global_load_lds_dwordx4 v33, s[12:13] offset:1024
    v_mfma_f32_16x16x32_bf16 v[240:243], a[24:27], a[116:119], v[240:243]
    ds_read_b128 a[100:103], v51 offset:0
    v_mfma_f32_16x16x32_bf16 v[244:247], a[4:7], a[112:115], v[244:247]
    ds_read_b64_tr_b16 a[76:77], v43 offset:36864
    v_mfma_f32_16x16x32_bf16 v[244:247], a[28:31], a[116:119], v[244:247]
    ds_read_b64_tr_b16 a[78:79], v43 offset:37376
    v_mfma_f32_16x16x32_bf16 v[112:115], a[8:11], a[112:115], v[112:115]
    ds_read_b64_tr_b16 a[56:57], v42 offset:25600
    v_mfma_f32_16x16x32_bf16 v[112:115], a[32:35], a[116:119], v[112:115]
    ds_read_b64_tr_b16 a[58:59], v42 offset:26112
    v_mfma_f32_16x16x32_bf16 v[116:119], a[12:15], a[112:115], v[116:119]
    ds_read_b64_tr_b16 a[80:81], v42 offset:37888
    v_mfma_f32_16x16x32_bf16 v[116:119], a[36:39], a[116:119], v[116:119]
    ds_read_b64_tr_b16 a[82:83], v42 offset:38400
    global_load_lds_dwordx4 v34, s[12:13] offset:2048
    v_mfma_f32_16x16x32_bf16 v[176:179], a[112:115], a[16:19], v[176:179]
    ds_read_b64_tr_b16 a[60:61], v43 offset:25600
    v_mfma_f32_16x16x32_bf16 v[176:179], a[116:119], a[40:43], v[176:179]
    ds_read_b64_tr_b16 a[62:63], v43 offset:26112
    v_mfma_f32_16x16x32_bf16 v[184:187], a[112:115], a[20:23], v[184:187]
    ds_read_b64_tr_b16 a[84:85], v43 offset:37888
    v_mfma_f32_16x16x32_bf16 v[184:187], a[116:119], a[44:47], v[184:187]
    s_waitcnt lgkmcnt(14)
    ds_read_b64_tr_b16 a[86:87], v43 offset:38400
    v_mfma_f32_16x16x32_bf16 v[248:251], a[0:3], a[120:123], v[248:251]
    ds_read_b128 a[104:107], v50 offset:2048
    v_mfma_f32_16x16x32_bf16 v[248:251], a[24:27], a[124:127], v[248:251]
    ds_read_b128 a[108:111], v51 offset:2048
    global_load_lds_dwordx4 v35, s[12:13] offset:3072
    v_mfma_f32_16x16x32_bf16 v[252:255], a[4:7], a[120:123], v[252:255]
    ds_read_b64_tr_b16 a[64:65], v42 offset:26624
    v_mfma_f32_16x16x32_bf16 v[252:255], a[28:31], a[124:127], v[252:255]
    ds_read_b64_tr_b16 a[66:67], v42 offset:27136
    v_mfma_f32_16x16x32_bf16 v[120:123], a[8:11], a[120:123], v[120:123]
    ds_read_b64_tr_b16 a[88:89], v42 offset:38912
    v_mfma_f32_16x16x32_bf16 v[120:123], a[32:35], a[124:127], v[120:123]
    ds_read_b64_tr_b16 a[90:91], v42 offset:39424
    v_mfma_f32_16x16x32_bf16 v[124:127], a[12:15], a[120:123], v[124:127]
    ds_read_b64_tr_b16 a[68:69], v43 offset:26624
    v_mfma_f32_16x16x32_bf16 v[124:127], a[36:39], a[124:127], v[124:127]
    ds_read_b64_tr_b16 a[70:71], v43 offset:27136
    v_mfma_f32_16x16x32_bf16 v[180:183], a[120:123], a[16:19], v[180:183]
    ds_read_b64_tr_b16 a[92:93], v43 offset:38912
    v_mfma_f32_16x16x32_bf16 v[180:183], a[124:127], a[40:43], v[180:183]
    s_xor_b32 s28, s53, 896
    ds_read_b64_tr_b16 a[94:95], v43 offset:39424
    v_mfma_f32_16x16x32_bf16 v[188:191], a[120:123], a[20:23], v[188:191]
    s_mul_i32 s29, s28, 3072
    v_mfma_f32_16x16x32_bf16 v[188:191], a[124:127], a[44:47], v[188:191]
    s_add_u32 s14, s18, s29
    s_waitcnt lgkmcnt(0)
    s_barrier
    v_mfma_f32_16x16x32_bf16 v[192:195], a[48:51], a[96:99], v[192:195]
    s_addc_u32 s15, s19, 0
    ds_read_b128 a[112:115], v50 offset:4096
    v_mfma_f32_16x16x32_bf16 v[192:195], a[72:75], a[100:103], v[192:195]
hook2:
    s_cbranch_execz hook15
    s_add_u32 m0, s31, 24576
    ds_read_b128 a[116:119], v51 offset:4096
    v_mfma_f32_16x16x32_bf16 v[196:199], a[52:55], a[96:99], v[196:199]
    global_load_lds_dwordx4 v36, s[14:15] offset:0
    v_mfma_f32_16x16x32_bf16 v[196:199], a[76:79], a[100:103], v[196:199]
    v_mfma_f32_16x16x32_bf16 v[64:67], a[56:59], a[96:99], v[64:67]
    v_mfma_f32_16x16x32_bf16 v[64:67], a[80:83], a[100:103], v[64:67]
    v_mfma_f32_16x16x32_bf16 v[68:71], a[60:63], a[96:99], v[68:71]
    s_add_u32 s12, s16, s28
    v_mfma_f32_16x16x32_bf16 v[68:71], a[84:87], a[100:103], v[68:71]
    s_addc_u32 s13, s17, 0
    v_mfma_f32_16x16x32_bf16 v[128:131], a[96:99], a[64:67], v[128:131]
    global_load_lds_dwordx4 v37, s[14:15] offset:1024
    v_mfma_f32_16x16x32_bf16 v[128:131], a[100:103], a[88:91], v[128:131]
    v_mfma_f32_16x16x32_bf16 v[136:139], a[96:99], a[68:71], v[136:139]
    v_mfma_f32_16x16x32_bf16 v[136:139], a[100:103], a[92:95], v[136:139]
    v_mfma_f32_16x16x32_bf16 v[200:203], a[48:51], a[104:107], v[200:203]
    ds_read_b128 a[120:123], v50 offset:6144
    v_mfma_f32_16x16x32_bf16 v[200:203], a[72:75], a[108:111], v[200:203]
    ds_read_b128 a[124:127], v51 offset:6144
    v_mfma_f32_16x16x32_bf16 v[204:207], a[52:55], a[104:107], v[204:207]
    global_load_lds_dwordx4 v38, s[14:15] offset:2048
    v_mfma_f32_16x16x32_bf16 v[204:207], a[76:79], a[108:111], v[204:207]
    v_mfma_f32_16x16x32_bf16 v[72:75], a[56:59], a[104:107], v[72:75]
    v_mfma_f32_16x16x32_bf16 v[72:75], a[80:83], a[108:111], v[72:75]
    v_mfma_f32_16x16x32_bf16 v[76:79], a[60:63], a[104:107], v[76:79]
    v_mfma_f32_16x16x32_bf16 v[76:79], a[84:87], a[108:111], v[76:79]
    v_mfma_f32_16x16x32_bf16 v[132:135], a[104:107], a[64:67], v[132:135]
    s_add_u32 m0, s46, 32768
    v_mfma_f32_16x16x32_bf16 v[132:135], a[108:111], a[88:91], v[132:135]
    global_load_lds_dwordx4 v28, s[12:13] offset:0
    v_mfma_f32_16x16x32_bf16 v[140:143], a[104:107], a[68:71], v[140:143]
    v_mfma_f32_16x16x32_bf16 v[140:143], a[108:111], a[92:95], v[140:143]
    s_waitcnt lgkmcnt(2)
    v_mfma_f32_16x16x32_bf16 v[208:211], a[48:51], a[112:115], v[208:211]
    ds_read_b128 a[96:99], v50 offset:8192
    v_mfma_f32_16x16x32_bf16 v[208:211], a[72:75], a[116:119], v[208:211]
    ds_read_b128 a[100:103], v51 offset:8192
    v_mfma_f32_16x16x32_bf16 v[212:215], a[52:55], a[112:115], v[212:215]
    v_mfma_f32_16x16x32_bf16 v[212:215], a[76:79], a[116:119], v[212:215]
    global_load_lds_dwordx4 v29, s[12:13] offset:1024
    v_mfma_f32_16x16x32_bf16 v[80:83], a[56:59], a[112:115], v[80:83]
    v_mfma_f32_16x16x32_bf16 v[80:83], a[80:83], a[116:119], v[80:83]
    v_mfma_f32_16x16x32_bf16 v[84:87], a[60:63], a[112:115], v[84:87]
    v_mfma_f32_16x16x32_bf16 v[84:87], a[84:87], a[116:119], v[84:87]
    v_mfma_f32_16x16x32_bf16 v[144:147], a[112:115], a[64:67], v[144:147]
    v_mfma_f32_16x16x32_bf16 v[144:147], a[116:119], a[88:91], v[144:147]
    v_mfma_f32_16x16x32_bf16 v[152:155], a[112:115], a[68:71], v[152:155]
    global_load_lds_dwordx4 v30, s[12:13] offset:2048
    v_mfma_f32_16x16x32_bf16 v[152:155], a[116:119], a[92:95], v[152:155]
    s_waitcnt lgkmcnt(2)
    v_mfma_f32_16x16x32_bf16 v[216:219], a[48:51], a[120:123], v[216:219]
    ds_read_b128 a[104:107], v50 offset:10240
    v_mfma_f32_16x16x32_bf16 v[216:219], a[72:75], a[124:127], v[216:219]
    ds_read_b128 a[108:111], v51 offset:10240
    v_mfma_f32_16x16x32_bf16 v[220:223], a[52:55], a[120:123], v[220:223]
    v_mfma_f32_16x16x32_bf16 v[220:223], a[76:79], a[124:127], v[220:223]
    v_mfma_f32_16x16x32_bf16 v[88:91], a[56:59], a[120:123], v[88:91]
    global_load_lds_dwordx4 v31, s[12:13] offset:3072
    v_mfma_f32_16x16x32_bf16 v[88:91], a[80:83], a[124:127], v[88:91]
    v_mfma_f32_16x16x32_bf16 v[92:95], a[60:63], a[120:123], v[92:95]
    v_mfma_f32_16x16x32_bf16 v[92:95], a[84:87], a[124:127], v[92:95]
    v_mfma_f32_16x16x32_bf16 v[148:151], a[120:123], a[64:67], v[148:151]
    v_mfma_f32_16x16x32_bf16 v[148:151], a[124:127], a[88:91], v[148:151]
    v_mfma_f32_16x16x32_bf16 v[156:159], a[120:123], a[68:71], v[156:159]
    s_add_u32 m0, s30, 24576
    v_mfma_f32_16x16x32_bf16 v[156:159], a[124:127], a[92:95], v[156:159]
    s_waitcnt lgkmcnt(2)
    global_load_lds_dwordx4 v39, s[14:15] offset:0
    v_mfma_f32_16x16x32_bf16 v[224:227], a[48:51], a[96:99], v[224:227]
    ds_read_b128 a[112:115], v50 offset:12288
    v_mfma_f32_16x16x32_bf16 v[224:227], a[72:75], a[100:103], v[224:227]
    ds_read_b128 a[116:119], v51 offset:12288
    v_mfma_f32_16x16x32_bf16 v[228:231], a[52:55], a[96:99], v[228:231]
    v_mfma_f32_16x16x32_bf16 v[228:231], a[76:79], a[100:103], v[228:231]
    v_mfma_f32_16x16x32_bf16 v[96:99], a[56:59], a[96:99], v[96:99]
    v_mfma_f32_16x16x32_bf16 v[96:99], a[80:83], a[100:103], v[96:99]
    global_load_lds_dwordx4 v40, s[14:15] offset:1024
    v_mfma_f32_16x16x32_bf16 v[100:103], a[60:63], a[96:99], v[100:103]
    v_mfma_f32_16x16x32_bf16 v[100:103], a[84:87], a[100:103], v[100:103]
    v_mfma_f32_16x16x32_bf16 v[160:163], a[96:99], a[64:67], v[160:163]
    v_mfma_f32_16x16x32_bf16 v[160:163], a[100:103], a[88:91], v[160:163]
    v_mfma_f32_16x16x32_bf16 v[168:171], a[96:99], a[68:71], v[168:171]
    v_mfma_f32_16x16x32_bf16 v[168:171], a[100:103], a[92:95], v[168:171]
    s_waitcnt lgkmcnt(2)
    global_load_lds_dwordx4 v41, s[14:15] offset:2048
    v_mfma_f32_16x16x32_bf16 v[232:235], a[48:51], a[104:107], v[232:235]
    ds_read_b128 a[120:123], v50 offset:14336
    v_mfma_f32_16x16x32_bf16 v[232:235], a[72:75], a[108:111], v[232:235]
    ds_read_b128 a[124:127], v51 offset:14336
    v_mfma_f32_16x16x32_bf16 v[236:239], a[52:55], a[104:107], v[236:239]
    v_mfma_f32_16x16x32_bf16 v[236:239], a[76:79], a[108:111], v[236:239]
    v_mfma_f32_16x16x32_bf16 v[104:107], a[56:59], a[104:107], v[104:107]
    v_mfma_f32_16x16x32_bf16 v[104:107], a[80:83], a[108:111], v[104:107]
    s_add_u32 m0, s47, 32768
    s_waitcnt vmcnt(10)
    s_barrier
    v_mfma_f32_16x16x32_bf16 v[108:111], a[60:63], a[104:107], v[108:111]
    ds_read_b64_tr_b16 a[0:1], v42 offset:0
    global_load_lds_dwordx4 v32, s[12:13] offset:0
    v_mfma_f32_16x16x32_bf16 v[108:111], a[84:87], a[108:111], v[108:111]
    ds_read_b64_tr_b16 a[2:3], v42 offset:512
    v_mfma_f32_16x16x32_bf16 v[164:167], a[104:107], a[64:67], v[164:167]
    ds_read_b64_tr_b16 a[24:25], v42 offset:12288
    v_mfma_f32_16x16x32_bf16 v[164:167], a[108:111], a[88:91], v[164:167]
    ds_read_b64_tr_b16 a[26:27], v42 offset:12800
    v_mfma_f32_16x16x32_bf16 v[172:175], a[104:107], a[68:71], v[172:175]
    ds_read_b64_tr_b16 a[4:5], v43 offset:0
    v_mfma_f32_16x16x32_bf16 v[172:175], a[108:111], a[92:95], v[172:175]
    s_waitcnt lgkmcnt(7)
    ds_read_b64_tr_b16 a[6:7], v43 offset:512
    v_mfma_f32_16x16x32_bf16 v[240:243], a[48:51], a[112:115], v[240:243]
    ds_read_b128 a[96:99], v48 offset:0
    global_load_lds_dwordx4 v33, s[12:13] offset:1024
    v_mfma_f32_16x16x32_bf16 v[240:243], a[72:75], a[116:119], v[240:243]
    ds_read_b128 a[100:103], v49 offset:0
    v_mfma_f32_16x16x32_bf16 v[244:247], a[52:55], a[112:115], v[244:247]
    ds_read_b64_tr_b16 a[28:29], v43 offset:12288
    v_mfma_f32_16x16x32_bf16 v[244:247], a[76:79], a[116:119], v[244:247]
    ds_read_b64_tr_b16 a[30:31], v43 offset:12800
    v_mfma_f32_16x16x32_bf16 v[112:115], a[56:59], a[112:115], v[112:115]
    ds_read_b64_tr_b16 a[8:9], v42 offset:1024
    v_mfma_f32_16x16x32_bf16 v[112:115], a[80:83], a[116:119], v[112:115]
    ds_read_b64_tr_b16 a[10:11], v42 offset:1536
    v_mfma_f32_16x16x32_bf16 v[116:119], a[60:63], a[112:115], v[116:119]
    ds_read_b64_tr_b16 a[32:33], v42 offset:13312
    v_mfma_f32_16x16x32_bf16 v[116:119], a[84:87], a[116:119], v[116:119]
    ds_read_b64_tr_b16 a[34:35], v42 offset:13824
    global_load_lds_dwordx4 v34, s[12:13] offset:2048
    v_mfma_f32_16x16x32_bf16 v[176:179], a[112:115], a[64:67], v[176:179]
    ds_read_b64_tr_b16 a[12:13], v43 offset:1024
    v_mfma_f32_16x16x32_bf16 v[176:179], a[116:119], a[88:91], v[176:179]
    ds_read_b64_tr_b16 a[14:15], v43 offset:1536
    v_mfma_f32_16x16x32_bf16 v[184:187], a[112:115], a[68:71], v[184:187]
    ds_read_b64_tr_b16 a[36:37], v43 offset:13312
    v_mfma_f32_16x16x32_bf16 v[184:187], a[116:119], a[92:95], v[184:187]
    s_waitcnt lgkmcnt(14)
    ds_read_b64_tr_b16 a[38:39], v43 offset:13824
    v_mfma_f32_16x16x32_bf16 v[248:251], a[48:51], a[120:123], v[248:251]
    ds_read_b128 a[104:107], v48 offset:2048
    v_mfma_f32_16x16x32_bf16 v[248:251], a[72:75], a[124:127], v[248:251]
    ds_read_b128 a[108:111], v49 offset:2048
    global_load_lds_dwordx4 v35, s[12:13] offset:3072
    v_mfma_f32_16x16x32_bf16 v[252:255], a[52:55], a[120:123], v[252:255]
    ds_read_b64_tr_b16 a[16:17], v42 offset:2048
    v_mfma_f32_16x16x32_bf16 v[252:255], a[76:79], a[124:127], v[252:255]
    ds_read_b64_tr_b16 a[18:19], v42 offset:2560
    v_mfma_f32_16x16x32_bf16 v[120:123], a[56:59], a[120:123], v[120:123]
    ds_read_b64_tr_b16 a[40:41], v42 offset:14336
    v_mfma_f32_16x16x32_bf16 v[120:123], a[80:83], a[124:127], v[120:123]
    ds_read_b64_tr_b16 a[42:43], v42 offset:14848
    v_mfma_f32_16x16x32_bf16 v[124:127], a[60:63], a[120:123], v[124:127]
    ds_read_b64_tr_b16 a[20:21], v43 offset:2048
    v_mfma_f32_16x16x32_bf16 v[124:127], a[84:87], a[124:127], v[124:127]
    ds_read_b64_tr_b16 a[22:23], v43 offset:2560
    v_mfma_f32_16x16x32_bf16 v[180:183], a[120:123], a[64:67], v[180:183]
    ds_read_b64_tr_b16 a[44:45], v43 offset:14336
    v_mfma_f32_16x16x32_bf16 v[180:183], a[124:127], a[88:91], v[180:183]
    s_xor_b32 s28, s53, 1152
    ds_read_b64_tr_b16 a[46:47], v43 offset:14848
    v_mfma_f32_16x16x32_bf16 v[188:191], a[120:123], a[68:71], v[188:191]
    s_mul_i32 s29, s28, 3072
    v_mfma_f32_16x16x32_bf16 v[188:191], a[124:127], a[92:95], v[188:191]
    s_add_u32 s14, s18, s29
    s_waitcnt lgkmcnt(0)
    s_barrier
    v_mfma_f32_16x16x32_bf16 v[192:195], a[0:3], a[96:99], v[192:195]
    s_addc_u32 s15, s19, 0
    ds_read_b128 a[112:115], v48 offset:4096
    v_mfma_f32_16x16x32_bf16 v[192:195], a[24:27], a[100:103], v[192:195]
    s_add_u32 m0, s31, 0
    ds_read_b128 a[116:119], v49 offset:4096
    v_mfma_f32_16x16x32_bf16 v[196:199], a[4:7], a[96:99], v[196:199]
    global_load_lds_dwordx4 v36, s[14:15] offset:0
    v_mfma_f32_16x16x32_bf16 v[196:199], a[28:31], a[100:103], v[196:199]
    v_mfma_f32_16x16x32_bf16 v[64:67], a[8:11], a[96:99], v[64:67]
    v_mfma_f32_16x16x32_bf16 v[64:67], a[32:35], a[100:103], v[64:67]
    v_mfma_f32_16x16x32_bf16 v[68:71], a[12:15], a[96:99], v[68:71]
    s_add_u32 s12, s16, s28
    v_mfma_f32_16x16x32_bf16 v[68:71], a[36:39], a[100:103], v[68:71]
    s_addc_u32 s13, s17, 0
    v_mfma_f32_16x16x32_bf16 v[128:131], a[96:99], a[16:19], v[128:131]
    global_load_lds_dwordx4 v37, s[14:15] offset:1024
    v_mfma_f32_16x16x32_bf16 v[128:131], a[100:103], a[40:43], v[128:131]
    v_mfma_f32_16x16x32_bf16 v[136:139], a[96:99], a[20:23], v[136:139]
    v_mfma_f32_16x16x32_bf16 v[136:139], a[100:103], a[44:47], v[136:139]
    v_mfma_f32_16x16x32_bf16 v[200:203], a[0:3], a[104:107], v[200:203]
    ds_read_b128 a[120:123], v48 offset:6144
    v_mfma_f32_16x16x32_bf16 v[200:203], a[24:27], a[108:111], v[200:203]
    ds_read_b128 a[124:127], v49 offset:6144
    v_mfma_f32_16x16x32_bf16 v[204:207], a[4:7], a[104:107], v[204:207]
    global_load_lds_dwordx4 v38, s[14:15] offset:2048
    v_mfma_f32_16x16x32_bf16 v[204:207], a[28:31], a[108:111], v[204:207]
    v_mfma_f32_16x16x32_bf16 v[72:75], a[8:11], a[104:107], v[72:75]
    v_mfma_f32_16x16x32_bf16 v[72:75], a[32:35], a[108:111], v[72:75]
    v_mfma_f32_16x16x32_bf16 v[76:79], a[12:15], a[104:107], v[76:79]
    v_mfma_f32_16x16x32_bf16 v[76:79], a[36:39], a[108:111], v[76:79]
    v_mfma_f32_16x16x32_bf16 v[132:135], a[104:107], a[16:19], v[132:135]
    s_add_u32 m0, s46, 65536
    v_mfma_f32_16x16x32_bf16 v[132:135], a[108:111], a[40:43], v[132:135]
    global_load_lds_dwordx4 v28, s[12:13] offset:0
    v_mfma_f32_16x16x32_bf16 v[140:143], a[104:107], a[20:23], v[140:143]
    v_mfma_f32_16x16x32_bf16 v[140:143], a[108:111], a[44:47], v[140:143]
    s_waitcnt lgkmcnt(2)
    v_mfma_f32_16x16x32_bf16 v[208:211], a[0:3], a[112:115], v[208:211]
    ds_read_b128 a[96:99], v48 offset:8192
    v_mfma_f32_16x16x32_bf16 v[208:211], a[24:27], a[116:119], v[208:211]
    ds_read_b128 a[100:103], v49 offset:8192
    v_mfma_f32_16x16x32_bf16 v[212:215], a[4:7], a[112:115], v[212:215]
    v_mfma_f32_16x16x32_bf16 v[212:215], a[28:31], a[116:119], v[212:215]
    global_load_lds_dwordx4 v29, s[12:13] offset:1024
    v_mfma_f32_16x16x32_bf16 v[80:83], a[8:11], a[112:115], v[80:83]
    v_mfma_f32_16x16x32_bf16 v[80:83], a[32:35], a[116:119], v[80:83]
    v_mfma_f32_16x16x32_bf16 v[84:87], a[12:15], a[112:115], v[84:87]
    v_mfma_f32_16x16x32_bf16 v[84:87], a[36:39], a[116:119], v[84:87]
    v_mfma_f32_16x16x32_bf16 v[144:147], a[112:115], a[16:19], v[144:147]
    v_mfma_f32_16x16x32_bf16 v[144:147], a[116:119], a[40:43], v[144:147]
    v_mfma_f32_16x16x32_bf16 v[152:155], a[112:115], a[20:23], v[152:155]
    global_load_lds_dwordx4 v30, s[12:13] offset:2048
    v_mfma_f32_16x16x32_bf16 v[152:155], a[116:119], a[44:47], v[152:155]
    s_waitcnt lgkmcnt(2)
    v_mfma_f32_16x16x32_bf16 v[216:219], a[0:3], a[120:123], v[216:219]
    ds_read_b128 a[104:107], v48 offset:10240
    v_mfma_f32_16x16x32_bf16 v[216:219], a[24:27], a[124:127], v[216:219]
    ds_read_b128 a[108:111], v49 offset:10240
    v_mfma_f32_16x16x32_bf16 v[220:223], a[4:7], a[120:123], v[220:223]
    v_mfma_f32_16x16x32_bf16 v[220:223], a[28:31], a[124:127], v[220:223]
    v_mfma_f32_16x16x32_bf16 v[88:91], a[8:11], a[120:123], v[88:91]
    global_load_lds_dwordx4 v31, s[12:13] offset:3072
    v_mfma_f32_16x16x32_bf16 v[88:91], a[32:35], a[124:127], v[88:91]
    v_mfma_f32_16x16x32_bf16 v[92:95], a[12:15], a[120:123], v[92:95]
    v_mfma_f32_16x16x32_bf16 v[92:95], a[36:39], a[124:127], v[92:95]
    v_mfma_f32_16x16x32_bf16 v[148:151], a[120:123], a[16:19], v[148:151]
    v_mfma_f32_16x16x32_bf16 v[148:151], a[124:127], a[40:43], v[148:151]
    v_mfma_f32_16x16x32_bf16 v[156:159], a[120:123], a[20:23], v[156:159]
    s_add_u32 m0, s30, 0
    v_mfma_f32_16x16x32_bf16 v[156:159], a[124:127], a[44:47], v[156:159]
    s_waitcnt lgkmcnt(2)
    global_load_lds_dwordx4 v39, s[14:15] offset:0
    v_mfma_f32_16x16x32_bf16 v[224:227], a[0:3], a[96:99], v[224:227]
    ds_read_b128 a[112:115], v48 offset:12288
    v_mfma_f32_16x16x32_bf16 v[224:227], a[24:27], a[100:103], v[224:227]
    ds_read_b128 a[116:119], v49 offset:12288
    v_mfma_f32_16x16x32_bf16 v[228:231], a[4:7], a[96:99], v[228:231]
    v_mfma_f32_16x16x32_bf16 v[228:231], a[28:31], a[100:103], v[228:231]
    v_mfma_f32_16x16x32_bf16 v[96:99], a[8:11], a[96:99], v[96:99]
    v_mfma_f32_16x16x32_bf16 v[96:99], a[32:35], a[100:103], v[96:99]
    global_load_lds_dwordx4 v40, s[14:15] offset:1024
    v_mfma_f32_16x16x32_bf16 v[100:103], a[12:15], a[96:99], v[100:103]
    v_mfma_f32_16x16x32_bf16 v[100:103], a[36:39], a[100:103], v[100:103]
    v_mfma_f32_16x16x32_bf16 v[160:163], a[96:99], a[16:19], v[160:163]
    v_mfma_f32_16x16x32_bf16 v[160:163], a[100:103], a[40:43], v[160:163]
    v_mfma_f32_16x16x32_bf16 v[168:171], a[96:99], a[20:23], v[168:171]
    v_mfma_f32_16x16x32_bf16 v[168:171], a[100:103], a[44:47], v[168:171]
    s_waitcnt lgkmcnt(2)
    global_load_lds_dwordx4 v41, s[14:15] offset:2048
    v_mfma_f32_16x16x32_bf16 v[232:235], a[0:3], a[104:107], v[232:235]
    ds_read_b128 a[120:123], v48 offset:14336
    v_mfma_f32_16x16x32_bf16 v[232:235], a[24:27], a[108:111], v[232:235]
    ds_read_b128 a[124:127], v49 offset:14336
    v_mfma_f32_16x16x32_bf16 v[236:239], a[4:7], a[104:107], v[236:239]
    v_mfma_f32_16x16x32_bf16 v[236:239], a[28:31], a[108:111], v[236:239]
    v_mfma_f32_16x16x32_bf16 v[104:107], a[8:11], a[104:107], v[104:107]
    v_mfma_f32_16x16x32_bf16 v[104:107], a[32:35], a[108:111], v[104:107]
    s_add_u32 m0, s47, 65536
    s_waitcnt vmcnt(10)
    s_barrier
    v_mfma_f32_16x16x32_bf16 v[108:111], a[12:15], a[104:107], v[108:111]
    ds_read_b64_tr_b16 a[48:49], v42 offset:24576
    global_load_lds_dwordx4 v32, s[12:13] offset:0
    v_mfma_f32_16x16x32_bf16 v[108:111], a[36:39], a[108:111], v[108:111]
    ds_read_b64_tr_b16 a[50:51], v42 offset:25088
    v_mfma_f32_16x16x32_bf16 v[164:167], a[104:107], a[16:19], v[164:167]
    ds_read_b64_tr_b16 a[72:73], v42 offset:36864
    v_mfma_f32_16x16x32_bf16 v[164:167], a[108:111], a[40:43], v[164:167]
    ds_read_b64_tr_b16 a[74:75], v42 offset:37376
    v_mfma_f32_16x16x32_bf16 v[172:175], a[104:107], a[20:23], v[172:175]
    ds_read_b64_tr_b16 a[52:53], v43 offset:24576
    v_mfma_f32_16x16x32_bf16 v[172:175], a[108:111], a[44:47], v[172:175]
    s_waitcnt lgkmcnt(7)
    ds_read_b64_tr_b16 a[54:55], v43 offset:25088
    v_mfma_f32_16x16x32_bf16 v[240:243], a[0:3], a[112:115], v[240:243]
    ds_read_b128 a[96:99], v48 offset:32768
    global_load_lds_dwordx4 v33, s[12:13] offset:1024
    v_mfma_f32_16x16x32_bf16 v[240:243], a[24:27], a[116:119], v[240:243]
    ds_read_b128 a[100:103], v49 offset:32768
    v_mfma_f32_16x16x32_bf16 v[244:247], a[4:7], a[112:115], v[244:247]
    ds_read_b64_tr_b16 a[76:77], v43 offset:36864
    v_mfma_f32_16x16x32_bf16 v[244:247], a[28:31], a[116:119], v[244:247]
    ds_read_b64_tr_b16 a[78:79], v43 offset:37376
    v_mfma_f32_16x16x32_bf16 v[112:115], a[8:11], a[112:115], v[112:115]
    ds_read_b64_tr_b16 a[56:57], v42 offset:25600
    v_mfma_f32_16x16x32_bf16 v[112:115], a[32:35], a[116:119], v[112:115]
    ds_read_b64_tr_b16 a[58:59], v42 offset:26112
    v_mfma_f32_16x16x32_bf16 v[116:119], a[12:15], a[112:115], v[116:119]
    ds_read_b64_tr_b16 a[80:81], v42 offset:37888
    v_mfma_f32_16x16x32_bf16 v[116:119], a[36:39], a[116:119], v[116:119]
    ds_read_b64_tr_b16 a[82:83], v42 offset:38400
    global_load_lds_dwordx4 v34, s[12:13] offset:2048
    v_mfma_f32_16x16x32_bf16 v[176:179], a[112:115], a[16:19], v[176:179]
    ds_read_b64_tr_b16 a[60:61], v43 offset:25600
    v_mfma_f32_16x16x32_bf16 v[176:179], a[116:119], a[40:43], v[176:179]
    ds_read_b64_tr_b16 a[62:63], v43 offset:26112
    v_mfma_f32_16x16x32_bf16 v[184:187], a[112:115], a[20:23], v[184:187]
    ds_read_b64_tr_b16 a[84:85], v43 offset:37888
    v_mfma_f32_16x16x32_bf16 v[184:187], a[116:119], a[44:47], v[184:187]
    s_waitcnt lgkmcnt(14)
    ds_read_b64_tr_b16 a[86:87], v43 offset:38400
    v_mfma_f32_16x16x32_bf16 v[248:251], a[0:3], a[120:123], v[248:251]
    ds_read_b128 a[104:107], v48 offset:34816
    v_mfma_f32_16x16x32_bf16 v[248:251], a[24:27], a[124:127], v[248:251]
    ds_read_b128 a[108:111], v49 offset:34816
    global_load_lds_dwordx4 v35, s[12:13] offset:3072
    v_mfma_f32_16x16x32_bf16 v[252:255], a[4:7], a[120:123], v[252:255]
    ds_read_b64_tr_b16 a[64:65], v42 offset:26624
    v_mfma_f32_16x16x32_bf16 v[252:255], a[28:31], a[124:127], v[252:255]
    ds_read_b64_tr_b16 a[66:67], v42 offset:27136
    v_mfma_f32_16x16x32_bf16 v[120:123], a[8:11], a[120:123], v[120:123]
    ds_read_b64_tr_b16 a[88:89], v42 offset:38912
    v_mfma_f32_16x16x32_bf16 v[120:123], a[32:35], a[124:127], v[120:123]
    ds_read_b64_tr_b16 a[90:91], v42 offset:39424
    v_mfma_f32_16x16x32_bf16 v[124:127], a[12:15], a[120:123], v[124:127]
    ds_read_b64_tr_b16 a[68:69], v43 offset:26624
    v_mfma_f32_16x16x32_bf16 v[124:127], a[36:39], a[124:127], v[124:127]
    ds_read_b64_tr_b16 a[70:71], v43 offset:27136
    v_mfma_f32_16x16x32_bf16 v[180:183], a[120:123], a[16:19], v[180:183]
    ds_read_b64_tr_b16 a[92:93], v43 offset:38912
    v_mfma_f32_16x16x32_bf16 v[180:183], a[124:127], a[40:43], v[180:183]
    s_xor_b32 s28, s53, 1024
    ds_read_b64_tr_b16 a[94:95], v43 offset:39424
    v_mfma_f32_16x16x32_bf16 v[188:191], a[120:123], a[20:23], v[188:191]
    s_mul_i32 s29, s28, 3072
    v_mfma_f32_16x16x32_bf16 v[188:191], a[124:127], a[44:47], v[188:191]
    s_add_u32 s14, s18, s29
    s_waitcnt lgkmcnt(0)
    s_barrier
    v_mfma_f32_16x16x32_bf16 v[192:195], a[48:51], a[96:99], v[192:195]
    s_addc_u32 s15, s19, 0
    ds_read_b128 a[112:115], v48 offset:36864
    v_mfma_f32_16x16x32_bf16 v[192:195], a[72:75], a[100:103], v[192:195]
    s_add_u32 m0, s31, 24576
    ds_read_b128 a[116:119], v49 offset:36864
    v_mfma_f32_16x16x32_bf16 v[196:199], a[52:55], a[96:99], v[196:199]
    global_load_lds_dwordx4 v36, s[14:15] offset:0
    v_mfma_f32_16x16x32_bf16 v[196:199], a[76:79], a[100:103], v[196:199]
    v_mfma_f32_16x16x32_bf16 v[64:67], a[56:59], a[96:99], v[64:67]
    v_mfma_f32_16x16x32_bf16 v[64:67], a[80:83], a[100:103], v[64:67]
    v_mfma_f32_16x16x32_bf16 v[68:71], a[60:63], a[96:99], v[68:71]
    s_add_u32 s12, s16, s28
    v_mfma_f32_16x16x32_bf16 v[68:71], a[84:87], a[100:103], v[68:71]
    s_addc_u32 s13, s17, 0
    v_mfma_f32_16x16x32_bf16 v[128:131], a[96:99], a[64:67], v[128:131]
    global_load_lds_dwordx4 v37, s[14:15] offset:1024
    v_mfma_f32_16x16x32_bf16 v[128:131], a[100:103], a[88:91], v[128:131]
    v_mfma_f32_16x16x32_bf16 v[136:139], a[96:99], a[68:71], v[136:139]
    v_mfma_f32_16x16x32_bf16 v[136:139], a[100:103], a[92:95], v[136:139]
    v_mfma_f32_16x16x32_bf16 v[200:203], a[48:51], a[104:107], v[200:203]
    ds_read_b128 a[120:123], v48 offset:38912
    v_mfma_f32_16x16x32_bf16 v[200:203], a[72:75], a[108:111], v[200:203]
    ds_read_b128 a[124:127], v49 offset:38912
    v_mfma_f32_16x16x32_bf16 v[204:207], a[52:55], a[104:107], v[204:207]
    global_load_lds_dwordx4 v38, s[14:15] offset:2048
    v_mfma_f32_16x16x32_bf16 v[204:207], a[76:79], a[108:111], v[204:207]
    v_mfma_f32_16x16x32_bf16 v[72:75], a[56:59], a[104:107], v[72:75]
    v_mfma_f32_16x16x32_bf16 v[72:75], a[80:83], a[108:111], v[72:75]
    v_mfma_f32_16x16x32_bf16 v[76:79], a[60:63], a[104:107], v[76:79]
    v_mfma_f32_16x16x32_bf16 v[76:79], a[84:87], a[108:111], v[76:79]
    v_mfma_f32_16x16x32_bf16 v[132:135], a[104:107], a[64:67], v[132:135]
    s_add_u32 m0, s46, 0
    v_mfma_f32_16x16x32_bf16 v[132:135], a[108:111], a[88:91], v[132:135]
    global_load_lds_dwordx4 v28, s[12:13] offset:0
    v_mfma_f32_16x16x32_bf16 v[140:143], a[104:107], a[68:71], v[140:143]
    v_mfma_f32_16x16x32_bf16 v[140:143], a[108:111], a[92:95], v[140:143]
    s_waitcnt lgkmcnt(2)
    v_mfma_f32_16x16x32_bf16 v[208:211], a[48:51], a[112:115], v[208:211]
    ds_read_b128 a[96:99], v48 offset:40960
    v_mfma_f32_16x16x32_bf16 v[208:211], a[72:75], a[116:119], v[208:211]
    ds_read_b128 a[100:103], v49 offset:40960
    v_mfma_f32_16x16x32_bf16 v[212:215], a[52:55], a[112:115], v[212:215]
    v_mfma_f32_16x16x32_bf16 v[212:215], a[76:79], a[116:119], v[212:215]
    global_load_lds_dwordx4 v29, s[12:13] offset:1024
    v_mfma_f32_16x16x32_bf16 v[80:83], a[56:59], a[112:115], v[80:83]
    v_mfma_f32_16x16x32_bf16 v[80:83], a[80:83], a[116:119], v[80:83]
    v_mfma_f32_16x16x32_bf16 v[84:87], a[60:63], a[112:115], v[84:87]
    v_mfma_f32_16x16x32_bf16 v[84:87], a[84:87], a[116:119], v[84:87]
    v_mfma_f32_16x16x32_bf16 v[144:147], a[112:115], a[64:67], v[144:147]
    v_mfma_f32_16x16x32_bf16 v[144:147], a[116:119], a[88:91], v[144:147]
    v_mfma_f32_16x16x32_bf16 v[152:155], a[112:115], a[68:71], v[152:155]
    global_load_lds_dwordx4 v30, s[12:13] offset:2048
    v_mfma_f32_16x16x32_bf16 v[152:155], a[116:119], a[92:95], v[152:155]
    s_waitcnt lgkmcnt(2)
    v_mfma_f32_16x16x32_bf16 v[216:219], a[48:51], a[120:123], v[216:219]
    ds_read_b128 a[104:107], v48 offset:43008
    v_mfma_f32_16x16x32_bf16 v[216:219], a[72:75], a[124:127], v[216:219]
    ds_read_b128 a[108:111], v49 offset:43008
    v_mfma_f32_16x16x32_bf16 v[220:223], a[52:55], a[120:123], v[220:223]
    v_mfma_f32_16x16x32_bf16 v[220:223], a[76:79], a[124:127], v[220:223]
    v_mfma_f32_16x16x32_bf16 v[88:91], a[56:59], a[120:123], v[88:91]
    global_load_lds_dwordx4 v31, s[12:13] offset:3072
    v_mfma_f32_16x16x32_bf16 v[88:91], a[80:83], a[124:127], v[88:91]
    v_mfma_f32_16x16x32_bf16 v[92:95], a[60:63], a[120:123], v[92:95]
    v_mfma_f32_16x16x32_bf16 v[92:95], a[84:87], a[124:127], v[92:95]
    v_mfma_f32_16x16x32_bf16 v[148:151], a[120:123], a[64:67], v[148:151]
    v_mfma_f32_16x16x32_bf16 v[148:151], a[124:127], a[88:91], v[148:151]
    v_mfma_f32_16x16x32_bf16 v[156:159], a[120:123], a[68:71], v[156:159]
    s_add_u32 m0, s30, 24576
    v_mfma_f32_16x16x32_bf16 v[156:159], a[124:127], a[92:95], v[156:159]
    s_waitcnt lgkmcnt(2)
    global_load_lds_dwordx4 v39, s[14:15] offset:0
    v_mfma_f32_16x16x32_bf16 v[224:227], a[48:51], a[96:99], v[224:227]
    ds_read_b128 a[112:115], v48 offset:45056
    v_mfma_f32_16x16x32_bf16 v[224:227], a[72:75], a[100:103], v[224:227]
    ds_read_b128 a[116:119], v49 offset:45056
    v_mfma_f32_16x16x32_bf16 v[228:231], a[52:55], a[96:99], v[228:231]
    v_mfma_f32_16x16x32_bf16 v[228:231], a[76:79], a[100:103], v[228:231]
    v_mfma_f32_16x16x32_bf16 v[96:99], a[56:59], a[96:99], v[96:99]
    v_mfma_f32_16x16x32_bf16 v[96:99], a[80:83], a[100:103], v[96:99]
    global_load_lds_dwordx4 v40, s[14:15] offset:1024
    v_mfma_f32_16x16x32_bf16 v[100:103], a[60:63], a[96:99], v[100:103]
    v_mfma_f32_16x16x32_bf16 v[100:103], a[84:87], a[100:103], v[100:103]
    v_mfma_f32_16x16x32_bf16 v[160:163], a[96:99], a[64:67], v[160:163]
    v_mfma_f32_16x16x32_bf16 v[160:163], a[100:103], a[88:91], v[160:163]
    v_mfma_f32_16x16x32_bf16 v[168:171], a[96:99], a[68:71], v[168:171]
    v_mfma_f32_16x16x32_bf16 v[168:171], a[100:103], a[92:95], v[168:171]
    s_waitcnt lgkmcnt(2)
    global_load_lds_dwordx4 v41, s[14:15] offset:2048
    v_mfma_f32_16x16x32_bf16 v[232:235], a[48:51], a[104:107], v[232:235]
    ds_read_b128 a[120:123], v48 offset:47104
    v_mfma_f32_16x16x32_bf16 v[232:235], a[72:75], a[108:111], v[232:235]
    ds_read_b128 a[124:127], v49 offset:47104
    v_mfma_f32_16x16x32_bf16 v[236:239], a[52:55], a[104:107], v[236:239]
    v_mfma_f32_16x16x32_bf16 v[236:239], a[76:79], a[108:111], v[236:239]
    v_mfma_f32_16x16x32_bf16 v[104:107], a[56:59], a[104:107], v[104:107]
    v_mfma_f32_16x16x32_bf16 v[104:107], a[80:83], a[108:111], v[104:107]
    s_add_u32 m0, s47, 0
    s_waitcnt vmcnt(10)
    s_barrier
    v_mfma_f32_16x16x32_bf16 v[108:111], a[60:63], a[104:107], v[108:111]
    ds_read_b64_tr_b16 a[0:1], v42 offset:0
    global_load_lds_dwordx4 v32, s[12:13] offset:0
    v_mfma_f32_16x16x32_bf16 v[108:111], a[84:87], a[108:111], v[108:111]
    ds_read_b64_tr_b16 a[2:3], v42 offset:512
    v_mfma_f32_16x16x32_bf16 v[164:167], a[104:107], a[64:67], v[164:167]
    ds_read_b64_tr_b16 a[24:25], v42 offset:12288
    v_mfma_f32_16x16x32_bf16 v[164:167], a[108:111], a[88:91], v[164:167]
    ds_read_b64_tr_b16 a[26:27], v42 offset:12800
    v_mfma_f32_16x16x32_bf16 v[172:175], a[104:107], a[68:71], v[172:175]
    ds_read_b64_tr_b16 a[4:5], v43 offset:0
    v_mfma_f32_16x16x32_bf16 v[172:175], a[108:111], a[92:95], v[172:175]
    s_waitcnt lgkmcnt(7)
    ds_read_b64_tr_b16 a[6:7], v43 offset:512
    v_mfma_f32_16x16x32_bf16 v[240:243], a[48:51], a[112:115], v[240:243]
    ds_read_b128 a[96:99], v50 offset:0
    global_load_lds_dwordx4 v33, s[12:13] offset:1024
    v_mfma_f32_16x16x32_bf16 v[240:243], a[72:75], a[116:119], v[240:243]
    ds_read_b128 a[100:103], v51 offset:0
    v_mfma_f32_16x16x32_bf16 v[244:247], a[52:55], a[112:115], v[244:247]
    ds_read_b64_tr_b16 a[28:29], v43 offset:12288
    v_mfma_f32_16x16x32_bf16 v[244:247], a[76:79], a[116:119], v[244:247]
    ds_read_b64_tr_b16 a[30:31], v43 offset:12800
    v_mfma_f32_16x16x32_bf16 v[112:115], a[56:59], a[112:115], v[112:115]
    ds_read_b64_tr_b16 a[8:9], v42 offset:1024
    v_mfma_f32_16x16x32_bf16 v[112:115], a[80:83], a[116:119], v[112:115]
    ds_read_b64_tr_b16 a[10:11], v42 offset:1536
    v_mfma_f32_16x16x32_bf16 v[116:119], a[60:63], a[112:115], v[116:119]
    ds_read_b64_tr_b16 a[32:33], v42 offset:13312
    v_mfma_f32_16x16x32_bf16 v[116:119], a[84:87], a[116:119], v[116:119]
    ds_read_b64_tr_b16 a[34:35], v42 offset:13824
    global_load_lds_dwordx4 v34, s[12:13] offset:2048
    v_mfma_f32_16x16x32_bf16 v[176:179], a[112:115], a[64:67], v[176:179]
    ds_read_b64_tr_b16 a[12:13], v43 offset:1024
    v_mfma_f32_16x16x32_bf16 v[176:179], a[116:119], a[88:91], v[176:179]
    ds_read_b64_tr_b16 a[14:15], v43 offset:1536
    v_mfma_f32_16x16x32_bf16 v[184:187], a[112:115], a[68:71], v[184:187]
    ds_read_b64_tr_b16 a[36:37], v43 offset:13312
    v_mfma_f32_16x16x32_bf16 v[184:187], a[116:119], a[92:95], v[184:187]
    s_waitcnt lgkmcnt(14)
    ds_read_b64_tr_b16 a[38:39], v43 offset:13824
    v_mfma_f32_16x16x32_bf16 v[248:251], a[48:51], a[120:123], v[248:251]
    ds_read_b128 a[104:107], v50 offset:2048
    v_mfma_f32_16x16x32_bf16 v[248:251], a[72:75], a[124:127], v[248:251]
    ds_read_b128 a[108:111], v51 offset:2048
    global_load_lds_dwordx4 v35, s[12:13] offset:3072
    v_mfma_f32_16x16x32_bf16 v[252:255], a[52:55], a[120:123], v[252:255]
    ds_read_b64_tr_b16 a[16:17], v42 offset:2048
    v_mfma_f32_16x16x32_bf16 v[252:255], a[76:79], a[124:127], v[252:255]
    ds_read_b64_tr_b16 a[18:19], v42 offset:2560
    v_mfma_f32_16x16x32_bf16 v[120:123], a[56:59], a[120:123], v[120:123]
    ds_read_b64_tr_b16 a[40:41], v42 offset:14336
    v_mfma_f32_16x16x32_bf16 v[120:123], a[80:83], a[124:127], v[120:123]
    ds_read_b64_tr_b16 a[42:43], v42 offset:14848
    v_mfma_f32_16x16x32_bf16 v[124:127], a[60:63], a[120:123], v[124:127]
    ds_read_b64_tr_b16 a[20:21], v43 offset:2048
    v_mfma_f32_16x16x32_bf16 v[124:127], a[84:87], a[124:127], v[124:127]
    ds_read_b64_tr_b16 a[22:23], v43 offset:2560
    v_mfma_f32_16x16x32_bf16 v[180:183], a[120:123], a[64:67], v[180:183]
    ds_read_b64_tr_b16 a[44:45], v43 offset:14336
    v_mfma_f32_16x16x32_bf16 v[180:183], a[124:127], a[88:91], v[180:183]
    s_xor_b32 s28, s53, 1408
    ds_read_b64_tr_b16 a[46:47], v43 offset:14848
    v_mfma_f32_16x16x32_bf16 v[188:191], a[120:123], a[68:71], v[188:191]
    s_mul_i32 s29, s28, 3072
    v_mfma_f32_16x16x32_bf16 v[188:191], a[124:127], a[92:95], v[188:191]
    s_add_u32 s14, s18, s29
    s_waitcnt lgkmcnt(0)
    s_barrier
    v_mfma_f32_16x16x32_bf16 v[192:195], a[0:3], a[96:99], v[192:195]
    s_addc_u32 s15, s19, 0
    ds_read_b128 a[112:115], v50 offset:4096
    v_mfma_f32_16x16x32_bf16 v[192:195], a[24:27], a[100:103], v[192:195]
    s_add_u32 m0, s31, 0
    ds_read_b128 a[116:119], v51 offset:4096
    v_mfma_f32_16x16x32_bf16 v[196:199], a[4:7], a[96:99], v[196:199]
    global_load_lds_dwordx4 v36, s[14:15] offset:0
    v_mfma_f32_16x16x32_bf16 v[196:199], a[28:31], a[100:103], v[196:199]
    v_mfma_f32_16x16x32_bf16 v[64:67], a[8:11], a[96:99], v[64:67]
    v_mfma_f32_16x16x32_bf16 v[64:67], a[32:35], a[100:103], v[64:67]
    v_mfma_f32_16x16x32_bf16 v[68:71], a[12:15], a[96:99], v[68:71]
    s_add_u32 s12, s16, s28
    v_mfma_f32_16x16x32_bf16 v[68:71], a[36:39], a[100:103], v[68:71]
    s_addc_u32 s13, s17, 0
    v_mfma_f32_16x16x32_bf16 v[128:131], a[96:99], a[16:19], v[128:131]
    global_load_lds_dwordx4 v37, s[14:15] offset:1024
    v_mfma_f32_16x16x32_bf16 v[128:131], a[100:103], a[40:43], v[128:131]
    v_mfma_f32_16x16x32_bf16 v[136:139], a[96:99], a[20:23], v[136:139]
    v_mfma_f32_16x16x32_bf16 v[136:139], a[100:103], a[44:47], v[136:139]
    v_mfma_f32_16x16x32_bf16 v[200:203], a[0:3], a[104:107], v[200:203]
    ds_read_b128 a[120:123], v50 offset:6144
    v_mfma_f32_16x16x32_bf16 v[200:203], a[24:27], a[108:111], v[200:203]
    ds_read_b128 a[124:127], v51 offset:6144
    v_mfma_f32_16x16x32_bf16 v[204:207], a[4:7], a[104:107], v[204:207]
hook3:
    s_cbranch_execz hook16
    global_load_lds_dwordx4 v38, s[14:15] offset:2048
    v_mfma_f32_16x16x32_bf16 v[204:207], a[28:31], a[108:111], v[204:207]
    v_mfma_f32_16x16x32_bf16 v[72:75], a[8:11], a[104:107], v[72:75]
    v_mfma_f32_16x16x32_bf16 v[72:75], a[32:35], a[108:111], v[72:75]
    v_mfma_f32_16x16x32_bf16 v[76:79], a[12:15], a[104:107], v[76:79]
    v_mfma_f32_16x16x32_bf16 v[76:79], a[36:39], a[108:111], v[76:79]
    v_mfma_f32_16x16x32_bf16 v[132:135], a[104:107], a[16:19], v[132:135]
    s_add_u32 m0, s46, 32768
    v_mfma_f32_16x16x32_bf16 v[132:135], a[108:111], a[40:43], v[132:135]
    global_load_lds_dwordx4 v28, s[12:13] offset:0
    v_mfma_f32_16x16x32_bf16 v[140:143], a[104:107], a[20:23], v[140:143]
    v_mfma_f32_16x16x32_bf16 v[140:143], a[108:111], a[44:47], v[140:143]
    s_waitcnt lgkmcnt(2)
    v_mfma_f32_16x16x32_bf16 v[208:211], a[0:3], a[112:115], v[208:211]
    ds_read_b128 a[96:99], v50 offset:8192
    v_mfma_f32_16x16x32_bf16 v[208:211], a[24:27], a[116:119], v[208:211]
    ds_read_b128 a[100:103], v51 offset:8192
    v_mfma_f32_16x16x32_bf16 v[212:215], a[4:7], a[112:115], v[212:215]
    v_mfma_f32_16x16x32_bf16 v[212:215], a[28:31], a[116:119], v[212:215]
    global_load_lds_dwordx4 v29, s[12:13] offset:1024
    v_mfma_f32_16x16x32_bf16 v[80:83], a[8:11], a[112:115], v[80:83]
    v_mfma_f32_16x16x32_bf16 v[80:83], a[32:35], a[116:119], v[80:83]
    v_mfma_f32_16x16x32_bf16 v[84:87], a[12:15], a[112:115], v[84:87]
    v_mfma_f32_16x16x32_bf16 v[84:87], a[36:39], a[116:119], v[84:87]
    v_mfma_f32_16x16x32_bf16 v[144:147], a[112:115], a[16:19], v[144:147]
    v_mfma_f32_16x16x32_bf16 v[144:147], a[116:119], a[40:43], v[144:147]
    v_mfma_f32_16x16x32_bf16 v[152:155], a[112:115], a[20:23], v[152:155]
    global_load_lds_dwordx4 v30, s[12:13] offset:2048
    v_mfma_f32_16x16x32_bf16 v[152:155], a[116:119], a[44:47], v[152:155]
    s_waitcnt lgkmcnt(2)
    v_mfma_f32_16x16x32_bf16 v[216:219], a[0:3], a[120:123], v[216:219]
    ds_read_b128 a[104:107], v50 offset:10240
    v_mfma_f32_16x16x32_bf16 v[216:219], a[24:27], a[124:127], v[216:219]
    ds_read_b128 a[108:111], v51 offset:10240
    v_mfma_f32_16x16x32_bf16 v[220:223], a[4:7], a[120:123], v[220:223]
    v_mfma_f32_16x16x32_bf16 v[220:223], a[28:31], a[124:127], v[220:223]
    v_mfma_f32_16x16x32_bf16 v[88:91], a[8:11], a[120:123], v[88:91]
    global_load_lds_dwordx4 v31, s[12:13] offset:3072
    v_mfma_f32_16x16x32_bf16 v[88:91], a[32:35], a[124:127], v[88:91]
    v_mfma_f32_16x16x32_bf16 v[92:95], a[12:15], a[120:123], v[92:95]
    v_mfma_f32_16x16x32_bf16 v[92:95], a[36:39], a[124:127], v[92:95]
    v_mfma_f32_16x16x32_bf16 v[148:151], a[120:123], a[16:19], v[148:151]
    v_mfma_f32_16x16x32_bf16 v[148:151], a[124:127], a[40:43], v[148:151]
    v_mfma_f32_16x16x32_bf16 v[156:159], a[120:123], a[20:23], v[156:159]
    s_add_u32 m0, s30, 0
    v_mfma_f32_16x16x32_bf16 v[156:159], a[124:127], a[44:47], v[156:159]
    s_waitcnt lgkmcnt(2)
    global_load_lds_dwordx4 v39, s[14:15] offset:0
    v_mfma_f32_16x16x32_bf16 v[224:227], a[0:3], a[96:99], v[224:227]
    ds_read_b128 a[112:115], v50 offset:12288
    v_mfma_f32_16x16x32_bf16 v[224:227], a[24:27], a[100:103], v[224:227]
    ds_read_b128 a[116:119], v51 offset:12288
    v_mfma_f32_16x16x32_bf16 v[228:231], a[4:7], a[96:99], v[228:231]
    v_mfma_f32_16x16x32_bf16 v[228:231], a[28:31], a[100:103], v[228:231]
    v_mfma_f32_16x16x32_bf16 v[96:99], a[8:11], a[96:99], v[96:99]
    v_mfma_f32_16x16x32_bf16 v[96:99], a[32:35], a[100:103], v[96:99]
    global_load_lds_dwordx4 v40, s[14:15] offset:1024
    v_mfma_f32_16x16x32_bf16 v[100:103], a[12:15], a[96:99], v[100:103]
    v_mfma_f32_16x16x32_bf16 v[100:103], a[36:39], a[100:103], v[100:103]
    v_mfma_f32_16x16x32_bf16 v[160:163], a[96:99], a[16:19], v[160:163]
    v_mfma_f32_16x16x32_bf16 v[160:163], a[100:103], a[40:43], v[160:163]
    v_mfma_f32_16x16x32_bf16 v[168:171], a[96:99], a[20:23], v[168:171]
    v_mfma_f32_16x16x32_bf16 v[168:171], a[100:103], a[44:47], v[168:171]
    s_waitcnt lgkmcnt(2)
    global_load_lds_dwordx4 v41, s[14:15] offset:2048
    v_mfma_f32_16x16x32_bf16 v[232:235], a[0:3], a[104:107], v[232:235]
    ds_read_b128 a[120:123], v50 offset:14336
    v_mfma_f32_16x16x32_bf16 v[232:235], a[24:27], a[108:111], v[232:235]
    ds_read_b128 a[124:127], v51 offset:14336
    v_mfma_f32_16x16x32_bf16 v[236:239], a[4:7], a[104:107], v[236:239]
    v_mfma_f32_16x16x32_bf16 v[236:239], a[28:31], a[108:111], v[236:239]
    v_mfma_f32_16x16x32_bf16 v[104:107], a[8:11], a[104:107], v[104:107]
    v_mfma_f32_16x16x32_bf16 v[104:107], a[32:35], a[108:111], v[104:107]
    s_add_u32 m0, s47, 32768
    s_waitcnt vmcnt(10)
    s_barrier
    v_mfma_f32_16x16x32_bf16 v[108:111], a[12:15], a[104:107], v[108:111]
    ds_read_b64_tr_b16 a[48:49], v42 offset:24576
    global_load_lds_dwordx4 v32, s[12:13] offset:0
    v_mfma_f32_16x16x32_bf16 v[108:111], a[36:39], a[108:111], v[108:111]
    ds_read_b64_tr_b16 a[50:51], v42 offset:25088
    v_mfma_f32_16x16x32_bf16 v[164:167], a[104:107], a[16:19], v[164:167]
    ds_read_b64_tr_b16 a[72:73], v42 offset:36864
    v_mfma_f32_16x16x32_bf16 v[164:167], a[108:111], a[40:43], v[164:167]
    ds_read_b64_tr_b16 a[74:75], v42 offset:37376
    v_mfma_f32_16x16x32_bf16 v[172:175], a[104:107], a[20:23], v[172:175]
    ds_read_b64_tr_b16 a[52:53], v43 offset:24576
    v_mfma_f32_16x16x32_bf16 v[172:175], a[108:111], a[44:47], v[172:175]
    s_waitcnt lgkmcnt(7)
    ds_read_b64_tr_b16 a[54:55], v43 offset:25088
    v_mfma_f32_16x16x32_bf16 v[240:243], a[0:3], a[112:115], v[240:243]
    ds_read_b128 a[96:99], v48 offset:0
    global_load_lds_dwordx4 v33, s[12:13] offset:1024
    v_mfma_f32_16x16x32_bf16 v[240:243], a[24:27], a[116:119], v[240:243]
    ds_read_b128 a[100:103], v49 offset:0
    v_mfma_f32_16x16x32_bf16 v[244:247], a[4:7], a[112:115], v[244:247]
    ds_read_b64_tr_b16 a[76:77], v43 offset:36864
    v_mfma_f32_16x16x32_bf16 v[244:247], a[28:31], a[116:119], v[244:247]
    ds_read_b64_tr_b16 a[78:79], v43 offset:37376
    v_mfma_f32_16x16x32_bf16 v[112:115], a[8:11], a[112:115], v[112:115]
    ds_read_b64_tr_b16 a[56:57], v42 offset:25600
    v_mfma_f32_16x16x32_bf16 v[112:115], a[32:35], a[116:119], v[112:115]
    ds_read_b64_tr_b16 a[58:59], v42 offset:26112
    v_mfma_f32_16x16x32_bf16 v[116:119], a[12:15], a[112:115], v[116:119]
    ds_read_b64_tr_b16 a[80:81], v42 offset:37888
    v_mfma_f32_16x16x32_bf16 v[116:119], a[36:39], a[116:119], v[116:119]
    ds_read_b64_tr_b16 a[82:83], v42 offset:38400
    global_load_lds_dwordx4 v34, s[12:13] offset:2048
    v_mfma_f32_16x16x32_bf16 v[176:179], a[112:115], a[16:19], v[176:179]
    ds_read_b64_tr_b16 a[60:61], v43 offset:25600
    v_mfma_f32_16x16x32_bf16 v[176:179], a[116:119], a[40:43], v[176:179]
    ds_read_b64_tr_b16 a[62:63], v43 offset:26112
    v_mfma_f32_16x16x32_bf16 v[184:187], a[112:115], a[20:23], v[184:187]
    ds_read_b64_tr_b16 a[84:85], v43 offset:37888
    v_mfma_f32_16x16x32_bf16 v[184:187], a[116:119], a[44:47], v[184:187]
    s_waitcnt lgkmcnt(14)
    ds_read_b64_tr_b16 a[86:87], v43 offset:38400
    v_mfma_f32_16x16x32_bf16 v[248:251], a[0:3], a[120:123], v[248:251]
    ds_read_b128 a[104:107], v48 offset:2048
    v_mfma_f32_16x16x32_bf16 v[248:251], a[24:27], a[124:127], v[248:251]
    ds_read_b128 a[108:111], v49 offset:2048
    global_load_lds_dwordx4 v35, s[12:13] offset:3072
    v_mfma_f32_16x16x32_bf16 v[252:255], a[4:7], a[120:123], v[252:255]
    ds_read_b64_tr_b16 a[64:65], v42 offset:26624
    v_mfma_f32_16x16x32_bf16 v[252:255], a[28:31], a[124:127], v[252:255]
    ds_read_b64_tr_b16 a[66:67], v42 offset:27136
    v_mfma_f32_16x16x32_bf16 v[120:123], a[8:11], a[120:123], v[120:123]
    ds_read_b64_tr_b16 a[88:89], v42 offset:38912
    v_mfma_f32_16x16x32_bf16 v[120:123], a[32:35], a[124:127], v[120:123]
    ds_read_b64_tr_b16 a[90:91], v42 offset:39424
    v_mfma_f32_16x16x32_bf16 v[124:127], a[12:15], a[120:123], v[124:127]
    ds_read_b64_tr_b16 a[68:69], v43 offset:26624
    v_mfma_f32_16x16x32_bf16 v[124:127], a[36:39], a[124:127], v[124:127]
    ds_read_b64_tr_b16 a[70:71], v43 offset:27136
    v_mfma_f32_16x16x32_bf16 v[180:183], a[120:123], a[16:19], v[180:183]
    ds_read_b64_tr_b16 a[92:93], v43 offset:38912
    v_mfma_f32_16x16x32_bf16 v[180:183], a[124:127], a[40:43], v[180:183]
    s_xor_b32 s28, s53, 1280
    ds_read_b64_tr_b16 a[94:95], v43 offset:39424
    v_mfma_f32_16x16x32_bf16 v[188:191], a[120:123], a[20:23], v[188:191]
    s_mul_i32 s29, s28, 3072
    v_mfma_f32_16x16x32_bf16 v[188:191], a[124:127], a[44:47], v[188:191]
    s_add_u32 s14, s18, s29
    s_waitcnt lgkmcnt(0)
    s_barrier
    v_mfma_f32_16x16x32_bf16 v[192:195], a[48:51], a[96:99], v[192:195]
    s_addc_u32 s15, s19, 0
    ds_read_b128 a[112:115], v48 offset:4096
    v_mfma_f32_16x16x32_bf16 v[192:195], a[72:75], a[100:103], v[192:195]
    s_add_u32 m0, s31, 24576
    ds_read_b128 a[116:119], v49 offset:4096
    v_mfma_f32_16x16x32_bf16 v[196:199], a[52:55], a[96:99], v[196:199]
    global_load_lds_dwordx4 v36, s[14:15] offset:0
    v_mfma_f32_16x16x32_bf16 v[196:199], a[76:79], a[100:103], v[196:199]
    v_mfma_f32_16x16x32_bf16 v[64:67], a[56:59], a[96:99], v[64:67]
    v_mfma_f32_16x16x32_bf16 v[64:67], a[80:83], a[100:103], v[64:67]
    v_mfma_f32_16x16x32_bf16 v[68:71], a[60:63], a[96:99], v[68:71]
    s_add_u32 s12, s16, s28
    v_mfma_f32_16x16x32_bf16 v[68:71], a[84:87], a[100:103], v[68:71]
    s_addc_u32 s13, s17, 0
    v_mfma_f32_16x16x32_bf16 v[128:131], a[96:99], a[64:67], v[128:131]
    global_load_lds_dwordx4 v37, s[14:15] offset:1024
    v_mfma_f32_16x16x32_bf16 v[128:131], a[100:103], a[88:91], v[128:131]
    v_mfma_f32_16x16x32_bf16 v[136:139], a[96:99], a[68:71], v[136:139]
    v_mfma_f32_16x16x32_bf16 v[136:139], a[100:103], a[92:95], v[136:139]
    v_mfma_f32_16x16x32_bf16 v[200:203], a[48:51], a[104:107], v[200:203]
    ds_read_b128 a[120:123], v48 offset:6144
    v_mfma_f32_16x16x32_bf16 v[200:203], a[72:75], a[108:111], v[200:203]
    ds_read_b128 a[124:127], v49 offset:6144
    v_mfma_f32_16x16x32_bf16 v[204:207], a[52:55], a[104:107], v[204:207]
    global_load_lds_dwordx4 v38, s[14:15] offset:2048
    v_mfma_f32_16x16x32_bf16 v[204:207], a[76:79], a[108:111], v[204:207]
    v_mfma_f32_16x16x32_bf16 v[72:75], a[56:59], a[104:107], v[72:75]
    v_mfma_f32_16x16x32_bf16 v[72:75], a[80:83], a[108:111], v[72:75]
    v_mfma_f32_16x16x32_bf16 v[76:79], a[60:63], a[104:107], v[76:79]
    v_mfma_f32_16x16x32_bf16 v[76:79], a[84:87], a[108:111], v[76:79]
    v_mfma_f32_16x16x32_bf16 v[132:135], a[104:107], a[64:67], v[132:135]
    s_add_u32 m0, s46, 65536
    buffer_load_dword v5, v4, s[4:7], 0 offen sc1
    v_mfma_f32_16x16x32_bf16 v[132:135], a[108:111], a[88:91], v[132:135]
    global_load_lds_dwordx4 v28, s[12:13] offset:0
    v_mfma_f32_16x16x32_bf16 v[140:143], a[104:107], a[68:71], v[140:143]
    v_mfma_f32_16x16x32_bf16 v[140:143], a[108:111], a[92:95], v[140:143]
    s_waitcnt lgkmcnt(2)
    v_mfma_f32_16x16x32_bf16 v[208:211], a[48:51], a[112:115], v[208:211]
    ds_read_b128 a[96:99], v48 offset:8192
    v_mfma_f32_16x16x32_bf16 v[208:211], a[72:75], a[116:119], v[208:211]
    ds_read_b128 a[100:103], v49 offset:8192
    v_mfma_f32_16x16x32_bf16 v[212:215], a[52:55], a[112:115], v[212:215]
    v_mfma_f32_16x16x32_bf16 v[212:215], a[76:79], a[116:119], v[212:215]
    global_load_lds_dwordx4 v29, s[12:13] offset:1024
    v_mfma_f32_16x16x32_bf16 v[80:83], a[56:59], a[112:115], v[80:83]
    v_mfma_f32_16x16x32_bf16 v[80:83], a[80:83], a[116:119], v[80:83]
    v_mfma_f32_16x16x32_bf16 v[84:87], a[60:63], a[112:115], v[84:87]
    v_mfma_f32_16x16x32_bf16 v[84:87], a[84:87], a[116:119], v[84:87]
    v_mfma_f32_16x16x32_bf16 v[144:147], a[112:115], a[64:67], v[144:147]
    v_mfma_f32_16x16x32_bf16 v[144:147], a[116:119], a[88:91], v[144:147]
    v_mfma_f32_16x16x32_bf16 v[152:155], a[112:115], a[68:71], v[152:155]
    global_load_lds_dwordx4 v30, s[12:13] offset:2048
    v_mfma_f32_16x16x32_bf16 v[152:155], a[116:119], a[92:95], v[152:155]
    s_waitcnt lgkmcnt(2)
    v_mfma_f32_16x16x32_bf16 v[216:219], a[48:51], a[120:123], v[216:219]
    ds_read_b128 a[104:107], v48 offset:10240
    v_mfma_f32_16x16x32_bf16 v[216:219], a[72:75], a[124:127], v[216:219]
    ds_read_b128 a[108:111], v49 offset:10240
    v_mfma_f32_16x16x32_bf16 v[220:223], a[52:55], a[120:123], v[220:223]
    v_mfma_f32_16x16x32_bf16 v[220:223], a[76:79], a[124:127], v[220:223]
    v_mfma_f32_16x16x32_bf16 v[88:91], a[56:59], a[120:123], v[88:91]
    global_load_lds_dwordx4 v31, s[12:13] offset:3072
    v_mfma_f32_16x16x32_bf16 v[88:91], a[80:83], a[124:127], v[88:91]
    v_mfma_f32_16x16x32_bf16 v[92:95], a[60:63], a[120:123], v[92:95]
    v_mfma_f32_16x16x32_bf16 v[92:95], a[84:87], a[124:127], v[92:95]
    v_mfma_f32_16x16x32_bf16 v[148:151], a[120:123], a[64:67], v[148:151]
    v_mfma_f32_16x16x32_bf16 v[148:151], a[124:127], a[88:91], v[148:151]
    v_mfma_f32_16x16x32_bf16 v[156:159], a[120:123], a[68:71], v[156:159]
    s_add_u32 m0, s30, 24576
    v_mfma_f32_16x16x32_bf16 v[156:159], a[124:127], a[92:95], v[156:159]
    s_waitcnt lgkmcnt(2)
    global_load_lds_dwordx4 v39, s[14:15] offset:0
    v_mfma_f32_16x16x32_bf16 v[224:227], a[48:51], a[96:99], v[224:227]
    ds_read_b128 a[112:115], v48 offset:12288
    v_mfma_f32_16x16x32_bf16 v[224:227], a[72:75], a[100:103], v[224:227]
    ds_read_b128 a[116:119], v49 offset:12288
    v_mfma_f32_16x16x32_bf16 v[228:231], a[52:55], a[96:99], v[228:231]
    v_mfma_f32_16x16x32_bf16 v[228:231], a[76:79], a[100:103], v[228:231]
    v_mfma_f32_16x16x32_bf16 v[96:99], a[56:59], a[96:99], v[96:99]
    v_mfma_f32_16x16x32_bf16 v[96:99], a[80:83], a[100:103], v[96:99]
    global_load_lds_dwordx4 v40, s[14:15] offset:1024
    v_mfma_f32_16x16x32_bf16 v[100:103], a[60:63], a[96:99], v[100:103]
    v_mfma_f32_16x16x32_bf16 v[100:103], a[84:87], a[100:103], v[100:103]
    v_mfma_f32_16x16x32_bf16 v[160:163], a[96:99], a[64:67], v[160:163]
    v_mfma_f32_16x16x32_bf16 v[160:163], a[100:103], a[88:91], v[160:163]
    v_mfma_f32_16x16x32_bf16 v[168:171], a[96:99], a[68:71], v[168:171]
    v_mfma_f32_16x16x32_bf16 v[168:171], a[100:103], a[92:95], v[168:171]
    s_waitcnt lgkmcnt(2)
    global_load_lds_dwordx4 v41, s[14:15] offset:2048
    v_mfma_f32_16x16x32_bf16 v[232:235], a[48:51], a[104:107], v[232:235]
    ds_read_b128 a[120:123], v48 offset:14336
    v_mfma_f32_16x16x32_bf16 v[232:235], a[72:75], a[108:111], v[232:235]
    ds_read_b128 a[124:127], v49 offset:14336
    v_mfma_f32_16x16x32_bf16 v[236:239], a[52:55], a[104:107], v[236:239]
    v_mfma_f32_16x16x32_bf16 v[236:239], a[76:79], a[108:111], v[236:239]
    v_mfma_f32_16x16x32_bf16 v[104:107], a[56:59], a[104:107], v[104:107]
    v_mfma_f32_16x16x32_bf16 v[104:107], a[80:83], a[108:111], v[104:107]
    s_add_u32 m0, s47, 65536
    s_waitcnt vmcnt(11)
    s_barrier
    v_mfma_f32_16x16x32_bf16 v[108:111], a[60:63], a[104:107], v[108:111]
    ds_read_b64_tr_b16 a[0:1], v42 offset:0
    global_load_lds_dwordx4 v32, s[12:13] offset:0
    v_mfma_f32_16x16x32_bf16 v[108:111], a[84:87], a[108:111], v[108:111]
    ds_read_b64_tr_b16 a[2:3], v42 offset:512
    v_mfma_f32_16x16x32_bf16 v[164:167], a[104:107], a[64:67], v[164:167]
    ds_read_b64_tr_b16 a[24:25], v42 offset:12288
    v_mfma_f32_16x16x32_bf16 v[164:167], a[108:111], a[88:91], v[164:167]
    ds_read_b64_tr_b16 a[26:27], v42 offset:12800
    v_mfma_f32_16x16x32_bf16 v[172:175], a[104:107], a[68:71], v[172:175]
    ds_read_b64_tr_b16 a[4:5], v43 offset:0
    v_mfma_f32_16x16x32_bf16 v[172:175], a[108:111], a[92:95], v[172:175]
    s_waitcnt lgkmcnt(7)
    ds_read_b64_tr_b16 a[6:7], v43 offset:512
    v_mfma_f32_16x16x32_bf16 v[240:243], a[48:51], a[112:115], v[240:243]
    ds_read_b128 a[96:99], v48 offset:32768
    global_load_lds_dwordx4 v33, s[12:13] offset:1024
    v_mfma_f32_16x16x32_bf16 v[240:243], a[72:75], a[116:119], v[240:243]
    ds_read_b128 a[100:103], v49 offset:32768
    v_mfma_f32_16x16x32_bf16 v[244:247], a[52:55], a[112:115], v[244:247]
    ds_read_b64_tr_b16 a[28:29], v43 offset:12288
    v_mfma_f32_16x16x32_bf16 v[244:247], a[76:79], a[116:119], v[244:247]
    ds_read_b64_tr_b16 a[30:31], v43 offset:12800
    v_mfma_f32_16x16x32_bf16 v[112:115], a[56:59], a[112:115], v[112:115]
    ds_read_b64_tr_b16 a[8:9], v42 offset:1024
    v_mfma_f32_16x16x32_bf16 v[112:115], a[80:83], a[116:119], v[112:115]
    ds_read_b64_tr_b16 a[10:11], v42 offset:1536
    v_mfma_f32_16x16x32_bf16 v[116:119], a[60:63], a[112:115], v[116:119]
    ds_read_b64_tr_b16 a[32:33], v42 offset:13312
    v_mfma_f32_16x16x32_bf16 v[116:119], a[84:87], a[116:119], v[116:119]
    ds_read_b64_tr_b16 a[34:35], v42 offset:13824
    global_load_lds_dwordx4 v34, s[12:13] offset:2048
    v_mfma_f32_16x16x32_bf16 v[176:179], a[112:115], a[64:67], v[176:179]
    ds_read_b64_tr_b16 a[12:13], v43 offset:1024
    v_mfma_f32_16x16x32_bf16 v[176:179], a[116:119], a[88:91], v[176:179]
    ds_read_b64_tr_b16 a[14:15], v43 offset:1536
    v_mfma_f32_16x16x32_bf16 v[184:187], a[112:115], a[68:71], v[184:187]
    ds_read_b64_tr_b16 a[36:37], v43 offset:13312
    v_mfma_f32_16x16x32_bf16 v[184:187], a[116:119], a[92:95], v[184:187]
    s_waitcnt lgkmcnt(14)
    ds_read_b64_tr_b16 a[38:39], v43 offset:13824
    v_mfma_f32_16x16x32_bf16 v[248:251], a[48:51], a[120:123], v[248:251]
    ds_read_b128 a[104:107], v48 offset:34816
    v_mfma_f32_16x16x32_bf16 v[248:251], a[72:75], a[124:127], v[248:251]
    ds_read_b128 a[108:111], v49 offset:34816
    global_load_lds_dwordx4 v35, s[12:13] offset:3072
    v_mfma_f32_16x16x32_bf16 v[252:255], a[52:55], a[120:123], v[252:255]
    ds_read_b64_tr_b16 a[16:17], v42 offset:2048
    v_mfma_f32_16x16x32_bf16 v[252:255], a[76:79], a[124:127], v[252:255]
    ds_read_b64_tr_b16 a[18:19], v42 offset:2560
    v_mfma_f32_16x16x32_bf16 v[120:123], a[56:59], a[120:123], v[120:123]
    ds_read_b64_tr_b16 a[40:41], v42 offset:14336
    v_mfma_f32_16x16x32_bf16 v[120:123], a[80:83], a[124:127], v[120:123]
    ds_read_b64_tr_b16 a[42:43], v42 offset:14848
    v_mfma_f32_16x16x32_bf16 v[124:127], a[60:63], a[120:123], v[124:127]
    ds_read_b64_tr_b16 a[20:21], v43 offset:2048
    v_mfma_f32_16x16x32_bf16 v[124:127], a[84:87], a[124:127], v[124:127]
    ds_read_b64_tr_b16 a[22:23], v43 offset:2560
    v_mfma_f32_16x16x32_bf16 v[180:183], a[120:123], a[64:67], v[180:183]
    ds_read_b64_tr_b16 a[44:45], v43 offset:14336
    v_mfma_f32_16x16x32_bf16 v[180:183], a[124:127], a[88:91], v[180:183]
    s_xor_b32 s28, s53, 1664
    ds_read_b64_tr_b16 a[46:47], v43 offset:14848
    v_mfma_f32_16x16x32_bf16 v[188:191], a[120:123], a[68:71], v[188:191]
    s_mul_i32 s29, s28, 3072
    v_mfma_f32_16x16x32_bf16 v[188:191], a[124:127], a[92:95], v[188:191]
    s_add_u32 s14, s18, s29
    s_waitcnt lgkmcnt(0)
    s_barrier
    v_mfma_f32_16x16x32_bf16 v[192:195], a[0:3], a[96:99], v[192:195]
    s_addc_u32 s15, s19, 0
    ds_read_b128 a[112:115], v48 offset:36864
    v_mfma_f32_16x16x32_bf16 v[192:195], a[24:27], a[100:103], v[192:195]
    s_add_u32 m0, s31, 0
    ds_read_b128 a[116:119], v49 offset:36864
    v_mfma_f32_16x16x32_bf16 v[196:199], a[4:7], a[96:99], v[196:199]
    global_load_lds_dwordx4 v36, s[14:15] offset:0
    v_mfma_f32_16x16x32_bf16 v[196:199], a[28:31], a[100:103], v[196:199]
    v_mfma_f32_16x16x32_bf16 v[64:67], a[8:11], a[96:99], v[64:67]
    v_mfma_f32_16x16x32_bf16 v[64:67], a[32:35], a[100:103], v[64:67]
    v_mfma_f32_16x16x32_bf16 v[68:71], a[12:15], a[96:99], v[68:71]
    s_add_u32 s12, s16, s28
    v_mfma_f32_16x16x32_bf16 v[68:71], a[36:39], a[100:103], v[68:71]
    s_addc_u32 s13, s17, 0
    v_mfma_f32_16x16x32_bf16 v[128:131], a[96:99], a[16:19], v[128:131]
    global_load_lds_dwordx4 v37, s[14:15] offset:1024
    v_mfma_f32_16x16x32_bf16 v[128:131], a[100:103], a[40:43], v[128:131]
    v_mfma_f32_16x16x32_bf16 v[136:139], a[96:99], a[20:23], v[136:139]
    v_mfma_f32_16x16x32_bf16 v[136:139], a[100:103], a[44:47], v[136:139]
    v_mfma_f32_16x16x32_bf16 v[200:203], a[0:3], a[104:107], v[200:203]
    ds_read_b128 a[120:123], v48 offset:38912
    v_mfma_f32_16x16x32_bf16 v[200:203], a[24:27], a[108:111], v[200:203]
    ds_read_b128 a[124:127], v49 offset:38912
    v_mfma_f32_16x16x32_bf16 v[204:207], a[4:7], a[104:107], v[204:207]
    global_load_lds_dwordx4 v38, s[14:15] offset:2048
    v_mfma_f32_16x16x32_bf16 v[204:207], a[28:31], a[108:111], v[204:207]
    v_mfma_f32_16x16x32_bf16 v[72:75], a[8:11], a[104:107], v[72:75]
    v_mfma_f32_16x16x32_bf16 v[72:75], a[32:35], a[108:111], v[72:75]
    v_mfma_f32_16x16x32_bf16 v[76:79], a[12:15], a[104:107], v[76:79]
    v_mfma_f32_16x16x32_bf16 v[76:79], a[36:39], a[108:111], v[76:79]
    v_mfma_f32_16x16x32_bf16 v[132:135], a[104:107], a[16:19], v[132:135]
    s_add_u32 m0, s46, 0
    v_mfma_f32_16x16x32_bf16 v[132:135], a[108:111], a[40:43], v[132:135]
    global_load_lds_dwordx4 v28, s[12:13] offset:0
    v_mfma_f32_16x16x32_bf16 v[140:143], a[104:107], a[20:23], v[140:143]
    v_mfma_f32_16x16x32_bf16 v[140:143], a[108:111], a[44:47], v[140:143]
    s_waitcnt lgkmcnt(2)
    v_mfma_f32_16x16x32_bf16 v[208:211], a[0:3], a[112:115], v[208:211]
    ds_read_b128 a[96:99], v48 offset:40960
    v_mfma_f32_16x16x32_bf16 v[208:211], a[24:27], a[116:119], v[208:211]
    ds_read_b128 a[100:103], v49 offset:40960
    v_mfma_f32_16x16x32_bf16 v[212:215], a[4:7], a[112:115], v[212:215]
    v_mfma_f32_16x16x32_bf16 v[212:215], a[28:31], a[116:119], v[212:215]
    global_load_lds_dwordx4 v29, s[12:13] offset:1024
    v_mfma_f32_16x16x32_bf16 v[80:83], a[8:11], a[112:115], v[80:83]
    v_mfma_f32_16x16x32_bf16 v[80:83], a[32:35], a[116:119], v[80:83]
    v_mfma_f32_16x16x32_bf16 v[84:87], a[12:15], a[112:115], v[84:87]
    v_mfma_f32_16x16x32_bf16 v[84:87], a[36:39], a[116:119], v[84:87]
    v_mfma_f32_16x16x32_bf16 v[144:147], a[112:115], a[16:19], v[144:147]
    v_mfma_f32_16x16x32_bf16 v[144:147], a[116:119], a[40:43], v[144:147]
    v_mfma_f32_16x16x32_bf16 v[152:155], a[112:115], a[20:23], v[152:155]
    global_load_lds_dwordx4 v30, s[12:13] offset:2048
    v_mfma_f32_16x16x32_bf16 v[152:155], a[116:119], a[44:47], v[152:155]
    s_waitcnt lgkmcnt(2)
    v_mfma_f32_16x16x32_bf16 v[216:219], a[0:3], a[120:123], v[216:219]
    ds_read_b128 a[104:107], v48 offset:43008
    v_mfma_f32_16x16x32_bf16 v[216:219], a[24:27], a[124:127], v[216:219]
    ds_read_b128 a[108:111], v49 offset:43008
    v_mfma_f32_16x16x32_bf16 v[220:223], a[4:7], a[120:123], v[220:223]
    v_mfma_f32_16x16x32_bf16 v[220:223], a[28:31], a[124:127], v[220:223]
    v_mfma_f32_16x16x32_bf16 v[88:91], a[8:11], a[120:123], v[88:91]
    global_load_lds_dwordx4 v31, s[12:13] offset:3072
    v_mfma_f32_16x16x32_bf16 v[88:91], a[32:35], a[124:127], v[88:91]
    v_mfma_f32_16x16x32_bf16 v[92:95], a[12:15], a[120:123], v[92:95]
    v_mfma_f32_16x16x32_bf16 v[92:95], a[36:39], a[124:127], v[92:95]
    v_mfma_f32_16x16x32_bf16 v[148:151], a[120:123], a[16:19], v[148:151]
    v_mfma_f32_16x16x32_bf16 v[148:151], a[124:127], a[40:43], v[148:151]
    v_mfma_f32_16x16x32_bf16 v[156:159], a[120:123], a[20:23], v[156:159]
    s_add_u32 m0, s30, 0
    v_mfma_f32_16x16x32_bf16 v[156:159], a[124:127], a[44:47], v[156:159]
    s_waitcnt lgkmcnt(2)
    global_load_lds_dwordx4 v39, s[14:15] offset:0
    v_mfma_f32_16x16x32_bf16 v[224:227], a[0:3], a[96:99], v[224:227]
    ds_read_b128 a[112:115], v48 offset:45056
    v_mfma_f32_16x16x32_bf16 v[224:227], a[24:27], a[100:103], v[224:227]
    ds_read_b128 a[116:119], v49 offset:45056
    v_mfma_f32_16x16x32_bf16 v[228:231], a[4:7], a[96:99], v[228:231]
    v_mfma_f32_16x16x32_bf16 v[228:231], a[28:31], a[100:103], v[228:231]
    v_mfma_f32_16x16x32_bf16 v[96:99], a[8:11], a[96:99], v[96:99]
    v_mfma_f32_16x16x32_bf16 v[96:99], a[32:35], a[100:103], v[96:99]
    global_load_lds_dwordx4 v40, s[14:15] offset:1024
    v_mfma_f32_16x16x32_bf16 v[100:103], a[12:15], a[96:99], v[100:103]
    v_mfma_f32_16x16x32_bf16 v[100:103], a[36:39], a[100:103], v[100:103]
    v_mfma_f32_16x16x32_bf16 v[160:163], a[96:99], a[16:19], v[160:163]
    v_mfma_f32_16x16x32_bf16 v[160:163], a[100:103], a[40:43], v[160:163]
    v_mfma_f32_16x16x32_bf16 v[168:171], a[96:99], a[20:23], v[168:171]
    v_mfma_f32_16x16x32_bf16 v[168:171], a[100:103], a[44:47], v[168:171]
    s_waitcnt lgkmcnt(2)
    global_load_lds_dwordx4 v41, s[14:15] offset:2048
    v_mfma_f32_16x16x32_bf16 v[232:235], a[0:3], a[104:107], v[232:235]
    ds_read_b128 a[120:123], v48 offset:47104
    v_mfma_f32_16x16x32_bf16 v[232:235], a[24:27], a[108:111], v[232:235]
    ds_read_b128 a[124:127], v49 offset:47104
    v_mfma_f32_16x16x32_bf16 v[236:239], a[4:7], a[104:107], v[236:239]
    v_mfma_f32_16x16x32_bf16 v[236:239], a[28:31], a[108:111], v[236:239]
    v_mfma_f32_16x16x32_bf16 v[104:107], a[8:11], a[104:107], v[104:107]
    v_mfma_f32_16x16x32_bf16 v[104:107], a[32:35], a[108:111], v[104:107]
    s_add_u32 m0, s47, 0
    s_waitcnt vmcnt(10)
    s_barrier
    v_mfma_f32_16x16x32_bf16 v[108:111], a[12:15], a[104:107], v[108:111]
    ds_read_b64_tr_b16 a[48:49], v42 offset:24576
    global_load_lds_dwordx4 v32, s[12:13] offset:0
    v_mfma_f32_16x16x32_bf16 v[108:111], a[36:39], a[108:111], v[108:111]
    ds_read_b64_tr_b16 a[50:51], v42 offset:25088
    v_mfma_f32_16x16x32_bf16 v[164:167], a[104:107], a[16:19], v[164:167]
    ds_read_b64_tr_b16 a[72:73], v42 offset:36864
    v_mfma_f32_16x16x32_bf16 v[164:167], a[108:111], a[40:43], v[164:167]
    ds_read_b64_tr_b16 a[74:75], v42 offset:37376
    v_mfma_f32_16x16x32_bf16 v[172:175], a[104:107], a[20:23], v[172:175]
    ds_read_b64_tr_b16 a[52:53], v43 offset:24576
    v_mfma_f32_16x16x32_bf16 v[172:175], a[108:111], a[44:47], v[172:175]
    s_waitcnt lgkmcnt(7)
    ds_read_b64_tr_b16 a[54:55], v43 offset:25088
    v_mfma_f32_16x16x32_bf16 v[240:243], a[0:3], a[112:115], v[240:243]
    ds_read_b128 a[96:99], v50 offset:0
    global_load_lds_dwordx4 v33, s[12:13] offset:1024
    v_mfma_f32_16x16x32_bf16 v[240:243], a[24:27], a[116:119], v[240:243]
    ds_read_b128 a[100:103], v51 offset:0
    v_mfma_f32_16x16x32_bf16 v[244:247], a[4:7], a[112:115], v[244:247]
    ds_read_b64_tr_b16 a[76:77], v43 offset:36864
    v_mfma_f32_16x16x32_bf16 v[244:247], a[28:31], a[116:119], v[244:247]
    ds_read_b64_tr_b16 a[78:79], v43 offset:37376
    v_mfma_f32_16x16x32_bf16 v[112:115], a[8:11], a[112:115], v[112:115]
    ds_read_b64_tr_b16 a[56:57], v42 offset:25600
    v_mfma_f32_16x16x32_bf16 v[112:115], a[32:35], a[116:119], v[112:115]
    ds_read_b64_tr_b16 a[58:59], v42 offset:26112
    v_mfma_f32_16x16x32_bf16 v[116:119], a[12:15], a[112:115], v[116:119]
    ds_read_b64_tr_b16 a[80:81], v42 offset:37888
    v_mfma_f32_16x16x32_bf16 v[116:119], a[36:39], a[116:119], v[116:119]
    ds_read_b64_tr_b16 a[82:83], v42 offset:38400
    global_load_lds_dwordx4 v34, s[12:13] offset:2048
    v_mfma_f32_16x16x32_bf16 v[176:179], a[112:115], a[16:19], v[176:179]
    ds_read_b64_tr_b16 a[60:61], v43 offset:25600
    v_mfma_f32_16x16x32_bf16 v[176:179], a[116:119], a[40:43], v[176:179]
    ds_read_b64_tr_b16 a[62:63], v43 offset:26112
    v_mfma_f32_16x16x32_bf16 v[184:187], a[112:115], a[20:23], v[184:187]
    ds_read_b64_tr_b16 a[84:85], v43 offset:37888
    v_mfma_f32_16x16x32_bf16 v[184:187], a[116:119], a[44:47], v[184:187]
    s_waitcnt lgkmcnt(14)
    ds_read_b64_tr_b16 a[86:87], v43 offset:38400
    v_mfma_f32_16x16x32_bf16 v[248:251], a[0:3], a[120:123], v[248:251]
    ds_read_b128 a[104:107], v50 offset:2048
    v_mfma_f32_16x16x32_bf16 v[248:251], a[24:27], a[124:127], v[248:251]
    ds_read_b128 a[108:111], v51 offset:2048
    global_load_lds_dwordx4 v35, s[12:13] offset:3072
    v_mfma_f32_16x16x32_bf16 v[252:255], a[4:7], a[120:123], v[252:255]
    ds_read_b64_tr_b16 a[64:65], v42 offset:26624
    v_mfma_f32_16x16x32_bf16 v[252:255], a[28:31], a[124:127], v[252:255]
    ds_read_b64_tr_b16 a[66:67], v42 offset:27136
    v_mfma_f32_16x16x32_bf16 v[120:123], a[8:11], a[120:123], v[120:123]
    ds_read_b64_tr_b16 a[88:89], v42 offset:38912
    v_mfma_f32_16x16x32_bf16 v[120:123], a[32:35], a[124:127], v[120:123]
    ds_read_b64_tr_b16 a[90:91], v42 offset:39424
    v_mfma_f32_16x16x32_bf16 v[124:127], a[12:15], a[120:123], v[124:127]
    ds_read_b64_tr_b16 a[68:69], v43 offset:26624
    v_mfma_f32_16x16x32_bf16 v[124:127], a[36:39], a[124:127], v[124:127]
    ds_read_b64_tr_b16 a[70:71], v43 offset:27136
    v_mfma_f32_16x16x32_bf16 v[180:183], a[120:123], a[16:19], v[180:183]
    ds_read_b64_tr_b16 a[92:93], v43 offset:38912
    v_mfma_f32_16x16x32_bf16 v[180:183], a[124:127], a[40:43], v[180:183]
    s_xor_b32 s28, s53, 1536
    ds_read_b64_tr_b16 a[94:95], v43 offset:39424
    v_mfma_f32_16x16x32_bf16 v[188:191], a[120:123], a[20:23], v[188:191]
    s_mul_i32 s29, s28, 3072
    v_mfma_f32_16x16x32_bf16 v[188:191], a[124:127], a[44:47], v[188:191]
    s_add_u32 s14, s18, s29
    s_waitcnt lgkmcnt(0)
    s_barrier
    v_mfma_f32_16x16x32_bf16 v[192:195], a[48:51], a[96:99], v[192:195]
    s_addc_u32 s15, s19, 0
    ds_read_b128 a[112:115], v50 offset:4096
    v_mfma_f32_16x16x32_bf16 v[192:195], a[72:75], a[100:103], v[192:195]
    s_add_u32 m0, s31, 24576
    ds_read_b128 a[116:119], v51 offset:4096
    v_mfma_f32_16x16x32_bf16 v[196:199], a[52:55], a[96:99], v[196:199]
    global_load_lds_dwordx4 v36, s[14:15] offset:0
    v_mfma_f32_16x16x32_bf16 v[196:199], a[76:79], a[100:103], v[196:199]
    v_mfma_f32_16x16x32_bf16 v[64:67], a[56:59], a[96:99], v[64:67]
    v_mfma_f32_16x16x32_bf16 v[64:67], a[80:83], a[100:103], v[64:67]
    v_mfma_f32_16x16x32_bf16 v[68:71], a[60:63], a[96:99], v[68:71]
    s_add_u32 s12, s16, s28
    v_mfma_f32_16x16x32_bf16 v[68:71], a[84:87], a[100:103], v[68:71]
    s_addc_u32 s13, s17, 0
    v_mfma_f32_16x16x32_bf16 v[128:131], a[96:99], a[64:67], v[128:131]
    global_load_lds_dwordx4 v37, s[14:15] offset:1024
    v_mfma_f32_16x16x32_bf16 v[128:131], a[100:103], a[88:91], v[128:131]
    v_mfma_f32_16x16x32_bf16 v[136:139], a[96:99], a[68:71], v[136:139]
    v_mfma_f32_16x16x32_bf16 v[136:139], a[100:103], a[92:95], v[136:139]
    v_mfma_f32_16x16x32_bf16 v[200:203], a[48:51], a[104:107], v[200:203]
    ds_read_b128 a[120:123], v50 offset:6144
    v_mfma_f32_16x16x32_bf16 v[200:203], a[72:75], a[108:111], v[200:203]
    ds_read_b128 a[124:127], v51 offset:6144
    v_mfma_f32_16x16x32_bf16 v[204:207], a[52:55], a[104:107], v[204:207]
    global_load_lds_dwordx4 v38, s[14:15] offset:2048
    v_mfma_f32_16x16x32_bf16 v[204:207], a[76:79], a[108:111], v[204:207]
    v_mfma_f32_16x16x32_bf16 v[72:75], a[56:59], a[104:107], v[72:75]
    v_mfma_f32_16x16x32_bf16 v[72:75], a[80:83], a[108:111], v[72:75]
    v_mfma_f32_16x16x32_bf16 v[76:79], a[60:63], a[104:107], v[76:79]
    v_mfma_f32_16x16x32_bf16 v[76:79], a[84:87], a[108:111], v[76:79]
    v_mfma_f32_16x16x32_bf16 v[132:135], a[104:107], a[64:67], v[132:135]
    s_add_u32 m0, s46, 32768
    v_mfma_f32_16x16x32_bf16 v[132:135], a[108:111], a[88:91], v[132:135]
    global_load_lds_dwordx4 v28, s[12:13] offset:0
    v_mfma_f32_16x16x32_bf16 v[140:143], a[104:107], a[68:71], v[140:143]
    v_mfma_f32_16x16x32_bf16 v[140:143], a[108:111], a[92:95], v[140:143]
    s_waitcnt lgkmcnt(2)
    v_mfma_f32_16x16x32_bf16 v[208:211], a[48:51], a[112:115], v[208:211]
    ds_read_b128 a[96:99], v50 offset:8192
    v_mfma_f32_16x16x32_bf16 v[208:211], a[72:75], a[116:119], v[208:211]
    ds_read_b128 a[100:103], v51 offset:8192
    v_mfma_f32_16x16x32_bf16 v[212:215], a[52:55], a[112:115], v[212:215]
    v_mfma_f32_16x16x32_bf16 v[212:215], a[76:79], a[116:119], v[212:215]
    global_load_lds_dwordx4 v29, s[12:13] offset:1024
    v_mfma_f32_16x16x32_bf16 v[80:83], a[56:59], a[112:115], v[80:83]
    v_mfma_f32_16x16x32_bf16 v[80:83], a[80:83], a[116:119], v[80:83]
    v_mfma_f32_16x16x32_bf16 v[84:87], a[60:63], a[112:115], v[84:87]
    v_mfma_f32_16x16x32_bf16 v[84:87], a[84:87], a[116:119], v[84:87]
hook4:
    s_cbranch_execz hook17
    v_mfma_f32_16x16x32_bf16 v[144:147], a[112:115], a[64:67], v[144:147]
    v_mfma_f32_16x16x32_bf16 v[144:147], a[116:119], a[88:91], v[144:147]
    v_mfma_f32_16x16x32_bf16 v[152:155], a[112:115], a[68:71], v[152:155]
    global_load_lds_dwordx4 v30, s[12:13] offset:2048
    v_mfma_f32_16x16x32_bf16 v[152:155], a[116:119], a[92:95], v[152:155]
    s_waitcnt lgkmcnt(2)
    v_mfma_f32_16x16x32_bf16 v[216:219], a[48:51], a[120:123], v[216:219]
    ds_read_b128 a[104:107], v50 offset:10240
    v_mfma_f32_16x16x32_bf16 v[216:219], a[72:75], a[124:127], v[216:219]
    ds_read_b128 a[108:111], v51 offset:10240
    v_mfma_f32_16x16x32_bf16 v[220:223], a[52:55], a[120:123], v[220:223]
    v_mfma_f32_16x16x32_bf16 v[220:223], a[76:79], a[124:127], v[220:223]
    v_mfma_f32_16x16x32_bf16 v[88:91], a[56:59], a[120:123], v[88:91]
    global_load_lds_dwordx4 v31, s[12:13] offset:3072
    v_mfma_f32_16x16x32_bf16 v[88:91], a[80:83], a[124:127], v[88:91]
    v_mfma_f32_16x16x32_bf16 v[92:95], a[60:63], a[120:123], v[92:95]
    v_mfma_f32_16x16x32_bf16 v[92:95], a[84:87], a[124:127], v[92:95]
    v_mfma_f32_16x16x32_bf16 v[148:151], a[120:123], a[64:67], v[148:151]
    v_mfma_f32_16x16x32_bf16 v[148:151], a[124:127], a[88:91], v[148:151]
    v_mfma_f32_16x16x32_bf16 v[156:159], a[120:123], a[68:71], v[156:159]
    s_add_u32 m0, s30, 24576
    v_mfma_f32_16x16x32_bf16 v[156:159], a[124:127], a[92:95], v[156:159]
    s_waitcnt lgkmcnt(2)
    global_load_lds_dwordx4 v39, s[14:15] offset:0
    v_mfma_f32_16x16x32_bf16 v[224:227], a[48:51], a[96:99], v[224:227]
    ds_read_b128 a[112:115], v50 offset:12288
    v_mfma_f32_16x16x32_bf16 v[224:227], a[72:75], a[100:103], v[224:227]
    ds_read_b128 a[116:119], v51 offset:12288
    v_mfma_f32_16x16x32_bf16 v[228:231], a[52:55], a[96:99], v[228:231]
    v_mfma_f32_16x16x32_bf16 v[228:231], a[76:79], a[100:103], v[228:231]
    v_mfma_f32_16x16x32_bf16 v[96:99], a[56:59], a[96:99], v[96:99]
    v_mfma_f32_16x16x32_bf16 v[96:99], a[80:83], a[100:103], v[96:99]
    global_load_lds_dwordx4 v40, s[14:15] offset:1024
    v_mfma_f32_16x16x32_bf16 v[100:103], a[60:63], a[96:99], v[100:103]
    v_mfma_f32_16x16x32_bf16 v[100:103], a[84:87], a[100:103], v[100:103]
    v_mfma_f32_16x16x32_bf16 v[160:163], a[96:99], a[64:67], v[160:163]
    v_mfma_f32_16x16x32_bf16 v[160:163], a[100:103], a[88:91], v[160:163]
    v_mfma_f32_16x16x32_bf16 v[168:171], a[96:99], a[68:71], v[168:171]
    v_mfma_f32_16x16x32_bf16 v[168:171], a[100:103], a[92:95], v[168:171]
    s_waitcnt lgkmcnt(2)
    global_load_lds_dwordx4 v41, s[14:15] offset:2048
    v_mfma_f32_16x16x32_bf16 v[232:235], a[48:51], a[104:107], v[232:235]
    ds_read_b128 a[120:123], v50 offset:14336
    v_mfma_f32_16x16x32_bf16 v[232:235], a[72:75], a[108:111], v[232:235]
    ds_read_b128 a[124:127], v51 offset:14336
    v_mfma_f32_16x16x32_bf16 v[236:239], a[52:55], a[104:107], v[236:239]
    v_mfma_f32_16x16x32_bf16 v[236:239], a[76:79], a[108:111], v[236:239]
    v_mfma_f32_16x16x32_bf16 v[104:107], a[56:59], a[104:107], v[104:107]
    v_mfma_f32_16x16x32_bf16 v[104:107], a[80:83], a[108:111], v[104:107]
    s_add_u32 m0, s47, 32768
    s_waitcnt vmcnt(10)
    s_barrier
    v_cmp_gt_u32 vcc, 32, v5
    s_cbranch_vccnz pinit_spin
pinit_ok:
    v_mfma_f32_16x16x32_bf16 v[108:111], a[60:63], a[104:107], v[108:111]
    ds_read_b64_tr_b16 a[0:1], v42 offset:0
    global_load_lds_dwordx4 v32, s[12:13] offset:0
    v_mfma_f32_16x16x32_bf16 v[108:111], a[84:87], a[108:111], v[108:111]
    ds_read_b64_tr_b16 a[2:3], v42 offset:512
    v_mfma_f32_16x16x32_bf16 v[164:167], a[104:107], a[64:67], v[164:167]
    ds_read_b64_tr_b16 a[24:25], v42 offset:12288
    v_mfma_f32_16x16x32_bf16 v[164:167], a[108:111], a[88:91], v[164:167]
    ds_read_b64_tr_b16 a[26:27], v42 offset:12800
    v_mfma_f32_16x16x32_bf16 v[172:175], a[104:107], a[68:71], v[172:175]
    ds_read_b64_tr_b16 a[4:5], v43 offset:0
    v_mfma_f32_16x16x32_bf16 v[172:175], a[108:111], a[92:95], v[172:175]
    s_waitcnt lgkmcnt(7)
    ds_read_b64_tr_b16 a[6:7], v43 offset:512
    v_mfma_f32_16x16x32_bf16 v[240:243], a[48:51], a[112:115], v[240:243]
    ds_read_b128 a[96:99], v48 offset:0
    global_load_lds_dwordx4 v33, s[12:13] offset:1024
    v_mfma_f32_16x16x32_bf16 v[240:243], a[72:75], a[116:119], v[240:243]
    ds_read_b128 a[100:103], v49 offset:0
    v_mfma_f32_16x16x32_bf16 v[244:247], a[52:55], a[112:115], v[244:247]
    ds_read_b64_tr_b16 a[28:29], v43 offset:12288
    v_mfma_f32_16x16x32_bf16 v[244:247], a[76:79], a[116:119], v[244:247]
    ds_read_b64_tr_b16 a[30:31], v43 offset:12800
    v_mfma_f32_16x16x32_bf16 v[112:115], a[56:59], a[112:115], v[112:115]
    ds_read_b64_tr_b16 a[8:9], v42 offset:1024
    v_mfma_f32_16x16x32_bf16 v[112:115], a[80:83], a[116:119], v[112:115]
    ds_read_b64_tr_b16 a[10:11], v42 offset:1536
    v_mfma_f32_16x16x32_bf16 v[116:119], a[60:63], a[112:115], v[116:119]
    ds_read_b64_tr_b16 a[32:33], v42 offset:13312
    v_mfma_f32_16x16x32_bf16 v[116:119], a[84:87], a[116:119], v[116:119]
    ds_read_b64_tr_b16 a[34:35], v42 offset:13824
    global_load_lds_dwordx4 v34, s[12:13] offset:2048
    v_mfma_f32_16x16x32_bf16 v[176:179], a[112:115], a[64:67], v[176:179]
    ds_read_b64_tr_b16 a[12:13], v43 offset:1024
    v_mfma_f32_16x16x32_bf16 v[176:179], a[116:119], a[88:91], v[176:179]
    ds_read_b64_tr_b16 a[14:15], v43 offset:1536
    v_mfma_f32_16x16x32_bf16 v[184:187], a[112:115], a[68:71], v[184:187]
    ds_read_b64_tr_b16 a[36:37], v43 offset:13312
    v_mfma_f32_16x16x32_bf16 v[184:187], a[116:119], a[92:95], v[184:187]
    s_waitcnt lgkmcnt(14)
    ds_read_b64_tr_b16 a[38:39], v43 offset:13824
    v_mfma_f32_16x16x32_bf16 v[248:251], a[48:51], a[120:123], v[248:251]
    ds_read_b128 a[104:107], v48 offset:2048
    v_mfma_f32_16x16x32_bf16 v[248:251], a[72:75], a[124:127], v[248:251]
    ds_read_b128 a[108:111], v49 offset:2048
    global_load_lds_dwordx4 v35, s[12:13] offset:3072
    v_mfma_f32_16x16x32_bf16 v[252:255], a[52:55], a[120:123], v[252:255]
    ds_read_b64_tr_b16 a[16:17], v42 offset:2048
    v_mfma_f32_16x16x32_bf16 v[252:255], a[76:79], a[124:127], v[252:255]
    ds_read_b64_tr_b16 a[18:19], v42 offset:2560
    v_mfma_f32_16x16x32_bf16 v[120:123], a[56:59], a[120:123], v[120:123]
    ds_read_b64_tr_b16 a[40:41], v42 offset:14336
    v_mfma_f32_16x16x32_bf16 v[120:123], a[80:83], a[124:127], v[120:123]
    ds_read_b64_tr_b16 a[42:43], v42 offset:14848
    v_mfma_f32_16x16x32_bf16 v[124:127], a[60:63], a[120:123], v[124:127]
    ds_read_b64_tr_b16 a[20:21], v43 offset:2048
    v_mfma_f32_16x16x32_bf16 v[124:127], a[84:87], a[124:127], v[124:127]
    ds_read_b64_tr_b16 a[22:23], v43 offset:2560
    v_mfma_f32_16x16x32_bf16 v[180:183], a[120:123], a[64:67], v[180:183]
    ds_read_b64_tr_b16 a[44:45], v43 offset:14336
    v_mfma_f32_16x16x32_bf16 v[180:183], a[124:127], a[88:91], v[180:183]
    s_xor_b32 s28, s53, 1920
    ds_read_b64_tr_b16 a[46:47], v43 offset:14848
    v_mfma_f32_16x16x32_bf16 v[188:191], a[120:123], a[68:71], v[188:191]
    s_mul_i32 s29, s28, 3072
    v_mfma_f32_16x16x32_bf16 v[188:191], a[124:127], a[92:95], v[188:191]
    s_add_u32 s14, s18, s29
    s_waitcnt lgkmcnt(0)
    s_barrier
    v_mfma_f32_16x16x32_bf16 v[192:195], a[0:3], a[96:99], v[192:195]
    s_addc_u32 s15, s19, 0
    ds_read_b128 a[112:115], v48 offset:4096
    v_mfma_f32_16x16x32_bf16 v[192:195], a[24:27], a[100:103], v[192:195]
    s_add_u32 m0, s31, 0
    ds_read_b128 a[116:119], v49 offset:4096
    v_mfma_f32_16x16x32_bf16 v[196:199], a[4:7], a[96:99], v[196:199]
    global_load_lds_dwordx4 v36, s[14:15] offset:0
    v_mfma_f32_16x16x32_bf16 v[196:199], a[28:31], a[100:103], v[196:199]
    v_mfma_f32_16x16x32_bf16 v[64:67], a[8:11], a[96:99], v[64:67]
    v_mfma_f32_16x16x32_bf16 v[64:67], a[32:35], a[100:103], v[64:67]
    v_mfma_f32_16x16x32_bf16 v[68:71], a[12:15], a[96:99], v[68:71]
    s_add_u32 s12, s16, s28
    v_mfma_f32_16x16x32_bf16 v[68:71], a[36:39], a[100:103], v[68:71]
    s_addc_u32 s13, s17, 0
    v_mfma_f32_16x16x32_bf16 v[128:131], a[96:99], a[16:19], v[128:131]
    global_load_lds_dwordx4 v37, s[14:15] offset:1024
    v_mfma_f32_16x16x32_bf16 v[128:131], a[100:103], a[40:43], v[128:131]
    v_mfma_f32_16x16x32_bf16 v[136:139], a[96:99], a[20:23], v[136:139]
    v_mfma_f32_16x16x32_bf16 v[136:139], a[100:103], a[44:47], v[136:139]
    v_mfma_f32_16x16x32_bf16 v[200:203], a[0:3], a[104:107], v[200:203]
    ds_read_b128 a[120:123], v48 offset:6144
    v_mfma_f32_16x16x32_bf16 v[200:203], a[24:27], a[108:111], v[200:203]
    ds_read_b128 a[124:127], v49 offset:6144
    v_mfma_f32_16x16x32_bf16 v[204:207], a[4:7], a[104:107], v[204:207]
    global_load_lds_dwordx4 v38, s[14:15] offset:2048
    v_mfma_f32_16x16x32_bf16 v[204:207], a[28:31], a[108:111], v[204:207]
    v_mfma_f32_16x16x32_bf16 v[72:75], a[8:11], a[104:107], v[72:75]
    v_mfma_f32_16x16x32_bf16 v[72:75], a[32:35], a[108:111], v[72:75]
    v_mfma_f32_16x16x32_bf16 v[76:79], a[12:15], a[104:107], v[76:79]
    v_mfma_f32_16x16x32_bf16 v[76:79], a[36:39], a[108:111], v[76:79]
    v_mfma_f32_16x16x32_bf16 v[132:135], a[104:107], a[16:19], v[132:135]
    s_add_u32 m0, s46, 65536
    v_mfma_f32_16x16x32_bf16 v[132:135], a[108:111], a[40:43], v[132:135]
    global_load_lds_dwordx4 v28, s[12:13] offset:0
    v_mfma_f32_16x16x32_bf16 v[140:143], a[104:107], a[20:23], v[140:143]
    v_mfma_f32_16x16x32_bf16 v[140:143], a[108:111], a[44:47], v[140:143]
    s_waitcnt lgkmcnt(2)
    v_mfma_f32_16x16x32_bf16 v[208:211], a[0:3], a[112:115], v[208:211]
    ds_read_b128 a[96:99], v48 offset:8192
    v_mfma_f32_16x16x32_bf16 v[208:211], a[24:27], a[116:119], v[208:211]
    ds_read_b128 a[100:103], v49 offset:8192
    v_mfma_f32_16x16x32_bf16 v[212:215], a[4:7], a[112:115], v[212:215]
    v_mfma_f32_16x16x32_bf16 v[212:215], a[28:31], a[116:119], v[212:215]
    global_load_lds_dwordx4 v29, s[12:13] offset:1024
    v_mfma_f32_16x16x32_bf16 v[80:83], a[8:11], a[112:115], v[80:83]
    v_mfma_f32_16x16x32_bf16 v[80:83], a[32:35], a[116:119], v[80:83]
    v_mfma_f32_16x16x32_bf16 v[84:87], a[12:15], a[112:115], v[84:87]
    v_mfma_f32_16x16x32_bf16 v[84:87], a[36:39], a[116:119], v[84:87]
    v_mfma_f32_16x16x32_bf16 v[144:147], a[112:115], a[16:19], v[144:147]
    v_mfma_f32_16x16x32_bf16 v[144:147], a[116:119], a[40:43], v[144:147]
    v_mfma_f32_16x16x32_bf16 v[152:155], a[112:115], a[20:23], v[152:155]
    global_load_lds_dwordx4 v30, s[12:13] offset:2048
    v_mfma_f32_16x16x32_bf16 v[152:155], a[116:119], a[44:47], v[152:155]
    s_waitcnt lgkmcnt(2)
    v_mfma_f32_16x16x32_bf16 v[216:219], a[0:3], a[120:123], v[216:219]
    ds_read_b128 a[104:107], v48 offset:10240
    v_mfma_f32_16x16x32_bf16 v[216:219], a[24:27], a[124:127], v[216:219]
    ds_read_b128 a[108:111], v49 offset:10240
    v_mfma_f32_16x16x32_bf16 v[220:223], a[4:7], a[120:123], v[220:223]
    v_mfma_f32_16x16x32_bf16 v[220:223], a[28:31], a[124:127], v[220:223]
    v_mfma_f32_16x16x32_bf16 v[88:91], a[8:11], a[120:123], v[88:91]
    global_load_lds_dwordx4 v31, s[12:13] offset:3072
    v_mfma_f32_16x16x32_bf16 v[88:91], a[32:35], a[124:127], v[88:91]
    v_mfma_f32_16x16x32_bf16 v[92:95], a[12:15], a[120:123], v[92:95]
    v_mfma_f32_16x16x32_bf16 v[92:95], a[36:39], a[124:127], v[92:95]
    v_mfma_f32_16x16x32_bf16 v[148:151], a[120:123], a[16:19], v[148:151]
    v_mfma_f32_16x16x32_bf16 v[148:151], a[124:127], a[40:43], v[148:151]
    v_mfma_f32_16x16x32_bf16 v[156:159], a[120:123], a[20:23], v[156:159]
    s_add_u32 m0, s30, 0
    v_mfma_f32_16x16x32_bf16 v[156:159], a[124:127], a[44:47], v[156:159]
    s_waitcnt lgkmcnt(2)
    global_load_lds_dwordx4 v39, s[14:15] offset:0
    v_mfma_f32_16x16x32_bf16 v[224:227], a[0:3], a[96:99], v[224:227]
    ds_read_b128 a[112:115], v48 offset:12288
    v_mfma_f32_16x16x32_bf16 v[224:227], a[24:27], a[100:103], v[224:227]
    ds_read_b128 a[116:119], v49 offset:12288
    v_mfma_f32_16x16x32_bf16 v[228:231], a[4:7], a[96:99], v[228:231]
    v_mfma_f32_16x16x32_bf16 v[228:231], a[28:31], a[100:103], v[228:231]
    v_mfma_f32_16x16x32_bf16 v[96:99], a[8:11], a[96:99], v[96:99]
    v_mfma_f32_16x16x32_bf16 v[96:99], a[32:35], a[100:103], v[96:99]
    global_load_lds_dwordx4 v40, s[14:15] offset:1024
    v_mfma_f32_16x16x32_bf16 v[100:103], a[12:15], a[96:99], v[100:103]
    v_mfma_f32_16x16x32_bf16 v[100:103], a[36:39], a[100:103], v[100:103]
    v_mfma_f32_16x16x32_bf16 v[160:163], a[96:99], a[16:19], v[160:163]
    v_mfma_f32_16x16x32_bf16 v[160:163], a[100:103], a[40:43], v[160:163]
    v_mfma_f32_16x16x32_bf16 v[168:171], a[96:99], a[20:23], v[168:171]
    v_mfma_f32_16x16x32_bf16 v[168:171], a[100:103], a[44:47], v[168:171]
    s_waitcnt lgkmcnt(2)
    global_load_lds_dwordx4 v41, s[14:15] offset:2048
    v_mfma_f32_16x16x32_bf16 v[232:235], a[0:3], a[104:107], v[232:235]
    ds_read_b128 a[120:123], v48 offset:14336
    v_mfma_f32_16x16x32_bf16 v[232:235], a[24:27], a[108:111], v[232:235]
    ds_read_b128 a[124:127], v49 offset:14336
    v_mfma_f32_16x16x32_bf16 v[236:239], a[4:7], a[104:107], v[236:239]
    v_mfma_f32_16x16x32_bf16 v[236:239], a[28:31], a[108:111], v[236:239]
    v_mfma_f32_16x16x32_bf16 v[104:107], a[8:11], a[104:107], v[104:107]
    v_mfma_f32_16x16x32_bf16 v[104:107], a[32:35], a[108:111], v[104:107]
    s_add_u32 m0, s47, 65536
    s_waitcnt vmcnt(10)
    s_barrier
    v_mfma_f32_16x16x32_bf16 v[108:111], a[12:15], a[104:107], v[108:111]
    ds_read_b64_tr_b16 a[48:49], v42 offset:24576
    global_load_lds_dwordx4 v32, s[12:13] offset:0
    v_mfma_f32_16x16x32_bf16 v[108:111], a[36:39], a[108:111], v[108:111]
    ds_read_b64_tr_b16 a[50:51], v42 offset:25088
    v_mfma_f32_16x16x32_bf16 v[164:167], a[104:107], a[16:19], v[164:167]
    ds_read_b64_tr_b16 a[72:73], v42 offset:36864
    v_mfma_f32_16x16x32_bf16 v[164:167], a[108:111], a[40:43], v[164:167]
    ds_read_b64_tr_b16 a[74:75], v42 offset:37376
    v_mfma_f32_16x16x32_bf16 v[172:175], a[104:107], a[20:23], v[172:175]
    ds_read_b64_tr_b16 a[52:53], v43 offset:24576
    v_mfma_f32_16x16x32_bf16 v[172:175], a[108:111], a[44:47], v[172:175]
    s_waitcnt lgkmcnt(7)
    ds_read_b64_tr_b16 a[54:55], v43 offset:25088
    v_mfma_f32_16x16x32_bf16 v[240:243], a[0:3], a[112:115], v[240:243]
    ds_read_b128 a[96:99], v48 offset:32768
    global_load_lds_dwordx4 v33, s[12:13] offset:1024
    v_mfma_f32_16x16x32_bf16 v[240:243], a[24:27], a[116:119], v[240:243]
    ds_read_b128 a[100:103], v49 offset:32768
    v_mfma_f32_16x16x32_bf16 v[244:247], a[4:7], a[112:115], v[244:247]
    ds_read_b64_tr_b16 a[76:77], v43 offset:36864
    v_mfma_f32_16x16x32_bf16 v[244:247], a[28:31], a[116:119], v[244:247]
    ds_read_b64_tr_b16 a[78:79], v43 offset:37376
    v_mfma_f32_16x16x32_bf16 v[112:115], a[8:11], a[112:115], v[112:115]
    ds_read_b64_tr_b16 a[56:57], v42 offset:25600
    v_mfma_f32_16x16x32_bf16 v[112:115], a[32:35], a[116:119], v[112:115]
    ds_read_b64_tr_b16 a[58:59], v42 offset:26112
    v_mfma_f32_16x16x32_bf16 v[116:119], a[12:15], a[112:115], v[116:119]
    ds_read_b64_tr_b16 a[80:81], v42 offset:37888
    v_mfma_f32_16x16x32_bf16 v[116:119], a[36:39], a[116:119], v[116:119]
    ds_read_b64_tr_b16 a[82:83], v42 offset:38400
    global_load_lds_dwordx4 v34, s[12:13] offset:2048
    v_mfma_f32_16x16x32_bf16 v[176:179], a[112:115], a[16:19], v[176:179]
    ds_read_b64_tr_b16 a[60:61], v43 offset:25600
    v_mfma_f32_16x16x32_bf16 v[176:179], a[116:119], a[40:43], v[176:179]
    ds_read_b64_tr_b16 a[62:63], v43 offset:26112
    v_mfma_f32_16x16x32_bf16 v[184:187], a[112:115], a[20:23], v[184:187]
    ds_read_b64_tr_b16 a[84:85], v43 offset:37888
    v_mfma_f32_16x16x32_bf16 v[184:187], a[116:119], a[44:47], v[184:187]
    s_waitcnt lgkmcnt(14)
    ds_read_b64_tr_b16 a[86:87], v43 offset:38400
    v_mfma_f32_16x16x32_bf16 v[248:251], a[0:3], a[120:123], v[248:251]
    ds_read_b128 a[104:107], v48 offset:34816
    v_mfma_f32_16x16x32_bf16 v[248:251], a[24:27], a[124:127], v[248:251]
    ds_read_b128 a[108:111], v49 offset:34816
    global_load_lds_dwordx4 v35, s[12:13] offset:3072
    v_mfma_f32_16x16x32_bf16 v[252:255], a[4:7], a[120:123], v[252:255]
    ds_read_b64_tr_b16 a[64:65], v42 offset:26624
    v_mfma_f32_16x16x32_bf16 v[252:255], a[28:31], a[124:127], v[252:255]
    ds_read_b64_tr_b16 a[66:67], v42 offset:27136
    v_mfma_f32_16x16x32_bf16 v[120:123], a[8:11], a[120:123], v[120:123]
    ds_read_b64_tr_b16 a[88:89], v42 offset:38912
    v_mfma_f32_16x16x32_bf16 v[120:123], a[32:35], a[124:127], v[120:123]
    ds_read_b64_tr_b16 a[90:91], v42 offset:39424
    v_mfma_f32_16x16x32_bf16 v[124:127], a[12:15], a[120:123], v[124:127]
    ds_read_b64_tr_b16 a[68:69], v43 offset:26624
    v_mfma_f32_16x16x32_bf16 v[124:127], a[36:39], a[124:127], v[124:127]
    ds_read_b64_tr_b16 a[70:71], v43 offset:27136
    v_mfma_f32_16x16x32_bf16 v[180:183], a[120:123], a[16:19], v[180:183]
    ds_read_b64_tr_b16 a[92:93], v43 offset:38912
    v_mfma_f32_16x16x32_bf16 v[180:183], a[124:127], a[40:43], v[180:183]
    s_xor_b32 s28, s53, 1792
    ds_read_b64_tr_b16 a[94:95], v43 offset:39424
    v_mfma_f32_16x16x32_bf16 v[188:191], a[120:123], a[20:23], v[188:191]
    s_mul_i32 s29, s28, 3072
    v_mfma_f32_16x16x32_bf16 v[188:191], a[124:127], a[44:47], v[188:191]
    s_add_u32 s14, s18, s29
    s_waitcnt lgkmcnt(0)
    s_barrier
    v_mfma_f32_16x16x32_bf16 v[192:195], a[48:51], a[96:99], v[192:195]
    s_addc_u32 s15, s19, 0
    ds_read_b128 a[112:115], v48 offset:36864
    v_mfma_f32_16x16x32_bf16 v[192:195], a[72:75], a[100:103], v[192:195]
    s_add_u32 m0, s31, 24576
    ds_read_b128 a[116:119], v49 offset:36864
    v_mfma_f32_16x16x32_bf16 v[196:199], a[52:55], a[96:99], v[196:199]
    global_load_lds_dwordx4 v36, s[14:15] offset:0
    v_mfma_f32_16x16x32_bf16 v[196:199], a[76:79], a[100:103], v[196:199]
    v_mfma_f32_16x16x32_bf16 v[64:67], a[56:59], a[96:99], v[64:67]
    s_add_u32 s12, s16, s28
    v_mfma_f32_16x16x32_bf16 v[64:67], a[80:83], a[100:103], v[64:67]
    s_addc_u32 s13, s17, 0
    v_mfma_f32_16x16x32_bf16 v[68:71], a[60:63], a[96:99], v[68:71]
    global_load_lds_dwordx4 v37, s[14:15] offset:1024
    v_mfma_f32_16x16x32_bf16 v[68:71], a[84:87], a[100:103], v[68:71]
    v_mfma_f32_16x16x32_bf16 v[128:131], a[96:99], a[64:67], v[128:131]
    v_mfma_f32_16x16x32_bf16 v[128:131], a[100:103], a[88:91], v[128:131]
    v_mfma_f32_16x16x32_bf16 v[136:139], a[96:99], a[68:71], v[136:139]
    global_load_lds_dwordx4 v38, s[14:15] offset:2048
    v_mfma_f32_16x16x32_bf16 v[136:139], a[100:103], a[92:95], v[136:139]
    v_mfma_f32_16x16x32_bf16 v[200:203], a[48:51], a[104:107], v[200:203]
    ds_read_b128 a[120:123], v48 offset:38912
    v_mfma_f32_16x16x32_bf16 v[200:203], a[72:75], a[108:111], v[200:203]
    ds_read_b128 a[124:127], v49 offset:38912
    v_mfma_f32_16x16x32_bf16 v[204:207], a[52:55], a[104:107], v[204:207]
    s_add_u32 m0, s46, 0
    v_mfma_f32_16x16x32_bf16 v[204:207], a[76:79], a[108:111], v[204:207]
    global_load_lds_dwordx4 v28, s[12:13] offset:0
    v_mfma_f32_16x16x32_bf16 v[72:75], a[56:59], a[104:107], v[72:75]
    v_mfma_f32_16x16x32_bf16 v[72:75], a[80:83], a[108:111], v[72:75]
    v_mfma_f32_16x16x32_bf16 v[76:79], a[60:63], a[104:107], v[76:79]
    v_mfma_f32_16x16x32_bf16 v[76:79], a[84:87], a[108:111], v[76:79]
    global_load_lds_dwordx4 v29, s[12:13] offset:1024
    v_mfma_f32_16x16x32_bf16 v[132:135], a[104:107], a[64:67], v[132:135]
    v_mfma_f32_16x16x32_bf16 v[132:135], a[108:111], a[88:91], v[132:135]
    v_mfma_f32_16x16x32_bf16 v[140:143], a[104:107], a[68:71], v[140:143]
    v_mfma_f32_16x16x32_bf16 v[140:143], a[108:111], a[92:95], v[140:143]
    s_waitcnt lgkmcnt(2)
    v_mfma_f32_16x16x32_bf16 v[208:211], a[48:51], a[112:115], v[208:211]
    ds_read_b128 a[96:99], v48 offset:40960
    global_load_lds_dwordx4 v30, s[12:13] offset:2048
    v_mfma_f32_16x16x32_bf16 v[208:211], a[72:75], a[116:119], v[208:211]
    ds_read_b128 a[100:103], v49 offset:40960
    v_mfma_f32_16x16x32_bf16 v[212:215], a[52:55], a[112:115], v[212:215]
    v_mfma_f32_16x16x32_bf16 v[212:215], a[76:79], a[116:119], v[212:215]
    v_mfma_f32_16x16x32_bf16 v[80:83], a[56:59], a[112:115], v[80:83]
    global_load_lds_dwordx4 v31, s[12:13] offset:3072
    v_mfma_f32_16x16x32_bf16 v[80:83], a[80:83], a[116:119], v[80:83]
    v_mfma_f32_16x16x32_bf16 v[84:87], a[60:63], a[112:115], v[84:87]
    v_mfma_f32_16x16x32_bf16 v[84:87], a[84:87], a[116:119], v[84:87]
    v_mfma_f32_16x16x32_bf16 v[144:147], a[112:115], a[64:67], v[144:147]
    s_add_u32 m0, s30, 24576
    v_mfma_f32_16x16x32_bf16 v[144:147], a[116:119], a[88:91], v[144:147]
    global_load_lds_dwordx4 v39, s[14:15] offset:0
    v_mfma_f32_16x16x32_bf16 v[152:155], a[112:115], a[68:71], v[152:155]
    v_mfma_f32_16x16x32_bf16 v[152:155], a[116:119], a[92:95], v[152:155]
    s_waitcnt lgkmcnt(2)
    v_mfma_f32_16x16x32_bf16 v[216:219], a[48:51], a[120:123], v[216:219]
    ds_read_b128 a[104:107], v48 offset:43008
    v_mfma_f32_16x16x32_bf16 v[216:219], a[72:75], a[124:127], v[216:219]
    ds_read_b128 a[108:111], v49 offset:43008
    global_load_lds_dwordx4 v40, s[14:15] offset:1024
    v_mfma_f32_16x16x32_bf16 v[220:223], a[52:55], a[120:123], v[220:223]
    v_mfma_f32_16x16x32_bf16 v[220:223], a[76:79], a[124:127], v[220:223]
    v_mfma_f32_16x16x32_bf16 v[88:91], a[56:59], a[120:123], v[88:91]
    v_mfma_f32_16x16x32_bf16 v[88:91], a[80:83], a[124:127], v[88:91]
    global_load_lds_dwordx4 v41, s[14:15] offset:2048
    v_mfma_f32_16x16x32_bf16 v[92:95], a[60:63], a[120:123], v[92:95]
    v_mfma_f32_16x16x32_bf16 v[92:95], a[84:87], a[124:127], v[92:95]
    v_mfma_f32_16x16x32_bf16 v[148:151], a[120:123], a[64:67], v[148:151]
    v_mfma_f32_16x16x32_bf16 v[148:151], a[124:127], a[88:91], v[148:151]
    s_add_u32 m0, s47, 0
    v_mfma_f32_16x16x32_bf16 v[156:159], a[120:123], a[68:71], v[156:159]
    global_load_lds_dwordx4 v32, s[12:13] offset:0
    v_mfma_f32_16x16x32_bf16 v[156:159], a[124:127], a[92:95], v[156:159]
    s_waitcnt lgkmcnt(2)
    v_mfma_f32_16x16x32_bf16 v[224:227], a[48:51], a[96:99], v[224:227]
    ds_read_b128 a[112:115], v48 offset:45056
    v_mfma_f32_16x16x32_bf16 v[224:227], a[72:75], a[100:103], v[224:227]
    ds_read_b128 a[116:119], v49 offset:45056
    v_mfma_f32_16x16x32_bf16 v[228:231], a[52:55], a[96:99], v[228:231]
    global_load_lds_dwordx4 v33, s[12:13] offset:1024
    v_mfma_f32_16x16x32_bf16 v[228:231], a[76:79], a[100:103], v[228:231]
    v_mfma_f32_16x16x32_bf16 v[96:99], a[56:59], a[96:99], v[96:99]
    v_mfma_f32_16x16x32_bf16 v[96:99], a[80:83], a[100:103], v[96:99]
    v_mfma_f32_16x16x32_bf16 v[100:103], a[60:63], a[96:99], v[100:103]
    v_mfma_f32_16x16x32_bf16 v[100:103], a[84:87], a[100:103], v[100:103]
    global_load_lds_dwordx4 v34, s[12:13] offset:2048
    v_mfma_f32_16x16x32_bf16 v[160:163], a[96:99], a[64:67], v[160:163]
    v_mfma_f32_16x16x32_bf16 v[160:163], a[100:103], a[88:91], v[160:163]
    v_mfma_f32_16x16x32_bf16 v[168:171], a[96:99], a[68:71], v[168:171]
    v_mfma_f32_16x16x32_bf16 v[168:171], a[100:103], a[92:95], v[168:171]
    s_waitcnt lgkmcnt(2)
    global_load_lds_dwordx4 v35, s[12:13] offset:3072
    v_mfma_f32_16x16x32_bf16 v[232:235], a[48:51], a[104:107], v[232:235]
    s_lshl_b32 s30, s24, 10
    ds_read_b128 a[120:123], v48 offset:47104
    v_mfma_f32_16x16x32_bf16 v[232:235], a[72:75], a[108:111], v[232:235]
    s_lshl_b32 s6, s27, 15
    ds_read_b128 a[124:127], v49 offset:47104
    v_mfma_f32_16x16x32_bf16 v[236:239], a[52:55], a[104:107], v[236:239]
    s_lshl_b32 s33, s26, 1
    v_mfma_f32_16x16x32_bf16 v[236:239], a[76:79], a[108:111], v[236:239]
    s_add_u32 s33, s33, 1
    global_load_dword v45, v44, s[98:99]
    v_mfma_f32_16x16x32_bf16 v[104:107], a[56:59], a[104:107], v[104:107]
    s_sub_u32 s33, s33, s62
    v_mfma_f32_16x16x32_bf16 v[104:107], a[80:83], a[108:111], v[104:107]
    s_lshl_b32 s34, s33, 11
    s_waitcnt vmcnt(15)
    s_barrier
    v_mfma_f32_16x16x32_bf16 v[108:111], a[60:63], a[104:107], v[108:111]
    s_lshl_b32 s53, s63, 16
    ds_read_b64_tr_b16 a[8:9], v42 offset:1024
    v_mfma_f32_16x16x32_bf16 v[108:111], a[84:87], a[108:111], v[108:111]
    s_add_u32 s53, s53, s34
    ds_read_b64_tr_b16 a[10:11], v42 offset:1536
    global_load_dword v45, v13, s[100:101]
    v_mfma_f32_16x16x32_bf16 v[164:167], a[104:107], a[64:67], v[164:167]
    s_add_u32 s53, s53, 0x1c00000
    ds_read_b64_tr_b16 a[32:33], v42 offset:13312
    v_mfma_f32_16x16x32_bf16 v[164:167], a[108:111], a[88:91], v[164:167]
    s_lshl_b32 s33, s33, 18
    ds_read_b64_tr_b16 a[34:35], v42 offset:13824
    v_mfma_f32_16x16x32_bf16 v[172:175], a[104:107], a[68:71], v[172:175]
    s_and_b32 s34, s24, 2
    ds_read_b64_tr_b16 a[12:13], v43 offset:1024
    v_mfma_f32_16x16x32_bf16 v[172:175], a[108:111], a[92:95], v[172:175]
    s_waitcnt lgkmcnt(7)
    ds_read_b64_tr_b16 a[14:15], v43 offset:1536
    v_mfma_f32_16x16x32_bf16 v[240:243], a[48:51], a[112:115], v[240:243]
    s_lshl_b32 s34, s34, 13
    ds_read_b128 a[96:99], v50 offset:8192
    v_mfma_f32_16x16x32_bf16 v[240:243], a[72:75], a[116:119], v[240:243]
    s_add_u32 s33, s33, s34
    ds_read_b128 a[100:103], v51 offset:8192
    v_mfma_f32_16x16x32_bf16 v[244:247], a[52:55], a[112:115], v[244:247]
    s_add_u32 s33, s33, 0x801000
    ds_read_b64_tr_b16 a[36:37], v43 offset:13312
    v_mfma_f32_16x16x32_bf16 v[244:247], a[76:79], a[116:119], v[244:247]
    s_add_u32 s4, s8, s33
    ds_read_b64_tr_b16 a[38:39], v43 offset:13824
    v_mfma_f32_16x16x32_bf16 v[112:115], a[56:59], a[112:115], v[112:115]
    s_addc_u32 s5, s9, 0
    ds_read_b64_tr_b16 a[16:17], v42 offset:2048
    v_mfma_f32_16x16x32_bf16 v[112:115], a[80:83], a[116:119], v[112:115]
    s_xor_b32 s31, s49, 0x200000
    ds_read_b64_tr_b16 a[18:19], v42 offset:2560
    v_mfma_f32_16x16x32_bf16 v[116:119], a[60:63], a[112:115], v[116:119]
    s_andn2_b32 s33, s31, 0x3000
    ds_read_b64_tr_b16 a[40:41], v42 offset:14336
    v_mfma_f32_16x16x32_bf16 v[116:119], a[84:87], a[116:119], v[116:119]
    s_and_b32 s34, s63, 7
    ds_read_b64_tr_b16 a[42:43], v42 offset:14848
    v_mfma_f32_16x16x32_bf16 v[176:179], a[112:115], a[64:67], v[176:179]
    s_lshl_b32 s34, s34, 11
    ds_read_b64_tr_b16 a[20:21], v43 offset:2048
    v_mfma_f32_16x16x32_bf16 v[176:179], a[116:119], a[88:91], v[176:179]
    s_or_b32 s33, s33, s34
    ds_read_b64_tr_b16 a[22:23], v43 offset:2560
    v_mfma_f32_16x16x32_bf16 v[184:187], a[112:115], a[68:71], v[184:187]
    ds_read_b64_tr_b16 a[44:45], v43 offset:14336
    v_mfma_f32_16x16x32_bf16 v[184:187], a[116:119], a[92:95], v[184:187]
    s_waitcnt lgkmcnt(14)
    ds_read_b64_tr_b16 a[46:47], v43 offset:14848
    v_mfma_f32_16x16x32_bf16 v[248:251], a[48:51], a[120:123], v[248:251]
    s_cmp_eq_u32 s62, 0
    ds_read_b128 a[104:107], v50 offset:10240
    v_mfma_f32_16x16x32_bf16 v[248:251], a[72:75], a[124:127], v[248:251]
    s_cselect_b32 s31, s33, s31
    ds_read_b128 a[108:111], v51 offset:10240
    v_mfma_f32_16x16x32_bf16 v[252:255], a[52:55], a[120:123], v[252:255]
    s_mov_b64 s[16:17], s[40:41]
    ds_read_b64_tr_b16 a[0:1], v42 offset:0
    v_mfma_f32_16x16x32_bf16 v[252:255], a[76:79], a[124:127], v[252:255]
    s_mov_b32 s18, 0x800000
    ds_read_b64_tr_b16 a[2:3], v42 offset:512
    v_mfma_f32_16x16x32_bf16 v[120:123], a[56:59], a[120:123], v[120:123]
    s_mov_b32 s19, 0x00020000
    ds_read_b64_tr_b16 a[24:25], v42 offset:12288
    v_mfma_f32_16x16x32_bf16 v[120:123], a[80:83], a[124:127], v[120:123]
    s_andn2_b32 s36, s48, 0x7000
    ds_read_b64_tr_b16 a[26:27], v42 offset:12800
    v_mfma_f32_16x16x32_bf16 v[124:127], a[60:63], a[120:123], v[124:127]
    s_and_b32 s33, s24, 2
    ds_read_b64_tr_b16 a[4:5], v43 offset:0
    v_mfma_f32_16x16x32_bf16 v[124:127], a[84:87], a[124:127], v[124:127]
    s_lshl_b32 s34, s33, 13
    ds_read_b64_tr_b16 a[6:7], v43 offset:512
    v_mfma_f32_16x16x32_bf16 v[180:183], a[120:123], a[64:67], v[180:183]
    s_add_u32 s36, s36, s34
    ds_read_b64_tr_b16 a[28:29], v43 offset:12288
    v_mfma_f32_16x16x32_bf16 v[180:183], a[124:127], a[88:91], v[180:183]
    s_or_b32 s34, s33, s62
    ds_read_b64_tr_b16 a[30:31], v43 offset:12800
    v_mfma_f32_16x16x32_bf16 v[188:191], a[120:123], a[68:71], v[188:191]
    s_cmp_eq_u32 s34, 2
    v_mfma_f32_16x16x32_bf16 v[188:191], a[124:127], a[92:95], v[188:191]
    s_cselect_b32 s37, s36, 0x80000000
    s_waitcnt lgkmcnt(0)
    s_barrier
    v_mfma_f32_16x16x32_bf16 v[96:99], a[8:11], a[96:99], v[96:99]
    s_cmp_eq_u32 s34, 0
    ds_read_b128 a[112:115], v50 offset:12288
    v_mfma_f32_16x16x32_bf16 v[96:99], a[32:35], a[100:103], v[96:99]
    s_cselect_b32 s36, 0x80000000, s36
    ds_read_b128 a[116:119], v51 offset:12288
    v_mfma_f32_16x16x32_bf16 v[100:103], a[12:15], a[96:99], v[100:103]
    s_andn2_b32 s38, s49, 0x1000
    v_mfma_f32_16x16x32_bf16 v[100:103], a[36:39], a[100:103], v[100:103]
    s_and_b32 s34, s24, s62
    v_mfma_f32_16x16x32_bf16 v[160:163], a[96:99], a[16:19], v[160:163]
    s_cmp_eq_u32 s34, 1
    v_mfma_f32_16x16x32_bf16 v[160:163], a[100:103], a[40:43], v[160:163]
    s_cselect_b32 s38, s38, 0x80000000
    s_waitcnt vmcnt(2)
    s_barrier
    v_mfma_f32_16x16x32_bf16 v[168:171], a[96:99], a[20:23], v[168:171]
    s_add_u32 s39, s38, 4096
    ds_read_b64_tr_b16 a[56:57], v42 offset:25600
    v_mfma_f32_16x16x32_bf16 v[168:171], a[100:103], a[44:47], v[168:171]
    ds_read_b64_tr_b16 a[58:59], v42 offset:26112
    v_mfma_f32_16x16x32_bf16 v[104:107], a[8:11], a[104:107], v[104:107]
    s_min_u32 s33, s27, 1
    ds_read_b128 a[120:123], v50 offset:14336
    v_mfma_f32_16x16x32_bf16 v[104:107], a[32:35], a[108:111], v[104:107]
    s_lshl_b32 s33, s33, 12
    ds_read_b128 a[124:127], v51 offset:14336
    v_mfma_f32_16x16x32_bf16 v[108:111], a[12:15], a[104:107], v[108:111]
    s_sub_u32 s33, s54, s33
    ds_read_b64_tr_b16 a[80:81], v42 offset:37888
    v_mfma_f32_16x16x32_bf16 v[108:111], a[36:39], a[108:111], v[108:111]
    s_bitset1_b32 s33, 11
    ds_read_b64_tr_b16 a[82:83], v42 offset:38400
    v_mfma_f32_16x16x32_bf16 v[164:167], a[104:107], a[16:19], v[164:167]
    ds_read_b64_tr_b16 a[60:61], v43 offset:25600
    v_mov_b32 v4, s33
    v_mfma_f32_16x16x32_bf16 v[164:167], a[108:111], a[40:43], v[164:167]
    ds_read_b64_tr_b16 a[62:63], v43 offset:26112
    v_mfma_f32_16x16x32_bf16 v[172:175], a[104:107], a[20:23], v[172:175]
    ds_read_b64_tr_b16 a[84:85], v43 offset:37888
    v_mfma_f32_16x16x32_bf16 v[172:175], a[108:111], a[44:47], v[172:175]
    s_waitcnt lgkmcnt(9)
    ds_read_b64_tr_b16 a[86:87], v43 offset:38400
    v_mfma_f32_16x16x32_bf16 v[112:115], a[8:11], a[112:115], v[112:115]
    ds_read_b128 a[96:99], v50 offset:0
    v_mfma_f32_16x16x32_bf16 v[112:115], a[32:35], a[116:119], v[112:115]
    ds_read_b128 a[100:103], v51 offset:0
    v_mfma_f32_16x16x32_bf16 v[116:119], a[12:15], a[112:115], v[116:119]
    ds_read_b64_tr_b16 a[64:65], v42 offset:26624
    v_mfma_f32_16x16x32_bf16 v[116:119], a[36:39], a[116:119], v[116:119]
    ds_read_b64_tr_b16 a[66:67], v42 offset:27136
    v_mfma_f32_16x16x32_bf16 v[176:179], a[112:115], a[16:19], v[176:179]
    ds_read_b64_tr_b16 a[88:89], v42 offset:38912
    v_mfma_f32_16x16x32_bf16 v[176:179], a[116:119], a[40:43], v[176:179]
    ds_read_b64_tr_b16 a[90:91], v42 offset:39424
    v_mfma_f32_16x16x32_bf16 v[184:187], a[112:115], a[20:23], v[184:187]
hook5:
    s_cbranch_execz hook18
    ds_read_b64_tr_b16 a[68:69], v43 offset:26624
    v_mfma_f32_16x16x32_bf16 v[184:187], a[116:119], a[44:47], v[184:187]
    s_waitcnt lgkmcnt(13)
    ds_read_b64_tr_b16 a[70:71], v43 offset:27136
    v_mfma_f32_16x16x32_bf16 v[120:123], a[8:11], a[120:123], v[120:123]
    ds_read_b128 a[104:107], v48 offset:0
    v_mfma_f32_16x16x32_bf16 v[120:123], a[32:35], a[124:127], v[120:123]
    ds_read_b128 a[108:111], v49 offset:0
    v_mfma_f32_16x16x32_bf16 v[124:127], a[12:15], a[120:123], v[124:127]
    ds_read_b64_tr_b16 a[92:93], v43 offset:38912
    v_mfma_f32_16x16x32_bf16 v[124:127], a[36:39], a[124:127], v[124:127]
    ds_read_b64_tr_b16 a[94:95], v43 offset:39424
    v_mfma_f32_16x16x32_bf16 v[180:183], a[120:123], a[16:19], v[180:183]
    ds_read_b64_tr_b16 a[48:49], v42 offset:24576
    v_mfma_f32_16x16x32_bf16 v[180:183], a[124:127], a[40:43], v[180:183]
    ds_read_b64_tr_b16 a[50:51], v42 offset:25088
    v_mfma_f32_16x16x32_bf16 v[188:191], a[120:123], a[20:23], v[188:191]
    ds_read_b64_tr_b16 a[72:73], v42 offset:36864
    v_mfma_f32_16x16x32_bf16 v[188:191], a[124:127], a[44:47], v[188:191]
    s_waitcnt lgkmcnt(13)
    ds_read_b64_tr_b16 a[74:75], v42 offset:37376
    v_mfma_f32_16x16x32_bf16 v[64:67], a[8:11], a[96:99], v[64:67]
    ds_read_b128 a[112:115], v50 offset:2048
    v_mfma_f32_16x16x32_bf16 v[64:67], a[32:35], a[100:103], v[64:67]
    ds_read_b128 a[116:119], v51 offset:2048
    v_mfma_f32_16x16x32_bf16 v[68:71], a[12:15], a[96:99], v[68:71]
    ds_read_b64_tr_b16 a[52:53], v43 offset:24576
    v_mfma_f32_16x16x32_bf16 v[68:71], a[36:39], a[100:103], v[68:71]
    ds_read_b64_tr_b16 a[54:55], v43 offset:25088
    v_mfma_f32_16x16x32_bf16 v[128:131], a[96:99], a[16:19], v[128:131]
    ds_read_b64_tr_b16 a[76:77], v43 offset:36864
    v_mfma_f32_16x16x32_bf16 v[128:131], a[100:103], a[40:43], v[128:131]
    ds_read_b64_tr_b16 a[78:79], v43 offset:37376
    v_mfma_f32_16x16x32_bf16 v[136:139], a[96:99], a[20:23], v[136:139]
    v_mfma_f32_16x16x32_bf16 v[136:139], a[100:103], a[44:47], v[136:139]
    s_waitcnt lgkmcnt(0)
    s_barrier
    v_mfma_f32_16x16x32_bf16 v[64:67], a[56:59], a[104:107], v[64:67]
    ds_read_b128 a[120:123], v48 offset:2048
    v_mov_b64 v[28:29], 0
    v_mfma_f32_16x16x32_bf16 v[64:67], a[80:83], a[108:111], v[64:67]
    ds_read_b128 a[124:127], v49 offset:2048
    v_mov_b64 v[30:31], 0
    v_mfma_f32_16x16x32_bf16 v[68:71], a[60:63], a[104:107], v[68:71]
    v_mov_b64 v[32:33], 0
    v_mov_b64 v[34:35], 0
    v_mfma_f32_16x16x32_bf16 v[68:71], a[84:87], a[108:111], v[68:71]
    v_mov_b64 v[36:37], 0
    v_mov_b64 v[38:39], 0
    v_mfma_f32_16x16x32_bf16 v[128:131], a[104:107], a[64:67], v[128:131]
    v_mov_b64 v[40:41], 0
    v_mov_b64 v[42:43], 0
    v_mfma_f32_16x16x32_bf16 v[128:131], a[108:111], a[88:91], v[128:131]
    v_cvt_pk_bf16_f32 v64, v64, v65
    v_cvt_pk_bf16_f32 v65, v66, v67
    v_mfma_f32_16x16x32_bf16 v[136:139], a[104:107], a[68:71], v[136:139]
    s_nop 0
    v_mfma_f32_16x16x32_bf16 v[136:139], a[108:111], a[92:95], v[136:139]
    v_cvt_pk_bf16_f32 v66, v68, v69
    v_cvt_pk_bf16_f32 v67, v70, v71
    v_mfma_f32_16x16x32_bf16 v[72:75], a[8:11], a[112:115], v[72:75]
    ds_read_b128 a[96:99], v50 offset:4096
    buffer_store_dwordx4 v[64:67], v3, s[20:23], s36 offen offset:0 sc1
    v_mfma_f32_16x16x32_bf16 v[72:75], a[32:35], a[116:119], v[72:75]
    ds_read_b128 a[100:103], v51 offset:4096
    v_cvt_pk_bf16_f32 v128, v128, v129
    v_mfma_f32_16x16x32_bf16 v[76:79], a[12:15], a[112:115], v[76:79]
    v_cvt_pk_bf16_f32 v129, v130, v131
    v_mfma_f32_16x16x32_bf16 v[76:79], a[36:39], a[116:119], v[76:79]
    v_cvt_pk_bf16_f32 v136, v136, v137
    v_cvt_pk_bf16_f32 v137, v138, v139
    v_mfma_f32_16x16x32_bf16 v[132:135], a[112:115], a[16:19], v[132:135]
    ds_write_b128 v53, v[64:67] offset:0
    v_mfma_f32_16x16x32_bf16 v[132:135], a[116:119], a[40:43], v[132:135]
    s_nop 0
    v_mfma_f32_16x16x32_bf16 v[140:143], a[112:115], a[20:23], v[140:143]
    s_nop 0
    v_mfma_f32_16x16x32_bf16 v[140:143], a[116:119], a[44:47], v[140:143]
    s_waitcnt lgkmcnt(3)
    v_mfma_f32_16x16x32_bf16 v[72:75], a[56:59], a[120:123], v[72:75]
    ds_read_b128 a[104:107], v48 offset:4096
    v_mfma_f32_16x16x32_bf16 v[72:75], a[80:83], a[124:127], v[72:75]
    ds_read_b128 a[108:111], v49 offset:4096
    v_mfma_f32_16x16x32_bf16 v[76:79], a[60:63], a[120:123], v[76:79]
    s_nop 0
    v_mfma_f32_16x16x32_bf16 v[76:79], a[84:87], a[124:127], v[76:79]
    s_nop 0
    v_mfma_f32_16x16x32_bf16 v[132:135], a[120:123], a[64:67], v[132:135]
    s_nop 0
    v_mfma_f32_16x16x32_bf16 v[132:135], a[124:127], a[88:91], v[132:135]
    v_cvt_pk_bf16_f32 v72, v72, v73
    v_cvt_pk_bf16_f32 v73, v74, v75
    v_mfma_f32_16x16x32_bf16 v[140:143], a[120:123], a[68:71], v[140:143]
    s_nop 0
    v_mfma_f32_16x16x32_bf16 v[140:143], a[124:127], a[92:95], v[140:143]
    s_waitcnt lgkmcnt(3)
    v_cvt_pk_bf16_f32 v74, v76, v77
    v_cvt_pk_bf16_f32 v75, v78, v79
    v_mfma_f32_16x16x32_bf16 v[80:83], a[8:11], a[96:99], v[80:83]
    ds_read_b128 a[112:115], v50 offset:6144
    buffer_store_dwordx4 v[72:75], v3, s[20:23], s36 offen offset:256 sc1
    v_mfma_f32_16x16x32_bf16 v[80:83], a[32:35], a[100:103], v[80:83]
    ds_read_b128 a[116:119], v51 offset:6144
    v_cvt_pk_bf16_f32 v130, v132, v133
    v_mfma_f32_16x16x32_bf16 v[84:87], a[12:15], a[96:99], v[84:87]
    v_cvt_pk_bf16_f32 v131, v134, v135
    v_mfma_f32_16x16x32_bf16 v[84:87], a[36:39], a[100:103], v[84:87]
    buffer_store_dwordx4 v[128:131], v3, s[20:23], s36 offen offset:2048 sc1
    v_mfma_f32_16x16x32_bf16 v[144:147], a[96:99], a[16:19], v[144:147]
    v_cvt_pk_bf16_f32 v138, v140, v141
    v_cvt_pk_bf16_f32 v139, v142, v143
    v_mfma_f32_16x16x32_bf16 v[144:147], a[100:103], a[40:43], v[144:147]
    buffer_store_dwordx4 v[136:139], v3, s[20:23], s36 offen offset:2304 sc1
    v_mfma_f32_16x16x32_bf16 v[152:155], a[96:99], a[20:23], v[152:155]
    ds_write_b128 v53, v[72:75] offset:256
    v_mfma_f32_16x16x32_bf16 v[152:155], a[100:103], a[44:47], v[152:155]
    s_waitcnt lgkmcnt(3)
    v_mfma_f32_16x16x32_bf16 v[80:83], a[56:59], a[104:107], v[80:83]
    ds_read_b128 a[120:123], v48 offset:6144
    v_mfma_f32_16x16x32_bf16 v[80:83], a[80:83], a[108:111], v[80:83]
    ds_read_b128 a[124:127], v49 offset:6144
    v_mfma_f32_16x16x32_bf16 v[84:87], a[60:63], a[104:107], v[84:87]
    ds_write_b128 v53, v[128:131] offset:2048
    v_mfma_f32_16x16x32_bf16 v[84:87], a[84:87], a[108:111], v[84:87]
    s_nop 0
    v_mfma_f32_16x16x32_bf16 v[144:147], a[104:107], a[64:67], v[144:147]
    ds_write_b128 v53, v[136:139] offset:2304
    v_mfma_f32_16x16x32_bf16 v[144:147], a[108:111], a[88:91], v[144:147]
    v_cvt_pk_bf16_f32 v80, v80, v81
    v_cvt_pk_bf16_f32 v81, v82, v83
    v_mfma_f32_16x16x32_bf16 v[152:155], a[104:107], a[68:71], v[152:155]
    s_nop 0
    v_mfma_f32_16x16x32_bf16 v[152:155], a[108:111], a[92:95], v[152:155]
    s_waitcnt lgkmcnt(5)
    v_cvt_pk_bf16_f32 v82, v84, v85
    v_cvt_pk_bf16_f32 v83, v86, v87
    v_mfma_f32_16x16x32_bf16 v[88:91], a[8:11], a[112:115], v[88:91]
    s_add_u32 s57, s37, 4096
    ds_read_b128 a[96:99], v48 offset:8192
    buffer_store_dwordx4 v[80:83], v3, s[20:23], s57 offen offset:0 sc1
    v_mfma_f32_16x16x32_bf16 v[88:91], a[32:35], a[116:119], v[88:91]
    ds_read_b128 a[100:103], v49 offset:8192
    v_cvt_pk_bf16_f32 v144, v144, v145
    v_mfma_f32_16x16x32_bf16 v[92:95], a[12:15], a[112:115], v[92:95]
    v_cvt_pk_bf16_f32 v145, v146, v147
    v_mfma_f32_16x16x32_bf16 v[92:95], a[36:39], a[116:119], v[92:95]
    v_cvt_pk_bf16_f32 v152, v152, v153
    v_cvt_pk_bf16_f32 v153, v154, v155
    v_mfma_f32_16x16x32_bf16 v[148:151], a[112:115], a[16:19], v[148:151]
    ds_write_b128 v53, v[80:83] offset:8192
    v_mfma_f32_16x16x32_bf16 v[148:151], a[116:119], a[40:43], v[148:151]
    s_nop 0
    v_mfma_f32_16x16x32_bf16 v[156:159], a[112:115], a[20:23], v[156:159]
    s_nop 0
    v_mfma_f32_16x16x32_bf16 v[156:159], a[116:119], a[44:47], v[156:159]
    s_waitcnt lgkmcnt(5)
    v_mfma_f32_16x16x32_bf16 v[88:91], a[56:59], a[120:123], v[88:91]
    ds_read_b128 a[104:107], v48 offset:10240
    v_mfma_f32_16x16x32_bf16 v[88:91], a[80:83], a[124:127], v[88:91]
    ds_read_b128 a[108:111], v49 offset:10240
    v_mfma_f32_16x16x32_bf16 v[92:95], a[60:63], a[120:123], v[92:95]
    s_nop 0
    v_mfma_f32_16x16x32_bf16 v[92:95], a[84:87], a[124:127], v[92:95]
    s_nop 0
    v_mfma_f32_16x16x32_bf16 v[148:151], a[120:123], a[64:67], v[148:151]
    s_nop 0
    v_mfma_f32_16x16x32_bf16 v[148:151], a[124:127], a[88:91], v[148:151]
    v_cvt_pk_bf16_f32 v88, v88, v89
    v_cvt_pk_bf16_f32 v89, v90, v91
    v_mfma_f32_16x16x32_bf16 v[156:159], a[120:123], a[68:71], v[156:159]
    s_nop 0
    v_mfma_f32_16x16x32_bf16 v[156:159], a[124:127], a[92:95], v[156:159]
    s_waitcnt lgkmcnt(3)
    v_cvt_pk_bf16_f32 v90, v92, v93
    v_cvt_pk_bf16_f32 v91, v94, v95
    v_mfma_f32_16x16x32_bf16 v[96:99], a[56:59], a[96:99], v[96:99]
    ds_read_b128 a[112:115], v48 offset:12288
    buffer_store_dwordx4 v[88:91], v3, s[20:23], s57 offen offset:256 sc1
    v_mfma_f32_16x16x32_bf16 v[96:99], a[80:83], a[100:103], v[96:99]
    ds_read_b128 a[116:119], v49 offset:12288
    v_cvt_pk_bf16_f32 v146, v148, v149
    v_mfma_f32_16x16x32_bf16 v[100:103], a[60:63], a[96:99], v[100:103]
    v_cvt_pk_bf16_f32 v147, v150, v151
    v_mfma_f32_16x16x32_bf16 v[100:103], a[84:87], a[100:103], v[100:103]
    buffer_store_dwordx4 v[144:147], v3, s[20:23], s57 offen offset:2048 sc1
    v_mfma_f32_16x16x32_bf16 v[160:163], a[96:99], a[64:67], v[160:163]
    v_cvt_pk_bf16_f32 v154, v156, v157
    v_cvt_pk_bf16_f32 v155, v158, v159
    v_mfma_f32_16x16x32_bf16 v[160:163], a[100:103], a[88:91], v[160:163]
    buffer_store_dwordx4 v[152:155], v3, s[20:23], s57 offen offset:2304 sc1
    v_mfma_f32_16x16x32_bf16 v[168:171], a[96:99], a[68:71], v[168:171]
    v_cvt_pk_bf16_f32 v96, v96, v97
    v_cvt_pk_bf16_f32 v97, v98, v99
    v_mfma_f32_16x16x32_bf16 v[168:171], a[100:103], a[92:95], v[168:171]
    s_waitcnt lgkmcnt(2)
    v_cvt_pk_bf16_f32 v98, v100, v101
    v_cvt_pk_bf16_f32 v99, v102, v103
    v_mfma_f32_16x16x32_bf16 v[104:107], a[56:59], a[104:107], v[104:107]
    s_add_u32 s57, s37, 8192
    ds_read_b128 a[120:123], v48 offset:14336
    buffer_store_dwordx4 v[96:99], v3, s[20:23], s57 offen offset:0 sc1
    v_mfma_f32_16x16x32_bf16 v[104:107], a[80:83], a[108:111], v[104:107]
    ds_read_b128 a[124:127], v49 offset:14336
    v_cvt_pk_bf16_f32 v160, v160, v161
    v_mfma_f32_16x16x32_bf16 v[108:111], a[60:63], a[104:107], v[108:111]
    ds_read_b128 a[96:99], v50 offset:0
    v_cvt_pk_bf16_f32 v161, v162, v163
    v_mfma_f32_16x16x32_bf16 v[108:111], a[84:87], a[108:111], v[108:111]
    ds_read_b128 a[100:103], v51 offset:0
    v_cvt_pk_bf16_f32 v168, v168, v169
    v_mfma_f32_16x16x32_bf16 v[164:167], a[104:107], a[64:67], v[164:167]
    v_cvt_pk_bf16_f32 v169, v170, v171
    v_mfma_f32_16x16x32_bf16 v[164:167], a[108:111], a[88:91], v[164:167]
    v_cvt_pk_bf16_f32 v104, v104, v105
    v_cvt_pk_bf16_f32 v105, v106, v107
    v_mfma_f32_16x16x32_bf16 v[172:175], a[104:107], a[68:71], v[172:175]
    ds_write_b128 v53, v[88:91] offset:8448
    v_mfma_f32_16x16x32_bf16 v[172:175], a[108:111], a[92:95], v[172:175]
    s_waitcnt lgkmcnt(5)
    v_cvt_pk_bf16_f32 v106, v108, v109
    v_cvt_pk_bf16_f32 v107, v110, v111
    v_mfma_f32_16x16x32_bf16 v[112:115], a[56:59], a[112:115], v[112:115]
    ds_read_b128 a[104:107], v48 offset:0
    buffer_store_dwordx4 v[104:107], v3, s[20:23], s57 offen offset:256 sc1
    v_mfma_f32_16x16x32_bf16 v[112:115], a[80:83], a[116:119], v[112:115]
    ds_read_b128 a[108:111], v49 offset:0
    v_cvt_pk_bf16_f32 v162, v164, v165
    v_mfma_f32_16x16x32_bf16 v[116:119], a[60:63], a[112:115], v[116:119]
    v_cvt_pk_bf16_f32 v163, v166, v167
    v_mfma_f32_16x16x32_bf16 v[116:119], a[84:87], a[116:119], v[116:119]
    buffer_store_dwordx4 v[160:163], v3, s[20:23], s57 offen offset:2048 sc1
    v_mfma_f32_16x16x32_bf16 v[176:179], a[112:115], a[64:67], v[176:179]
    v_cvt_pk_bf16_f32 v170, v172, v173
    v_cvt_pk_bf16_f32 v171, v174, v175
    v_mfma_f32_16x16x32_bf16 v[176:179], a[116:119], a[88:91], v[176:179]
    buffer_store_dwordx4 v[168:171], v3, s[20:23], s57 offen offset:2304 sc1
    v_mfma_f32_16x16x32_bf16 v[184:187], a[112:115], a[68:71], v[184:187]
    v_cvt_pk_bf16_f32 v112, v112, v113
    v_cvt_pk_bf16_f32 v113, v114, v115
    v_mfma_f32_16x16x32_bf16 v[184:187], a[116:119], a[92:95], v[184:187]
    s_waitcnt lgkmcnt(5)
    v_cvt_pk_bf16_f32 v114, v116, v117
    v_cvt_pk_bf16_f32 v115, v118, v119
    v_mfma_f32_16x16x32_bf16 v[120:123], a[56:59], a[120:123], v[120:123]
    s_add_u32 s57, s37, 12288
    ds_read_b128 a[112:115], v50 offset:2048
    buffer_store_dwordx4 v[112:115], v3, s[20:23], s57 offen offset:0 sc1
    v_mfma_f32_16x16x32_bf16 v[120:123], a[80:83], a[124:127], v[120:123]
    ds_read_b128 a[116:119], v51 offset:2048
    v_cvt_pk_bf16_f32 v176, v176, v177
    v_mfma_f32_16x16x32_bf16 v[124:127], a[60:63], a[120:123], v[124:127]
    v_cvt_pk_bf16_f32 v177, v178, v179
    v_mfma_f32_16x16x32_bf16 v[124:127], a[84:87], a[124:127], v[124:127]
    v_cvt_pk_bf16_f32 v184, v184, v185
    v_cvt_pk_bf16_f32 v185, v186, v187
    v_mfma_f32_16x16x32_bf16 v[180:183], a[120:123], a[64:67], v[180:183]
    ds_write_b128 v53, v[144:147] offset:10240
    v_mfma_f32_16x16x32_bf16 v[180:183], a[124:127], a[88:91], v[180:183]
    v_cvt_pk_bf16_f32 v120, v120, v121
    v_cvt_pk_bf16_f32 v121, v122, v123
    v_mfma_f32_16x16x32_bf16 v[188:191], a[120:123], a[68:71], v[188:191]
    ds_write_b128 v53, v[152:155] offset:10496
    v_mfma_f32_16x16x32_bf16 v[188:191], a[124:127], a[92:95], v[188:191]
    s_waitcnt lgkmcnt(7)
    v_cvt_pk_bf16_f32 v122, v124, v125
    v_cvt_pk_bf16_f32 v123, v126, v127
    v_mfma_f32_16x16x32_bf16 v[192:195], a[0:3], a[96:99], v[192:195]
    ds_read_b128 a[120:123], v48 offset:2048
    buffer_store_dwordx4 v[120:123], v3, s[20:23], s57 offen offset:256 sc1
    v_mfma_f32_16x16x32_bf16 v[192:195], a[24:27], a[100:103], v[192:195]
    ds_read_b128 a[124:127], v49 offset:2048
    v_cvt_pk_bf16_f32 v178, v180, v181
    v_mfma_f32_16x16x32_bf16 v[196:199], a[4:7], a[96:99], v[196:199]
    v_cvt_pk_bf16_f32 v179, v182, v183
    v_mfma_f32_16x16x32_bf16 v[196:199], a[28:31], a[100:103], v[196:199]
    s_waitcnt lgkmcnt(6)
    buffer_store_dwordx4 v[176:179], v3, s[20:23], s57 offen offset:2048 sc1
    v_mfma_f32_16x16x32_bf16 v[192:195], a[48:51], a[104:107], v[192:195]
    ds_read_b128 a[96:99], v50 offset:4096
    v_cvt_pk_bf16_f32 v186, v188, v189
    v_mfma_f32_16x16x32_bf16 v[192:195], a[72:75], a[108:111], v[192:195]
    ds_read_b128 a[100:103], v51 offset:4096
    v_cvt_pk_bf16_f32 v187, v190, v191
    v_mfma_f32_16x16x32_bf16 v[196:199], a[52:55], a[104:107], v[196:199]
    buffer_store_dwordx4 v[184:187], v3, s[20:23], s57 offen offset:2304 sc1
    v_mfma_f32_16x16x32_bf16 v[196:199], a[76:79], a[108:111], v[196:199]
    s_waitcnt lgkmcnt(6)
    ds_write_b128 v53, v[96:99] offset:16384
    v_mfma_f32_16x16x32_bf16 v[200:203], a[0:3], a[112:115], v[200:203]
    ds_read_b128 a[104:107], v48 offset:4096
    v_mfma_f32_16x16x32_bf16 v[200:203], a[24:27], a[116:119], v[200:203]
    ds_read_b128 a[108:111], v49 offset:4096
    v_mul_f32 v192, s32, v192
    v_mfma_f32_16x16x32_bf16 v[204:207], a[4:7], a[112:115], v[204:207]
    ds_write_b128 v53, v[104:107] offset:16640
    v_mfma_f32_16x16x32_bf16 v[204:207], a[28:31], a[116:119], v[204:207]
    s_waitcnt lgkmcnt(6)
    v_mul_f32 v193, s32, v193
    v_mul_f32 v194, s32, v194
    v_mfma_f32_16x16x32_bf16 v[200:203], a[48:51], a[120:123], v[200:203]
    ds_read_b128 a[112:115], v50 offset:6144
    v_mul_f32 v195, s32, v195
    v_mfma_f32_16x16x32_bf16 v[200:203], a[72:75], a[124:127], v[200:203]
    ds_read_b128 a[116:119], v51 offset:6144
    v_cvt_pk_bf16_f32 v192, v192, v193
    v_mfma_f32_16x16x32_bf16 v[204:207], a[52:55], a[120:123], v[204:207]
    ds_write_b128 v53, v[160:163] offset:18432
    v_mfma_f32_16x16x32_bf16 v[204:207], a[76:79], a[124:127], v[204:207]
    s_waitcnt lgkmcnt(7)
    v_cvt_pk_bf16_f32 v193, v194, v195
    v_mul_f32 v196, s32, v196
    v_mfma_f32_16x16x32_bf16 v[208:211], a[0:3], a[96:99], v[208:211]
    ds_read_b128 a[120:123], v48 offset:6144
    v_mul_f32 v197, s32, v197
    v_mfma_f32_16x16x32_bf16 v[208:211], a[24:27], a[100:103], v[208:211]
    ds_read_b128 a[124:127], v49 offset:6144
    v_mul_f32 v198, s32, v198
    v_mfma_f32_16x16x32_bf16 v[212:215], a[4:7], a[96:99], v[212:215]
    ds_write_b128 v53, v[168:171] offset:18688
    v_mfma_f32_16x16x32_bf16 v[212:215], a[28:31], a[100:103], v[212:215]
    s_waitcnt lgkmcnt(7)
    v_mul_f32 v199, s32, v199
    v_cvt_pk_bf16_f32 v194, v196, v197
    v_mfma_f32_16x16x32_bf16 v[208:211], a[48:51], a[104:107], v[208:211]
    ds_read_b128 a[96:99], v50 offset:8192
    v_cvt_pk_bf16_f32 v195, v198, v199
    v_mfma_f32_16x16x32_bf16 v[208:211], a[72:75], a[108:111], v[208:211]
    ds_read_b128 a[100:103], v51 offset:8192
    buffer_store_dwordx4 v[192:195], v3, s[20:23], s38 offen offset:0 sc1
    v_mfma_f32_16x16x32_bf16 v[212:215], a[52:55], a[104:107], v[212:215]
    ds_write_b128 v53, v[112:115] offset:24576
    v_mfma_f32_16x16x32_bf16 v[212:215], a[76:79], a[108:111], v[212:215]
    s_waitcnt lgkmcnt(7)
    ds_write_b128 v54, v[192:195] offset:0
    v_mfma_f32_16x16x32_bf16 v[216:219], a[0:3], a[112:115], v[216:219]
    ds_read_b128 a[104:107], v48 offset:8192
    v_mul_f32 v200, s32, v200
    v_mfma_f32_16x16x32_bf16 v[216:219], a[24:27], a[116:119], v[216:219]
    ds_read_b128 a[108:111], v49 offset:8192
    v_mul_f32 v201, s32, v201
    v_mfma_f32_16x16x32_bf16 v[220:223], a[4:7], a[112:115], v[220:223]
    ds_write_b128 v53, v[120:123] offset:24832
    v_mfma_f32_16x16x32_bf16 v[220:223], a[28:31], a[116:119], v[220:223]
    s_waitcnt lgkmcnt(8)
    v_mul_f32 v202, s32, v202
    v_mul_f32 v203, s32, v203
    v_mfma_f32_16x16x32_bf16 v[216:219], a[48:51], a[120:123], v[216:219]
    ds_read_b128 a[112:115], v50 offset:10240
    v_cvt_pk_bf16_f32 v200, v200, v201
    v_mfma_f32_16x16x32_bf16 v[216:219], a[72:75], a[124:127], v[216:219]
    ds_read_b128 a[116:119], v51 offset:10240
    v_cvt_pk_bf16_f32 v201, v202, v203
    v_mfma_f32_16x16x32_bf16 v[220:223], a[52:55], a[120:123], v[220:223]
    ds_write_b128 v53, v[176:179] offset:26624
    v_mfma_f32_16x16x32_bf16 v[220:223], a[76:79], a[124:127], v[220:223]
    s_waitcnt lgkmcnt(8)
    v_mul_f32 v204, s32, v204
    v_mul_f32 v205, s32, v205
    v_mfma_f32_16x16x32_bf16 v[224:227], a[0:3], a[96:99], v[224:227]
    ds_read_b128 a[120:123], v48 offset:10240
    v_mul_f32 v206, s32, v206
    v_mfma_f32_16x16x32_bf16 v[224:227], a[24:27], a[100:103], v[224:227]
    ds_read_b128 a[124:127], v49 offset:10240
    v_mul_f32 v207, s32, v207
    v_mfma_f32_16x16x32_bf16 v[228:231], a[4:7], a[96:99], v[228:231]
    ds_write_b128 v53, v[184:187] offset:26880
    v_mfma_f32_16x16x32_bf16 v[228:231], a[28:31], a[100:103], v[228:231]
    s_waitcnt lgkmcnt(7)
    v_cvt_pk_bf16_f32 v202, v204, v205
    v_cvt_pk_bf16_f32 v203, v206, v207
    v_mfma_f32_16x16x32_bf16 v[224:227], a[48:51], a[104:107], v[224:227]
    ds_read_b128 a[96:99], v50 offset:12288
    buffer_store_dwordx4 v[200:203], v3, s[20:23], s38 offen offset:256 sc1
    v_mfma_f32_16x16x32_bf16 v[224:227], a[72:75], a[108:111], v[224:227]
    ds_read_b128 a[100:103], v51 offset:12288
    v_mfma_f32_16x16x32_bf16 v[228:231], a[52:55], a[104:107], v[228:231]
    ds_write_b128 v54, v[200:203] offset:256
    v_mfma_f32_16x16x32_bf16 v[228:231], a[76:79], a[108:111], v[228:231]
    s_waitcnt lgkmcnt(7)
    v_mul_f32 v208, s32, v208
    v_mul_f32 v209, s32, v209
    v_mfma_f32_16x16x32_bf16 v[232:235], a[0:3], a[112:115], v[232:235]
    ds_read_b128 a[104:107], v48 offset:12288
    v_mul_f32 v210, s32, v210
    v_mfma_f32_16x16x32_bf16 v[232:235], a[24:27], a[116:119], v[232:235]
    ds_read_b128 a[108:111], v49 offset:12288
    v_mul_f32 v211, s32, v211
    v_mfma_f32_16x16x32_bf16 v[236:239], a[4:7], a[112:115], v[236:239]
    v_cvt_pk_bf16_f32 v208, v208, v209
    v_cvt_pk_bf16_f32 v209, v210, v211
    v_mfma_f32_16x16x32_bf16 v[236:239], a[28:31], a[116:119], v[236:239]
    s_waitcnt lgkmcnt(6)
    v_mul_f32 v212, s32, v212
    v_mul_f32 v213, s32, v213
    v_mfma_f32_16x16x32_bf16 v[232:235], a[48:51], a[120:123], v[232:235]
    ds_read_b128 a[112:115], v50 offset:14336
    v_mul_f32 v214, s32, v214
    v_mfma_f32_16x16x32_bf16 v[232:235], a[72:75], a[124:127], v[232:235]
    ds_read_b128 a[116:119], v51 offset:14336
    v_mul_f32 v215, s32, v215
    v_mfma_f32_16x16x32_bf16 v[236:239], a[52:55], a[120:123], v[236:239]
    v_cvt_pk_bf16_f32 v210, v212, v213
    v_cvt_pk_bf16_f32 v211, v214, v215
    v_mfma_f32_16x16x32_bf16 v[236:239], a[76:79], a[124:127], v[236:239]
    s_waitcnt lgkmcnt(5)
    buffer_store_dwordx4 v[208:211], v3, s[20:23], s38 offen offset:2048 sc1
    v_mfma_f32_16x16x32_bf16 v[240:243], a[0:3], a[96:99], v[240:243]
    ds_read_b128 a[120:123], v48 offset:14336
    v_mfma_f32_16x16x32_bf16 v[240:243], a[24:27], a[100:103], v[240:243]
    ds_read_b128 a[124:127], v49 offset:14336
    v_mfma_f32_16x16x32_bf16 v[244:247], a[4:7], a[96:99], v[244:247]
    ds_write_b128 v54, v[208:211] offset:2048
    v_mfma_f32_16x16x32_bf16 v[244:247], a[28:31], a[100:103], v[244:247]
    s_waitcnt lgkmcnt(5)
    v_mul_f32 v216, s32, v216
    v_mul_f32 v217, s32, v217
    v_mfma_f32_16x16x32_bf16 v[240:243], a[48:51], a[104:107], v[240:243]
    v_mul_f32 v218, s32, v218
    v_mul_f32 v219, s32, v219
    v_mfma_f32_16x16x32_bf16 v[240:243], a[72:75], a[108:111], v[240:243]
    v_cvt_pk_bf16_f32 v216, v216, v217
    v_cvt_pk_bf16_f32 v217, v218, v219
    v_mfma_f32_16x16x32_bf16 v[244:247], a[52:55], a[104:107], v[244:247]
    v_mul_f32 v220, s32, v220
    v_mul_f32 v221, s32, v221
    v_mfma_f32_16x16x32_bf16 v[244:247], a[76:79], a[108:111], v[244:247]
    s_waitcnt lgkmcnt(3)
    v_mul_f32 v222, s32, v222
    v_mul_f32 v223, s32, v223
    v_mfma_f32_16x16x32_bf16 v[248:251], a[0:3], a[112:115], v[248:251]
    v_cvt_pk_bf16_f32 v218, v220, v221
    v_cvt_pk_bf16_f32 v219, v222, v223
    v_mfma_f32_16x16x32_bf16 v[248:251], a[24:27], a[116:119], v[248:251]
    buffer_store_dwordx4 v[216:219], v3, s[20:23], s38 offen offset:2304 sc1
    v_mfma_f32_16x16x32_bf16 v[252:255], a[4:7], a[112:115], v[252:255]
    ds_write_b128 v54, v[216:219] offset:2304
    v_mfma_f32_16x16x32_bf16 v[252:255], a[28:31], a[116:119], v[252:255]
    s_waitcnt lgkmcnt(2)
    v_mul_f32 v224, s32, v224
    v_mul_f32 v225, s32, v225
    v_mfma_f32_16x16x32_bf16 v[248:251], a[48:51], a[120:123], v[248:251]
    v_mul_f32 v226, s32, v226
    v_mul_f32 v227, s32, v227
    v_mfma_f32_16x16x32_bf16 v[248:251], a[72:75], a[124:127], v[248:251]
    v_cvt_pk_bf16_f32 v224, v224, v225
    v_cvt_pk_bf16_f32 v225, v226, v227
    v_mfma_f32_16x16x32_bf16 v[252:255], a[52:55], a[120:123], v[252:255]
    v_mul_f32 v228, s32, v228
    v_mul_f32 v229, s32, v229
    v_mfma_f32_16x16x32_bf16 v[252:255], a[76:79], a[124:127], v[252:255]
    v_mul_f32 v230, s32, v230
    v_mul_f32 v231, s32, v231
    v_cvt_pk_bf16_f32 v226, v228, v229
    v_cvt_pk_bf16_f32 v227, v230, v231
    buffer_store_dwordx4 v[224:227], v3, s[20:23], s39 offen offset:0 sc1
    ds_write_b128 v54, v[224:227] offset:4096
    v_pk_mul_f32 v[232:233], s[32:33], v[232:233] op_sel_hi:[0,1]
    v_pk_mul_f32 v[234:235], s[32:33], v[234:235] op_sel_hi:[0,1]
    v_cvt_pk_bf16_f32 v232, v232, v233
    v_cvt_pk_bf16_f32 v233, v234, v235
    v_pk_mul_f32 v[236:237], s[32:33], v[236:237] op_sel_hi:[0,1]
    v_pk_mul_f32 v[238:239], s[32:33], v[238:239] op_sel_hi:[0,1]
    v_cvt_pk_bf16_f32 v234, v236, v237
    v_cvt_pk_bf16_f32 v235, v238, v239
    buffer_store_dwordx4 v[232:235], v3, s[20:23], s39 offen offset:256 sc1
    ds_write_b128 v54, v[232:235] offset:4352
    v_pk_mul_f32 v[240:241], s[32:33], v[240:241] op_sel_hi:[0,1]
    v_pk_mul_f32 v[242:243], s[32:33], v[242:243] op_sel_hi:[0,1]
    v_cvt_pk_bf16_f32 v240, v240, v241
    v_cvt_pk_bf16_f32 v241, v242, v243
    v_pk_mul_f32 v[244:245], s[32:33], v[244:245] op_sel_hi:[0,1]
    v_pk_mul_f32 v[246:247], s[32:33], v[246:247] op_sel_hi:[0,1]
    v_cvt_pk_bf16_f32 v242, v244, v245
    v_cvt_pk_bf16_f32 v243, v246, v247
    buffer_store_dwordx4 v[240:243], v3, s[20:23], s39 offen offset:2048 sc1
    ds_write_b128 v54, v[240:243] offset:6144
    v_pk_mul_f32 v[248:249], s[32:33], v[248:249] op_sel_hi:[0,1]
    v_pk_mul_f32 v[250:251], s[32:33], v[250:251] op_sel_hi:[0,1]
    v_cvt_pk_bf16_f32 v248, v248, v249
    v_cvt_pk_bf16_f32 v249, v250, v251
    v_pk_mul_f32 v[252:253], s[32:33], v[252:253] op_sel_hi:[0,1]
    v_pk_mul_f32 v[254:255], s[32:33], v[254:255] op_sel_hi:[0,1]
    v_cvt_pk_bf16_f32 v250, v252, v253
    v_cvt_pk_bf16_f32 v251, v254, v255
    buffer_store_dwordx4 v[248:251], v3, s[20:23], s39 offen offset:2304 sc1
    ds_write_b128 v54, v[248:251] offset:6400
    v_mov_b32 v7, v55
    v_sub_u32 v15, v52, v1
    v_add_u32 v8, v7, v15
    v_mov_b64 v[48:49], 0
    v_mov_b64 v[50:51], 0
    v_mov_b64 v[52:53], 0
    v_mov_b64 v[54:55], 0
    s_waitcnt lgkmcnt(0)
    s_barrier
    s_cmp_eq_u32 s62, 0
    s_cbranch_scc1 role_a
    ds_read_b128 a[192:195], v8 offset:0
    ds_read_b128 a[196:199], v8 offset:1024
    ds_read_b128 a[160:163], v63 offset:0
    ds_read_b128 a[164:167], v63 offset:1024
    ds_read_b128 a[168:171], v63 offset:2048
    ds_read_b128 a[172:175], v63 offset:3072
    ds_read_b128 a[216:219], v7 offset:2048
    ds_read_b128 a[220:223], v7 offset:3072
    v_xor_b32 v6, 4096, v63
    ds_read_b128 a[176:179], v6 offset:0
    ds_read_b128 a[180:183], v6 offset:1024
    ds_read_b128 a[184:187], v6 offset:2048
    ds_read_b128 a[188:191], v6 offset:3072
    v_add_u32 v6, v61, v15
    v_add_u32 v63, v1, v15
    v_mfma_f32_32x32x16_bf16 v[160:175], v[28:31], v[28:31], 0
    v_mfma_f32_32x32x16_bf16 v[176:191], v[28:31], v[28:31], 0
    s_waitcnt lgkmcnt(8)
    v_mfma_f32_32x32x16_bf16 v[80:95], a[192:195], a[160:163], 0
    v_mfma_f32_32x32x16_bf16 v[80:95], a[196:199], a[164:167], v[80:95]
    s_waitcnt lgkmcnt(6)
    v_mfma_f32_32x32x16_bf16 v[96:111], a[192:195], a[168:171], 0
    v_mfma_f32_32x32x16_bf16 v[96:111], a[196:199], a[172:175], v[96:111]
    s_nop 10
    v_max3_f32 v16, v80, v81, v82
    v_max3_f32 v17, v96, v97, v98
    v_mfma_f32_32x32x16_bf16 v[208:223], v[28:31], v[28:31], 0
    v_max3_f32 v16, v16, v83, v84
    v_max3_f32 v17, v17, v99, v100
    v_max3_f32 v16, v16, v85, v86
    v_max3_f32 v17, v17, v101, v102
    v_max3_f32 v16, v16, v87, v88
    v_max3_f32 v17, v17, v103, v104
    v_max3_f32 v16, v16, v89, v90
    v_max3_f32 v17, v17, v105, v106
    v_mfma_f32_32x32x16_bf16 v[192:207], v[28:31], v[28:31], 0
    v_max3_f32 v16, v16, v91, v92
    v_max3_f32 v17, v17, v107, v108
    v_max3_f32 v16, v16, v93, v94
    v_max3_f32 v17, v17, v109, v110
    v_max_f32 v16, v16, v95
    v_mov_b32 v14, v16
    v_max_f32 v17, v17, v111
    v_mov_b32 v15, v17
    v_permlane32_swap_b32 v16, v14
    v_max_f32 v16, v16, v14
    v_permlane32_swap_b32 v17, v15
    v_max_f32 v17, v17, v15
    v_sub_f32 v16, 0xc2c80000, v16
    v_sub_f32 v17, 0xc2c80000, v17
    ds_write_b64 v59, v[16:17]
    v_mov_b32 v144, v17
    v_mov_b32 v145, v17
    v_mfma_f32_32x32x16_bf16 a[16:31], v[28:31], v[28:31], 0
    v_mov_b64 v[146:147], v[144:145]
    v_mov_b64 v[148:149], v[144:145]
    v_mov_b64 v[150:151], v[144:145]
    v_mov_b64 v[152:153], v[144:145]
    v_mov_b64 v[154:155], v[144:145]
    v_mov_b64 v[156:157], v[144:145]
    v_mov_b64 v[158:159], v[144:145]
    v_mfma_f32_32x32x16_bf16 a[0:15], v[28:31], v[28:31], 0
    v_mov_b32 v128, v16
    v_mov_b32 v129, v16
    v_mov_b64 v[130:131], v[128:129]
    v_mov_b64 v[132:133], v[128:129]
    v_mov_b64 v[134:135], v[128:129]
    v_mov_b64 v[136:137], v[128:129]
    v_mov_b64 v[138:139], v[128:129]
    v_mov_b64 v[140:141], v[128:129]
    v_mov_b64 v[142:143], v[128:129]
    s_waitcnt vmcnt(0)
    buffer_store_dword v24, v25, s[20:23], s54 offen offset:0 sc1
    v_pk_add_f32 v[80:81], v[80:81], v[128:129]
    v_pk_add_f32 v[82:83], v[82:83], v[128:129]
    v_pk_add_f32 v[84:85], v[84:85], v[128:129]
    v_pk_add_f32 v[86:87], v[86:87], v[128:129]
    v_pk_add_f32 v[88:89], v[88:89], v[128:129]
    v_pk_add_f32 v[90:91], v[90:91], v[128:129]
    v_pk_add_f32 v[92:93], v[92:93], v[128:129]
    v_pk_add_f32 v[94:95], v[94:95], v[128:129]
    s_waitcnt lgkmcnt(5)
    v_mfma_f32_32x32x16_bf16 v[96:111], a[192:195], a[168:171], v[144:159]
hook6:
    s_cbranch_execz hook3
    v_exp_f32 v80, v80
    v_exp_f32 v81, v81
    v_exp_f32 v82, v82
    v_mfma_f32_32x32x16_bf16 v[96:111], a[196:199], a[172:175], v[96:111]
    s_waitcnt lgkmcnt(0)
    s_barrier
    ds_read_b64 v[14:15], v58
    v_exp_f32 v83, v83
    v_exp_f32 v84, v84
    v_exp_f32 v85, v85
    v_exp_f32 v86, v86
    v_exp_f32 v87, v87
    v_exp_f32 v88, v88
    v_exp_f32 v89, v89
    v_exp_f32 v90, v90
    v_exp_f32 v91, v91
    ds_read_b128 a[200:203], v6 offset:8192
    v_exp_f32 v92, v92
    v_exp_f32 v93, v93
    ds_read_b128 a[204:207], v6 offset:9216
    ds_read_b128 a[224:227], v61 offset:10240
    v_exp_f32 v94, v94
    v_exp_f32 v95, v95
    s_waitcnt lgkmcnt(3)
    v_mov_b32 v224, v14
    v_mov_b32 v225, v14
    v_mov_b64 v[226:227], v[224:225]
    v_mov_b64 v[228:229], v[224:225]
    v_mov_b64 v[230:231], v[224:225]
    v_mov_b64 v[232:233], v[224:225]
    v_mov_b64 v[234:235], v[224:225]
    v_mov_b64 v[236:237], v[224:225]
    v_mov_b64 v[238:239], v[224:225]
    v_mov_b32 v240, v15
    v_mov_b32 v241, v15
    v_mov_b64 v[242:243], v[240:241]
    v_mov_b64 v[244:245], v[240:241]
    v_mov_b64 v[246:247], v[240:241]
    v_mov_b64 v[248:249], v[240:241]
    v_mov_b64 v[250:251], v[240:241]
    v_mov_b64 v[252:253], v[240:241]
    v_mov_b64 v[254:255], v[240:241]
    v_mfma_f32_32x32x16_bf16 v[112:127], a[192:195], a[176:179], v[224:239]
    ds_read_b128 a[48:51], v60 offset:8192
    v_exp_f32 v96, v96
    v_exp_f32 v97, v97
    v_exp_f32 v98, v98
    v_mfma_f32_32x32x16_bf16 v[112:127], a[196:199], a[180:183], v[112:127]
    v_exp_f32 v99, v99
    v_exp_f32 v100, v100
    v_exp_f32 v101, v101
    v_smfmac_f32_32x32x32_bf16 v[160:175], a[216:219], v[80:87], v24
    v_exp_f32 v102, v102
    v_exp_f32 v103, v103
    v_exp_f32 v104, v104
    v_smfmac_f32_32x32x32_bf16 v[160:175], a[220:223], v[88:95], v24
    v_exp_f32 v105, v105
    v_exp_f32 v106, v106
    v_exp_f32 v107, v107
    v_smfmac_f32_16x16x64_bf16 v[28:31], v[20:23], v[80:87], v24
    ds_read_b128 a[228:231], v61 offset:11264
    v_exp_f32 v108, v108
    v_exp_f32 v109, v109
    v_smfmac_f32_16x16x64_bf16 v[28:31], v[20:23], v[88:95], v24
    v_exp_f32 v110, v110
    v_exp_f32 v111, v111
    v_mfma_f32_32x32x16_bf16 v[80:95], a[192:195], a[184:187], v[240:255]
    ds_read_b128 a[52:55], v60 offset:9216
    v_exp_f32 v112, v112
    v_exp_f32 v113, v113
    v_exp_f32 v114, v114
    v_mfma_f32_32x32x16_bf16 v[80:95], a[196:199], a[188:191], v[80:95]
    v_exp_f32 v115, v115
    v_exp_f32 v116, v116
    v_exp_f32 v117, v117
    v_smfmac_f32_32x32x32_bf16 v[176:191], a[216:219], v[96:103], v24
    v_exp_f32 v118, v118
    v_exp_f32 v119, v119
    v_exp_f32 v120, v120
    v_smfmac_f32_32x32x32_bf16 v[176:191], a[220:223], v[104:111], v24
    s_waitcnt lgkmcnt(4)
    v_exp_f32 v121, v121
    v_exp_f32 v122, v122
    v_exp_f32 v123, v123
    v_smfmac_f32_16x16x64_bf16 v[32:35], v[20:23], v[96:103], v24
    ds_read_b128 a[208:211], v6 offset:16384
    v_exp_f32 v124, v124
    v_exp_f32 v125, v125
    v_smfmac_f32_16x16x64_bf16 v[32:35], v[20:23], v[104:111], v24
    v_exp_f32 v126, v126
    v_exp_f32 v127, v127
    v_mfma_f32_32x32x16_bf16 v[96:111], a[200:203], a[160:163], v[128:143]
    ds_read_b128 a[56:59], v60 offset:10240
    v_exp_f32 v80, v80
    v_exp_f32 v81, v81
    v_exp_f32 v82, v82
    v_mfma_f32_32x32x16_bf16 v[96:111], a[204:207], a[164:167], v[96:111]
    v_exp_f32 v83, v83
    v_exp_f32 v84, v84
    v_exp_f32 v85, v85
    v_smfmac_f32_32x32x32_bf16 a[0:15], a[216:219], v[112:119], v24
    v_exp_f32 v86, v86
    v_exp_f32 v87, v87
    v_exp_f32 v88, v88
    v_smfmac_f32_32x32x32_bf16 a[0:15], a[220:223], v[120:127], v24
    v_exp_f32 v89, v89
    v_exp_f32 v90, v90
    v_exp_f32 v91, v91
    v_smfmac_f32_16x16x64_bf16 v[48:51], v[20:23], v[112:119], v24
    ds_read_b128 a[212:215], v6 offset:17408
    v_exp_f32 v92, v92
    v_exp_f32 v93, v93
    v_smfmac_f32_16x16x64_bf16 v[48:51], v[20:23], v[120:127], v24
    v_exp_f32 v94, v94
    v_exp_f32 v95, v95
    v_mfma_f32_32x32x16_bf16 v[112:127], a[200:203], a[168:171], v[144:159]
    ds_read_b128 a[60:63], v60 offset:11264
    v_exp_f32 v96, v96
    v_exp_f32 v97, v97
    v_exp_f32 v98, v98
    v_mfma_f32_32x32x16_bf16 v[112:127], a[204:207], a[172:175], v[112:127]
    v_exp_f32 v99, v99
    v_exp_f32 v100, v100
    v_exp_f32 v101, v101
    v_smfmac_f32_32x32x32_bf16 a[16:31], a[216:219], v[80:87], v24
    v_exp_f32 v102, v102
    v_exp_f32 v103, v103
    v_exp_f32 v104, v104
    v_smfmac_f32_32x32x32_bf16 a[16:31], a[220:223], v[88:95], v24
    s_waitcnt lgkmcnt(5)
    v_exp_f32 v105, v105
    v_exp_f32 v106, v106
    v_exp_f32 v107, v107
    v_smfmac_f32_16x16x64_bf16 v[52:55], v[20:23], v[80:87], v24
    ds_read_b128 a[232:235], v61 offset:18432
    v_exp_f32 v108, v108
    v_exp_f32 v109, v109
    v_smfmac_f32_16x16x64_bf16 v[52:55], v[20:23], v[88:95], v24
    v_exp_f32 v110, v110
    v_exp_f32 v111, v111
    v_mfma_f32_32x32x16_bf16 v[80:95], a[200:203], a[176:179], v[224:239]
    ds_read_b128 a[64:67], v60 offset:16384
    v_exp_f32 v112, v112
    v_exp_f32 v113, v113
    v_exp_f32 v114, v114
    v_mfma_f32_32x32x16_bf16 v[80:95], a[204:207], a[180:183], v[80:95]
    v_exp_f32 v115, v115
    v_exp_f32 v116, v116
    v_exp_f32 v117, v117
    v_smfmac_f32_32x32x32_bf16 v[160:175], a[224:227], v[96:103], v24
    v_exp_f32 v118, v118
    v_exp_f32 v119, v119
    v_exp_f32 v120, v120
    v_smfmac_f32_32x32x32_bf16 v[160:175], a[228:231], v[104:111], v24
    v_exp_f32 v121, v121
    v_exp_f32 v122, v122
    v_exp_f32 v123, v123
    v_smfmac_f32_16x16x64_bf16 v[28:31], v[20:23], v[96:103], v24
    ds_read_b128 a[236:239], v61 offset:19456
    v_exp_f32 v124, v124
    v_exp_f32 v125, v125
    v_smfmac_f32_16x16x64_bf16 v[28:31], v[20:23], v[104:111], v24
    v_exp_f32 v126, v126
    v_exp_f32 v127, v127
    v_mfma_f32_32x32x16_bf16 v[96:111], a[200:203], a[184:187], v[240:255]
    ds_read_b128 a[68:71], v60 offset:17408
    v_exp_f32 v80, v80
    v_exp_f32 v81, v81
    v_exp_f32 v82, v82
    v_mfma_f32_32x32x16_bf16 v[96:111], a[204:207], a[188:191], v[96:111]
    v_exp_f32 v83, v83
    v_exp_f32 v84, v84
    v_exp_f32 v85, v85
    v_smfmac_f32_32x32x32_bf16 v[176:191], a[224:227], v[112:119], v24
    v_exp_f32 v86, v86
    v_exp_f32 v87, v87
    v_exp_f32 v88, v88
    v_smfmac_f32_32x32x32_bf16 v[176:191], a[228:231], v[120:127], v24
    s_waitcnt lgkmcnt(5)
    v_exp_f32 v89, v89
    v_exp_f32 v90, v90
    v_exp_f32 v91, v91
    v_smfmac_f32_16x16x64_bf16 v[32:35], v[20:23], v[112:119], v24
    ds_read_b128 a[192:195], v6 offset:24576
    v_exp_f32 v92, v92
    v_exp_f32 v93, v93
    v_smfmac_f32_16x16x64_bf16 v[32:35], v[20:23], v[120:127], v24
    v_exp_f32 v94, v94
    v_exp_f32 v95, v95
    v_mfma_f32_32x32x16_bf16 v[112:127], a[208:211], a[160:163], v[128:143]
    ds_read_b128 a[72:75], v60 offset:18432
    v_exp_f32 v96, v96
    v_exp_f32 v97, v97
    v_exp_f32 v98, v98
    v_mfma_f32_32x32x16_bf16 v[112:127], a[212:215], a[164:167], v[112:127]
    v_exp_f32 v99, v99
    v_exp_f32 v100, v100
    v_exp_f32 v101, v101
    v_smfmac_f32_32x32x32_bf16 a[0:15], a[224:227], v[80:87], v24
    v_exp_f32 v102, v102
    v_exp_f32 v103, v103
    v_exp_f32 v104, v104
    v_smfmac_f32_32x32x32_bf16 a[0:15], a[228:231], v[88:95], v24
    v_exp_f32 v105, v105
    v_exp_f32 v106, v106
    v_exp_f32 v107, v107
    v_smfmac_f32_16x16x64_bf16 v[48:51], v[20:23], v[80:87], v24
    buffer_load_dword v5, v19, s[20:23], 0 offen offset:0 sc1
    v_exp_f32 v108, v108
    v_exp_f32 v109, v109
    v_smfmac_f32_16x16x64_bf16 v[48:51], v[20:23], v[88:95], v24
    ds_read_b128 a[196:199], v6 offset:25600
    v_exp_f32 v110, v110
    v_exp_f32 v111, v111
    v_mfma_f32_32x32x16_bf16 v[80:95], a[208:211], a[168:171], v[144:159]
    ds_read_b128 a[76:79], v60 offset:19456
    v_exp_f32 v112, v112
    v_exp_f32 v113, v113
    v_exp_f32 v114, v114
    v_mfma_f32_32x32x16_bf16 v[80:95], a[212:215], a[172:175], v[80:95]
    v_exp_f32 v115, v115
    v_exp_f32 v116, v116
    v_exp_f32 v117, v117
    v_smfmac_f32_32x32x32_bf16 a[16:31], a[224:227], v[96:103], v24
    v_exp_f32 v118, v118
    v_exp_f32 v119, v119
    v_exp_f32 v120, v120
    v_smfmac_f32_32x32x32_bf16 a[16:31], a[228:231], v[104:111], v24
    s_waitcnt lgkmcnt(5)
    v_exp_f32 v121, v121
    v_exp_f32 v122, v122
    v_exp_f32 v123, v123
    v_smfmac_f32_16x16x64_bf16 v[52:55], v[20:23], v[96:103], v24
    ds_read_b128 a[216:219], v61 offset:26624
    v_exp_f32 v124, v124
    v_exp_f32 v125, v125
    v_smfmac_f32_16x16x64_bf16 v[52:55], v[20:23], v[104:111], v24
    v_exp_f32 v126, v126
    v_exp_f32 v127, v127
    v_mfma_f32_32x32x16_bf16 v[96:111], a[208:211], a[176:179], v[224:239]
    ds_read_b128 a[80:83], v60 offset:24576
    v_exp_f32 v80, v80
    v_exp_f32 v81, v81
    v_exp_f32 v82, v82
    v_mfma_f32_32x32x16_bf16 v[96:111], a[212:215], a[180:183], v[96:111]
    v_exp_f32 v83, v83
    v_exp_f32 v84, v84
    v_exp_f32 v85, v85
    v_smfmac_f32_32x32x32_bf16 v[160:175], a[232:235], v[112:119], v24
    s_add_u32 s33, s6, 0x8000
    v_exp_f32 v86, v86
    v_exp_f32 v87, v87
    v_exp_f32 v88, v88
    v_smfmac_f32_32x32x32_bf16 v[160:175], a[236:239], v[120:127], v24
    s_and_b32 s33, s33, 0x3ffff
    v_exp_f32 v89, v89
    v_exp_f32 v90, v90
    v_exp_f32 v91, v91
    v_smfmac_f32_16x16x64_bf16 v[28:31], v[20:23], v[112:119], v24
    ds_read_b128 a[220:223], v61 offset:27648
    v_exp_f32 v92, v92
    v_exp_f32 v93, v93
    v_smfmac_f32_16x16x64_bf16 v[28:31], v[20:23], v[120:127], v24
    v_exp_f32 v94, v94
    v_exp_f32 v95, v95
    s_waitcnt vmcnt(0)
    v_cmp_gt_u32 vcc, 1, v5
    s_cbranch_vccnz bpb0_spin
bpb0_ok:
    v_mfma_f32_32x32x16_bf16 v[112:127], a[208:211], a[184:187], v[240:255]
    ds_read_b128 a[84:87], v60 offset:25600
    v_exp_f32 v96, v96
    v_exp_f32 v97, v97
    v_exp_f32 v98, v98
    v_mfma_f32_32x32x16_bf16 v[112:127], a[212:215], a[188:191], v[112:127]
    s_add_u32 s36, s4, s33
    v_exp_f32 v99, v99
    v_exp_f32 v100, v100
    v_exp_f32 v101, v101
    v_smfmac_f32_32x32x32_bf16 v[176:191], a[232:235], v[80:87], v24
    s_addc_u32 s37, s5, 0
    v_exp_f32 v102, v102
    v_exp_f32 v103, v103
    v_exp_f32 v104, v104
    v_smfmac_f32_32x32x32_bf16 v[176:191], a[236:239], v[88:95], v24
    s_waitcnt lgkmcnt(5)
    v_exp_f32 v105, v105
    v_exp_f32 v106, v106
    v_exp_f32 v107, v107
    v_smfmac_f32_16x16x64_bf16 v[32:35], v[20:23], v[80:87], v24
    global_load_dwordx4 a[200:203], v63, s[36:37] offset:-4096
    v_exp_f32 v108, v108
    v_exp_f32 v109, v109
    v_smfmac_f32_16x16x64_bf16 v[32:35], v[20:23], v[88:95], v24
    global_load_dwordx4 a[204:207], v63, s[36:37] offset:-3072
    v_exp_f32 v110, v110
    v_exp_f32 v111, v111
    v_mfma_f32_32x32x16_bf16 v[80:95], a[192:195], a[160:163], v[128:143]
    ds_read_b128 a[88:91], v60 offset:26624
    v_exp_f32 v112, v112
    v_exp_f32 v113, v113
    v_exp_f32 v114, v114
    v_mfma_f32_32x32x16_bf16 v[80:95], a[196:199], a[164:167], v[80:95]
    v_exp_f32 v115, v115
    v_exp_f32 v116, v116
    v_exp_f32 v117, v117
    v_smfmac_f32_32x32x32_bf16 a[0:15], a[232:235], v[96:103], v24
    s_add_u32 s33, s6, 0x10000
    v_exp_f32 v118, v118
    v_exp_f32 v119, v119
    v_exp_f32 v120, v120
    v_smfmac_f32_32x32x32_bf16 a[0:15], a[236:239], v[104:111], v24
    s_and_b32 s33, s33, 0x3ffff
    v_exp_f32 v121, v121
    v_exp_f32 v122, v122
    v_exp_f32 v123, v123
    v_smfmac_f32_16x16x64_bf16 v[48:51], v[20:23], v[96:103], v24
    global_load_dwordx4 a[224:227], v1, s[36:37] offset:-2048
    v_exp_f32 v124, v124
    v_exp_f32 v125, v125
    v_smfmac_f32_16x16x64_bf16 v[48:51], v[20:23], v[104:111], v24
    global_load_dwordx4 a[228:231], v1, s[36:37] offset:-1024
    v_exp_f32 v126, v126
    v_exp_f32 v127, v127
    v_mfma_f32_32x32x16_bf16 v[96:111], a[192:195], a[168:171], v[144:159]
    ds_read_b128 a[92:95], v60 offset:27648
    v_exp_f32 v80, v80
    v_exp_f32 v81, v81
    v_exp_f32 v82, v82
    v_mfma_f32_32x32x16_bf16 v[96:111], a[196:199], a[172:175], v[96:111]
    s_add_u32 s38, s4, s33
    v_exp_f32 v83, v83
    v_exp_f32 v84, v84
    v_exp_f32 v85, v85
    v_smfmac_f32_32x32x32_bf16 a[16:31], a[232:235], v[112:119], v24
    s_addc_u32 s39, s5, 0
    v_exp_f32 v86, v86
    v_exp_f32 v87, v87
    v_exp_f32 v88, v88
    v_smfmac_f32_32x32x32_bf16 a[16:31], a[236:239], v[120:127], v24
    s_waitcnt lgkmcnt(3)
    s_add_u32 s56, s48, 4096
    buffer_store_dwordx4 a[48:51], v1, s[20:23], s56 offen offset:0 sc1
    v_exp_f32 v89, v89
    v_exp_f32 v90, v90
    v_exp_f32 v91, v91
    v_smfmac_f32_16x16x64_bf16 v[52:55], v[20:23], v[112:119], v24
    global_load_dwordx4 a[208:211], v63, s[38:39] offset:-4096
    v_exp_f32 v92, v92
    v_exp_f32 v93, v93
    v_smfmac_f32_16x16x64_bf16 v[52:55], v[20:23], v[120:127], v24
    global_load_dwordx4 a[212:215], v63, s[38:39] offset:-3072
    v_exp_f32 v94, v94
    v_exp_f32 v95, v95
    v_mfma_f32_32x32x16_bf16 v[112:127], a[192:195], a[176:179], v[224:239]
    v_exp_f32 v96, v96
    v_exp_f32 v97, v97
    v_exp_f32 v98, v98
    v_mfma_f32_32x32x16_bf16 v[112:127], a[196:199], a[180:183], v[112:127]
    v_exp_f32 v99, v99
    v_exp_f32 v100, v100
    v_exp_f32 v101, v101
    v_smfmac_f32_32x32x32_bf16 v[160:175], a[216:219], v[80:87], v24
    v_exp_f32 v102, v102
    v_exp_f32 v103, v103
    v_exp_f32 v104, v104
    v_smfmac_f32_32x32x32_bf16 v[160:175], a[220:223], v[88:95], v24
    v_exp_f32 v105, v105
    v_exp_f32 v106, v106
    v_exp_f32 v107, v107
    v_smfmac_f32_16x16x64_bf16 v[28:31], v[20:23], v[80:87], v24
    global_load_dwordx4 a[232:235], v1, s[38:39] offset:-2048
    v_exp_f32 v108, v108
    v_exp_f32 v109, v109
    v_smfmac_f32_16x16x64_bf16 v[28:31], v[20:23], v[88:95], v24
    v_exp_f32 v110, v110
    v_exp_f32 v111, v111
    v_mfma_f32_32x32x16_bf16 v[80:95], a[192:195], a[184:187], v[240:255]
    v_exp_f32 v112, v112
    v_exp_f32 v113, v113
    v_exp_f32 v114, v114
    v_mfma_f32_32x32x16_bf16 v[80:95], a[196:199], a[188:191], v[80:95]
    v_exp_f32 v115, v115
    v_exp_f32 v116, v116
    v_exp_f32 v117, v117
    v_smfmac_f32_32x32x32_bf16 v[176:191], a[216:219], v[96:103], v24
    v_exp_f32 v118, v118
    v_exp_f32 v119, v119
    v_exp_f32 v120, v120
    v_smfmac_f32_32x32x32_bf16 v[176:191], a[220:223], v[104:111], v24
    s_waitcnt vmcnt(6)
    buffer_store_dwordx4 a[52:55], v1, s[20:23], s56 offen offset:1024 sc1
    v_exp_f32 v121, v121
    v_exp_f32 v122, v122
    v_exp_f32 v123, v123
    v_smfmac_f32_16x16x64_bf16 v[32:35], v[20:23], v[96:103], v24
    s_waitcnt lgkmcnt(0)
    s_barrier
    v_exp_f32 v124, v124
    v_exp_f32 v125, v125
    v_smfmac_f32_16x16x64_bf16 v[32:35], v[20:23], v[104:111], v24
    global_load_dwordx4 a[236:239], v1, s[38:39] offset:-1024
    v_exp_f32 v126, v126
    v_exp_f32 v127, v127
    v_mfma_f32_32x32x16_bf16 v[96:111], a[200:203], a[160:163], v[128:143]
    s_add_u32 s33, s6, 0x18000
    v_exp_f32 v80, v80
    v_exp_f32 v81, v81
    v_exp_f32 v82, v82
    v_mfma_f32_32x32x16_bf16 v[96:111], a[204:207], a[164:167], v[96:111]
    s_and_b32 s33, s33, 0x3ffff
    v_exp_f32 v83, v83
    v_exp_f32 v84, v84
    v_exp_f32 v85, v85
    v_smfmac_f32_32x32x32_bf16 a[0:15], a[216:219], v[112:119], v24
    s_add_u32 s36, s4, s33
    v_exp_f32 v86, v86
    v_exp_f32 v87, v87
    v_exp_f32 v88, v88
    v_smfmac_f32_32x32x32_bf16 a[0:15], a[220:223], v[120:127], v24
    s_addc_u32 s37, s5, 0
    v_exp_f32 v89, v89
    v_exp_f32 v90, v90
    v_exp_f32 v91, v91
    v_smfmac_f32_16x16x64_bf16 v[48:51], v[20:23], v[112:119], v24
    global_load_dwordx4 a[192:195], v63, s[36:37] offset:-4096
    v_exp_f32 v92, v92
    v_exp_f32 v93, v93
    v_smfmac_f32_16x16x64_bf16 v[48:51], v[20:23], v[120:127], v24
    v_exp_f32 v94, v94
    v_exp_f32 v95, v95
    v_mfma_f32_32x32x16_bf16 v[112:127], a[200:203], a[168:171], v[144:159]
    v_exp_f32 v96, v96
    v_exp_f32 v97, v97
    v_exp_f32 v98, v98
    v_mfma_f32_32x32x16_bf16 v[112:127], a[204:207], a[172:175], v[112:127]
    v_exp_f32 v99, v99
    v_exp_f32 v100, v100
    v_exp_f32 v101, v101
    v_smfmac_f32_32x32x32_bf16 a[16:31], a[216:219], v[80:87], v24
    v_exp_f32 v102, v102
    v_exp_f32 v103, v103
    v_exp_f32 v104, v104
    v_smfmac_f32_32x32x32_bf16 a[16:31], a[220:223], v[88:95], v24
    s_waitcnt vmcnt(7)
    buffer_store_dwordx4 a[56:59], v1, s[20:23], s56 offen offset:2048 sc1
    v_exp_f32 v105, v105
    v_exp_f32 v106, v106
    v_exp_f32 v107, v107
    v_smfmac_f32_16x16x64_bf16 v[52:55], v[20:23], v[80:87], v24
    global_load_dwordx4 a[196:199], v63, s[36:37] offset:-3072
    v_exp_f32 v108, v108
    v_exp_f32 v109, v109
    v_smfmac_f32_16x16x64_bf16 v[52:55], v[20:23], v[88:95], v24
    v_exp_f32 v110, v110
    v_exp_f32 v111, v111
    v_mfma_f32_32x32x16_bf16 v[80:95], a[200:203], a[176:179], v[224:239]
    s_add_u32 m0, s30, 4096
    v_exp_f32 v112, v112
    v_exp_f32 v113, v113
    v_exp_f32 v114, v114
    v_mfma_f32_32x32x16_bf16 v[80:95], a[204:207], a[180:183], v[80:95]
    s_xor_b32 s28, s1, 0x0
    v_exp_f32 v115, v115
    v_exp_f32 v116, v116
    v_exp_f32 v117, v117
    v_smfmac_f32_32x32x32_bf16 v[160:175], a[224:227], v[96:103], v24
    s_add_u32 s46, s42, s28
    v_exp_f32 v118, v118
    v_exp_f32 v119, v119
    v_exp_f32 v120, v120
    v_smfmac_f32_32x32x32_bf16 v[160:175], a[228:231], v[104:111], v24
    s_addc_u32 s47, s43, 0
    v_exp_f32 v121, v121
    v_exp_f32 v122, v122
    v_exp_f32 v123, v123
    v_smfmac_f32_16x16x64_bf16 v[28:31], v[20:23], v[96:103], v24
    global_load_dwordx4 a[216:219], v1, s[36:37] offset:-2048
    v_exp_f32 v124, v124
    v_exp_f32 v125, v125
    v_smfmac_f32_16x16x64_bf16 v[28:31], v[20:23], v[104:111], v24
    global_load_lds_dwordx4 v9, s[46:47]
    v_exp_f32 v126, v126
    v_exp_f32 v127, v127
    v_mfma_f32_32x32x16_bf16 v[96:111], a[200:203], a[184:187], v[240:255]
    s_add_u32 m0, s30, 8192
    v_exp_f32 v80, v80
    v_exp_f32 v81, v81
    v_exp_f32 v82, v82
    v_mfma_f32_32x32x16_bf16 v[96:111], a[204:207], a[188:191], v[96:111]
    s_add_u32 s46, s46, 0x10000
    v_exp_f32 v83, v83
    v_exp_f32 v84, v84
    v_exp_f32 v85, v85
    v_smfmac_f32_32x32x32_bf16 v[176:191], a[224:227], v[112:119], v24
    s_addc_u32 s47, s47, 0
    v_exp_f32 v86, v86
    v_exp_f32 v87, v87
    v_exp_f32 v88, v88
    v_smfmac_f32_32x32x32_bf16 v[176:191], a[228:231], v[120:127], v24
    s_waitcnt vmcnt(8)
    buffer_store_dwordx4 a[60:63], v1, s[20:23], s56 offen offset:3072 sc1
    v_exp_f32 v89, v89
    v_exp_f32 v90, v90
    v_exp_f32 v91, v91
    v_smfmac_f32_16x16x64_bf16 v[32:35], v[20:23], v[112:119], v24
    global_load_dwordx4 a[220:223], v1, s[36:37] offset:-1024
    v_exp_f32 v92, v92
    v_exp_f32 v93, v93
    v_smfmac_f32_16x16x64_bf16 v[32:35], v[20:23], v[120:127], v24
    global_load_lds_dwordx4 v9, s[46:47]
    v_exp_f32 v94, v94
    v_exp_f32 v95, v95
    v_mfma_f32_32x32x16_bf16 v[112:127], a[208:211], a[160:163], v[128:143]
    s_add_u32 s33, s6, 0x20000
    v_exp_f32 v96, v96
    v_exp_f32 v97, v97
    v_exp_f32 v98, v98
    v_mfma_f32_32x32x16_bf16 v[112:127], a[212:215], a[164:167], v[112:127]
    s_and_b32 s33, s33, 0x3ffff
    v_exp_f32 v99, v99
    v_exp_f32 v100, v100
    v_exp_f32 v101, v101
    v_smfmac_f32_32x32x32_bf16 a[0:15], a[224:227], v[80:87], v24
    s_add_u32 s38, s4, s33
    v_exp_f32 v102, v102
    v_exp_f32 v103, v103
    v_exp_f32 v104, v104
    v_smfmac_f32_32x32x32_bf16 a[0:15], a[228:231], v[88:95], v24
    s_addc_u32 s39, s5, 0
    v_exp_f32 v105, v105
    v_exp_f32 v106, v106
    v_exp_f32 v107, v107
    v_smfmac_f32_16x16x64_bf16 v[48:51], v[20:23], v[80:87], v24
    global_load_dwordx4 a[200:203], v63, s[38:39] offset:-4096
    v_exp_f32 v108, v108
    v_exp_f32 v109, v109
    v_smfmac_f32_16x16x64_bf16 v[48:51], v[20:23], v[88:95], v24
    v_exp_f32 v110, v110
    v_exp_f32 v111, v111
    v_mfma_f32_32x32x16_bf16 v[80:95], a[208:211], a[168:171], v[144:159]
    s_add_u32 m0, s30, 12288
    v_exp_f32 v112, v112
    v_exp_f32 v113, v113
    v_exp_f32 v114, v114
    v_mfma_f32_32x32x16_bf16 v[80:95], a[212:215], a[172:175], v[80:95]
    s_add_u32 s46, s46, 0x10000
    v_exp_f32 v115, v115
    v_exp_f32 v116, v116
    v_exp_f32 v117, v117
    v_smfmac_f32_32x32x32_bf16 a[16:31], a[224:227], v[96:103], v24
    s_addc_u32 s47, s47, 0
    v_exp_f32 v118, v118
    v_exp_f32 v119, v119
    v_exp_f32 v120, v120
    v_smfmac_f32_32x32x32_bf16 a[16:31], a[228:231], v[104:111], v24
    s_waitcnt vmcnt(9)
    s_add_u32 s56, s48, 8192
    buffer_store_dwordx4 a[64:67], v1, s[20:23], s56 offen offset:0 sc1
    v_exp_f32 v121, v121
    v_exp_f32 v122, v122
    v_exp_f32 v123, v123
    v_smfmac_f32_16x16x64_bf16 v[52:55], v[20:23], v[96:103], v24
    global_load_dwordx4 a[204:207], v63, s[38:39] offset:-3072
    v_exp_f32 v124, v124
    v_exp_f32 v125, v125
    v_smfmac_f32_16x16x64_bf16 v[52:55], v[20:23], v[104:111], v24
    global_load_lds_dwordx4 v9, s[46:47]
    v_exp_f32 v126, v126
    v_exp_f32 v127, v127
    v_mfma_f32_32x32x16_bf16 v[96:111], a[208:211], a[176:179], v[224:239]
    v_exp_f32 v80, v80
    v_exp_f32 v81, v81
    v_exp_f32 v82, v82
    v_mfma_f32_32x32x16_bf16 v[96:111], a[212:215], a[180:183], v[96:111]
    s_add_u32 m0, s30, 16384
    v_exp_f32 v83, v83
    v_exp_f32 v84, v84
    v_exp_f32 v85, v85
    v_smfmac_f32_32x32x32_bf16 v[160:175], a[232:235], v[112:119], v24
    s_add_u32 s46, s46, 0x10000
    v_exp_f32 v86, v86
    v_exp_f32 v87, v87
    v_exp_f32 v88, v88
    v_smfmac_f32_32x32x32_bf16 v[160:175], a[236:239], v[120:127], v24
    s_addc_u32 s47, s47, 0
    v_exp_f32 v89, v89
    v_exp_f32 v90, v90
    v_exp_f32 v91, v91
    v_smfmac_f32_16x16x64_bf16 v[28:31], v[20:23], v[112:119], v24
    global_load_dwordx4 a[224:227], v1, s[38:39] offset:-2048
    v_exp_f32 v92, v92
    v_exp_f32 v93, v93
    v_smfmac_f32_16x16x64_bf16 v[28:31], v[20:23], v[120:127], v24
    global_load_lds_dwordx4 v9, s[46:47]
    v_exp_f32 v94, v94
    v_exp_f32 v95, v95
    v_mfma_f32_32x32x16_bf16 v[112:127], a[208:211], a[184:187], v[240:255]
    v_exp_f32 v96, v96
    v_exp_f32 v97, v97
    v_exp_f32 v98, v98
    v_mfma_f32_32x32x16_bf16 v[112:127], a[212:215], a[188:191], v[112:127]
    v_exp_f32 v99, v99
    v_exp_f32 v100, v100
    v_exp_f32 v101, v101
    v_smfmac_f32_32x32x32_bf16 v[176:191], a[232:235], v[80:87], v24
    s_add_u32 m0, s30, 20480
    v_exp_f32 v102, v102
    v_exp_f32 v103, v103
    v_exp_f32 v104, v104
    v_smfmac_f32_32x32x32_bf16 v[176:191], a[236:239], v[88:95], v24
    s_waitcnt vmcnt(11)
    buffer_store_dwordx4 a[68:71], v1, s[20:23], s56 offen offset:1024 sc1
    v_exp_f32 v105, v105
    v_exp_f32 v106, v106
    v_exp_f32 v107, v107
    v_smfmac_f32_16x16x64_bf16 v[32:35], v[20:23], v[80:87], v24
    global_load_dwordx4 a[228:231], v1, s[38:39] offset:-1024
    v_exp_f32 v108, v108
    v_exp_f32 v109, v109
    v_smfmac_f32_16x16x64_bf16 v[32:35], v[20:23], v[88:95], v24
    v_exp_f32 v110, v110
    v_exp_f32 v111, v111
    v_mfma_f32_32x32x16_bf16 v[80:95], a[192:195], a[160:163], v[128:143]
    s_add_u32 s33, s6, 0x28000
    v_exp_f32 v112, v112
    v_exp_f32 v113, v113
    v_exp_f32 v114, v114
    v_mfma_f32_32x32x16_bf16 v[80:95], a[196:199], a[164:167], v[80:95]
    s_and_b32 s33, s33, 0x3ffff
    v_exp_f32 v115, v115
    v_exp_f32 v116, v116
    v_exp_f32 v117, v117
    v_smfmac_f32_32x32x32_bf16 a[0:15], a[232:235], v[96:103], v24
    s_add_u32 s36, s4, s33
    v_exp_f32 v118, v118
    v_exp_f32 v119, v119
    v_exp_f32 v120, v120
    v_smfmac_f32_32x32x32_bf16 a[0:15], a[236:239], v[104:111], v24
    s_addc_u32 s37, s5, 0
    v_exp_f32 v121, v121
    v_exp_f32 v122, v122
    v_exp_f32 v123, v123
    v_smfmac_f32_16x16x64_bf16 v[48:51], v[20:23], v[96:103], v24
    global_load_dwordx4 a[208:211], v63, s[36:37] offset:-4096
    v_exp_f32 v124, v124
    v_exp_f32 v125, v125
    v_smfmac_f32_16x16x64_bf16 v[48:51], v[20:23], v[104:111], v24
    s_waitcnt vmcnt(11)
    buffer_store_dword v24, v25, s[20:23], s54 offen offset:128 sc1
    v_exp_f32 v126, v126
    v_exp_f32 v127, v127
    v_mfma_f32_32x32x16_bf16 v[96:111], a[192:195], a[168:171], v[144:159]
    s_xor_b32 s28, s1, 0x40000
    v_exp_f32 v80, v80
    v_exp_f32 v81, v81
    v_exp_f32 v82, v82
    v_mfma_f32_32x32x16_bf16 v[96:111], a[196:199], a[172:175], v[96:111]
    s_add_u32 s46, s42, s28
    v_exp_f32 v83, v83
    v_exp_f32 v84, v84
    v_exp_f32 v85, v85
    v_smfmac_f32_32x32x32_bf16 a[16:31], a[232:235], v[112:119], v24
    s_addc_u32 s47, s43, 0
    v_exp_f32 v86, v86
    v_exp_f32 v87, v87
    v_exp_f32 v88, v88
    v_smfmac_f32_32x32x32_bf16 a[16:31], a[236:239], v[120:127], v24
    s_waitcnt vmcnt(11)
    buffer_store_dwordx4 a[72:75], v1, s[20:23], s56 offen offset:2048 sc1
    v_exp_f32 v89, v89
    v_exp_f32 v90, v90
    v_exp_f32 v91, v91
    v_smfmac_f32_16x16x64_bf16 v[52:55], v[20:23], v[112:119], v24
    global_load_dwordx4 a[212:215], v63, s[36:37] offset:-3072
    v_exp_f32 v92, v92
    v_exp_f32 v93, v93
    v_smfmac_f32_16x16x64_bf16 v[52:55], v[20:23], v[120:127], v24
    global_load_lds_dwordx4 v9, s[46:47]
    v_exp_f32 v94, v94
    v_exp_f32 v95, v95
    v_mfma_f32_32x32x16_bf16 v[112:127], a[192:195], a[176:179], v[224:239]
    v_exp_f32 v96, v96
    v_exp_f32 v97, v97
    v_exp_f32 v98, v98
    v_mfma_f32_32x32x16_bf16 v[112:127], a[196:199], a[180:183], v[112:127]
    s_add_u32 m0, s30, 24576
    v_exp_f32 v99, v99
    v_exp_f32 v100, v100
    v_exp_f32 v101, v101
    v_smfmac_f32_32x32x32_bf16 v[160:175], a[216:219], v[80:87], v24
    s_add_u32 s46, s46, 0x10000
    v_exp_f32 v102, v102
    v_exp_f32 v103, v103
    v_exp_f32 v104, v104
    v_smfmac_f32_32x32x32_bf16 v[160:175], a[220:223], v[88:95], v24
    s_addc_u32 s47, s47, 0
    v_exp_f32 v105, v105
    v_exp_f32 v106, v106
    v_exp_f32 v107, v107
    v_smfmac_f32_16x16x64_bf16 v[28:31], v[20:23], v[80:87], v24
    global_load_dwordx4 a[232:235], v1, s[36:37] offset:-2048
    v_exp_f32 v108, v108
    v_exp_f32 v109, v109
    v_smfmac_f32_16x16x64_bf16 v[28:31], v[20:23], v[88:95], v24
    global_load_lds_dwordx4 v9, s[46:47]
    v_exp_f32 v110, v110
    v_exp_f32 v111, v111
    v_mfma_f32_32x32x16_bf16 v[80:95], a[192:195], a[184:187], v[240:255]
    s_add_u32 m0, s30, 28672
    v_exp_f32 v112, v112
    v_exp_f32 v113, v113
    v_exp_f32 v114, v114
    v_mfma_f32_32x32x16_bf16 v[80:95], a[196:199], a[188:191], v[80:95]
    s_add_u32 s46, s46, 0x10000
    v_exp_f32 v115, v115
    v_exp_f32 v116, v116
    v_exp_f32 v117, v117
    v_smfmac_f32_32x32x32_bf16 v[176:191], a[216:219], v[96:103], v24
    s_addc_u32 s47, s47, 0
    v_exp_f32 v118, v118
    v_exp_f32 v119, v119
    v_exp_f32 v120, v120
    v_smfmac_f32_32x32x32_bf16 v[176:191], a[220:223], v[104:111], v24
    s_waitcnt vmcnt(12)
    buffer_store_dwordx4 a[76:79], v1, s[20:23], s56 offen offset:3072 sc1
    v_exp_f32 v121, v121
    v_exp_f32 v122, v122
    v_exp_f32 v123, v123
    v_smfmac_f32_16x16x64_bf16 v[32:35], v[20:23], v[96:103], v24
    global_load_dwordx4 a[236:239], v1, s[36:37] offset:-1024
    v_exp_f32 v124, v124
    v_exp_f32 v125, v125
    v_smfmac_f32_16x16x64_bf16 v[32:35], v[20:23], v[104:111], v24
    global_load_lds_dwordx4 v9, s[46:47]
    v_exp_f32 v126, v126
    v_exp_f32 v127, v127
    v_mfma_f32_32x32x16_bf16 v[96:111], a[200:203], a[160:163], v[128:143]
    s_add_u32 s33, s6, 0x30000
    v_exp_f32 v80, v80
    v_exp_f32 v81, v81
    v_exp_f32 v82, v82
    v_mfma_f32_32x32x16_bf16 v[96:111], a[204:207], a[164:167], v[96:111]
    s_and_b32 s33, s33, 0x3ffff
    v_exp_f32 v83, v83
    v_exp_f32 v84, v84
    v_exp_f32 v85, v85
    v_smfmac_f32_32x32x32_bf16 a[0:15], a[216:219], v[112:119], v24
    s_add_u32 s38, s4, s33
    v_exp_f32 v86, v86
    v_exp_f32 v87, v87
    v_exp_f32 v88, v88
    v_smfmac_f32_32x32x32_bf16 a[0:15], a[220:223], v[120:127], v24
    s_addc_u32 s39, s5, 0
    v_exp_f32 v89, v89
    v_exp_f32 v90, v90
    v_exp_f32 v91, v91
    v_smfmac_f32_16x16x64_bf16 v[48:51], v[20:23], v[112:119], v24
    global_load_dwordx4 a[192:195], v63, s[38:39] offset:-4096
    v_exp_f32 v92, v92
    v_exp_f32 v93, v93
    v_smfmac_f32_16x16x64_bf16 v[48:51], v[20:23], v[120:127], v24
    v_exp_f32 v94, v94
    v_exp_f32 v95, v95
    v_mfma_f32_32x32x16_bf16 v[112:127], a[200:203], a[168:171], v[144:159]
    s_add_u32 m0, s30, 32768
    v_exp_f32 v96, v96
    v_exp_f32 v97, v97
    v_exp_f32 v98, v98
    v_mfma_f32_32x32x16_bf16 v[112:127], a[204:207], a[172:175], v[112:127]
    s_add_u32 s46, s46, 0x10000
    v_exp_f32 v99, v99
    v_exp_f32 v100, v100
    v_exp_f32 v101, v101
    v_smfmac_f32_32x32x32_bf16 a[16:31], a[216:219], v[80:87], v24
hook7:
    s_cbranch_execz hook2
    s_addc_u32 s47, s47, 0
    v_exp_f32 v102, v102
    v_exp_f32 v103, v103
    v_exp_f32 v104, v104
    v_smfmac_f32_32x32x32_bf16 a[16:31], a[220:223], v[88:95], v24
    s_waitcnt vmcnt(11)
    s_add_u32 s56, s48, 12288
    buffer_store_dwordx4 a[80:83], v1, s[20:23], s56 offen offset:0 sc1
    v_exp_f32 v105, v105
    v_exp_f32 v106, v106
    v_exp_f32 v107, v107
    v_smfmac_f32_16x16x64_bf16 v[52:55], v[20:23], v[80:87], v24
    global_load_dwordx4 a[196:199], v63, s[38:39] offset:-3072
    v_exp_f32 v108, v108
    v_exp_f32 v109, v109
    v_smfmac_f32_16x16x64_bf16 v[52:55], v[20:23], v[88:95], v24
    global_load_lds_dwordx4 v9, s[46:47]
    v_exp_f32 v110, v110
    v_exp_f32 v111, v111
    v_mfma_f32_32x32x16_bf16 v[80:95], a[200:203], a[176:179], v[224:239]
    v_exp_f32 v112, v112
    v_exp_f32 v113, v113
    v_exp_f32 v114, v114
    v_mfma_f32_32x32x16_bf16 v[80:95], a[204:207], a[180:183], v[80:95]
    v_exp_f32 v115, v115
    v_exp_f32 v116, v116
    v_exp_f32 v117, v117
    v_smfmac_f32_32x32x32_bf16 v[160:175], a[224:227], v[96:103], v24
    v_exp_f32 v118, v118
    v_exp_f32 v119, v119
    v_exp_f32 v120, v120
    v_smfmac_f32_32x32x32_bf16 v[160:175], a[228:231], v[104:111], v24
    s_add_u32 m0, s30, 36864
    v_exp_f32 v121, v121
    v_exp_f32 v122, v122
    v_exp_f32 v123, v123
    v_smfmac_f32_16x16x64_bf16 v[28:31], v[20:23], v[96:103], v24
    buffer_load_dword v5, v19, s[20:23], 0 offen offset:128 sc1
    v_exp_f32 v124, v124
    v_exp_f32 v125, v125
    v_smfmac_f32_16x16x64_bf16 v[28:31], v[20:23], v[104:111], v24
    global_load_dwordx4 a[216:219], v1, s[38:39] offset:-2048
    v_exp_f32 v126, v126
    v_exp_f32 v127, v127
    v_mfma_f32_32x32x16_bf16 v[96:111], a[200:203], a[184:187], v[240:255]
    s_xor_b32 s28, s1, 0x80000
    v_exp_f32 v80, v80
    v_exp_f32 v81, v81
    v_exp_f32 v82, v82
    v_mfma_f32_32x32x16_bf16 v[96:111], a[204:207], a[188:191], v[96:111]
    s_add_u32 s46, s42, s28
    v_exp_f32 v83, v83
    v_exp_f32 v84, v84
    v_exp_f32 v85, v85
    v_smfmac_f32_32x32x32_bf16 v[176:191], a[224:227], v[112:119], v24
    s_addc_u32 s47, s43, 0
    v_exp_f32 v86, v86
    v_exp_f32 v87, v87
    v_exp_f32 v88, v88
    v_smfmac_f32_32x32x32_bf16 v[176:191], a[228:231], v[120:127], v24
    s_waitcnt vmcnt(12)
    buffer_store_dwordx4 a[84:87], v1, s[20:23], s56 offen offset:1024 sc1
    v_exp_f32 v89, v89
    v_exp_f32 v90, v90
    v_exp_f32 v91, v91
    v_smfmac_f32_16x16x64_bf16 v[32:35], v[20:23], v[112:119], v24
    global_load_dwordx4 a[220:223], v1, s[38:39] offset:-1024
    v_exp_f32 v92, v92
    v_exp_f32 v93, v93
    v_smfmac_f32_16x16x64_bf16 v[32:35], v[20:23], v[120:127], v24
    global_load_dword v45, v44, s[98:99]
    v_exp_f32 v94, v94
    v_exp_f32 v95, v95
    v_mfma_f32_32x32x16_bf16 v[112:127], a[208:211], a[160:163], v[128:143]
    s_add_u32 s33, s6, 0x38000
    v_exp_f32 v96, v96
    v_exp_f32 v97, v97
    v_exp_f32 v98, v98
    v_mfma_f32_32x32x16_bf16 v[112:127], a[212:215], a[164:167], v[112:127]
    s_and_b32 s33, s33, 0x3ffff
    v_exp_f32 v99, v99
    v_exp_f32 v100, v100
    v_exp_f32 v101, v101
    v_smfmac_f32_32x32x32_bf16 a[0:15], a[224:227], v[80:87], v24
    s_add_u32 s36, s4, s33
    v_exp_f32 v102, v102
    v_exp_f32 v103, v103
    v_exp_f32 v104, v104
    v_smfmac_f32_32x32x32_bf16 a[0:15], a[228:231], v[88:95], v24
    s_addc_u32 s37, s5, 0
    v_exp_f32 v105, v105
    v_exp_f32 v106, v106
    v_exp_f32 v107, v107
    v_smfmac_f32_16x16x64_bf16 v[48:51], v[20:23], v[80:87], v24
    global_load_dwordx4 a[200:203], v63, s[36:37] offset:-4096
    v_exp_f32 v108, v108
    v_exp_f32 v109, v109
    v_smfmac_f32_16x16x64_bf16 v[48:51], v[20:23], v[88:95], v24
    global_load_lds_dwordx4 v9, s[46:47]
    v_exp_f32 v110, v110
    v_exp_f32 v111, v111
    v_mfma_f32_32x32x16_bf16 v[80:95], a[208:211], a[168:171], v[144:159]
    s_add_u32 m0, s30, 40960
    v_exp_f32 v112, v112
    v_exp_f32 v113, v113
    v_exp_f32 v114, v114
    v_mfma_f32_32x32x16_bf16 v[80:95], a[212:215], a[172:175], v[80:95]
    s_add_u32 s46, s46, 0x10000
    v_exp_f32 v115, v115
    v_exp_f32 v116, v116
    v_exp_f32 v117, v117
    v_smfmac_f32_32x32x32_bf16 a[16:31], a[224:227], v[96:103], v24
    s_addc_u32 s47, s47, 0
    v_exp_f32 v118, v118
    v_exp_f32 v119, v119
    v_exp_f32 v120, v120
    v_smfmac_f32_32x32x32_bf16 a[16:31], a[228:231], v[104:111], v24
    s_waitcnt vmcnt(12)
    buffer_store_dwordx4 a[88:91], v1, s[20:23], s56 offen offset:2048 sc1
    v_exp_f32 v121, v121
    v_exp_f32 v122, v122
    v_exp_f32 v123, v123
    v_smfmac_f32_16x16x64_bf16 v[52:55], v[20:23], v[96:103], v24
    global_load_dwordx4 a[204:207], v63, s[36:37] offset:-3072
    v_exp_f32 v124, v124
    v_exp_f32 v125, v125
    v_smfmac_f32_16x16x64_bf16 v[52:55], v[20:23], v[104:111], v24
    global_load_lds_dwordx4 v9, s[46:47]
    v_exp_f32 v126, v126
    v_exp_f32 v127, v127
    v_mfma_f32_32x32x16_bf16 v[96:111], a[208:211], a[176:179], v[224:239]
    v_exp_f32 v80, v80
    v_exp_f32 v81, v81
    v_exp_f32 v82, v82
    v_mfma_f32_32x32x16_bf16 v[96:111], a[212:215], a[180:183], v[96:111]
    s_add_u32 m0, s30, 45056
    v_exp_f32 v83, v83
    v_exp_f32 v84, v84
    v_exp_f32 v85, v85
    v_smfmac_f32_32x32x32_bf16 v[160:175], a[232:235], v[112:119], v24
    s_add_u32 s46, s46, 0x10000
    v_exp_f32 v86, v86
    v_exp_f32 v87, v87
    v_exp_f32 v88, v88
    v_smfmac_f32_32x32x32_bf16 v[160:175], a[236:239], v[120:127], v24
    s_addc_u32 s47, s47, 0
    v_exp_f32 v89, v89
    v_exp_f32 v90, v90
    v_exp_f32 v91, v91
    v_smfmac_f32_16x16x64_bf16 v[28:31], v[20:23], v[112:119], v24
    global_load_dwordx4 a[224:227], v1, s[36:37] offset:-2048
    v_exp_f32 v92, v92
    v_exp_f32 v93, v93
    v_smfmac_f32_16x16x64_bf16 v[28:31], v[20:23], v[120:127], v24
    global_load_lds_dwordx4 v9, s[46:47]
    v_exp_f32 v94, v94
    v_exp_f32 v95, v95
    v_mfma_f32_32x32x16_bf16 v[112:127], a[208:211], a[184:187], v[240:255]
    s_add_u32 m0, s30, 49152
    v_exp_f32 v96, v96
    v_exp_f32 v97, v97
    v_exp_f32 v98, v98
    v_mfma_f32_32x32x16_bf16 v[112:127], a[212:215], a[188:191], v[112:127]
    s_add_u32 s46, s46, 0x10000
    v_exp_f32 v99, v99
    v_exp_f32 v100, v100
    v_exp_f32 v101, v101
    v_smfmac_f32_32x32x32_bf16 v[176:191], a[232:235], v[80:87], v24
    s_addc_u32 s47, s47, 0
    v_exp_f32 v102, v102
    v_exp_f32 v103, v103
    v_exp_f32 v104, v104
    v_smfmac_f32_32x32x32_bf16 v[176:191], a[236:239], v[88:95], v24
    s_waitcnt vmcnt(13)
    buffer_store_dwordx4 a[92:95], v1, s[20:23], s56 offen offset:3072 sc1
    v_exp_f32 v105, v105
    v_exp_f32 v106, v106
    v_exp_f32 v107, v107
    v_smfmac_f32_16x16x64_bf16 v[32:35], v[20:23], v[80:87], v24
    global_load_dwordx4 a[228:231], v1, s[36:37] offset:-1024
    v_exp_f32 v108, v108
    v_exp_f32 v109, v109
    v_smfmac_f32_16x16x64_bf16 v[32:35], v[20:23], v[88:95], v24
    global_load_lds_dwordx4 v9, s[46:47]
    v_exp_f32 v110, v110
    v_exp_f32 v111, v111
    s_waitcnt vmcnt(14)
    v_cmp_gt_u32 vcc, 1, v5
    s_cbranch_vccnz bpb1_spin
bpb1_ok:
    v_mfma_f32_32x32x16_bf16 v[80:95], a[192:195], a[160:163], v[128:143]
    s_add_u32 s33, s6, 0x8000
    v_exp_f32 v112, v112
    v_exp_f32 v113, v113
    v_exp_f32 v114, v114
    v_mfma_f32_32x32x16_bf16 v[80:95], a[196:199], a[164:167], v[80:95]
    s_and_b32 s33, s33, 0x3ffff
    v_exp_f32 v115, v115
    v_exp_f32 v116, v116
    v_exp_f32 v117, v117
    v_smfmac_f32_32x32x32_bf16 a[0:15], a[232:235], v[96:103], v24
    s_add_u32 s38, s4, s33
    v_exp_f32 v118, v118
    v_exp_f32 v119, v119
    v_exp_f32 v120, v120
    v_smfmac_f32_32x32x32_bf16 a[0:15], a[236:239], v[104:111], v24
    s_addc_u32 s39, s5, 0
    v_exp_f32 v121, v121
    v_exp_f32 v122, v122
    v_exp_f32 v123, v123
    v_smfmac_f32_16x16x64_bf16 v[48:51], v[20:23], v[96:103], v24
    global_load_dwordx4 a[208:211], v63, s[38:39] offset:0
    v_exp_f32 v124, v124
    v_exp_f32 v125, v125
    v_smfmac_f32_16x16x64_bf16 v[48:51], v[20:23], v[104:111], v24
    v_exp_f32 v126, v126
    v_exp_f32 v127, v127
    v_mfma_f32_32x32x16_bf16 v[96:111], a[192:195], a[168:171], v[144:159]
    v_exp_f32 v80, v80
    v_exp_f32 v81, v81
    v_exp_f32 v82, v82
    v_mfma_f32_32x32x16_bf16 v[96:111], a[196:199], a[172:175], v[96:111]
    v_exp_f32 v83, v83
    v_exp_f32 v84, v84
    v_exp_f32 v85, v85
    v_smfmac_f32_32x32x32_bf16 a[16:31], a[232:235], v[112:119], v24
    v_exp_f32 v86, v86
    v_exp_f32 v87, v87
    v_exp_f32 v88, v88
    v_smfmac_f32_32x32x32_bf16 a[16:31], a[236:239], v[120:127], v24
    s_waitcnt vmcnt(12)
    v_exp_f32 v89, v89
    v_exp_f32 v90, v90
    v_exp_f32 v91, v91
    v_smfmac_f32_16x16x64_bf16 v[52:55], v[20:23], v[112:119], v24
    global_load_dwordx4 a[212:215], v63, s[38:39] offset:1024
    v_exp_f32 v92, v92
    v_exp_f32 v93, v93
    v_smfmac_f32_16x16x64_bf16 v[52:55], v[20:23], v[120:127], v24
    v_exp_f32 v94, v94
    v_exp_f32 v95, v95
    v_mfma_f32_32x32x16_bf16 v[112:127], a[192:195], a[176:179], v[224:239]
    s_add_u32 m0, s30, 53248
    v_exp_f32 v96, v96
    v_exp_f32 v97, v97
    v_exp_f32 v98, v98
    v_mfma_f32_32x32x16_bf16 v[112:127], a[196:199], a[180:183], v[112:127]
    s_xor_b32 s28, s1, 0xc0000
    v_exp_f32 v99, v99
    v_exp_f32 v100, v100
    v_exp_f32 v101, v101
    v_smfmac_f32_32x32x32_bf16 v[160:175], a[216:219], v[80:87], v24
    s_add_u32 s46, s42, s28
    v_exp_f32 v102, v102
    v_exp_f32 v103, v103
    v_exp_f32 v104, v104
    v_smfmac_f32_32x32x32_bf16 v[160:175], a[220:223], v[88:95], v24
    s_addc_u32 s47, s43, 0
    v_exp_f32 v105, v105
    v_exp_f32 v106, v106
    v_exp_f32 v107, v107
    v_smfmac_f32_16x16x64_bf16 v[28:31], v[20:23], v[80:87], v24
    global_load_dwordx4 a[232:235], v1, s[38:39] offset:2048
    v_exp_f32 v108, v108
    v_exp_f32 v109, v109
    v_smfmac_f32_16x16x64_bf16 v[28:31], v[20:23], v[88:95], v24
    global_load_lds_dwordx4 v9, s[46:47]
    v_exp_f32 v110, v110
    v_exp_f32 v111, v111
    v_mfma_f32_32x32x16_bf16 v[80:95], a[192:195], a[184:187], v[240:255]
    s_add_u32 m0, s30, 57344
    v_exp_f32 v112, v112
    v_exp_f32 v113, v113
    v_exp_f32 v114, v114
    v_mfma_f32_32x32x16_bf16 v[80:95], a[196:199], a[188:191], v[80:95]
    s_add_u32 s46, s46, 0x10000
    v_exp_f32 v115, v115
    v_exp_f32 v116, v116
    v_exp_f32 v117, v117
    v_smfmac_f32_32x32x32_bf16 v[176:191], a[216:219], v[96:103], v24
    s_addc_u32 s47, s47, 0
    v_exp_f32 v118, v118
    v_exp_f32 v119, v119
    v_exp_f32 v120, v120
    v_smfmac_f32_32x32x32_bf16 v[176:191], a[220:223], v[104:111], v24
    s_waitcnt vmcnt(10)
    v_exp_f32 v121, v121
    v_exp_f32 v122, v122
    v_exp_f32 v123, v123
    v_smfmac_f32_16x16x64_bf16 v[32:35], v[20:23], v[96:103], v24
    global_load_dwordx4 a[236:239], v1, s[38:39] offset:3072
    v_exp_f32 v124, v124
    v_exp_f32 v125, v125
    v_smfmac_f32_16x16x64_bf16 v[32:35], v[20:23], v[104:111], v24
    global_load_lds_dwordx4 v9, s[46:47]
    v_exp_f32 v126, v126
    v_exp_f32 v127, v127
    v_mfma_f32_32x32x16_bf16 v[96:111], a[200:203], a[160:163], v[128:143]
    s_add_u32 s33, s6, 0x10000
    v_exp_f32 v80, v80
    v_exp_f32 v81, v81
    v_exp_f32 v82, v82
    v_mfma_f32_32x32x16_bf16 v[96:111], a[204:207], a[164:167], v[96:111]
    s_and_b32 s33, s33, 0x3ffff
    v_exp_f32 v83, v83
    v_exp_f32 v84, v84
    v_exp_f32 v85, v85
    v_smfmac_f32_32x32x32_bf16 a[0:15], a[216:219], v[112:119], v24
    s_add_u32 s36, s4, s33
    v_exp_f32 v86, v86
    v_exp_f32 v87, v87
    v_exp_f32 v88, v88
    v_smfmac_f32_32x32x32_bf16 a[0:15], a[220:223], v[120:127], v24
    s_addc_u32 s37, s5, 0
    v_exp_f32 v89, v89
    v_exp_f32 v90, v90
    v_exp_f32 v91, v91
    v_smfmac_f32_16x16x64_bf16 v[48:51], v[20:23], v[112:119], v24
    global_load_dwordx4 a[192:195], v63, s[36:37] offset:0
    v_exp_f32 v92, v92
    v_exp_f32 v93, v93
    v_smfmac_f32_16x16x64_bf16 v[48:51], v[20:23], v[120:127], v24
    s_waitcnt vmcnt(9)
    buffer_store_dword v24, v25, s[20:23], s54 offen offset:256 sc1
    v_exp_f32 v94, v94
    v_exp_f32 v95, v95
    v_mfma_f32_32x32x16_bf16 v[112:127], a[200:203], a[168:171], v[144:159]
    s_add_u32 m0, s30, 61440
    v_exp_f32 v96, v96
    v_exp_f32 v97, v97
    v_exp_f32 v98, v98
    v_mfma_f32_32x32x16_bf16 v[112:127], a[204:207], a[172:175], v[112:127]
    s_add_u32 s46, s46, 0x10000
    v_exp_f32 v99, v99
    v_exp_f32 v100, v100
    v_exp_f32 v101, v101
    v_smfmac_f32_32x32x32_bf16 a[16:31], a[216:219], v[80:87], v24
    s_addc_u32 s47, s47, 0
    v_exp_f32 v102, v102
    v_exp_f32 v103, v103
    v_exp_f32 v104, v104
    v_smfmac_f32_32x32x32_bf16 a[16:31], a[220:223], v[88:95], v24
    s_waitcnt vmcnt(9)
    v_exp_f32 v105, v105
    v_exp_f32 v106, v106
    v_exp_f32 v107, v107
    v_smfmac_f32_16x16x64_bf16 v[52:55], v[20:23], v[80:87], v24
    global_load_dwordx4 a[196:199], v63, s[36:37] offset:1024
    v_exp_f32 v108, v108
    v_exp_f32 v109, v109
    v_smfmac_f32_16x16x64_bf16 v[52:55], v[20:23], v[88:95], v24
    global_load_lds_dwordx4 v9, s[46:47]
    v_exp_f32 v110, v110
    v_exp_f32 v111, v111
    v_mfma_f32_32x32x16_bf16 v[80:95], a[200:203], a[176:179], v[224:239]
    v_exp_f32 v112, v112
    v_exp_f32 v113, v113
    v_exp_f32 v114, v114
    v_mfma_f32_32x32x16_bf16 v[80:95], a[204:207], a[180:183], v[80:95]
    s_add_u32 m0, s30, 65536
    v_exp_f32 v115, v115
    v_exp_f32 v116, v116
    v_exp_f32 v117, v117
    v_smfmac_f32_32x32x32_bf16 v[160:175], a[224:227], v[96:103], v24
    s_add_u32 s46, s46, 0x10000
    v_exp_f32 v118, v118
    v_exp_f32 v119, v119
    v_exp_f32 v120, v120
    v_smfmac_f32_32x32x32_bf16 v[160:175], a[228:231], v[104:111], v24
    s_addc_u32 s47, s47, 0
    v_exp_f32 v121, v121
    v_exp_f32 v122, v122
    v_exp_f32 v123, v123
    v_smfmac_f32_16x16x64_bf16 v[28:31], v[20:23], v[96:103], v24
    global_load_dwordx4 a[216:219], v1, s[36:37] offset:2048
    v_exp_f32 v124, v124
    v_exp_f32 v125, v125
    v_smfmac_f32_16x16x64_bf16 v[28:31], v[20:23], v[104:111], v24
    global_load_lds_dwordx4 v9, s[46:47]
    v_exp_f32 v126, v126
    v_exp_f32 v127, v127
    v_mfma_f32_32x32x16_bf16 v[96:111], a[200:203], a[184:187], v[240:255]
    v_exp_f32 v80, v80
    v_exp_f32 v81, v81
    v_exp_f32 v82, v82
    v_mfma_f32_32x32x16_bf16 v[96:111], a[204:207], a[188:191], v[96:111]
    v_exp_f32 v83, v83
    v_exp_f32 v84, v84
    v_exp_f32 v85, v85
    v_smfmac_f32_32x32x32_bf16 v[176:191], a[224:227], v[112:119], v24
    s_add_u32 m0, s30, 69632
    v_exp_f32 v86, v86
    v_exp_f32 v87, v87
    v_exp_f32 v88, v88
    v_smfmac_f32_32x32x32_bf16 v[176:191], a[228:231], v[120:127], v24
    s_waitcnt vmcnt(10)
    v_exp_f32 v89, v89
    v_exp_f32 v90, v90
    v_exp_f32 v91, v91
    v_smfmac_f32_16x16x64_bf16 v[32:35], v[20:23], v[112:119], v24
    global_load_dwordx4 a[220:223], v1, s[36:37] offset:3072
    v_exp_f32 v92, v92
    v_exp_f32 v93, v93
    v_smfmac_f32_16x16x64_bf16 v[32:35], v[20:23], v[120:127], v24
    v_exp_f32 v94, v94
    v_exp_f32 v95, v95
    v_mfma_f32_32x32x16_bf16 v[112:127], a[208:211], a[160:163], v[128:143]
    s_add_u32 s33, s6, 0x18000
    v_exp_f32 v96, v96
    v_exp_f32 v97, v97
    v_exp_f32 v98, v98
    v_mfma_f32_32x32x16_bf16 v[112:127], a[212:215], a[164:167], v[112:127]
    s_and_b32 s33, s33, 0x3ffff
    v_exp_f32 v99, v99
    v_exp_f32 v100, v100
    v_exp_f32 v101, v101
    v_smfmac_f32_32x32x32_bf16 a[0:15], a[224:227], v[80:87], v24
    s_add_u32 s38, s4, s33
    v_exp_f32 v102, v102
    v_exp_f32 v103, v103
    v_exp_f32 v104, v104
    v_smfmac_f32_32x32x32_bf16 a[0:15], a[228:231], v[88:95], v24
    s_addc_u32 s39, s5, 0
    v_exp_f32 v105, v105
    v_exp_f32 v106, v106
    v_exp_f32 v107, v107
    v_smfmac_f32_16x16x64_bf16 v[48:51], v[20:23], v[80:87], v24
    global_load_dwordx4 a[200:203], v63, s[38:39] offset:0
    v_exp_f32 v108, v108
    v_exp_f32 v109, v109
    v_smfmac_f32_16x16x64_bf16 v[48:51], v[20:23], v[88:95], v24
    v_exp_f32 v110, v110
    v_exp_f32 v111, v111
    v_mfma_f32_32x32x16_bf16 v[80:95], a[208:211], a[168:171], v[144:159]
    s_xor_b32 s28, s1, 0x100000
    v_exp_f32 v112, v112
    v_exp_f32 v113, v113
    v_exp_f32 v114, v114
    v_mfma_f32_32x32x16_bf16 v[80:95], a[212:215], a[172:175], v[80:95]
    s_add_u32 s46, s42, s28
    v_exp_f32 v115, v115
    v_exp_f32 v116, v116
    v_exp_f32 v117, v117
    v_smfmac_f32_32x32x32_bf16 a[16:31], a[224:227], v[96:103], v24
    s_addc_u32 s47, s43, 0
    v_exp_f32 v118, v118
    v_exp_f32 v119, v119
    v_exp_f32 v120, v120
    v_smfmac_f32_32x32x32_bf16 a[16:31], a[228:231], v[104:111], v24
    s_waitcnt vmcnt(9)
    v_exp_f32 v121, v121
    v_exp_f32 v122, v122
    v_exp_f32 v123, v123
    v_smfmac_f32_16x16x64_bf16 v[52:55], v[20:23], v[96:103], v24
    global_load_dwordx4 a[204:207], v63, s[38:39] offset:1024
    v_exp_f32 v124, v124
    v_exp_f32 v125, v125
    v_smfmac_f32_16x16x64_bf16 v[52:55], v[20:23], v[104:111], v24
    global_load_lds_dwordx4 v9, s[46:47]
    v_exp_f32 v126, v126
    v_exp_f32 v127, v127
    v_mfma_f32_32x32x16_bf16 v[96:111], a[208:211], a[176:179], v[224:239]
    v_exp_f32 v80, v80
    v_exp_f32 v81, v81
    v_exp_f32 v82, v82
    v_mfma_f32_32x32x16_bf16 v[96:111], a[212:215], a[180:183], v[96:111]
    s_add_u32 m0, s30, 73728
    v_exp_f32 v83, v83
    v_exp_f32 v84, v84
    v_exp_f32 v85, v85
    v_smfmac_f32_32x32x32_bf16 v[160:175], a[232:235], v[112:119], v24
    s_add_u32 s46, s46, 0x10000
    v_exp_f32 v86, v86
    v_exp_f32 v87, v87
    v_exp_f32 v88, v88
    v_smfmac_f32_32x32x32_bf16 v[160:175], a[236:239], v[120:127], v24
    s_addc_u32 s47, s47, 0
    v_exp_f32 v89, v89
    v_exp_f32 v90, v90
    v_exp_f32 v91, v91
    v_smfmac_f32_16x16x64_bf16 v[28:31], v[20:23], v[112:119], v24
    global_load_dwordx4 a[224:227], v1, s[38:39] offset:2048
    v_exp_f32 v92, v92
    v_exp_f32 v93, v93
    v_smfmac_f32_16x16x64_bf16 v[28:31], v[20:23], v[120:127], v24
    global_load_lds_dwordx4 v9, s[46:47]
    v_exp_f32 v94, v94
    v_exp_f32 v95, v95
    v_mfma_f32_32x32x16_bf16 v[112:127], a[208:211], a[184:187], v[240:255]
    s_add_u32 m0, s30, 77824
    v_exp_f32 v96, v96
    v_exp_f32 v97, v97
    v_exp_f32 v98, v98
    v_mfma_f32_32x32x16_bf16 v[112:127], a[212:215], a[188:191], v[112:127]
    s_add_u32 s46, s46, 0x10000
    v_exp_f32 v99, v99
    v_exp_f32 v100, v100
    v_exp_f32 v101, v101
    v_smfmac_f32_32x32x32_bf16 v[176:191], a[232:235], v[80:87], v24
    s_addc_u32 s47, s47, 0
    v_exp_f32 v102, v102
    v_exp_f32 v103, v103
    v_exp_f32 v104, v104
    v_smfmac_f32_32x32x32_bf16 v[176:191], a[236:239], v[88:95], v24
    s_waitcnt vmcnt(9)
    v_exp_f32 v105, v105
    v_exp_f32 v106, v106
    v_exp_f32 v107, v107
    v_smfmac_f32_16x16x64_bf16 v[32:35], v[20:23], v[80:87], v24
    global_load_dwordx4 a[228:231], v1, s[38:39] offset:3072
    v_exp_f32 v108, v108
    v_exp_f32 v109, v109
    v_smfmac_f32_16x16x64_bf16 v[32:35], v[20:23], v[88:95], v24
    global_load_lds_dwordx4 v9, s[46:47]
    v_exp_f32 v110, v110
    v_exp_f32 v111, v111
    v_mfma_f32_32x32x16_bf16 v[80:95], a[192:195], a[160:163], v[128:143]
    s_add_u32 s33, s6, 0x20000
    v_exp_f32 v112, v112
    v_exp_f32 v113, v113
    v_exp_f32 v114, v114
    v_mfma_f32_32x32x16_bf16 v[80:95], a[196:199], a[164:167], v[80:95]
    s_and_b32 s33, s33, 0x3ffff
    v_exp_f32 v115, v115
    v_exp_f32 v116, v116
    v_exp_f32 v117, v117
    v_smfmac_f32_32x32x32_bf16 a[0:15], a[232:235], v[96:103], v24
    s_add_u32 s36, s4, s33
    v_exp_f32 v118, v118
    v_exp_f32 v119, v119
    v_exp_f32 v120, v120
    v_smfmac_f32_32x32x32_bf16 a[0:15], a[236:239], v[104:111], v24
    s_addc_u32 s37, s5, 0
    v_exp_f32 v121, v121
    v_exp_f32 v122, v122
    v_exp_f32 v123, v123
    v_smfmac_f32_16x16x64_bf16 v[48:51], v[20:23], v[96:103], v24
    global_load_dwordx4 a[208:211], v63, s[36:37] offset:0
    v_exp_f32 v124, v124
    v_exp_f32 v125, v125
    v_smfmac_f32_16x16x64_bf16 v[48:51], v[20:23], v[104:111], v24
    v_exp_f32 v126, v126
    v_exp_f32 v127, v127
    v_mfma_f32_32x32x16_bf16 v[96:111], a[192:195], a[168:171], v[144:159]
    s_add_u32 m0, s30, 81920
    v_exp_f32 v80, v80
    v_exp_f32 v81, v81
    v_exp_f32 v82, v82
    v_mfma_f32_32x32x16_bf16 v[96:111], a[196:199], a[172:175], v[96:111]
    s_add_u32 s46, s46, 0x10000
    v_exp_f32 v83, v83
    v_exp_f32 v84, v84
    v_exp_f32 v85, v85
    v_smfmac_f32_32x32x32_bf16 a[16:31], a[232:235], v[112:119], v24
    s_addc_u32 s47, s47, 0
    v_exp_f32 v86, v86
    v_exp_f32 v87, v87
    v_exp_f32 v88, v88
    v_smfmac_f32_32x32x32_bf16 a[16:31], a[236:239], v[120:127], v24
    s_waitcnt vmcnt(8)
    v_exp_f32 v89, v89
    v_exp_f32 v90, v90
    v_exp_f32 v91, v91
    v_smfmac_f32_16x16x64_bf16 v[52:55], v[20:23], v[112:119], v24
    global_load_dwordx4 a[212:215], v63, s[36:37] offset:1024
    v_exp_f32 v92, v92
    v_exp_f32 v93, v93
    v_smfmac_f32_16x16x64_bf16 v[52:55], v[20:23], v[120:127], v24
    global_load_lds_dwordx4 v9, s[46:47]
    v_exp_f32 v94, v94
    v_exp_f32 v95, v95
    v_mfma_f32_32x32x16_bf16 v[112:127], a[192:195], a[176:179], v[224:239]
    s_add_u32 m0, s30, 86016
    v_exp_f32 v96, v96
    v_exp_f32 v97, v97
    v_exp_f32 v98, v98
    v_mfma_f32_32x32x16_bf16 v[112:127], a[196:199], a[180:183], v[112:127]
    s_xor_b32 s28, s1, 0x140000
    v_exp_f32 v99, v99
    v_exp_f32 v100, v100
    v_exp_f32 v101, v101
    v_smfmac_f32_32x32x32_bf16 v[160:175], a[216:219], v[80:87], v24
    s_add_u32 s46, s42, s28
    v_exp_f32 v102, v102
    v_exp_f32 v103, v103
    v_exp_f32 v104, v104
    v_smfmac_f32_32x32x32_bf16 v[160:175], a[220:223], v[88:95], v24
    s_addc_u32 s47, s43, 0
    v_exp_f32 v105, v105
    v_exp_f32 v106, v106
    v_exp_f32 v107, v107
    v_smfmac_f32_16x16x64_bf16 v[28:31], v[20:23], v[80:87], v24
    global_load_dwordx4 a[232:235], v1, s[36:37] offset:2048
    v_exp_f32 v108, v108
    v_exp_f32 v109, v109
    v_smfmac_f32_16x16x64_bf16 v[28:31], v[20:23], v[88:95], v24
    global_load_lds_dwordx4 v9, s[46:47]
    v_exp_f32 v110, v110
    v_exp_f32 v111, v111
    v_mfma_f32_32x32x16_bf16 v[80:95], a[192:195], a[184:187], v[240:255]
    s_add_u32 m0, s30, 90112
    v_exp_f32 v112, v112
    v_exp_f32 v113, v113
    v_exp_f32 v114, v114
    v_mfma_f32_32x32x16_bf16 v[80:95], a[196:199], a[188:191], v[80:95]
    s_add_u32 s46, s46, 0x10000
    v_exp_f32 v115, v115
    v_exp_f32 v116, v116
    v_exp_f32 v117, v117
    v_smfmac_f32_32x32x32_bf16 v[176:191], a[216:219], v[96:103], v24
    s_addc_u32 s47, s47, 0
    v_exp_f32 v118, v118
    v_exp_f32 v119, v119
    v_exp_f32 v120, v120
    v_smfmac_f32_32x32x32_bf16 v[176:191], a[220:223], v[104:111], v24
    s_waitcnt vmcnt(10)
    v_exp_f32 v121, v121
    v_exp_f32 v122, v122
    v_exp_f32 v123, v123
    v_smfmac_f32_16x16x64_bf16 v[32:35], v[20:23], v[96:103], v24
    global_load_dwordx4 a[236:239], v1, s[36:37] offset:3072
    v_exp_f32 v124, v124
    v_exp_f32 v125, v125
    v_smfmac_f32_16x16x64_bf16 v[32:35], v[20:23], v[104:111], v24
    global_load_lds_dwordx4 v9, s[46:47]
    v_exp_f32 v126, v126
    v_exp_f32 v127, v127
    v_mfma_f32_32x32x16_bf16 v[96:111], a[200:203], a[160:163], v[128:143]
    s_add_u32 s33, s6, 0x28000
    v_exp_f32 v80, v80
    v_exp_f32 v81, v81
    v_exp_f32 v82, v82
    v_mfma_f32_32x32x16_bf16 v[96:111], a[204:207], a[164:167], v[96:111]
    s_and_b32 s33, s33, 0x3ffff
    v_exp_f32 v83, v83
    v_exp_f32 v84, v84
    v_exp_f32 v85, v85
    v_smfmac_f32_32x32x32_bf16 a[0:15], a[216:219], v[112:119], v24
    s_add_u32 s38, s4, s33
    v_exp_f32 v86, v86
    v_exp_f32 v87, v87
    v_exp_f32 v88, v88
    v_smfmac_f32_32x32x32_bf16 a[0:15], a[220:223], v[120:127], v24
    s_addc_u32 s39, s5, 0
    v_exp_f32 v89, v89
    v_exp_f32 v90, v90
    v_exp_f32 v91, v91
    v_smfmac_f32_16x16x64_bf16 v[48:51], v[20:23], v[112:119], v24
    global_load_dwordx4 a[192:195], v63, s[38:39] offset:0
    v_exp_f32 v92, v92
    v_exp_f32 v93, v93
    v_smfmac_f32_16x16x64_bf16 v[48:51], v[20:23], v[120:127], v24
    v_exp_f32 v94, v94
    v_exp_f32 v95, v95
    v_mfma_f32_32x32x16_bf16 v[112:127], a[200:203], a[168:171], v[144:159]
    v_exp_f32 v96, v96
    v_exp_f32 v97, v97
    v_exp_f32 v98, v98
    v_mfma_f32_32x32x16_bf16 v[112:127], a[204:207], a[172:175], v[112:127]
    v_exp_f32 v99, v99
    v_exp_f32 v100, v100
    v_exp_f32 v101, v101
    v_smfmac_f32_32x32x32_bf16 a[16:31], a[216:219], v[80:87], v24
    v_exp_f32 v102, v102
    v_exp_f32 v103, v103
    v_exp_f32 v104, v104
    v_smfmac_f32_32x32x32_bf16 a[16:31], a[220:223], v[88:95], v24
    s_waitcnt vmcnt(9)
    v_exp_f32 v105, v105
    v_exp_f32 v106, v106
    v_exp_f32 v107, v107
    v_smfmac_f32_16x16x64_bf16 v[52:55], v[20:23], v[80:87], v24
    buffer_load_dword v8, v18, s[20:23], 0 offen offset:256 sc1
    v_exp_f32 v108, v108
    v_exp_f32 v109, v109
    v_smfmac_f32_16x16x64_bf16 v[52:55], v[20:23], v[88:95], v24
    global_load_dwordx4 a[196:199], v63, s[38:39] offset:1024
    v_exp_f32 v110, v110
    v_exp_f32 v111, v111
    v_mfma_f32_32x32x16_bf16 v[80:95], a[200:203], a[176:179], v[224:239]
    v_exp_f32 v112, v112
    v_exp_f32 v113, v113
    v_exp_f32 v114, v114
    v_mfma_f32_32x32x16_bf16 v[80:95], a[204:207], a[180:183], v[80:95]
    s_add_u32 m0, s30, 94208
    v_exp_f32 v115, v115
    v_exp_f32 v116, v116
    v_exp_f32 v117, v117
    v_smfmac_f32_32x32x32_bf16 v[160:175], a[224:227], v[96:103], v24
    s_add_u32 s46, s46, 0x10000
    v_exp_f32 v118, v118
    v_exp_f32 v119, v119
    v_exp_f32 v120, v120
    v_smfmac_f32_32x32x32_bf16 v[160:175], a[228:231], v[104:111], v24
    s_addc_u32 s47, s47, 0
    v_exp_f32 v121, v121
    v_exp_f32 v122, v122
    v_exp_f32 v123, v123
    v_smfmac_f32_16x16x64_bf16 v[28:31], v[20:23], v[96:103], v24
    global_load_dwordx4 a[216:219], v1, s[38:39] offset:2048
    v_exp_f32 v124, v124
    v_exp_f32 v125, v125
    v_smfmac_f32_16x16x64_bf16 v[28:31], v[20:23], v[104:111], v24
    global_load_lds_dwordx4 v9, s[46:47]
    v_exp_f32 v126, v126
    v_exp_f32 v127, v127
    v_mfma_f32_32x32x16_bf16 v[96:111], a[200:203], a[184:187], v[240:255]
    s_add_u32 m0, s30, 98304
    v_exp_f32 v80, v80
    v_exp_f32 v81, v81
    v_exp_f32 v82, v82
    v_mfma_f32_32x32x16_bf16 v[96:111], a[204:207], a[188:191], v[96:111]
    s_add_u32 s46, s46, 0x10000
    v_exp_f32 v83, v83
    v_exp_f32 v84, v84
    v_exp_f32 v85, v85
    v_smfmac_f32_32x32x32_bf16 v[176:191], a[224:227], v[112:119], v24
    s_addc_u32 s47, s47, 0
    v_exp_f32 v86, v86
    v_exp_f32 v87, v87
    v_exp_f32 v88, v88
    v_smfmac_f32_32x32x32_bf16 v[176:191], a[228:231], v[120:127], v24
    s_waitcnt vmcnt(10)
    v_exp_f32 v89, v89
    v_exp_f32 v90, v90
    v_exp_f32 v91, v91
    v_smfmac_f32_16x16x64_bf16 v[32:35], v[20:23], v[112:119], v24
    global_load_dwordx4 a[220:223], v1, s[38:39] offset:3072
    v_exp_f32 v92, v92
    v_exp_f32 v93, v93
    v_smfmac_f32_16x16x64_bf16 v[32:35], v[20:23], v[120:127], v24
    global_load_lds_dwordx4 v9, s[46:47]
    v_exp_f32 v94, v94
    v_exp_f32 v95, v95
    v_mfma_f32_32x32x16_bf16 v[112:127], a[208:211], a[160:163], v[128:143]
    s_add_u32 s33, s6, 0x30000
    v_exp_f32 v96, v96
    v_exp_f32 v97, v97
    v_exp_f32 v98, v98
    v_mfma_f32_32x32x16_bf16 v[112:127], a[212:215], a[164:167], v[112:127]
    s_and_b32 s33, s33, 0x3ffff
    v_exp_f32 v99, v99
    v_exp_f32 v100, v100
    v_exp_f32 v101, v101
    v_smfmac_f32_32x32x32_bf16 a[0:15], a[224:227], v[80:87], v24
    s_add_u32 s36, s4, s33
    v_exp_f32 v102, v102
    v_exp_f32 v103, v103
    v_exp_f32 v104, v104
    v_smfmac_f32_32x32x32_bf16 a[0:15], a[228:231], v[88:95], v24
    s_addc_u32 s37, s5, 0
    v_exp_f32 v105, v105
    v_exp_f32 v106, v106
    v_exp_f32 v107, v107
    v_smfmac_f32_16x16x64_bf16 v[48:51], v[20:23], v[80:87], v24
hook8:
    s_cbranch_execz hook1
    global_load_dwordx4 a[200:203], v63, s[36:37] offset:0
    v_exp_f32 v108, v108
    v_exp_f32 v109, v109
    v_smfmac_f32_16x16x64_bf16 v[48:51], v[20:23], v[88:95], v24
    v_exp_f32 v110, v110
    v_exp_f32 v111, v111
    v_mfma_f32_32x32x16_bf16 v[80:95], a[208:211], a[168:171], v[144:159]
    v_exp_f32 v112, v112
    v_exp_f32 v113, v113
    v_exp_f32 v114, v114
    v_mfma_f32_32x32x16_bf16 v[80:95], a[212:215], a[172:175], v[80:95]
    s_add_u32 m0, s30, 102400
    v_exp_f32 v115, v115
    v_exp_f32 v116, v116
    v_exp_f32 v117, v117
    v_smfmac_f32_32x32x32_bf16 a[16:31], a[224:227], v[96:103], v24
    s_xor_b32 s28, s1, 0x180000
    v_exp_f32 v118, v118
    v_exp_f32 v119, v119
    v_exp_f32 v120, v120
    v_smfmac_f32_32x32x32_bf16 a[16:31], a[228:231], v[104:111], v24
    s_waitcnt vmcnt(9)
    v_exp_f32 v121, v121
    v_exp_f32 v122, v122
    v_exp_f32 v123, v123
    v_smfmac_f32_16x16x64_bf16 v[52:55], v[20:23], v[96:103], v24
    global_load_dwordx4 a[204:207], v63, s[36:37] offset:1024
    v_exp_f32 v124, v124
    v_exp_f32 v125, v125
    v_smfmac_f32_16x16x64_bf16 v[52:55], v[20:23], v[104:111], v24
    v_exp_f32 v126, v126
    v_exp_f32 v127, v127
    s_waitcnt vmcnt(7)
    v_cmp_gt_u32 vcc, 1, v8
    s_cbranch_vccnz bpa_spin
bpa_ok:
    v_mfma_f32_32x32x16_bf16 v[96:111], a[208:211], a[176:179], v[224:239]
    s_add_u32 s46, s42, s28
    buffer_load_dwordx4 v[64:67], v1, s[20:23], s31 offen offset:0
    v_exp_f32 v80, v80
    v_exp_f32 v81, v81
    v_exp_f32 v82, v82
    v_mfma_f32_32x32x16_bf16 v[96:111], a[212:215], a[180:183], v[96:111]
    s_addc_u32 s47, s43, 0
    buffer_load_dwordx4 v[68:71], v1, s[20:23], s31 offen offset:1024
    v_exp_f32 v83, v83
    v_exp_f32 v84, v84
    v_exp_f32 v85, v85
    v_smfmac_f32_32x32x32_bf16 v[160:175], a[232:235], v[112:119], v24
    s_add_i32 s29, s3, 8192
    buffer_load_dwordx4 v[72:75], v1, s[20:23], s31 offen offset:2048
    v_exp_f32 v86, v86
    v_exp_f32 v87, v87
    v_exp_f32 v88, v88
    v_smfmac_f32_32x32x32_bf16 v[160:175], a[236:239], v[120:127], v24
    s_max_i32 s29, s29, 0
    buffer_load_dwordx4 v[76:79], v1, s[20:23], s31 offen offset:3072
    v_exp_f32 v89, v89
    v_exp_f32 v90, v90
    v_exp_f32 v91, v91
    v_smfmac_f32_16x16x64_bf16 v[28:31], v[20:23], v[112:119], v24
    global_load_dwordx4 a[224:227], v1, s[36:37] offset:2048
    v_exp_f32 v92, v92
    v_exp_f32 v93, v93
    v_smfmac_f32_16x16x64_bf16 v[28:31], v[20:23], v[120:127], v24
    global_load_lds_dwordx4 v9, s[46:47]
    v_exp_f32 v94, v94
    v_exp_f32 v95, v95
    v_mfma_f32_32x32x16_bf16 v[112:127], a[208:211], a[184:187], v[240:255]
    v_exp_f32 v96, v96
    v_exp_f32 v97, v97
    v_exp_f32 v98, v98
    v_mfma_f32_32x32x16_bf16 v[112:127], a[212:215], a[188:191], v[112:127]
    s_add_u32 s40, s58, s29
    v_exp_f32 v99, v99
    v_exp_f32 v100, v100
    v_exp_f32 v101, v101
    v_smfmac_f32_32x32x32_bf16 v[176:191], a[232:235], v[80:87], v24
    s_addc_u32 s41, s59, 0
    v_exp_f32 v102, v102
    v_exp_f32 v103, v103
    v_exp_f32 v104, v104
    v_smfmac_f32_32x32x32_bf16 v[176:191], a[236:239], v[88:95], v24
    s_waitcnt vmcnt(12)
    v_exp_f32 v105, v105
    v_exp_f32 v106, v106
    v_exp_f32 v107, v107
    v_smfmac_f32_16x16x64_bf16 v[32:35], v[20:23], v[80:87], v24
    global_load_dwordx4 a[228:231], v1, s[36:37] offset:3072
    v_exp_f32 v108, v108
    v_exp_f32 v109, v109
    v_smfmac_f32_16x16x64_bf16 v[32:35], v[20:23], v[88:95], v24
    global_load_dwordx4 a[64:67], v63, s[40:41] offset:-4096
    v_exp_f32 v110, v110
    v_exp_f32 v111, v111
    v_mfma_f32_32x32x16_bf16 v[80:95], a[192:195], a[160:163], v[128:143]
    s_add_i32 s29, s3, 0
    v_exp_f32 v112, v112
    v_exp_f32 v113, v113
    v_exp_f32 v114, v114
    v_mfma_f32_32x32x16_bf16 v[80:95], a[196:199], a[164:167], v[80:95]
    s_max_i32 s29, s29, 0
    v_exp_f32 v115, v115
    v_exp_f32 v116, v116
    v_exp_f32 v117, v117
    v_smfmac_f32_32x32x32_bf16 a[0:15], a[232:235], v[96:103], v24
    s_add_u32 s12, s58, s29
    v_exp_f32 v118, v118
    v_exp_f32 v119, v119
    v_exp_f32 v120, v120
    v_smfmac_f32_32x32x32_bf16 a[0:15], a[236:239], v[104:111], v24
    s_addc_u32 s13, s59, 0
    v_exp_f32 v121, v121
    v_exp_f32 v122, v122
    v_exp_f32 v123, v123
    v_smfmac_f32_16x16x64_bf16 v[48:51], v[20:23], v[96:103], v24
    global_load_dwordx4 a[68:71], v63, s[40:41] offset:-3072
    v_exp_f32 v124, v124
    v_exp_f32 v125, v125
    v_smfmac_f32_16x16x64_bf16 v[48:51], v[20:23], v[104:111], v24
    global_load_dwordx4 a[32:35], v63, s[12:13] offset:-4096
    v_exp_f32 v126, v126
    v_exp_f32 v127, v127
    v_mfma_f32_32x32x16_bf16 v[96:111], a[192:195], a[168:171], v[144:159]
    v_exp_f32 v80, v80
    v_exp_f32 v81, v81
    v_exp_f32 v82, v82
    v_mfma_f32_32x32x16_bf16 v[96:111], a[196:199], a[172:175], v[96:111]
    v_exp_f32 v83, v83
    v_exp_f32 v84, v84
    v_exp_f32 v85, v85
    v_smfmac_f32_32x32x32_bf16 a[16:31], a[232:235], v[112:119], v24
    v_exp_f32 v86, v86
    v_exp_f32 v87, v87
    v_exp_f32 v88, v88
    v_smfmac_f32_32x32x32_bf16 a[16:31], a[236:239], v[120:127], v24
    s_waitcnt vmcnt(13)
    v_exp_f32 v89, v89
    v_exp_f32 v90, v90
    v_exp_f32 v91, v91
    v_smfmac_f32_16x16x64_bf16 v[52:55], v[20:23], v[112:119], v24
    global_load_dwordx4 a[36:39], v63, s[12:13] offset:-3072
    v_exp_f32 v92, v92
    v_exp_f32 v93, v93
    v_smfmac_f32_16x16x64_bf16 v[52:55], v[20:23], v[120:127], v24
    global_load_dwordx4 a[72:75], v1, s[40:41] offset:-2048
    v_exp_f32 v94, v94
    v_exp_f32 v95, v95
    v_mfma_f32_32x32x16_bf16 v[112:127], a[192:195], a[176:179], v[224:239]
    v_exp_f32 v96, v96
    v_exp_f32 v97, v97
    v_exp_f32 v98, v98
    v_mfma_f32_32x32x16_bf16 v[112:127], a[196:199], a[180:183], v[112:127]
    v_exp_f32 v99, v99
    v_exp_f32 v100, v100
    v_exp_f32 v101, v101
    v_smfmac_f32_32x32x32_bf16 v[160:175], a[216:219], v[80:87], v24
    v_exp_f32 v102, v102
    v_exp_f32 v103, v103
    v_exp_f32 v104, v104
    v_smfmac_f32_32x32x32_bf16 v[160:175], a[220:223], v[88:95], v24
    v_exp_f32 v105, v105
    v_exp_f32 v106, v106
    v_exp_f32 v107, v107
    v_smfmac_f32_16x16x64_bf16 v[28:31], v[20:23], v[80:87], v24
    global_load_dwordx4 a[76:79], v1, s[40:41] offset:-1024
    v_exp_f32 v108, v108
    v_exp_f32 v109, v109
    v_smfmac_f32_16x16x64_bf16 v[28:31], v[20:23], v[88:95], v24
    global_load_dwordx4 a[48:51], v63, s[12:13] offset:0
    v_exp_f32 v110, v110
    v_exp_f32 v111, v111
    v_mfma_f32_32x32x16_bf16 v[80:95], a[192:195], a[184:187], v[240:255]
    v_exp_f32 v112, v112
    v_exp_f32 v113, v113
    v_exp_f32 v114, v114
    v_mfma_f32_32x32x16_bf16 v[80:95], a[196:199], a[188:191], v[80:95]
    v_exp_f32 v115, v115
    v_exp_f32 v116, v116
    v_exp_f32 v117, v117
    v_smfmac_f32_32x32x32_bf16 v[176:191], a[216:219], v[96:103], v24
    v_exp_f32 v118, v118
    v_exp_f32 v119, v119
    v_exp_f32 v120, v120
    v_smfmac_f32_32x32x32_bf16 v[176:191], a[220:223], v[104:111], v24
    s_waitcnt vmcnt(14)
    v_exp_f32 v121, v121
    v_exp_f32 v122, v122
    v_exp_f32 v123, v123
    v_smfmac_f32_16x16x64_bf16 v[32:35], v[20:23], v[96:103], v24
    global_load_dwordx4 a[52:55], v63, s[12:13] offset:1024
    v_exp_f32 v124, v124
    v_exp_f32 v125, v125
    v_smfmac_f32_16x16x64_bf16 v[32:35], v[20:23], v[104:111], v24
    global_load_dwordx4 a[40:43], v1, s[12:13] offset:-2048
    v_exp_f32 v126, v126
    v_exp_f32 v127, v127
    v_mfma_f32_32x32x16_bf16 v[96:111], a[200:203], a[160:163], v[128:143]
    v_exp_f32 v80, v80
    v_exp_f32 v81, v81
    v_exp_f32 v82, v82
    v_mfma_f32_32x32x16_bf16 v[96:111], a[204:207], a[164:167], v[96:111]
    v_exp_f32 v83, v83
    v_exp_f32 v84, v84
    v_exp_f32 v85, v85
    v_smfmac_f32_32x32x32_bf16 a[0:15], a[216:219], v[112:119], v24
    v_exp_f32 v86, v86
    v_exp_f32 v87, v87
    v_exp_f32 v88, v88
    v_smfmac_f32_32x32x32_bf16 a[0:15], a[220:223], v[120:127], v24
    v_exp_f32 v89, v89
    v_exp_f32 v90, v90
    v_exp_f32 v91, v91
    v_smfmac_f32_16x16x64_bf16 v[48:51], v[20:23], v[112:119], v24
    global_load_dwordx4 a[44:47], v1, s[12:13] offset:-1024
    v_exp_f32 v92, v92
    v_exp_f32 v93, v93
    v_smfmac_f32_16x16x64_bf16 v[48:51], v[20:23], v[120:127], v24
    global_load_dwordx4 a[80:83], v63, s[40:41] offset:0
    v_exp_f32 v94, v94
    v_exp_f32 v95, v95
    v_mfma_f32_32x32x16_bf16 v[112:127], a[200:203], a[168:171], v[144:159]
    v_exp_f32 v96, v96
    v_exp_f32 v97, v97
    v_exp_f32 v98, v98
    v_mfma_f32_32x32x16_bf16 v[112:127], a[204:207], a[172:175], v[112:127]
    v_exp_f32 v99, v99
    v_exp_f32 v100, v100
    v_exp_f32 v101, v101
    v_smfmac_f32_32x32x32_bf16 a[16:31], a[216:219], v[80:87], v24
    v_exp_f32 v102, v102
    v_exp_f32 v103, v103
    v_exp_f32 v104, v104
    v_smfmac_f32_32x32x32_bf16 a[16:31], a[220:223], v[88:95], v24
    s_waitcnt vmcnt(11)
    v_exp_f32 v105, v105
    v_exp_f32 v106, v106
    v_exp_f32 v107, v107
    v_smfmac_f32_16x16x64_bf16 v[52:55], v[20:23], v[80:87], v24
    global_load_dwordx4 a[84:87], v63, s[40:41] offset:1024
    v_exp_f32 v108, v108
    v_exp_f32 v109, v109
    v_smfmac_f32_16x16x64_bf16 v[52:55], v[20:23], v[88:95], v24
    global_load_dwordx4 a[56:59], v1, s[12:13] offset:2048
    v_exp_f32 v110, v110
    v_exp_f32 v111, v111
    v_mfma_f32_32x32x16_bf16 v[80:95], a[200:203], a[176:179], v[224:239]
    s_add_i32 s29, s3, 16384
    v_exp_f32 v112, v112
    v_exp_f32 v113, v113
    v_exp_f32 v114, v114
    v_mfma_f32_32x32x16_bf16 v[80:95], a[204:207], a[180:183], v[80:95]
    s_max_i32 s29, s29, 0
    v_exp_f32 v115, v115
    v_exp_f32 v116, v116
    v_exp_f32 v117, v117
    v_smfmac_f32_32x32x32_bf16 v[160:175], a[224:227], v[96:103], v24
    s_add_u32 s14, s58, s29
    v_exp_f32 v118, v118
    v_exp_f32 v119, v119
    v_exp_f32 v120, v120
    v_smfmac_f32_32x32x32_bf16 v[160:175], a[228:231], v[104:111], v24
    s_addc_u32 s15, s59, 0
    v_exp_f32 v121, v121
    v_exp_f32 v122, v122
    v_exp_f32 v123, v123
    v_smfmac_f32_16x16x64_bf16 v[28:31], v[20:23], v[96:103], v24
    global_load_dwordx4 a[60:63], v1, s[12:13] offset:3072
    v_exp_f32 v124, v124
    v_exp_f32 v125, v125
    v_smfmac_f32_16x16x64_bf16 v[28:31], v[20:23], v[104:111], v24
    global_load_dwordx4 a[96:99], v63, s[14:15] offset:-4096
    v_exp_f32 v126, v126
    v_exp_f32 v127, v127
    v_mfma_f32_32x32x16_bf16 v[96:111], a[200:203], a[184:187], v[240:255]
    v_exp_f32 v80, v80
    v_exp_f32 v81, v81
    v_exp_f32 v82, v82
    v_mfma_f32_32x32x16_bf16 v[96:111], a[204:207], a[188:191], v[96:111]
    v_exp_f32 v83, v83
    v_exp_f32 v84, v84
    v_exp_f32 v85, v85
    v_smfmac_f32_32x32x32_bf16 v[176:191], a[224:227], v[112:119], v24
    v_exp_f32 v86, v86
    v_exp_f32 v87, v87
    v_exp_f32 v88, v88
    v_smfmac_f32_32x32x32_bf16 v[176:191], a[228:231], v[120:127], v24
    s_waitcnt vmcnt(13)
    v_exp_f32 v89, v89
    v_exp_f32 v90, v90
    v_exp_f32 v91, v91
    v_smfmac_f32_16x16x64_bf16 v[32:35], v[20:23], v[112:119], v24
    global_load_dwordx4 a[100:103], v63, s[14:15] offset:-3072
    v_exp_f32 v92, v92
    v_exp_f32 v93, v93
    v_smfmac_f32_16x16x64_bf16 v[32:35], v[20:23], v[120:127], v24
    global_load_dwordx4 a[88:91], v1, s[40:41] offset:2048
    v_exp_f32 v94, v94
    v_exp_f32 v95, v95
    v_mfma_f32_32x32x16_bf16 v[112:127], a[64:67], v[64:67], 0
    v_exp_f32 v96, v96
    v_exp_f32 v97, v97
    v_exp_f32 v98, v98
    v_mfma_f32_32x32x16_bf16 v[112:127], a[68:71], v[68:71], v[112:127]
    v_exp_f32 v99, v99
    v_exp_f32 v100, v100
    v_exp_f32 v101, v101
    v_smfmac_f32_32x32x32_bf16 a[0:15], a[224:227], v[80:87], v24
    v_exp_f32 v102, v102
    v_exp_f32 v103, v103
    v_exp_f32 v104, v104
    v_smfmac_f32_32x32x32_bf16 a[0:15], a[228:231], v[88:95], v24
    v_exp_f32 v105, v105
    v_exp_f32 v106, v106
    v_exp_f32 v107, v107
    v_smfmac_f32_16x16x64_bf16 v[48:51], v[20:23], v[80:87], v24
    global_load_dwordx4 a[92:95], v1, s[40:41] offset:3072
    v_exp_f32 v108, v108
    v_exp_f32 v109, v109
    v_smfmac_f32_16x16x64_bf16 v[48:51], v[20:23], v[88:95], v24
    global_load_dwordx4 a[112:115], v63, s[14:15] offset:0
    v_exp_f32 v110, v110
    v_exp_f32 v111, v111
    s_cmp_eq_u32 s50, 0
    s_cbranch_scc1 b_diag
b_diagb:
    s_cmp_lg_u32 s52, 0
    s_cselect_b64 s[10:11], -1, 0
    v_max3_f32 v12, v112, v113, v114
    v_max3_f32 v14, v115, v116, v117
    v_max3_f32 v14, v14, v118, v119
    v_max3_f32 v12, v12, v120, v121
    v_max3_f32 v14, v14, v122, v123
    v_max3_f32 v12, v12, v124, v125
    v_max3_f32 v14, v14, v126, v127
    v_max_f32 v12, v12, v14
    v_mov_b32 v14, v12
    s_nop 1
    v_permlane32_swap_b32 v12, v14
    v_max_f32 v12, v12, v14
    v_sub_f32 v12, 0xc2c80000, v12
    v_cndmask_b32 v6, v12, v11, s[10:11]
    v_mov_b32 v128, v6
    v_mov_b32 v129, v6
    v_mov_b64 v[130:131], v[128:129]
    v_mov_b64 v[132:133], v[128:129]
    v_mov_b64 v[134:135], v[128:129]
    v_mov_b64 v[136:137], v[128:129]
    v_mov_b64 v[138:139], v[128:129]
    v_mov_b64 v[140:141], v[128:129]
    v_mov_b64 v[142:143], v[128:129]
    v_pk_add_f32 v[112:113], v[112:113], v[128:129]
    v_pk_add_f32 v[114:115], v[114:115], v[128:129]
    v_pk_add_f32 v[116:117], v[116:117], v[128:129]
    v_pk_add_f32 v[118:119], v[118:119], v[128:129]
    v_pk_add_f32 v[120:121], v[120:121], v[128:129]
    v_pk_add_f32 v[122:123], v[122:123], v[128:129]
    v_pk_add_f32 v[124:125], v[124:125], v[128:129]
    v_pk_add_f32 v[126:127], v[126:127], v[128:129]
    v_mfma_f32_32x32x16_bf16 v[80:95], a[64:67], v[72:75], 0
    v_exp_f32 v112, v112
    v_exp_f32 v113, v113
    v_exp_f32 v114, v114
    v_mfma_f32_32x32x16_bf16 v[80:95], a[68:71], v[76:79], v[80:95]
    s_add_i32 s29, s3, 24576
    v_exp_f32 v115, v115
    v_exp_f32 v116, v116
    v_exp_f32 v117, v117
    v_smfmac_f32_32x32x32_bf16 a[16:31], a[224:227], v[96:103], v24
    s_max_i32 s29, s29, 0
    v_exp_f32 v118, v118
    v_exp_f32 v119, v119
    v_exp_f32 v120, v120
    v_smfmac_f32_32x32x32_bf16 a[16:31], a[228:231], v[104:111], v24
    s_waitcnt vmcnt(13)
    v_exp_f32 v121, v121
    v_exp_f32 v122, v122
    v_exp_f32 v123, v123
    v_smfmac_f32_16x16x64_bf16 v[52:55], v[20:23], v[96:103], v24
    global_load_dwordx4 a[116:119], v63, s[14:15] offset:1024
    v_exp_f32 v124, v124
    v_exp_f32 v125, v125
    v_smfmac_f32_16x16x64_bf16 v[52:55], v[20:23], v[104:111], v24
    global_load_dwordx4 a[104:107], v1, s[14:15] offset:-2048
    v_exp_f32 v126, v126
    v_exp_f32 v127, v127
    v_max3_f32 v13, v80, v81, v82
    v_max3_f32 v14, v83, v84, v85
    v_max3_f32 v14, v14, v86, v87
    v_max3_f32 v13, v13, v88, v89
    v_max3_f32 v14, v14, v90, v91
    v_max3_f32 v13, v13, v92, v93
    v_max3_f32 v14, v14, v94, v95
    v_max_f32 v13, v13, v14
    v_mov_b32 v14, v13
    s_nop 1
    v_permlane32_swap_b32 v13, v14
    v_max_f32 v13, v13, v14
    v_sub_f32 v13, 0xc2c80000, v13
    v_cndmask_b32 v6, v13, v11, s[10:11]
    v_mov_b32 v144, v6
    v_mov_b32 v145, v6
    v_mov_b64 v[146:147], v[144:145]
    v_mov_b64 v[148:149], v[144:145]
    v_mov_b64 v[150:151], v[144:145]
    v_mov_b64 v[152:153], v[144:145]
    v_mov_b64 v[154:155], v[144:145]
    v_mov_b64 v[156:157], v[144:145]
    v_mov_b64 v[158:159], v[144:145]
    v_pk_add_f32 v[80:81], v[80:81], v[144:145]
    v_pk_add_f32 v[82:83], v[82:83], v[144:145]
    v_pk_add_f32 v[84:85], v[84:85], v[144:145]
    v_pk_add_f32 v[86:87], v[86:87], v[144:145]
    v_pk_add_f32 v[88:89], v[88:89], v[144:145]
    v_pk_add_f32 v[90:91], v[90:91], v[144:145]
    v_pk_add_f32 v[92:93], v[92:93], v[144:145]
    v_pk_add_f32 v[94:95], v[94:95], v[144:145]
    v_cndmask_b32 v96, v128, v11, s[64:65]
    v_cndmask_b32 v97, v128, v11, s[66:67]
    v_cndmask_b32 v98, v128, v11, s[68:69]
    v_cndmask_b32 v99, v128, v11, s[70:71]
    v_cndmask_b32 v100, v128, v11, s[72:73]
    v_cndmask_b32 v101, v128, v11, s[74:75]
    v_cndmask_b32 v102, v128, v11, s[76:77]
    v_cndmask_b32 v103, v128, v11, s[78:79]
    v_cndmask_b32 v104, v128, v11, s[80:81]
    v_cndmask_b32 v105, v128, v11, s[82:83]
    v_cndmask_b32 v106, v128, v11, s[84:85]
    v_cndmask_b32 v107, v128, v11, s[86:87]
    v_cndmask_b32 v108, v128, v11, s[88:89]
    v_cndmask_b32 v109, v128, v11, s[90:91]
    v_cndmask_b32 v110, v128, v11, s[92:93]
    v_cndmask_b32 v111, v128, v11, s[94:95]
    v_exp_f32 v80, v80
    v_exp_f32 v81, v81
    v_mfma_f32_32x32x16_bf16 v[96:111], a[32:35], v[64:67], v[96:111]
    v_exp_f32 v82, v82
    v_exp_f32 v83, v83
    v_exp_f32 v84, v84
    v_mfma_f32_32x32x16_bf16 v[96:111], a[36:39], v[68:71], v[96:111]
    s_add_u32 s12, s58, s29
    v_exp_f32 v85, v85
    v_exp_f32 v86, v86
    v_exp_f32 v87, v87
    v_smfmac_f32_32x32x32_bf16 v[192:207], a[72:75], v[112:119], v24
    s_addc_u32 s13, s59, 0
    v_exp_f32 v88, v88
    v_exp_f32 v89, v89
    v_exp_f32 v90, v90
    v_smfmac_f32_32x32x32_bf16 v[192:207], a[76:79], v[120:127], v24
    s_waitcnt vmcnt(13)
    v_exp_f32 v91, v91
    v_exp_f32 v92, v92
    v_exp_f32 v93, v93
    v_smfmac_f32_16x16x64_bf16 v[36:39], v[20:23], v[112:119], v24
    global_load_dwordx4 a[108:111], v1, s[14:15] offset:-1024
    v_exp_f32 v94, v94
    v_smfmac_f32_16x16x64_bf16 v[36:39], v[20:23], v[120:127], v24
    global_load_dwordx4 a[128:131], v63, s[12:13] offset:-4096
    v_exp_f32 v95, v95
    v_cndmask_b32 v112, v144, v11, s[64:65]
    v_cndmask_b32 v113, v144, v11, s[66:67]
    v_cndmask_b32 v114, v144, v11, s[68:69]
    v_cndmask_b32 v115, v144, v11, s[70:71]
    v_cndmask_b32 v116, v144, v11, s[72:73]
    v_cndmask_b32 v117, v144, v11, s[74:75]
    v_cndmask_b32 v118, v144, v11, s[76:77]
    v_cndmask_b32 v119, v144, v11, s[78:79]
    v_cndmask_b32 v120, v144, v11, s[80:81]
    v_cndmask_b32 v121, v144, v11, s[82:83]
    v_cndmask_b32 v122, v144, v11, s[84:85]
    v_cndmask_b32 v123, v144, v11, s[86:87]
    v_cndmask_b32 v124, v144, v11, s[88:89]
    v_cndmask_b32 v125, v144, v11, s[90:91]
    v_cndmask_b32 v126, v144, v11, s[92:93]
    v_cndmask_b32 v127, v144, v11, s[94:95]
    v_exp_f32 v96, v96
    v_exp_f32 v97, v97
    v_mfma_f32_32x32x16_bf16 v[112:127], a[48:51], v[72:75], v[112:127]
    v_exp_f32 v98, v98
    v_exp_f32 v99, v99
    v_exp_f32 v100, v100
    v_mfma_f32_32x32x16_bf16 v[112:127], a[52:55], v[76:79], v[112:127]
    v_exp_f32 v101, v101
    v_exp_f32 v102, v102
    v_exp_f32 v103, v103
    v_smfmac_f32_32x32x32_bf16 v[208:223], a[72:75], v[80:87], v24
    v_exp_f32 v104, v104
    v_exp_f32 v105, v105
    v_exp_f32 v106, v106
    v_smfmac_f32_32x32x32_bf16 v[208:223], a[76:79], v[88:95], v24
    s_waitcnt vmcnt(13)
    v_exp_f32 v107, v107
    v_exp_f32 v108, v108
    v_exp_f32 v109, v109
    v_smfmac_f32_16x16x64_bf16 v[40:43], v[20:23], v[80:87], v24
    global_load_dwordx4 a[132:135], v63, s[12:13] offset:-3072
    v_exp_f32 v110, v110
    v_smfmac_f32_16x16x64_bf16 v[40:43], v[20:23], v[88:95], v24
    global_load_dwordx4 a[120:123], v1, s[14:15] offset:2048
    v_exp_f32 v111, v111
    v_mfma_f32_32x32x16_bf16 v[80:95], a[48:51], v[64:67], v[128:143]
    v_exp_f32 v112, v112
    v_exp_f32 v113, v113
    v_exp_f32 v114, v114
    v_mfma_f32_32x32x16_bf16 v[80:95], a[52:55], v[68:71], v[80:95]
    v_exp_f32 v115, v115
    v_exp_f32 v116, v116
    v_exp_f32 v117, v117
    v_smfmac_f32_32x32x32_bf16 v[192:207], a[40:43], v[96:103], v24
    v_exp_f32 v118, v118
    v_exp_f32 v119, v119
    v_exp_f32 v120, v120
    v_smfmac_f32_32x32x32_bf16 v[192:207], a[44:47], v[104:111], v24
    s_waitcnt vmcnt(11)
    v_exp_f32 v121, v121
    v_exp_f32 v122, v122
    v_exp_f32 v123, v123
    v_smfmac_f32_16x16x64_bf16 v[36:39], v[20:23], v[96:103], v24
    global_load_dwordx4 a[124:127], v1, s[14:15] offset:3072
    v_exp_f32 v124, v124
    v_exp_f32 v125, v125
    v_smfmac_f32_16x16x64_bf16 v[36:39], v[20:23], v[104:111], v24
    global_load_dwordx4 a[144:147], v63, s[12:13] offset:0
    v_exp_f32 v126, v126
    v_exp_f32 v127, v127
    v_mfma_f32_32x32x16_bf16 v[96:111], a[80:83], v[72:75], v[144:159]
    v_exp_f32 v80, v80
    v_exp_f32 v81, v81
    v_exp_f32 v82, v82
    v_mfma_f32_32x32x16_bf16 v[96:111], a[84:87], v[76:79], v[96:111]
    v_exp_f32 v83, v83
    v_exp_f32 v84, v84
    v_exp_f32 v85, v85
    v_smfmac_f32_32x32x32_bf16 v[208:223], a[56:59], v[112:119], v24
    s_add_i32 s29, s3, 32768
    v_exp_f32 v86, v86
    v_exp_f32 v87, v87
    v_exp_f32 v88, v88
    v_smfmac_f32_32x32x32_bf16 v[208:223], a[60:63], v[120:127], v24
    s_max_i32 s29, s29, 0
    v_exp_f32 v89, v89
    v_exp_f32 v90, v90
    v_exp_f32 v91, v91
    v_smfmac_f32_16x16x64_bf16 v[40:43], v[20:23], v[112:119], v24
    global_load_dwordx4 a[148:151], v63, s[12:13] offset:1024
    v_exp_f32 v92, v92
    v_exp_f32 v93, v93
    v_smfmac_f32_16x16x64_bf16 v[40:43], v[20:23], v[120:127], v24
    global_load_dwordx4 a[136:139], v1, s[12:13] offset:-2048
    v_exp_f32 v94, v94
    v_exp_f32 v95, v95
    v_mfma_f32_32x32x16_bf16 v[112:127], a[80:83], v[64:67], v[128:143]
    v_exp_f32 v96, v96
    v_exp_f32 v97, v97
    v_exp_f32 v98, v98
    v_mfma_f32_32x32x16_bf16 v[112:127], a[84:87], v[68:71], v[112:127]
    s_add_u32 s40, s58, s29
    v_exp_f32 v99, v99
    v_exp_f32 v100, v100
    v_exp_f32 v101, v101
    v_smfmac_f32_32x32x32_bf16 v[192:207], a[56:59], v[80:87], v24
    s_addc_u32 s41, s59, 0
    v_exp_f32 v102, v102
    v_exp_f32 v103, v103
    v_exp_f32 v104, v104
    v_smfmac_f32_32x32x32_bf16 v[192:207], a[60:63], v[88:95], v24
    s_waitcnt vmcnt(11)
    v_exp_f32 v105, v105
    v_exp_f32 v106, v106
    v_exp_f32 v107, v107
    v_smfmac_f32_16x16x64_bf16 v[36:39], v[20:23], v[80:87], v24
    global_load_dwordx4 a[140:143], v1, s[12:13] offset:-1024
    v_exp_f32 v108, v108
    v_exp_f32 v109, v109
    v_smfmac_f32_16x16x64_bf16 v[36:39], v[20:23], v[88:95], v24
    global_load_dwordx4 a[32:35], v63, s[40:41] offset:-4096
    v_exp_f32 v110, v110
    v_exp_f32 v111, v111
    v_mfma_f32_32x32x16_bf16 v[80:95], a[96:99], v[72:75], v[144:159]
    v_exp_f32 v112, v112
    v_exp_f32 v113, v113
    v_exp_f32 v114, v114
    v_mfma_f32_32x32x16_bf16 v[80:95], a[100:103], v[76:79], v[80:95]
    v_exp_f32 v115, v115
    v_exp_f32 v116, v116
    v_exp_f32 v117, v117
    v_smfmac_f32_32x32x32_bf16 v[208:223], a[88:91], v[96:103], v24
    v_exp_f32 v118, v118
    v_exp_f32 v119, v119
    v_exp_f32 v120, v120
    v_smfmac_f32_32x32x32_bf16 v[208:223], a[92:95], v[104:111], v24
    v_exp_f32 v121, v121
    v_exp_f32 v122, v122
    v_exp_f32 v123, v123
    v_smfmac_f32_16x16x64_bf16 v[40:43], v[20:23], v[96:103], v24
    global_load_dwordx4 a[36:39], v63, s[40:41] offset:-3072
    v_exp_f32 v124, v124
    v_exp_f32 v125, v125
    v_smfmac_f32_16x16x64_bf16 v[40:43], v[20:23], v[104:111], v24
    global_load_dwordx4 a[152:155], v1, s[12:13] offset:2048
    v_exp_f32 v126, v126
    v_exp_f32 v127, v127
    v_mfma_f32_32x32x16_bf16 v[96:111], a[96:99], v[64:67], v[128:143]
    v_exp_f32 v80, v80
    v_exp_f32 v81, v81
    v_exp_f32 v82, v82
    v_mfma_f32_32x32x16_bf16 v[96:111], a[100:103], v[68:71], v[96:111]
    v_exp_f32 v83, v83
    v_exp_f32 v84, v84
    v_exp_f32 v85, v85
    v_smfmac_f32_32x32x32_bf16 v[192:207], a[88:91], v[112:119], v24
    v_exp_f32 v86, v86
    v_exp_f32 v87, v87
    v_exp_f32 v88, v88
    v_smfmac_f32_32x32x32_bf16 v[192:207], a[92:95], v[120:127], v24
    s_waitcnt vmcnt(11)
    v_exp_f32 v89, v89
    v_exp_f32 v90, v90
    v_exp_f32 v91, v91
    v_smfmac_f32_16x16x64_bf16 v[36:39], v[20:23], v[112:119], v24
    buffer_load_dword v5, v19, s[20:23], 0 offen offset:256 sc1
    v_exp_f32 v92, v92
    v_exp_f32 v93, v93
    v_smfmac_f32_16x16x64_bf16 v[36:39], v[20:23], v[120:127], v24
    global_load_dwordx4 a[156:159], v1, s[12:13] offset:3072
    global_load_dwordx4 a[48:51], v63, s[40:41] offset:0
    v_exp_f32 v94, v94
    v_exp_f32 v95, v95
    v_mfma_f32_32x32x16_bf16 v[112:127], a[112:115], v[72:75], v[144:159]
    s_add_u32 s33, s6, 0x38000
    v_exp_f32 v96, v96
    v_exp_f32 v97, v97
    v_exp_f32 v98, v98
    v_mfma_f32_32x32x16_bf16 v[112:127], a[116:119], v[76:79], v[112:127]
    s_and_b32 s33, s33, 0x3ffff
    v_exp_f32 v99, v99
    v_exp_f32 v100, v100
    v_exp_f32 v101, v101
    v_smfmac_f32_32x32x32_bf16 v[208:223], a[104:107], v[80:87], v24
    s_add_u32 s38, s4, s33
    v_exp_f32 v102, v102
    v_exp_f32 v103, v103
    v_exp_f32 v104, v104
    v_smfmac_f32_32x32x32_bf16 v[208:223], a[108:111], v[88:95], v24
    s_addc_u32 s39, s5, 0
    v_exp_f32 v105, v105
    v_exp_f32 v106, v106
    v_exp_f32 v107, v107
    v_smfmac_f32_16x16x64_bf16 v[40:43], v[20:23], v[80:87], v24
    global_load_dwordx4 a[52:55], v63, s[40:41] offset:1024
    v_exp_f32 v108, v108
    v_exp_f32 v109, v109
    v_smfmac_f32_16x16x64_bf16 v[40:43], v[20:23], v[88:95], v24
    global_load_dwordx4 a[40:43], v1, s[40:41] offset:-2048
    v_exp_f32 v110, v110
    v_exp_f32 v111, v111
    v_mfma_f32_32x32x16_bf16 v[80:95], a[112:115], v[64:67], v[128:143]
    v_exp_f32 v112, v112
    v_exp_f32 v113, v113
    v_exp_f32 v114, v114
    v_mfma_f32_32x32x16_bf16 v[80:95], a[116:119], v[68:71], v[80:95]
    s_cmp_eq_u32 s52, 6
    v_exp_f32 v115, v115
    v_exp_f32 v116, v116
    v_exp_f32 v117, v117
    v_smfmac_f32_32x32x32_bf16 v[192:207], a[104:107], v[96:103], v24
    s_cbranch_scc1 b_set6
b_set6b:
    v_exp_f32 v118, v118
    v_exp_f32 v119, v119
    v_exp_f32 v120, v120
    v_smfmac_f32_32x32x32_bf16 v[192:207], a[108:111], v[104:111], v24
    s_waitcnt vmcnt(12)
    v_exp_f32 v121, v121
    v_exp_f32 v122, v122
    v_exp_f32 v123, v123
    v_smfmac_f32_16x16x64_bf16 v[36:39], v[20:23], v[96:103], v24
    global_load_dwordx4 a[44:47], v1, s[40:41] offset:-1024
    v_exp_f32 v124, v124
    v_exp_f32 v125, v125
    v_smfmac_f32_16x16x64_bf16 v[36:39], v[20:23], v[104:111], v24
    global_load_dwordx4 a[208:211], v63, s[38:39] offset:0
    v_exp_f32 v126, v126
    v_exp_f32 v127, v127
    v_mfma_f32_32x32x16_bf16 v[96:111], a[128:131], v[72:75], v[144:159]
    v_exp_f32 v80, v80
    v_exp_f32 v81, v81
    v_exp_f32 v82, v82
    v_mfma_f32_32x32x16_bf16 v[96:111], a[132:135], v[76:79], v[96:111]
    v_exp_f32 v83, v83
    v_exp_f32 v84, v84
    v_exp_f32 v85, v85
    v_smfmac_f32_32x32x32_bf16 v[208:223], a[120:123], v[112:119], v24
    v_exp_f32 v86, v86
    v_exp_f32 v87, v87
    v_exp_f32 v88, v88
    v_smfmac_f32_32x32x32_bf16 v[208:223], a[124:127], v[120:127], v24
    v_exp_f32 v89, v89
    v_exp_f32 v90, v90
    v_exp_f32 v91, v91
    v_smfmac_f32_16x16x64_bf16 v[40:43], v[20:23], v[112:119], v24
    global_load_dwordx4 a[212:215], v63, s[38:39] offset:1024
    v_exp_f32 v92, v92
    v_exp_f32 v93, v93
    v_smfmac_f32_16x16x64_bf16 v[40:43], v[20:23], v[120:127], v24
    global_load_dwordx4 a[56:59], v1, s[40:41] offset:2048
    v_exp_f32 v94, v94
    v_exp_f32 v95, v95
    v_mfma_f32_32x32x16_bf16 v[112:127], a[128:131], v[64:67], v[128:143]
    s_add_u32 m0, s30, 106496
    v_exp_f32 v96, v96
    v_exp_f32 v97, v97
    v_exp_f32 v98, v98
    v_mfma_f32_32x32x16_bf16 v[112:127], a[132:135], v[68:71], v[112:127]
    s_add_u32 s46, s46, 0x10000
    v_exp_f32 v99, v99
    v_exp_f32 v100, v100
    v_exp_f32 v101, v101
    v_smfmac_f32_32x32x32_bf16 v[192:207], a[120:123], v[80:87], v24
    s_addc_u32 s47, s47, 0
    v_exp_f32 v102, v102
    v_exp_f32 v103, v103
    v_exp_f32 v104, v104
    v_smfmac_f32_32x32x32_bf16 v[192:207], a[124:127], v[88:95], v24
    s_waitcnt vmcnt(12)
    v_exp_f32 v105, v105
    v_exp_f32 v106, v106
    v_exp_f32 v107, v107
    v_smfmac_f32_16x16x64_bf16 v[36:39], v[20:23], v[80:87], v24
    global_load_dwordx4 a[60:63], v1, s[40:41] offset:3072
    v_exp_f32 v108, v108
    v_exp_f32 v109, v109
    v_smfmac_f32_16x16x64_bf16 v[36:39], v[20:23], v[88:95], v24
    global_load_dwordx4 a[232:235], v1, s[38:39] offset:2048
    v_exp_f32 v110, v110
    v_exp_f32 v111, v111
    v_mfma_f32_32x32x16_bf16 v[80:95], a[144:147], v[72:75], v[144:159]
    s_add_u32 s33, s6, 0xa000
    v_exp_f32 v112, v112
    v_exp_f32 v113, v113
    v_exp_f32 v114, v114
    v_mfma_f32_32x32x16_bf16 v[80:95], a[148:151], v[76:79], v[80:95]
    s_and_b32 s33, s33, 0x3ffff
    v_exp_f32 v115, v115
    v_exp_f32 v116, v116
    v_exp_f32 v117, v117
    v_smfmac_f32_32x32x32_bf16 v[208:223], a[136:139], v[96:103], v24
    s_add_u32 s36, s4, s33
    v_exp_f32 v118, v118
    v_exp_f32 v119, v119
    v_exp_f32 v120, v120
    v_smfmac_f32_32x32x32_bf16 v[208:223], a[140:143], v[104:111], v24
hook9:
    s_cbranch_execz hook0
    s_addc_u32 s37, s5, 0
    v_exp_f32 v121, v121
    v_exp_f32 v122, v122
    v_exp_f32 v123, v123
    v_smfmac_f32_16x16x64_bf16 v[40:43], v[20:23], v[96:103], v24
    global_load_dwordx4 a[236:239], v1, s[38:39] offset:3072
    v_exp_f32 v124, v124
    v_exp_f32 v125, v125
    v_smfmac_f32_16x16x64_bf16 v[40:43], v[20:23], v[104:111], v24
    global_load_lds_dwordx4 v9, s[46:47]
    v_exp_f32 v126, v126
    v_exp_f32 v127, v127
    s_waitcnt vmcnt(12)
    v_cmp_gt_u32 vcc, 1, v5
    s_cbranch_vccnz bpb2_spin
bpb2_ok:
    v_mfma_f32_32x32x16_bf16 v[96:111], a[144:147], v[64:67], v[128:143]
    v_exp_f32 v80, v80
    v_exp_f32 v81, v81
    v_exp_f32 v82, v82
    v_mfma_f32_32x32x16_bf16 v[96:111], a[148:151], v[68:71], v[96:111]
    s_cmp_eq_u32 s52, 8
    v_exp_f32 v83, v83
    v_exp_f32 v84, v84
    v_exp_f32 v85, v85
    v_smfmac_f32_32x32x32_bf16 v[192:207], a[136:139], v[112:119], v24
    s_cbranch_scc1 b_set8
b_set8b:
    v_exp_f32 v86, v86
    v_exp_f32 v87, v87
    v_exp_f32 v88, v88
    v_smfmac_f32_32x32x32_bf16 v[192:207], a[140:143], v[120:127], v24
    s_waitcnt vmcnt(11)
    v_exp_f32 v89, v89
    v_exp_f32 v90, v90
    v_exp_f32 v91, v91
    v_smfmac_f32_16x16x64_bf16 v[36:39], v[20:23], v[112:119], v24
    global_load_dwordx4 a[192:195], v63, s[36:37] offset:-4096
    v_exp_f32 v92, v92
    v_exp_f32 v93, v93
    v_smfmac_f32_16x16x64_bf16 v[36:39], v[20:23], v[120:127], v24
    v_exp_f32 v94, v94
    v_exp_f32 v95, v95
    v_mfma_f32_32x32x16_bf16 v[112:127], a[32:35], v[72:75], v[144:159]
    v_exp_f32 v96, v96
    v_exp_f32 v97, v97
    v_exp_f32 v98, v98
    v_mfma_f32_32x32x16_bf16 v[112:127], a[36:39], v[76:79], v[112:127]
    s_add_u32 m0, s30, 110592
    v_exp_f32 v99, v99
    v_exp_f32 v100, v100
    v_exp_f32 v101, v101
    v_smfmac_f32_32x32x32_bf16 v[208:223], a[152:155], v[80:87], v24
    s_add_u32 s46, s46, 0x10000
    v_exp_f32 v102, v102
    v_exp_f32 v103, v103
    v_exp_f32 v104, v104
    v_smfmac_f32_32x32x32_bf16 v[208:223], a[156:159], v[88:95], v24
    s_addc_u32 s47, s47, 0
    v_exp_f32 v105, v105
    v_exp_f32 v106, v106
    v_exp_f32 v107, v107
    v_smfmac_f32_16x16x64_bf16 v[40:43], v[20:23], v[80:87], v24
    global_load_dwordx4 a[196:199], v63, s[36:37] offset:-3072
    v_exp_f32 v108, v108
    v_exp_f32 v109, v109
    v_smfmac_f32_16x16x64_bf16 v[40:43], v[20:23], v[88:95], v24
    global_load_lds_dwordx4 v9, s[46:47]
    v_exp_f32 v110, v110
    v_exp_f32 v111, v111
    v_cndmask_b32 v80, v11, v128, s[64:65]
    v_cndmask_b32 v81, v11, v128, s[66:67]
    v_cndmask_b32 v82, v11, v128, s[68:69]
    v_cndmask_b32 v83, v11, v128, s[70:71]
    v_cndmask_b32 v84, v11, v128, s[72:73]
    v_cndmask_b32 v85, v11, v128, s[74:75]
    v_cndmask_b32 v86, v11, v128, s[76:77]
    v_cndmask_b32 v87, v11, v128, s[78:79]
    v_cndmask_b32 v88, v11, v128, s[80:81]
    v_cndmask_b32 v89, v11, v128, s[82:83]
    v_cndmask_b32 v90, v11, v128, s[84:85]
    v_cndmask_b32 v91, v11, v128, s[86:87]
    v_cndmask_b32 v92, v11, v128, s[88:89]
    v_cndmask_b32 v93, v11, v128, s[90:91]
    v_cndmask_b32 v94, v11, v128, s[92:93]
    v_cndmask_b32 v95, v11, v128, s[94:95]
    v_exp_f32 v112, v112
    v_exp_f32 v113, v113
    v_mfma_f32_32x32x16_bf16 v[80:95], a[32:35], v[64:67], v[80:95]
    s_add_u32 m0, s30, 114688
    v_exp_f32 v114, v114
    v_exp_f32 v115, v115
    v_exp_f32 v116, v116
    v_mfma_f32_32x32x16_bf16 v[80:95], a[36:39], v[68:71], v[80:95]
    s_add_u32 s46, s46, 0x10000
    v_exp_f32 v117, v117
    v_exp_f32 v118, v118
    v_exp_f32 v119, v119
    v_smfmac_f32_32x32x32_bf16 v[192:207], a[152:155], v[96:103], v24
    s_addc_u32 s47, s47, 0
    v_exp_f32 v120, v120
    v_exp_f32 v121, v121
    v_exp_f32 v122, v122
    v_smfmac_f32_32x32x32_bf16 v[192:207], a[156:159], v[104:111], v24
    s_waitcnt vmcnt(10)
    v_exp_f32 v123, v123
    v_exp_f32 v124, v124
    v_exp_f32 v125, v125
    v_smfmac_f32_16x16x64_bf16 v[36:39], v[20:23], v[96:103], v24
    global_load_dwordx4 a[216:219], v1, s[36:37] offset:-2048
    v_exp_f32 v126, v126
    v_smfmac_f32_16x16x64_bf16 v[36:39], v[20:23], v[104:111], v24
    global_load_lds_dwordx4 v9, s[46:47]
    v_exp_f32 v127, v127
    v_cndmask_b32 v96, v11, v144, s[64:65]
    v_cndmask_b32 v97, v11, v144, s[66:67]
    v_cndmask_b32 v98, v11, v144, s[68:69]
    v_cndmask_b32 v99, v11, v144, s[70:71]
    v_cndmask_b32 v100, v11, v144, s[72:73]
    v_cndmask_b32 v101, v11, v144, s[74:75]
    v_cndmask_b32 v102, v11, v144, s[76:77]
    v_cndmask_b32 v103, v11, v144, s[78:79]
    v_cndmask_b32 v104, v11, v144, s[80:81]
    v_cndmask_b32 v105, v11, v144, s[82:83]
    v_cndmask_b32 v106, v11, v144, s[84:85]
    v_cndmask_b32 v107, v11, v144, s[86:87]
    v_cndmask_b32 v108, v11, v144, s[88:89]
    v_cndmask_b32 v109, v11, v144, s[90:91]
    v_cndmask_b32 v110, v11, v144, s[92:93]
    v_cndmask_b32 v111, v11, v144, s[94:95]
    v_exp_f32 v80, v80
    v_exp_f32 v81, v81
    v_mfma_f32_32x32x16_bf16 v[96:111], a[48:51], v[72:75], v[96:111]
    v_exp_f32 v82, v82
    v_exp_f32 v83, v83
    v_exp_f32 v84, v84
    v_mfma_f32_32x32x16_bf16 v[96:111], a[52:55], v[76:79], v[96:111]
    s_add_u32 s33, s6, 0x12000
    v_exp_f32 v85, v85
    v_exp_f32 v86, v86
    v_exp_f32 v87, v87
    v_smfmac_f32_32x32x32_bf16 v[208:223], a[40:43], v[112:119], v24
    s_and_b32 s33, s33, 0x3ffff
    v_exp_f32 v88, v88
    v_exp_f32 v89, v89
    v_exp_f32 v90, v90
    v_smfmac_f32_32x32x32_bf16 v[208:223], a[44:47], v[120:127], v24
    s_waitcnt vmcnt(10)
    v_exp_f32 v91, v91
    v_exp_f32 v92, v92
    v_exp_f32 v93, v93
    v_smfmac_f32_16x16x64_bf16 v[40:43], v[20:23], v[112:119], v24
    global_load_dwordx4 a[220:223], v1, s[36:37] offset:-1024
    v_exp_f32 v94, v94
    v_smfmac_f32_16x16x64_bf16 v[40:43], v[20:23], v[120:127], v24
    v_exp_f32 v95, v95
    v_mfma_f32_32x32x16_bf16 v[112:127], a[208:211], a[176:179], v[224:239]
    s_add_u32 m0, s30, 118784
    v_exp_f32 v96, v96
    v_exp_f32 v97, v97
    v_exp_f32 v98, v98
    v_mfma_f32_32x32x16_bf16 v[112:127], a[212:215], a[180:183], v[112:127]
    s_add_u32 s38, s4, s33
    v_exp_f32 v99, v99
    v_exp_f32 v100, v100
    v_exp_f32 v101, v101
    v_smfmac_f32_32x32x32_bf16 v[192:207], a[40:43], v[80:87], v24
    s_addc_u32 s39, s5, 0
    v_exp_f32 v102, v102
    v_exp_f32 v103, v103
    v_exp_f32 v104, v104
    v_smfmac_f32_32x32x32_bf16 v[192:207], a[44:47], v[88:95], v24
    s_waitcnt vmcnt(9)
    v_exp_f32 v105, v105
    v_exp_f32 v106, v106
    v_exp_f32 v107, v107
    v_smfmac_f32_16x16x64_bf16 v[36:39], v[20:23], v[80:87], v24
    global_load_dwordx4 a[200:203], v63, s[38:39] offset:-4096
    v_exp_f32 v108, v108
    v_exp_f32 v109, v109
    v_smfmac_f32_16x16x64_bf16 v[36:39], v[20:23], v[88:95], v24
    v_exp_f32 v110, v110
    v_exp_f32 v111, v111
    v_mfma_f32_32x32x16_bf16 v[80:95], a[208:211], a[184:187], v[240:255]
    s_xor_b32 s28, s1, 0x1c0000
    v_exp_f32 v112, v112
    v_exp_f32 v113, v113
    v_exp_f32 v114, v114
    v_mfma_f32_32x32x16_bf16 v[80:95], a[212:215], a[188:191], v[80:95]
    s_add_u32 s46, s42, s28
    v_exp_f32 v115, v115
    v_exp_f32 v116, v116
    v_exp_f32 v117, v117
    v_smfmac_f32_32x32x32_bf16 v[208:223], a[56:59], v[96:103], v24
    s_addc_u32 s47, s43, 0
    v_exp_f32 v118, v118
    v_exp_f32 v119, v119
    v_exp_f32 v120, v120
    v_smfmac_f32_32x32x32_bf16 v[208:223], a[60:63], v[104:111], v24
    s_waitcnt vmcnt(8)
    v_exp_f32 v121, v121
    v_exp_f32 v122, v122
    v_exp_f32 v123, v123
    v_smfmac_f32_16x16x64_bf16 v[40:43], v[20:23], v[96:103], v24
    global_load_dwordx4 a[204:207], v63, s[38:39] offset:-3072
    v_exp_f32 v124, v124
    v_exp_f32 v125, v125
    v_smfmac_f32_16x16x64_bf16 v[40:43], v[20:23], v[104:111], v24
    global_load_lds_dwordx4 v9, s[46:47]
    v_exp_f32 v126, v126
    v_exp_f32 v127, v127
    v_mov_b32 v6, v36
    v_maximum3_f32 v7, abs(v192), abs(v193), abs(v194)
    v_maximum3_f32 v8, abs(v195), abs(v196), abs(v197)
    v_maximum3_f32 v8, abs(v198), abs(v199), v8
    v_maximum3_f32 v7, abs(v200), abs(v201), v7
    v_maximum3_f32 v8, abs(v202), abs(v203), v8
    v_maximum3_f32 v7, abs(v204), abs(v205), v7
    v_maximum3_f32 v8, abs(v206), abs(v207), v8
    v_maximum3_f32 v7, v7, v8, v8
    v_maximum3_f32 v8, v7, v6, v6
    v_cmp_nlt_f32 vcc, 0xb800000, v7
    s_mov_b64 s[10:11], vcc
    v_cmp_ngt_f32 vcc, 0x7e000000, v8
    s_or_b64 vcc, vcc, s[10:11]
    s_cbranch_vccnz bfa_fix0
bfa_ok0:
    v_rcp_f32 v6, v6
    s_add_u32 s34, s55, 0x0
    v_pk_mul_f32 v[192:193], v[6:7], v[192:193] op_sel_hi:[0,1]
    v_pk_mul_f32 v[194:195], v[6:7], v[194:195] op_sel_hi:[0,1]
    v_pk_mul_f32 v[196:197], v[6:7], v[196:197] op_sel_hi:[0,1]
    v_pk_mul_f32 v[198:199], v[6:7], v[198:199] op_sel_hi:[0,1]
    v_pk_mul_f32 v[200:201], v[6:7], v[200:201] op_sel_hi:[0,1]
    v_pk_mul_f32 v[202:203], v[6:7], v[202:203] op_sel_hi:[0,1]
    v_pk_mul_f32 v[204:205], v[6:7], v[204:205] op_sel_hi:[0,1]
    v_pk_mul_f32 v[206:207], v[6:7], v[206:207] op_sel_hi:[0,1]
    v_cvt_pk_bf16_f32 v192, v192, v193
    v_cvt_pk_bf16_f32 v193, v194, v195
    v_cvt_pk_bf16_f32 v194, v196, v197
    v_cvt_pk_bf16_f32 v195, v198, v199
    v_cvt_pk_bf16_f32 v196, v200, v201
    v_cvt_pk_bf16_f32 v197, v202, v203
    v_cvt_pk_bf16_f32 v198, v204, v205
    v_cvt_pk_bf16_f32 v199, v206, v207
    buffer_store_dwordx4 v[192:195], v3, s[20:23], s34 offen offset:0 sc1
    buffer_store_dwordx4 v[196:199], v3, s[20:23], s34 offen offset:256 sc1
    v_mov_b32 v6, v40
    v_maximum3_f32 v7, abs(v208), abs(v209), abs(v210)
    v_maximum3_f32 v8, abs(v211), abs(v212), abs(v213)
    v_maximum3_f32 v8, abs(v214), abs(v215), v8
    v_maximum3_f32 v7, abs(v216), abs(v217), v7
    v_maximum3_f32 v8, abs(v218), abs(v219), v8
    v_maximum3_f32 v7, abs(v220), abs(v221), v7
    v_maximum3_f32 v8, abs(v222), abs(v223), v8
    v_maximum3_f32 v7, v7, v8, v8
    v_maximum3_f32 v8, v7, v6, v6
    v_cmp_nlt_f32 vcc, 0xb800000, v7
    s_mov_b64 s[10:11], vcc
    v_cmp_ngt_f32 vcc, 0x7e000000, v8
    s_or_b64 vcc, vcc, s[10:11]
    s_cbranch_vccnz bfa_fix1
bfa_ok1:
    v_rcp_f32 v6, v6
    s_add_u32 s34, s55, 0x10000
    v_pk_mul_f32 v[208:209], v[6:7], v[208:209] op_sel_hi:[0,1]
    v_pk_mul_f32 v[210:211], v[6:7], v[210:211] op_sel_hi:[0,1]
    v_pk_mul_f32 v[212:213], v[6:7], v[212:213] op_sel_hi:[0,1]
    v_pk_mul_f32 v[214:215], v[6:7], v[214:215] op_sel_hi:[0,1]
    v_pk_mul_f32 v[216:217], v[6:7], v[216:217] op_sel_hi:[0,1]
    v_pk_mul_f32 v[218:219], v[6:7], v[218:219] op_sel_hi:[0,1]
    v_pk_mul_f32 v[220:221], v[6:7], v[220:221] op_sel_hi:[0,1]
    v_pk_mul_f32 v[222:223], v[6:7], v[222:223] op_sel_hi:[0,1]
    v_cvt_pk_bf16_f32 v208, v208, v209
    v_cvt_pk_bf16_f32 v209, v210, v211
    v_cvt_pk_bf16_f32 v210, v212, v213
    v_cvt_pk_bf16_f32 v211, v214, v215
    v_cvt_pk_bf16_f32 v212, v216, v217
    v_cvt_pk_bf16_f32 v213, v218, v219
    v_cvt_pk_bf16_f32 v214, v220, v221
    v_cvt_pk_bf16_f32 v215, v222, v223
    buffer_store_dwordx4 v[208:211], v3, s[20:23], s34 offen offset:0 sc1
    buffer_store_dwordx4 v[212:215], v3, s[20:23], s34 offen offset:256 sc1
    v_mov_b32 v128, v16
    v_mov_b32 v129, v16
    v_mov_b64 v[130:131], v[128:129]
    v_mov_b64 v[132:133], v[128:129]
    v_mov_b64 v[134:135], v[128:129]
    v_mov_b64 v[136:137], v[128:129]
    v_mov_b64 v[138:139], v[128:129]
    v_mov_b64 v[140:141], v[128:129]
    v_mov_b64 v[142:143], v[128:129]
    v_mov_b32 v144, v17
    v_mov_b32 v145, v17
    v_mov_b64 v[146:147], v[144:145]
    v_mov_b64 v[148:149], v[144:145]
    v_mov_b64 v[150:151], v[144:145]
    v_mov_b64 v[152:153], v[144:145]
    v_mov_b64 v[154:155], v[144:145]
    v_mov_b64 v[156:157], v[144:145]
    v_mov_b64 v[158:159], v[144:145]
    v_mfma_f32_32x32x16_bf16 v[96:111], a[208:211], a[160:163], v[128:143]
    v_exp_f32 v80, v80
    v_exp_f32 v81, v81
    v_exp_f32 v82, v82
    v_mfma_f32_32x32x16_bf16 v[96:111], a[212:215], a[164:167], v[96:111]
    s_add_u32 m0, s30, 122880
    v_exp_f32 v83, v83
    v_exp_f32 v84, v84
    v_exp_f32 v85, v85
    v_smfmac_f32_32x32x32_bf16 a[0:15], a[232:235], v[112:119], v24
    s_add_u32 s46, s46, 0x10000
    v_exp_f32 v86, v86
    v_exp_f32 v87, v87
    v_exp_f32 v88, v88
    v_smfmac_f32_32x32x32_bf16 a[0:15], a[236:239], v[120:127], v24
    s_addc_u32 s47, s47, 0
    v_exp_f32 v89, v89
    v_exp_f32 v90, v90
    v_exp_f32 v91, v91
    v_smfmac_f32_16x16x64_bf16 v[48:51], v[20:23], v[112:119], v24
    global_load_dwordx4 a[224:227], v1, s[38:39] offset:-2048
    v_exp_f32 v92, v92
    v_exp_f32 v93, v93
    v_smfmac_f32_16x16x64_bf16 v[48:51], v[20:23], v[120:127], v24
    global_load_lds_dwordx4 v9, s[46:47]
    v_exp_f32 v94, v94
    v_exp_f32 v95, v95
    v_mfma_f32_32x32x16_bf16 v[112:127], a[208:211], a[168:171], v[144:159]
    s_add_u32 m0, s30, 126976
    v_exp_f32 v96, v96
    v_exp_f32 v97, v97
    v_exp_f32 v98, v98
    v_mfma_f32_32x32x16_bf16 v[112:127], a[212:215], a[172:175], v[112:127]
    s_add_u32 s46, s46, 0x10000
    v_exp_f32 v99, v99
    v_exp_f32 v100, v100
    v_exp_f32 v101, v101
    v_smfmac_f32_32x32x32_bf16 a[16:31], a[232:235], v[80:87], v24
    s_addc_u32 s47, s47, 0
    v_exp_f32 v102, v102
    v_exp_f32 v103, v103
    v_exp_f32 v104, v104
    v_smfmac_f32_32x32x32_bf16 a[16:31], a[236:239], v[88:95], v24
    s_waitcnt vmcnt(13)
    v_exp_f32 v105, v105
    v_exp_f32 v106, v106
    v_exp_f32 v107, v107
    v_smfmac_f32_16x16x64_bf16 v[52:55], v[20:23], v[80:87], v24
    global_load_dwordx4 a[228:231], v1, s[38:39] offset:-1024
    v_exp_f32 v108, v108
    v_exp_f32 v109, v109
    v_smfmac_f32_16x16x64_bf16 v[52:55], v[20:23], v[88:95], v24
    global_load_lds_dwordx4 v9, s[46:47]
    v_exp_f32 v110, v110
    v_exp_f32 v111, v111
    v_mfma_f32_32x32x16_bf16 v[80:95], a[192:195], a[176:179], v[224:239]
    s_add_u32 s33, s6, 0x1a000
    v_exp_f32 v112, v112
    v_exp_f32 v113, v113
    v_exp_f32 v114, v114
    v_mfma_f32_32x32x16_bf16 v[80:95], a[196:199], a[180:183], v[80:95]
    s_and_b32 s33, s33, 0x3ffff
    v_exp_f32 v115, v115
    v_exp_f32 v116, v116
    v_exp_f32 v117, v117
    v_smfmac_f32_32x32x32_bf16 v[160:175], a[232:235], v[96:103], v24
    s_add_u32 s36, s4, s33
    v_exp_f32 v118, v118
    v_exp_f32 v119, v119
    v_exp_f32 v120, v120
    v_smfmac_f32_32x32x32_bf16 v[160:175], a[236:239], v[104:111], v24
    s_addc_u32 s37, s5, 0
    v_exp_f32 v121, v121
    v_exp_f32 v122, v122
    v_exp_f32 v123, v123
    v_smfmac_f32_16x16x64_bf16 v[28:31], v[20:23], v[96:103], v24
    global_load_dwordx4 a[208:211], v63, s[36:37] offset:-4096
    v_exp_f32 v124, v124
    v_exp_f32 v125, v125
    v_smfmac_f32_16x16x64_bf16 v[28:31], v[20:23], v[104:111], v24
    v_exp_f32 v126, v126
    v_exp_f32 v127, v127
    v_mfma_f32_32x32x16_bf16 v[96:111], a[192:195], a[184:187], v[240:255]
    v_exp_f32 v80, v80
    v_exp_f32 v81, v81
    v_exp_f32 v82, v82
    v_mfma_f32_32x32x16_bf16 v[96:111], a[196:199], a[188:191], v[96:111]
    v_exp_f32 v83, v83
    v_exp_f32 v84, v84
    v_exp_f32 v85, v85
    v_smfmac_f32_32x32x32_bf16 v[176:191], a[232:235], v[112:119], v24
    v_exp_f32 v86, v86
    v_exp_f32 v87, v87
    v_exp_f32 v88, v88
    v_smfmac_f32_32x32x32_bf16 v[176:191], a[236:239], v[120:127], v24
    s_waitcnt vmcnt(12)
    v_exp_f32 v89, v89
    v_exp_f32 v90, v90
    v_exp_f32 v91, v91
    v_smfmac_f32_16x16x64_bf16 v[32:35], v[20:23], v[112:119], v24
    global_load_dwordx4 a[212:215], v63, s[36:37] offset:-3072
    v_exp_f32 v92, v92
    v_exp_f32 v93, v93
    v_smfmac_f32_16x16x64_bf16 v[32:35], v[20:23], v[120:127], v24
    v_exp_f32 v94, v94
    v_exp_f32 v95, v95
    v_mfma_f32_32x32x16_bf16 v[112:127], a[192:195], a[160:163], v[128:143]
    v_exp_f32 v96, v96
    v_exp_f32 v97, v97
    v_exp_f32 v98, v98
    v_mfma_f32_32x32x16_bf16 v[112:127], a[196:199], a[164:167], v[112:127]
    v_exp_f32 v99, v99
    v_exp_f32 v100, v100
    v_exp_f32 v101, v101
    v_smfmac_f32_32x32x32_bf16 a[0:15], a[216:219], v[80:87], v24
    v_exp_f32 v102, v102
    v_exp_f32 v103, v103
    v_exp_f32 v104, v104
    v_smfmac_f32_32x32x32_bf16 a[0:15], a[220:223], v[88:95], v24
    v_exp_f32 v105, v105
    v_exp_f32 v106, v106
    v_exp_f32 v107, v107
    v_smfmac_f32_16x16x64_bf16 v[48:51], v[20:23], v[80:87], v24
    global_load_dwordx4 a[232:235], v1, s[36:37] offset:-2048
    v_exp_f32 v108, v108
    v_exp_f32 v109, v109
    v_smfmac_f32_16x16x64_bf16 v[48:51], v[20:23], v[88:95], v24
    v_exp_f32 v110, v110
    v_exp_f32 v111, v111
    v_mfma_f32_32x32x16_bf16 v[80:95], a[192:195], a[168:171], v[144:159]
    v_exp_f32 v112, v112
    v_exp_f32 v113, v113
    v_exp_f32 v114, v114
    v_mfma_f32_32x32x16_bf16 v[80:95], a[196:199], a[172:175], v[80:95]
    v_exp_f32 v115, v115
    v_exp_f32 v116, v116
    v_exp_f32 v117, v117
    v_smfmac_f32_32x32x32_bf16 a[16:31], a[216:219], v[96:103], v24
    v_exp_f32 v118, v118
    v_exp_f32 v119, v119
    v_exp_f32 v120, v120
    v_smfmac_f32_32x32x32_bf16 a[16:31], a[220:223], v[104:111], v24
    s_waitcnt vmcnt(12)
    v_exp_f32 v121, v121
    v_exp_f32 v122, v122
    v_exp_f32 v123, v123
    v_smfmac_f32_16x16x64_bf16 v[52:55], v[20:23], v[96:103], v24
    global_load_dwordx4 a[236:239], v1, s[36:37] offset:-1024
    v_exp_f32 v124, v124
    v_exp_f32 v125, v125
    v_smfmac_f32_16x16x64_bf16 v[52:55], v[20:23], v[104:111], v24
    v_exp_f32 v126, v126
    v_exp_f32 v127, v127
    v_mfma_f32_32x32x16_bf16 v[96:111], a[200:203], a[176:179], v[224:239]
    s_add_u32 s33, s6, 0x22000
    v_exp_f32 v80, v80
    v_exp_f32 v81, v81
    v_exp_f32 v82, v82
    v_mfma_f32_32x32x16_bf16 v[96:111], a[204:207], a[180:183], v[96:111]
    s_and_b32 s33, s33, 0x3ffff
    v_exp_f32 v83, v83
    v_exp_f32 v84, v84
    v_exp_f32 v85, v85
    v_smfmac_f32_32x32x32_bf16 v[160:175], a[216:219], v[112:119], v24
    s_add_u32 s38, s4, s33
    v_exp_f32 v86, v86
    v_exp_f32 v87, v87
    v_exp_f32 v88, v88
    v_smfmac_f32_32x32x32_bf16 v[160:175], a[220:223], v[120:127], v24
    s_addc_u32 s39, s5, 0
    v_exp_f32 v89, v89
    v_exp_f32 v90, v90
    v_exp_f32 v91, v91
    v_smfmac_f32_16x16x64_bf16 v[28:31], v[20:23], v[112:119], v24
    global_load_dwordx4 a[192:195], v63, s[38:39] offset:-4096
    v_exp_f32 v92, v92
    v_exp_f32 v93, v93
    v_smfmac_f32_16x16x64_bf16 v[28:31], v[20:23], v[120:127], v24
    s_waitcnt vmcnt(9)
    buffer_store_dword v24, v25, s[20:23], s54 offen offset:384 sc1
    v_exp_f32 v94, v94
    v_exp_f32 v95, v95
    v_mfma_f32_32x32x16_bf16 v[112:127], a[200:203], a[184:187], v[240:255]
    v_exp_f32 v96, v96
    v_exp_f32 v97, v97
    v_exp_f32 v98, v98
    v_mfma_f32_32x32x16_bf16 v[112:127], a[204:207], a[188:191], v[112:127]
    v_exp_f32 v99, v99
    v_exp_f32 v100, v100
    v_exp_f32 v101, v101
    v_smfmac_f32_32x32x32_bf16 v[176:191], a[216:219], v[80:87], v24
    v_exp_f32 v102, v102
    v_exp_f32 v103, v103
    v_exp_f32 v104, v104
    v_smfmac_f32_32x32x32_bf16 v[176:191], a[220:223], v[88:95], v24
    s_waitcnt vmcnt(7)
    v_exp_f32 v105, v105
    v_exp_f32 v106, v106
    v_exp_f32 v107, v107
    v_smfmac_f32_16x16x64_bf16 v[32:35], v[20:23], v[80:87], v24
    global_load_dwordx4 a[196:199], v63, s[38:39] offset:-3072
    v_exp_f32 v108, v108
    v_exp_f32 v109, v109
    v_smfmac_f32_16x16x64_bf16 v[32:35], v[20:23], v[88:95], v24
    v_exp_f32 v110, v110
    v_exp_f32 v111, v111
    v_mfma_f32_32x32x16_bf16 v[80:95], a[200:203], a[160:163], v[128:143]
    v_exp_f32 v112, v112
    v_exp_f32 v113, v113
    v_exp_f32 v114, v114
    v_mfma_f32_32x32x16_bf16 v[80:95], a[204:207], a[164:167], v[80:95]
    v_exp_f32 v115, v115
    v_exp_f32 v116, v116
    v_exp_f32 v117, v117
    v_smfmac_f32_32x32x32_bf16 a[0:15], a[224:227], v[96:103], v24
    v_exp_f32 v118, v118
    v_exp_f32 v119, v119
    v_exp_f32 v120, v120
    v_smfmac_f32_32x32x32_bf16 a[0:15], a[228:231], v[104:111], v24
    v_exp_f32 v121, v121
    v_exp_f32 v122, v122
    v_exp_f32 v123, v123
    v_smfmac_f32_16x16x64_bf16 v[48:51], v[20:23], v[96:103], v24
    global_load_dwordx4 a[216:219], v1, s[38:39] offset:-2048
    v_exp_f32 v124, v124
    v_exp_f32 v125, v125
    v_smfmac_f32_16x16x64_bf16 v[48:51], v[20:23], v[104:111], v24
    v_exp_f32 v126, v126
    v_exp_f32 v127, v127
    v_mfma_f32_32x32x16_bf16 v[96:111], a[200:203], a[168:171], v[144:159]
    v_exp_f32 v80, v80
    v_exp_f32 v81, v81
    v_exp_f32 v82, v82
    v_mfma_f32_32x32x16_bf16 v[96:111], a[204:207], a[172:175], v[96:111]
    v_exp_f32 v83, v83
    v_exp_f32 v84, v84
    v_exp_f32 v85, v85
    v_smfmac_f32_32x32x32_bf16 a[16:31], a[224:227], v[112:119], v24
    v_exp_f32 v86, v86
    v_exp_f32 v87, v87
    v_exp_f32 v88, v88
    v_smfmac_f32_32x32x32_bf16 a[16:31], a[228:231], v[120:127], v24
    s_waitcnt vmcnt(6)
    v_exp_f32 v89, v89
    v_exp_f32 v90, v90
    v_exp_f32 v91, v91
    v_smfmac_f32_16x16x64_bf16 v[52:55], v[20:23], v[112:119], v24
    global_load_dwordx4 a[220:223], v1, s[38:39] offset:-1024
    v_exp_f32 v92, v92
    v_exp_f32 v93, v93
    v_smfmac_f32_16x16x64_bf16 v[52:55], v[20:23], v[120:127], v24
    v_exp_f32 v94, v94
    v_exp_f32 v95, v95
    v_mfma_f32_32x32x16_bf16 v[112:127], a[208:211], a[176:179], v[224:239]
    s_add_u32 s33, s6, 0x2a000
    v_exp_f32 v96, v96
    v_exp_f32 v97, v97
    v_exp_f32 v98, v98
    v_mfma_f32_32x32x16_bf16 v[112:127], a[212:215], a[180:183], v[112:127]
    s_and_b32 s33, s33, 0x3ffff
    v_exp_f32 v99, v99
    v_exp_f32 v100, v100
    v_exp_f32 v101, v101
    v_smfmac_f32_32x32x32_bf16 v[160:175], a[224:227], v[80:87], v24
    s_add_u32 s36, s4, s33
    v_exp_f32 v102, v102
    v_exp_f32 v103, v103
    v_exp_f32 v104, v104
    v_smfmac_f32_32x32x32_bf16 v[160:175], a[228:231], v[88:95], v24
    s_addc_u32 s37, s5, 0
    v_exp_f32 v105, v105
    v_exp_f32 v106, v106
    v_exp_f32 v107, v107
    v_smfmac_f32_16x16x64_bf16 v[28:31], v[20:23], v[80:87], v24
    global_load_dwordx4 a[200:203], v63, s[36:37] offset:-4096
    v_exp_f32 v108, v108
    v_exp_f32 v109, v109
    v_smfmac_f32_16x16x64_bf16 v[28:31], v[20:23], v[88:95], v24
    v_exp_f32 v110, v110
    v_exp_f32 v111, v111
    s_branch att_join
role_a:
hook10:
    s_cbranch_execz hook14
    ds_read_b128 a[192:195], v8 offset:0
    ds_read_b128 a[196:199], v8 offset:1024
    ds_read_b128 v[64:67], v63 offset:0
    ds_read_b128 v[68:71], v63 offset:1024
    ds_read_b128 v[72:75], v63 offset:2048
    ds_read_b128 v[76:79], v63 offset:3072
    ds_read_b128 a[216:219], v7 offset:2048
    ds_read_b128 a[220:223], v7 offset:3072
    ds_read_b128 a[240:243], v16 offset:0
    ds_read_b128 a[244:247], v16 offset:1024
    ds_read_b128 a[248:251], v16 offset:2048
    ds_read_b128 a[252:255], v16 offset:3072
    v_add_u32 v6, v61, v15
    v_add_u32 v63, v1, v15
    v_mfma_f32_32x32x16_bf16 v[160:175], v[28:31], v[28:31], 0
    v_mfma_f32_32x32x16_bf16 v[176:191], v[28:31], v[28:31], 0
    s_waitcnt lgkmcnt(8)
    v_mfma_f32_32x32x16_bf16 v[80:95], a[192:195], v[64:67], 0
    v_mfma_f32_32x32x16_bf16 v[80:95], a[196:199], v[68:71], v[80:95]
    s_waitcnt lgkmcnt(6)
    v_mfma_f32_32x32x16_bf16 v[96:111], a[192:195], v[72:75], 0
    v_mfma_f32_32x32x16_bf16 v[96:111], a[196:199], v[76:79], v[96:111]
    s_waitcnt vmcnt(8)
    buffer_store_dword v24, v25, s[20:23], s54 offen offset:0 sc1
    s_nop 8
    v_max3_f32 v12, v80, v81, v82
    v_max3_f32 v13, v96, v97, v98
    v_mfma_f32_32x32x16_bf16 v[208:223], v[28:31], v[28:31], 0
    v_max3_f32 v12, v12, v83, v84
    v_max3_f32 v13, v13, v99, v100
    v_max3_f32 v12, v12, v85, v86
    v_max3_f32 v13, v13, v101, v102
    v_max3_f32 v12, v12, v87, v88
    v_max3_f32 v13, v13, v103, v104
    v_max3_f32 v12, v12, v89, v90
    v_max3_f32 v13, v13, v105, v106
    v_mfma_f32_32x32x16_bf16 v[192:207], v[28:31], v[28:31], 0
    v_max3_f32 v12, v12, v91, v92
    v_max3_f32 v13, v13, v107, v108
    v_max3_f32 v12, v12, v93, v94
    v_max3_f32 v13, v13, v109, v110
    v_max_f32 v12, v12, v95
    v_mov_b32 v14, v12
    v_max_f32 v13, v13, v111
    v_mov_b32 v15, v13
    v_permlane32_swap_b32 v12, v14
    v_max_f32 v12, v12, v14
    v_permlane32_swap_b32 v13, v15
    v_max_f32 v13, v13, v15
    v_sub_f32 v12, 0xc2c80000, v12
    v_sub_f32 v13, 0xc2c80000, v13
    v_mov_b32 v240, v13
    v_mov_b32 v241, v13
    v_mov_b64 v[242:243], v[240:241]
    v_mfma_f32_32x32x16_bf16 a[16:31], v[28:31], v[28:31], 0
    v_mov_b64 v[244:245], v[240:241]
    v_mov_b64 v[246:247], v[240:241]
    v_mov_b64 v[248:249], v[240:241]
    v_mov_b64 v[250:251], v[240:241]
    v_mov_b64 v[252:253], v[240:241]
    v_mov_b64 v[254:255], v[240:241]
    v_mov_b32 v224, v12
    v_mfma_f32_32x32x16_bf16 a[0:15], v[28:31], v[28:31], 0
    v_mov_b32 v225, v12
    v_mov_b64 v[226:227], v[224:225]
    v_mov_b64 v[228:229], v[224:225]
    v_mov_b64 v[230:231], v[224:225]
    v_mov_b64 v[232:233], v[224:225]
    v_mov_b64 v[234:235], v[224:225]
    v_mov_b64 v[236:237], v[224:225]
    v_mov_b64 v[238:239], v[224:225]
    v_pk_add_f32 v[80:81], v[80:81], v[224:225]
    v_pk_add_f32 v[82:83], v[82:83], v[224:225]
    v_pk_add_f32 v[84:85], v[84:85], v[224:225]
    v_pk_add_f32 v[86:87], v[86:87], v[224:225]
    v_pk_add_f32 v[88:89], v[88:89], v[224:225]
    v_pk_add_f32 v[90:91], v[90:91], v[224:225]
    v_pk_add_f32 v[92:93], v[92:93], v[224:225]
    v_pk_add_f32 v[94:95], v[94:95], v[224:225]
    s_waitcnt lgkmcnt(4)
    v_mfma_f32_32x32x16_bf16 v[96:111], a[192:195], v[72:75], v[240:255]
    v_exp_f32 v80, v80
    v_exp_f32 v81, v81
    v_exp_f32 v82, v82
    v_mfma_f32_32x32x16_bf16 v[96:111], a[196:199], v[76:79], v[96:111]
    v_exp_f32 v83, v83
    v_exp_f32 v84, v84
    v_exp_f32 v85, v85
    v_exp_f32 v86, v86
    v_exp_f32 v87, v87
    v_exp_f32 v88, v88
    v_exp_f32 v89, v89
    v_exp_f32 v90, v90
    v_exp_f32 v91, v91
    ds_read_b128 a[200:203], v8 offset:8192
    v_exp_f32 v92, v92
    v_exp_f32 v93, v93
    ds_read_b128 a[204:207], v8 offset:9216
    ds_read_b128 a[208:211], v8 offset:16384
    ds_read_b128 a[212:215], v8 offset:17408
    ds_read_b128 a[224:227], v7 offset:10240
    ds_read_b128 a[228:231], v7 offset:11264
    v_exp_f32 v94, v94
    v_exp_f32 v95, v95
    s_waitcnt lgkmcnt(4)
    v_cndmask_b32 v112, v11, v224, s[64:65]
    v_cndmask_b32 v113, v11, v224, s[66:67]
    v_cndmask_b32 v114, v11, v224, s[68:69]
    v_cndmask_b32 v115, v11, v224, s[70:71]
    v_cndmask_b32 v116, v11, v224, s[72:73]
    v_cndmask_b32 v117, v11, v224, s[74:75]
    v_cndmask_b32 v118, v11, v224, s[76:77]
    v_cndmask_b32 v119, v11, v224, s[78:79]
    v_cndmask_b32 v120, v11, v224, s[80:81]
    v_cndmask_b32 v121, v11, v224, s[82:83]
    v_cndmask_b32 v122, v11, v224, s[84:85]
    v_cndmask_b32 v123, v11, v224, s[86:87]
    v_cndmask_b32 v124, v11, v224, s[88:89]
    v_cndmask_b32 v125, v11, v224, s[90:91]
    v_cndmask_b32 v126, v11, v224, s[92:93]
    v_cndmask_b32 v127, v11, v224, s[94:95]
    v_exp_f32 v96, v96
    v_exp_f32 v97, v97
    v_mfma_f32_32x32x16_bf16 v[112:127], a[200:203], v[64:67], v[112:127]
hook11:
    s_cbranch_execz hook2
    v_exp_f32 v98, v98
    v_exp_f32 v99, v99
    v_exp_f32 v100, v100
    v_mfma_f32_32x32x16_bf16 v[112:127], a[204:207], v[68:71], v[112:127]
    v_exp_f32 v101, v101
    v_exp_f32 v102, v102
    v_exp_f32 v103, v103
    v_smfmac_f32_32x32x32_bf16 v[192:207], a[216:219], v[80:87], v24
    v_exp_f32 v104, v104
    v_exp_f32 v105, v105
    v_exp_f32 v106, v106
    v_smfmac_f32_32x32x32_bf16 v[192:207], a[220:223], v[88:95], v24
    v_exp_f32 v107, v107
    v_exp_f32 v108, v108
    v_exp_f32 v109, v109
    v_smfmac_f32_16x16x64_bf16 v[36:39], v[20:23], v[80:87], v24
    buffer_load_dword v5, v4, s[20:23], 0 offen offset:0 sc1
    v_exp_f32 v110, v110
    v_smfmac_f32_16x16x64_bf16 v[36:39], v[20:23], v[88:95], v24
    ds_read_b128 a[112:115], v6 offset:49152
    ds_read_b128 a[116:119], v6 offset:50176
    v_exp_f32 v111, v111
    v_mfma_f32_32x32x16_bf16 v[80:95], a[200:203], v[72:75], v[240:255]
    v_exp_f32 v112, v112
    v_exp_f32 v113, v113
    v_exp_f32 v114, v114
    v_mfma_f32_32x32x16_bf16 v[80:95], a[204:207], v[76:79], v[80:95]
    v_exp_f32 v115, v115
    v_exp_f32 v116, v116
    v_exp_f32 v117, v117
    v_smfmac_f32_32x32x32_bf16 v[208:223], a[216:219], v[96:103], v24
    v_exp_f32 v118, v118
    v_exp_f32 v119, v119
    v_exp_f32 v120, v120
    v_smfmac_f32_32x32x32_bf16 v[208:223], a[220:223], v[104:111], v24
    s_waitcnt lgkmcnt(2)
    v_exp_f32 v121, v121
    v_exp_f32 v122, v122
    v_exp_f32 v123, v123
    v_smfmac_f32_16x16x64_bf16 v[40:43], v[20:23], v[96:103], v24
    ds_read_b128 a[232:235], v7 offset:18432
    v_exp_f32 v124, v124
    v_exp_f32 v125, v125
    v_smfmac_f32_16x16x64_bf16 v[40:43], v[20:23], v[104:111], v24
    ds_read_b128 a[236:239], v7 offset:19456
    v_exp_f32 v126, v126
    v_exp_f32 v127, v127
    v_cndmask_b32 v96, v11, v240, s[64:65]
    v_cndmask_b32 v97, v11, v240, s[66:67]
    v_cndmask_b32 v98, v11, v240, s[68:69]
    v_cndmask_b32 v99, v11, v240, s[70:71]
    v_cndmask_b32 v100, v11, v240, s[72:73]
    v_cndmask_b32 v101, v11, v240, s[74:75]
    v_cndmask_b32 v102, v11, v240, s[76:77]
    v_cndmask_b32 v103, v11, v240, s[78:79]
    v_cndmask_b32 v104, v11, v240, s[80:81]
    v_cndmask_b32 v105, v11, v240, s[82:83]
    v_cndmask_b32 v106, v11, v240, s[84:85]
    v_cndmask_b32 v107, v11, v240, s[86:87]
    v_cndmask_b32 v108, v11, v240, s[88:89]
    v_cndmask_b32 v109, v11, v240, s[90:91]
    v_cndmask_b32 v110, v11, v240, s[92:93]
    v_cndmask_b32 v111, v11, v240, s[94:95]
    v_exp_f32 v80, v80
    v_exp_f32 v81, v81
    v_mfma_f32_32x32x16_bf16 v[96:111], a[208:211], v[72:75], v[96:111]
    v_exp_f32 v82, v82
    v_exp_f32 v83, v83
    v_exp_f32 v84, v84
    v_mfma_f32_32x32x16_bf16 v[96:111], a[212:215], v[76:79], v[96:111]
    v_exp_f32 v85, v85
    v_exp_f32 v86, v86
    v_exp_f32 v87, v87
    v_smfmac_f32_32x32x32_bf16 v[192:207], a[224:227], v[112:119], v24
    v_exp_f32 v88, v88
    v_exp_f32 v89, v89
    v_exp_f32 v90, v90
    v_smfmac_f32_32x32x32_bf16 v[192:207], a[228:231], v[120:127], v24
    s_waitcnt lgkmcnt(2)
    v_exp_f32 v91, v91
    v_exp_f32 v92, v92
    v_exp_f32 v93, v93
    v_smfmac_f32_16x16x64_bf16 v[36:39], v[20:23], v[112:119], v24
    ds_read_b128 a[96:99], v6 offset:40960
    v_exp_f32 v94, v94
    v_smfmac_f32_16x16x64_bf16 v[36:39], v[20:23], v[120:127], v24
    ds_read_b128 a[120:123], v61 offset:51200
    v_exp_f32 v95, v95
    s_waitcnt vmcnt(0)
    v_cmp_gt_u32 vcc, 1, v5
    s_cbranch_vccnz apa_spin
apa_ok:
    s_sub_u32 s57, s48, 0x2000
    s_cmp_eq_u32 s27, 0
    s_cselect_b32 s57, 0x80000000, s57
    v_readfirstlane_b32 s34, v60
    s_sub_u32 m0, s34, 16384
    v_mfma_f32_32x32x16_bf16 v[112:127], a[112:115], v[64:67], v[224:239]
    buffer_load_dwordx4 v1, s[20:23], s57 offen offset:0 lds
    v_exp_f32 v96, v96
    v_exp_f32 v97, v97
    v_exp_f32 v98, v98
    v_mfma_f32_32x32x16_bf16 v[112:127], a[116:119], v[68:71], v[112:127]
    buffer_load_dwordx4 v1, s[20:23], s57 offen offset:1024 lds
    v_exp_f32 v99, v99
    v_exp_f32 v100, v100
    v_exp_f32 v101, v101
    v_smfmac_f32_32x32x32_bf16 v[208:223], a[224:227], v[80:87], v24
    buffer_load_dwordx4 v1, s[20:23], s57 offen offset:2048 lds
    v_exp_f32 v102, v102
    v_exp_f32 v103, v103
    v_exp_f32 v104, v104
    v_smfmac_f32_32x32x32_bf16 v[208:223], a[228:231], v[88:95], v24
    s_waitcnt lgkmcnt(2)
    buffer_load_dwordx4 v1, s[20:23], s57 offen offset:3072 lds
    v_exp_f32 v105, v105
    v_exp_f32 v106, v106
    v_exp_f32 v107, v107
    v_smfmac_f32_16x16x64_bf16 v[40:43], v[20:23], v[80:87], v24
    ds_read_b128 a[100:103], v6 offset:41984
    v_exp_f32 v108, v108
    v_exp_f32 v109, v109
    v_smfmac_f32_16x16x64_bf16 v[40:43], v[20:23], v[88:95], v24
    ds_read_b128 a[124:127], v61 offset:52224
    v_exp_f32 v110, v110
    v_exp_f32 v111, v111
    s_sub_u32 s57, s48, 0x4000
    s_cmp_eq_u32 s27, 0
    s_cselect_b32 s57, 0x80000000, s57
    v_readfirstlane_b32 s34, v60
    s_sub_u32 m0, s34, 32768
    v_mfma_f32_32x32x16_bf16 v[80:95], a[112:115], v[72:75], v[240:255]
    buffer_load_dwordx4 v1, s[20:23], s57 offen offset:0 lds
    v_exp_f32 v112, v112
    v_exp_f32 v113, v113
    v_exp_f32 v114, v114
    v_mfma_f32_32x32x16_bf16 v[80:95], a[116:119], v[76:79], v[80:95]
    buffer_load_dwordx4 v1, s[20:23], s57 offen offset:1024 lds
    v_exp_f32 v115, v115
    v_exp_f32 v116, v116
    v_exp_f32 v117, v117
    v_smfmac_f32_32x32x32_bf16 v[208:223], a[232:235], v[96:103], v24
    buffer_load_dwordx4 v1, s[20:23], s57 offen offset:2048 lds
    v_exp_f32 v118, v118
    v_exp_f32 v119, v119
    v_exp_f32 v120, v120
    v_smfmac_f32_32x32x32_bf16 v[208:223], a[236:239], v[104:111], v24
    s_waitcnt lgkmcnt(0)
    buffer_load_dwordx4 v1, s[20:23], s57 offen offset:3072 lds
    v_exp_f32 v121, v121
    v_exp_f32 v122, v122
    v_exp_f32 v123, v123
    v_smfmac_f32_16x16x64_bf16 v[40:43], v[20:23], v[96:103], v24
    ds_read_b128 a[80:83], v6 offset:32768
    v_exp_f32 v124, v124
    v_exp_f32 v125, v125
    v_smfmac_f32_16x16x64_bf16 v[40:43], v[20:23], v[104:111], v24
    ds_read_b128 a[104:107], v61 offset:43008
    v_exp_f32 v126, v126
    v_exp_f32 v127, v127
    v_mfma_f32_32x32x16_bf16 v[96:111], a[96:99], v[64:67], v[224:239]
    v_exp_f32 v80, v80
    v_exp_f32 v81, v81
    v_exp_f32 v82, v82
    v_mfma_f32_32x32x16_bf16 v[96:111], a[100:103], v[68:71], v[96:111]
    v_exp_f32 v83, v83
    v_exp_f32 v84, v84
    v_exp_f32 v85, v85
    v_smfmac_f32_32x32x32_bf16 v[192:207], a[120:123], v[112:119], v24
    v_exp_f32 v86, v86
    v_exp_f32 v87, v87
    v_exp_f32 v88, v88
    v_smfmac_f32_32x32x32_bf16 v[192:207], a[124:127], v[120:127], v24
    v_exp_f32 v89, v89
    v_exp_f32 v90, v90
    v_exp_f32 v91, v91
    v_smfmac_f32_16x16x64_bf16 v[36:39], v[20:23], v[112:119], v24
    ds_read_b128 a[84:87], v6 offset:33792
    v_exp_f32 v92, v92
    v_exp_f32 v93, v93
    v_smfmac_f32_16x16x64_bf16 v[36:39], v[20:23], v[120:127], v24
    ds_read_b128 a[108:111], v61 offset:44032
    v_exp_f32 v94, v94
    v_exp_f32 v95, v95
    v_mfma_f32_32x32x16_bf16 v[112:127], a[96:99], v[72:75], v[240:255]
    v_exp_f32 v96, v96
    v_exp_f32 v97, v97
    v_exp_f32 v98, v98
    v_mfma_f32_32x32x16_bf16 v[112:127], a[100:103], v[76:79], v[112:127]
    v_exp_f32 v99, v99
    v_exp_f32 v100, v100
    v_exp_f32 v101, v101
    v_smfmac_f32_32x32x32_bf16 v[208:223], a[120:123], v[80:87], v24
    v_exp_f32 v102, v102
    v_exp_f32 v103, v103
    v_exp_f32 v104, v104
    v_smfmac_f32_32x32x32_bf16 v[208:223], a[124:127], v[88:95], v24
    s_waitcnt lgkmcnt(0)
    v_exp_f32 v105, v105
    v_exp_f32 v106, v106
    v_exp_f32 v107, v107
    v_smfmac_f32_16x16x64_bf16 v[40:43], v[20:23], v[80:87], v24
    v_exp_f32 v108, v108
    v_exp_f32 v109, v109
    v_smfmac_f32_16x16x64_bf16 v[40:43], v[20:23], v[88:95], v24
    v_exp_f32 v110, v110
    v_exp_f32 v111, v111
    v_mfma_f32_32x32x16_bf16 v[80:95], a[80:83], v[64:67], v[224:239]
    v_exp_f32 v112, v112
    v_exp_f32 v113, v113
    v_exp_f32 v114, v114
    v_mfma_f32_32x32x16_bf16 v[80:95], a[84:87], v[68:71], v[80:95]
    v_exp_f32 v115, v115
    v_exp_f32 v116, v116
    v_exp_f32 v117, v117
    v_smfmac_f32_32x32x32_bf16 v[192:207], a[104:107], v[96:103], v24
    v_exp_f32 v118, v118
    v_exp_f32 v119, v119
    v_exp_f32 v120, v120
    v_smfmac_f32_32x32x32_bf16 v[192:207], a[108:111], v[104:111], v24
    v_exp_f32 v121, v121
    v_exp_f32 v122, v122
    v_exp_f32 v123, v123
    v_smfmac_f32_16x16x64_bf16 v[36:39], v[20:23], v[96:103], v24
    buffer_load_dword v8, v19, s[20:23], 0 offen offset:0 sc1
    v_exp_f32 v124, v124
    v_exp_f32 v125, v125
    v_smfmac_f32_16x16x64_bf16 v[36:39], v[20:23], v[104:111], v24
    ds_read_b128 a[88:91], v61 offset:34816
    ds_read_b128 a[92:95], v61 offset:35840
    v_exp_f32 v126, v126
    v_exp_f32 v127, v127
    v_mfma_f32_32x32x16_bf16 v[96:111], a[80:83], v[72:75], v[240:255]
    ds_read_b128 a[128:131], v60 offset:16384
    v_exp_f32 v80, v80
    v_exp_f32 v81, v81
    v_exp_f32 v82, v82
    v_mfma_f32_32x32x16_bf16 v[96:111], a[84:87], v[76:79], v[96:111]
    s_cmp_eq_u32 s52, 4
    v_exp_f32 v83, v83
    v_exp_f32 v84, v84
    v_exp_f32 v85, v85
    v_smfmac_f32_32x32x32_bf16 v[208:223], a[104:107], v[112:119], v24
    s_cbranch_scc1 a_set4
a_set4b:
    v_exp_f32 v86, v86
    v_exp_f32 v87, v87
    v_exp_f32 v88, v88
    v_smfmac_f32_32x32x32_bf16 v[208:223], a[108:111], v[120:127], v24
    s_waitcnt lgkmcnt(1)
    v_exp_f32 v89, v89
    v_exp_f32 v90, v90
    v_exp_f32 v91, v91
    v_smfmac_f32_16x16x64_bf16 v[40:43], v[20:23], v[112:119], v24
    s_waitcnt vmcnt(5)
    s_barrier
    v_exp_f32 v92, v92
    v_exp_f32 v93, v93
    v_smfmac_f32_16x16x64_bf16 v[40:43], v[20:23], v[120:127], v24
    ds_read_b128 a[64:67], v6 offset:24576
    ds_read_b128 a[68:71], v6 offset:25600
    ds_read_b128 a[48:51], v6 offset:16384
    ds_read_b128 a[72:75], v61 offset:26624
    v_exp_f32 v94, v94
    v_exp_f32 v95, v95
    s_waitcnt lgkmcnt(2)
    v_mfma_f32_32x32x16_bf16 v[112:127], a[64:67], v[64:67], v[224:239]
    ds_read_b128 a[132:135], v60 offset:17408
    v_exp_f32 v96, v96
    v_exp_f32 v97, v97
    v_exp_f32 v98, v98
    v_mfma_f32_32x32x16_bf16 v[112:127], a[68:71], v[68:71], v[112:127]
    v_exp_f32 v99, v99
    v_exp_f32 v100, v100
    v_exp_f32 v101, v101
    v_smfmac_f32_32x32x32_bf16 v[192:207], a[88:91], v[80:87], v24
    s_add_u32 s33, s6, 0x0
    v_exp_f32 v102, v102
    v_exp_f32 v103, v103
    v_exp_f32 v104, v104
    v_smfmac_f32_32x32x32_bf16 v[192:207], a[92:95], v[88:95], v24
    s_and_b32 s33, s33, 0x3ffff
    v_exp_f32 v105, v105
    v_exp_f32 v106, v106
    v_exp_f32 v107, v107
    v_smfmac_f32_16x16x64_bf16 v[36:39], v[20:23], v[80:87], v24
    ds_read_b128 a[52:55], v6 offset:17408
    v_exp_f32 v108, v108
    v_exp_f32 v109, v109
    v_smfmac_f32_16x16x64_bf16 v[36:39], v[20:23], v[88:95], v24
    ds_read_b128 a[76:79], v61 offset:27648
    v_exp_f32 v110, v110
    v_exp_f32 v111, v111
    s_waitcnt vmcnt(0)
    v_cmp_gt_u32 vcc, 1, v8
    s_cbranch_vccnz apb0_spin
apb0_ok:
    s_xor_b32 s29, s31, 4096
    v_mfma_f32_32x32x16_bf16 v[80:95], a[64:67], v[72:75], v[240:255]
    buffer_load_dwordx4 a[160:163], v1, s[20:23], s31 offen offset:0
    ds_read_b128 a[136:139], v60 offset:18432
    v_exp_f32 v112, v112
    v_exp_f32 v113, v113
    v_exp_f32 v114, v114
    v_mfma_f32_32x32x16_bf16 v[80:95], a[68:71], v[76:79], v[80:95]
    s_add_u32 s36, s4, s33
    buffer_load_dwordx4 a[164:167], v1, s[20:23], s31 offen offset:1024
    v_exp_f32 v115, v115
    v_exp_f32 v116, v116
    v_exp_f32 v117, v117
    v_smfmac_f32_32x32x32_bf16 v[208:223], a[88:91], v[96:103], v24
    s_addc_u32 s37, s5, 0
    buffer_load_dwordx4 a[168:171], v1, s[20:23], s31 offen offset:2048
    v_exp_f32 v118, v118
    v_exp_f32 v119, v119
    v_exp_f32 v120, v120
    v_smfmac_f32_32x32x32_bf16 v[208:223], a[92:95], v[104:111], v24
    s_waitcnt lgkmcnt(1)
    buffer_load_dwordx4 a[172:175], v1, s[20:23], s31 offen offset:3072
    v_exp_f32 v121, v121
    v_exp_f32 v122, v122
    v_exp_f32 v123, v123
    v_smfmac_f32_16x16x64_bf16 v[40:43], v[20:23], v[96:103], v24
    global_load_dwordx4 a[192:195], v63, s[36:37] offset:-4096
    v_exp_f32 v124, v124
    v_exp_f32 v125, v125
    v_smfmac_f32_16x16x64_bf16 v[40:43], v[20:23], v[104:111], v24
    global_load_dwordx4 a[196:199], v63, s[36:37] offset:-3072
    v_exp_f32 v126, v126
    v_exp_f32 v127, v127
    v_mfma_f32_32x32x16_bf16 v[96:111], a[48:51], v[64:67], v[224:239]
    s_add_u32 s33, s6, 0x8000
    ds_read_b128 a[140:143], v60 offset:19456
    v_exp_f32 v80, v80
    v_exp_f32 v81, v81
    v_exp_f32 v82, v82
    v_mfma_f32_32x32x16_bf16 v[96:111], a[52:55], v[68:71], v[96:111]
    s_and_b32 s33, s33, 0x3ffff
    v_exp_f32 v83, v83
    v_exp_f32 v84, v84
    v_exp_f32 v85, v85
    v_smfmac_f32_32x32x32_bf16 v[192:207], a[72:75], v[112:119], v24
    s_add_u32 s38, s4, s33
    v_exp_f32 v86, v86
    v_exp_f32 v87, v87
    v_exp_f32 v88, v88
    v_smfmac_f32_32x32x32_bf16 v[192:207], a[76:79], v[120:127], v24
    s_addc_u32 s39, s5, 0
    v_exp_f32 v89, v89
    v_exp_f32 v90, v90
    v_exp_f32 v91, v91
    v_smfmac_f32_16x16x64_bf16 v[36:39], v[20:23], v[112:119], v24
    ds_read_b128 a[56:59], v61 offset:18432
    v_exp_f32 v92, v92
    v_exp_f32 v93, v93
    v_smfmac_f32_16x16x64_bf16 v[36:39], v[20:23], v[120:127], v24
    ds_read_b128 a[60:63], v61 offset:19456
    global_load_dwordx4 a[216:219], v1, s[36:37] offset:-2048
    global_load_dwordx4 a[220:223], v1, s[36:37] offset:-1024
    v_exp_f32 v94, v94
    v_exp_f32 v95, v95
    v_mfma_f32_32x32x16_bf16 v[112:127], a[48:51], v[72:75], v[240:255]
    buffer_load_dwordx4 a[176:179], v1, s[20:23], s29 offen offset:0
    ds_read_b128 a[144:147], v60 offset:0
    v_exp_f32 v96, v96
    v_exp_f32 v97, v97
    v_exp_f32 v98, v98
    v_mfma_f32_32x32x16_bf16 v[112:127], a[52:55], v[76:79], v[112:127]
    s_cmp_eq_u32 s52, 2
    buffer_load_dwordx4 a[180:183], v1, s[20:23], s29 offen offset:1024
    v_exp_f32 v99, v99
    v_exp_f32 v100, v100
    v_exp_f32 v101, v101
    v_smfmac_f32_32x32x32_bf16 v[208:223], a[72:75], v[80:87], v24
    s_cbranch_scc1 a_set2
a_set2b:
    buffer_load_dwordx4 a[184:187], v1, s[20:23], s29 offen offset:2048
    v_exp_f32 v102, v102
    v_exp_f32 v103, v103
    v_exp_f32 v104, v104
    v_smfmac_f32_32x32x32_bf16 v[208:223], a[76:79], v[88:95], v24
    s_waitcnt lgkmcnt(1)
    buffer_load_dwordx4 a[188:191], v1, s[20:23], s29 offen offset:3072
    v_exp_f32 v105, v105
    v_exp_f32 v106, v106
    v_exp_f32 v107, v107
    v_smfmac_f32_16x16x64_bf16 v[40:43], v[20:23], v[80:87], v24
    s_barrier
    v_exp_f32 v108, v108
    v_exp_f32 v109, v109
    v_smfmac_f32_16x16x64_bf16 v[40:43], v[20:23], v[88:95], v24
    ds_read_b128 a[32:35], v6 offset:8192
    ds_read_b128 a[36:39], v6 offset:9216
    ds_read_b128 a[112:115], v6 offset:0
    ds_read_b128 a[40:43], v61 offset:10240
    global_load_dwordx4 a[200:203], v63, s[38:39] offset:-4096
    global_load_dwordx4 a[204:207], v63, s[38:39] offset:-3072
    v_exp_f32 v110, v110
    v_exp_f32 v111, v111
    s_waitcnt lgkmcnt(2)
    v_mfma_f32_32x32x16_bf16 v[80:95], a[32:35], v[64:67], v[224:239]
    ds_read_b128 a[148:151], v60 offset:1024
    v_exp_f32 v112, v112
    v_exp_f32 v113, v113
    v_exp_f32 v114, v114
    v_mfma_f32_32x32x16_bf16 v[80:95], a[36:39], v[68:71], v[80:95]
    v_exp_f32 v115, v115
    v_exp_f32 v116, v116
    v_exp_f32 v117, v117
    v_smfmac_f32_32x32x32_bf16 v[192:207], a[56:59], v[96:103], v24
    v_exp_f32 v118, v118
    v_exp_f32 v119, v119
    v_exp_f32 v120, v120
    v_smfmac_f32_32x32x32_bf16 v[192:207], a[60:63], v[104:111], v24
    s_add_u32 s56, s48, 8192
    buffer_store_dwordx4 a[128:131], v1, s[20:23], s56 offen offset:0 sc1
    v_exp_f32 v121, v121
    v_exp_f32 v122, v122
    v_exp_f32 v123, v123
    v_smfmac_f32_16x16x64_bf16 v[36:39], v[20:23], v[96:103], v24
    ds_read_b128 a[116:119], v6 offset:1024
    v_exp_f32 v124, v124
    v_exp_f32 v125, v125
    v_smfmac_f32_16x16x64_bf16 v[36:39], v[20:23], v[104:111], v24
    ds_read_b128 a[44:47], v61 offset:11264
    global_load_dwordx4 a[224:227], v1, s[38:39] offset:-2048
    global_load_dwordx4 a[228:231], v1, s[38:39] offset:-1024
    v_exp_f32 v126, v126
    v_exp_f32 v127, v127
    v_cndmask_b32 v96, v240, v11, s[64:65]
    v_cndmask_b32 v97, v240, v11, s[66:67]
    v_cndmask_b32 v98, v240, v11, s[68:69]
    v_cndmask_b32 v99, v240, v11, s[70:71]
    v_cndmask_b32 v100, v240, v11, s[72:73]
    v_cndmask_b32 v101, v240, v11, s[74:75]
    v_cndmask_b32 v102, v240, v11, s[76:77]
    v_cndmask_b32 v103, v240, v11, s[78:79]
    v_cndmask_b32 v104, v240, v11, s[80:81]
    v_cndmask_b32 v105, v240, v11, s[82:83]
    v_cndmask_b32 v106, v240, v11, s[84:85]
    v_cndmask_b32 v107, v240, v11, s[86:87]
    v_cndmask_b32 v108, v240, v11, s[88:89]
    v_cndmask_b32 v109, v240, v11, s[90:91]
    v_cndmask_b32 v110, v240, v11, s[92:93]
    v_cndmask_b32 v111, v240, v11, s[94:95]
    v_exp_f32 v80, v80
    v_exp_f32 v81, v81
    v_mfma_f32_32x32x16_bf16 v[96:111], a[32:35], v[72:75], v[96:111]
    ds_read_b128 a[152:155], v60 offset:2048
    v_exp_f32 v82, v82
    v_exp_f32 v83, v83
    v_exp_f32 v84, v84
    v_mfma_f32_32x32x16_bf16 v[96:111], a[36:39], v[76:79], v[96:111]
    v_exp_f32 v85, v85
    v_exp_f32 v86, v86
    v_exp_f32 v87, v87
    v_smfmac_f32_32x32x32_bf16 v[208:223], a[56:59], v[112:119], v24
    v_exp_f32 v88, v88
    v_exp_f32 v89, v89
    v_exp_f32 v90, v90
    v_smfmac_f32_32x32x32_bf16 v[208:223], a[60:63], v[120:127], v24
    s_waitcnt lgkmcnt(1)
    buffer_store_dwordx4 a[132:135], v1, s[20:23], s56 offen offset:1024 sc1
    v_exp_f32 v91, v91
    v_exp_f32 v92, v92
    v_exp_f32 v93, v93
    v_smfmac_f32_16x16x64_bf16 v[40:43], v[20:23], v[112:119], v24
    v_exp_f32 v94, v94
    v_smfmac_f32_16x16x64_bf16 v[40:43], v[20:23], v[120:127], v24
    v_exp_f32 v95, v95
    v_cndmask_b32 v112, v224, v11, s[64:65]
    v_cndmask_b32 v113, v224, v11, s[66:67]
    v_cndmask_b32 v114, v224, v11, s[68:69]
    v_cndmask_b32 v115, v224, v11, s[70:71]
    v_cndmask_b32 v116, v224, v11, s[72:73]
    v_cndmask_b32 v117, v224, v11, s[74:75]
    v_cndmask_b32 v118, v224, v11, s[76:77]
    v_cndmask_b32 v119, v224, v11, s[78:79]
    v_cndmask_b32 v120, v224, v11, s[80:81]
    v_cndmask_b32 v121, v224, v11, s[82:83]
    v_cndmask_b32 v122, v224, v11, s[84:85]
    v_cndmask_b32 v123, v224, v11, s[86:87]
    v_cndmask_b32 v124, v224, v11, s[88:89]
    v_cndmask_b32 v125, v224, v11, s[90:91]
    v_cndmask_b32 v126, v224, v11, s[92:93]
    v_cndmask_b32 v127, v224, v11, s[94:95]
    v_exp_f32 v96, v96
    v_exp_f32 v97, v97
    v_mfma_f32_32x32x16_bf16 v[112:127], a[112:115], v[64:67], v[112:127]
    ds_read_b128 a[156:159], v60 offset:3072
    v_exp_f32 v98, v98
    v_exp_f32 v99, v99
    v_exp_f32 v100, v100
    v_mfma_f32_32x32x16_bf16 v[112:127], a[116:119], v[68:71], v[112:127]
    s_add_u32 s33, s6, 0x10000
    v_exp_f32 v101, v101
    v_exp_f32 v102, v102
    v_exp_f32 v103, v103
    v_smfmac_f32_32x32x32_bf16 v[192:207], a[40:43], v[80:87], v24
    s_and_b32 s33, s33, 0x3ffff
    v_exp_f32 v104, v104
    v_exp_f32 v105, v105
    v_exp_f32 v106, v106
    v_smfmac_f32_32x32x32_bf16 v[192:207], a[44:47], v[88:95], v24
    s_waitcnt vmcnt(12)
    v_exp_f32 v107, v107
    v_exp_f32 v108, v108
    v_exp_f32 v109, v109
    v_smfmac_f32_16x16x64_bf16 v[36:39], v[20:23], v[80:87], v24
    ds_read_b128 a[120:123], v61 offset:2048
    v_exp_f32 v110, v110
    v_smfmac_f32_16x16x64_bf16 v[36:39], v[20:23], v[88:95], v24
    ds_read_b128 a[124:127], v61 offset:3072
    v_exp_f32 v111, v111
    v_mfma_f32_32x32x16_bf16 v[80:95], a[192:195], a[160:163], 0
    v_exp_f32 v112, v112
    v_exp_f32 v113, v113
    v_exp_f32 v114, v114
    v_mfma_f32_32x32x16_bf16 v[80:95], a[196:199], a[164:167], v[80:95]
    s_add_u32 s36, s4, s33
    v_exp_f32 v115, v115
    v_exp_f32 v116, v116
    v_exp_f32 v117, v117
    v_smfmac_f32_32x32x32_bf16 v[208:223], a[40:43], v[96:103], v24
    s_addc_u32 s37, s5, 0
    v_exp_f32 v118, v118
    v_exp_f32 v119, v119
    v_exp_f32 v120, v120
    v_smfmac_f32_32x32x32_bf16 v[208:223], a[44:47], v[104:111], v24
    s_waitcnt lgkmcnt(0)
    buffer_store_dwordx4 a[136:139], v1, s[20:23], s56 offen offset:2048 sc1
    v_exp_f32 v121, v121
    v_exp_f32 v122, v122
    v_exp_f32 v123, v123
    v_smfmac_f32_16x16x64_bf16 v[40:43], v[20:23], v[96:103], v24
    global_load_dwordx4 a[208:211], v63, s[36:37] offset:-4096
    v_exp_f32 v124, v124
    v_exp_f32 v125, v125
    v_smfmac_f32_16x16x64_bf16 v[40:43], v[20:23], v[104:111], v24
    v_exp_f32 v126, v126
    v_exp_f32 v127, v127
    v_max3_f32 v16, v80, v81, v82
    v_max3_f32 v14, v83, v84, v85
    v_max3_f32 v14, v14, v86, v87
    v_max3_f32 v16, v16, v88, v89
    v_max3_f32 v14, v14, v90, v91
    v_max3_f32 v16, v16, v92, v93
    v_max3_f32 v14, v14, v94, v95
    v_max_f32 v16, v16, v14
    v_mov_b32 v14, v16
    s_nop 1
    v_permlane32_swap_b32 v16, v14
    v_max_f32 v16, v16, v14
    v_sub_f32 v16, 0xc2c80000, v16
    v_mov_b32 v128, v16
    v_mov_b32 v129, v16
    v_mov_b64 v[130:131], v[128:129]
    v_mov_b64 v[132:133], v[128:129]
    v_mov_b64 v[134:135], v[128:129]
    v_mov_b64 v[136:137], v[128:129]
    v_mov_b64 v[138:139], v[128:129]
    v_mov_b64 v[140:141], v[128:129]
    v_mov_b64 v[142:143], v[128:129]
    v_pk_add_f32 v[80:81], v[80:81], v[128:129]
    v_pk_add_f32 v[82:83], v[82:83], v[128:129]
    v_pk_add_f32 v[84:85], v[84:85], v[128:129]
    v_pk_add_f32 v[86:87], v[86:87], v[128:129]
    v_pk_add_f32 v[88:89], v[88:89], v[128:129]
    v_pk_add_f32 v[90:91], v[90:91], v[128:129]
    v_pk_add_f32 v[92:93], v[92:93], v[128:129]
    v_pk_add_f32 v[94:95], v[94:95], v[128:129]
    v_mfma_f32_32x32x16_bf16 v[96:111], a[192:195], a[168:171], 0
    v_exp_f32 v80, v80
    v_exp_f32 v81, v81
    v_exp_f32 v82, v82
    v_mfma_f32_32x32x16_bf16 v[96:111], a[196:199], a[172:175], v[96:111]
    v_exp_f32 v83, v83
    v_exp_f32 v84, v84
    v_exp_f32 v85, v85
    v_smfmac_f32_32x32x32_bf16 v[192:207], a[120:123], v[112:119], v24
    v_exp_f32 v86, v86
    v_exp_f32 v87, v87
    v_exp_f32 v88, v88
    v_smfmac_f32_32x32x32_bf16 v[192:207], a[124:127], v[120:127], v24
    s_waitcnt vmcnt(6)
    buffer_store_dwordx4 a[140:143], v1, s[20:23], s56 offen offset:3072 sc1
    v_exp_f32 v89, v89
    v_exp_f32 v90, v90
    v_exp_f32 v91, v91
    v_smfmac_f32_16x16x64_bf16 v[36:39], v[20:23], v[112:119], v24
    global_load_dwordx4 a[212:215], v63, s[36:37] offset:-3072
    v_exp_f32 v92, v92
    v_exp_f32 v93, v93
    v_smfmac_f32_16x16x64_bf16 v[36:39], v[20:23], v[120:127], v24
    v_exp_f32 v94, v94
    v_exp_f32 v95, v95
    v_max3_f32 v17, v96, v97, v98
    v_max3_f32 v14, v99, v100, v101
    v_max3_f32 v14, v14, v102, v103
    v_max3_f32 v17, v17, v104, v105
    v_max3_f32 v14, v14, v106, v107
    v_max3_f32 v17, v17, v108, v109
    v_max3_f32 v14, v14, v110, v111
    v_max_f32 v17, v17, v14
    v_mov_b32 v14, v17
    s_nop 1
    v_permlane32_swap_b32 v17, v14
    v_max_f32 v17, v17, v14
    v_sub_f32 v17, 0xc2c80000, v17
    ds_write_b64 v59, v[16:17]
    v_mov_b32 v144, v17
    v_mov_b32 v145, v17
    v_mov_b64 v[146:147], v[144:145]
    v_mov_b64 v[148:149], v[144:145]
    v_mov_b64 v[150:151], v[144:145]
    v_mov_b64 v[152:153], v[144:145]
    v_mov_b64 v[154:155], v[144:145]
    v_mov_b64 v[156:157], v[144:145]
    v_mov_b64 v[158:159], v[144:145]
    v_pk_add_f32 v[96:97], v[96:97], v[144:145]
    v_pk_add_f32 v[98:99], v[98:99], v[144:145]
    v_pk_add_f32 v[100:101], v[100:101], v[144:145]
    v_pk_add_f32 v[102:103], v[102:103], v[144:145]
    v_pk_add_f32 v[104:105], v[104:105], v[144:145]
    v_pk_add_f32 v[106:107], v[106:107], v[144:145]
    v_pk_add_f32 v[108:109], v[108:109], v[144:145]
    v_pk_add_f32 v[110:111], v[110:111], v[144:145]
    v_mfma_f32_32x32x16_bf16 v[112:127], a[200:203], a[160:163], v[128:143]
    v_exp_f32 v96, v96
    v_exp_f32 v97, v97
    v_exp_f32 v98, v98
    v_mfma_f32_32x32x16_bf16 v[112:127], a[204:207], a[164:167], v[112:127]
    s_waitcnt lgkmcnt(0)
    s_barrier
    ds_read_b64 v[14:15], v58
    v_exp_f32 v99, v99
    v_exp_f32 v100, v100
    v_exp_f32 v101, v101
    v_smfmac_f32_32x32x32_bf16 v[160:175], a[216:219], v[80:87], v24
    v_exp_f32 v102, v102
    v_exp_f32 v103, v103
    v_exp_f32 v104, v104
    v_smfmac_f32_32x32x32_bf16 v[160:175], a[220:223], v[88:95], v24
    v_exp_f32 v105, v105
    v_exp_f32 v106, v106
    v_exp_f32 v107, v107
    v_smfmac_f32_16x16x64_bf16 v[28:31], v[20:23], v[80:87], v24
    global_load_dwordx4 a[232:235], v1, s[36:37] offset:-2048
    v_exp_f32 v108, v108
    v_exp_f32 v109, v109
    v_smfmac_f32_16x16x64_bf16 v[28:31], v[20:23], v[88:95], v24
    v_exp_f32 v110, v110
    v_exp_f32 v111, v111
    v_mfma_f32_32x32x16_bf16 v[80:95], a[200:203], a[168:171], v[144:159]
    v_exp_f32 v112, v112
    v_exp_f32 v113, v113
    v_exp_f32 v114, v114
    v_mfma_f32_32x32x16_bf16 v[80:95], a[204:207], a[172:175], v[80:95]
    v_exp_f32 v115, v115
    v_exp_f32 v116, v116
    v_exp_f32 v117, v117
    v_smfmac_f32_32x32x32_bf16 v[176:191], a[216:219], v[96:103], v24
    v_exp_f32 v118, v118
    v_exp_f32 v119, v119
    v_exp_f32 v120, v120
    v_smfmac_f32_32x32x32_bf16 v[176:191], a[220:223], v[104:111], v24
    s_waitcnt vmcnt(6)
    s_add_u32 s56, s48, 0
    buffer_store_dwordx4 a[144:147], v1, s[20:23], s56 offen offset:0 sc1
    v_exp_f32 v121, v121
    v_exp_f32 v122, v122
    v_exp_f32 v123, v123
    v_smfmac_f32_16x16x64_bf16 v[32:35], v[20:23], v[96:103], v24
    global_load_dwordx4 a[236:239], v1, s[36:37] offset:-1024
    v_exp_f32 v124, v124
    v_exp_f32 v125, v125
    v_smfmac_f32_16x16x64_bf16 v[32:35], v[20:23], v[104:111], v24
    v_exp_f32 v126, v126
    v_exp_f32 v127, v127
    s_waitcnt lgkmcnt(0)
    v_mov_b32 v224, v14
    v_mov_b32 v225, v14
    v_mov_b64 v[226:227], v[224:225]
    v_mov_b64 v[228:229], v[224:225]
    v_mov_b64 v[230:231], v[224:225]
    v_mov_b64 v[232:233], v[224:225]
    v_mov_b64 v[234:235], v[224:225]
    v_mov_b64 v[236:237], v[224:225]
    v_mov_b64 v[238:239], v[224:225]
    v_mov_b32 v240, v15
    v_mov_b32 v241, v15
    v_mov_b64 v[242:243], v[240:241]
    v_mov_b64 v[244:245], v[240:241]
    v_mov_b64 v[246:247], v[240:241]
    v_mov_b64 v[248:249], v[240:241]
    v_mov_b64 v[250:251], v[240:241]
    v_mov_b64 v[252:253], v[240:241]
    v_mov_b64 v[254:255], v[240:241]
    v_mfma_f32_32x32x16_bf16 v[96:111], a[192:195], a[176:179], v[224:239]
    s_add_u32 m0, s30, 4096
    v_exp_f32 v80, v80
    v_exp_f32 v81, v81
    v_exp_f32 v82, v82
    v_mfma_f32_32x32x16_bf16 v[96:111], a[196:199], a[180:183], v[96:111]
    s_xor_b32 s28, s1, 0x0
    v_exp_f32 v83, v83
    v_exp_f32 v84, v84
    v_exp_f32 v85, v85
    v_smfmac_f32_32x32x32_bf16 v[160:175], a[224:227], v[112:119], v24
    s_add_u32 s46, s42, s28
    v_exp_f32 v86, v86
    v_exp_f32 v87, v87
    v_exp_f32 v88, v88
    v_smfmac_f32_32x32x32_bf16 v[160:175], a[228:231], v[120:127], v24
    s_addc_u32 s47, s43, 0
    buffer_store_dwordx4 a[148:151], v1, s[20:23], s56 offen offset:1024 sc1
    v_exp_f32 v89, v89
    v_exp_f32 v90, v90
    v_exp_f32 v91, v91
    v_smfmac_f32_16x16x64_bf16 v[28:31], v[20:23], v[112:119], v24
    global_load_lds_dwordx4 v9, s[46:47]
    v_exp_f32 v92, v92
    v_exp_f32 v93, v93
    v_smfmac_f32_16x16x64_bf16 v[28:31], v[20:23], v[120:127], v24
    v_exp_f32 v94, v94
    v_exp_f32 v95, v95
    v_mfma_f32_32x32x16_bf16 v[112:127], a[192:195], a[184:187], v[240:255]
    s_add_u32 s33, s6, 0x18000
    v_exp_f32 v96, v96
    v_exp_f32 v97, v97
    v_exp_f32 v98, v98
    v_mfma_f32_32x32x16_bf16 v[112:127], a[196:199], a[188:191], v[112:127]
    s_and_b32 s33, s33, 0x3ffff
    v_exp_f32 v99, v99
    v_exp_f32 v100, v100
    v_exp_f32 v101, v101
    v_smfmac_f32_32x32x32_bf16 v[176:191], a[224:227], v[80:87], v24
hook12:
    s_cbranch_execz hook1
    s_add_u32 s38, s4, s33
    v_exp_f32 v102, v102
    v_exp_f32 v103, v103
    v_exp_f32 v104, v104
    v_smfmac_f32_32x32x32_bf16 v[176:191], a[228:231], v[88:95], v24
    s_addc_u32 s39, s5, 0
    v_exp_f32 v105, v105
    v_exp_f32 v106, v106
    v_exp_f32 v107, v107
    v_smfmac_f32_16x16x64_bf16 v[32:35], v[20:23], v[80:87], v24
    global_load_dwordx4 a[192:195], v63, s[38:39] offset:-4096
    v_exp_f32 v108, v108
    v_exp_f32 v109, v109
    v_smfmac_f32_16x16x64_bf16 v[32:35], v[20:23], v[88:95], v24
    global_load_dwordx4 a[196:199], v63, s[38:39] offset:-3072
    v_exp_f32 v110, v110
    v_exp_f32 v111, v111
    v_mfma_f32_32x32x16_bf16 v[80:95], a[200:203], a[176:179], v[224:239]
    v_exp_f32 v112, v112
    v_exp_f32 v113, v113
    v_exp_f32 v114, v114
    v_mfma_f32_32x32x16_bf16 v[80:95], a[204:207], a[180:183], v[80:95]
    s_add_u32 m0, s30, 8192
    v_exp_f32 v115, v115
    v_exp_f32 v116, v116
    v_exp_f32 v117, v117
    v_smfmac_f32_32x32x32_bf16 a[0:15], a[216:219], v[96:103], v24
    s_add_u32 s46, s46, 0x10000
    v_exp_f32 v118, v118
    v_exp_f32 v119, v119
    v_exp_f32 v120, v120
    v_smfmac_f32_32x32x32_bf16 a[0:15], a[220:223], v[104:111], v24
    s_addc_u32 s47, s47, 0
    buffer_store_dwordx4 a[152:155], v1, s[20:23], s56 offen offset:2048 sc1
    v_exp_f32 v121, v121
    v_exp_f32 v122, v122
    v_exp_f32 v123, v123
    v_smfmac_f32_16x16x64_bf16 v[48:51], v[20:23], v[96:103], v24
    global_load_lds_dwordx4 v9, s[46:47]
    v_exp_f32 v124, v124
    v_exp_f32 v125, v125
    v_smfmac_f32_16x16x64_bf16 v[48:51], v[20:23], v[104:111], v24
    v_exp_f32 v126, v126
    v_exp_f32 v127, v127
    v_mfma_f32_32x32x16_bf16 v[96:111], a[200:203], a[184:187], v[240:255]
    s_add_u32 m0, s30, 12288
    v_exp_f32 v80, v80
    v_exp_f32 v81, v81
    v_exp_f32 v82, v82
    v_mfma_f32_32x32x16_bf16 v[96:111], a[204:207], a[188:191], v[96:111]
    s_add_u32 s46, s46, 0x10000
    v_exp_f32 v83, v83
    v_exp_f32 v84, v84
    v_exp_f32 v85, v85
    v_smfmac_f32_32x32x32_bf16 a[16:31], a[216:219], v[112:119], v24
    s_addc_u32 s47, s47, 0
    v_exp_f32 v86, v86
    v_exp_f32 v87, v87
    v_exp_f32 v88, v88
    v_smfmac_f32_32x32x32_bf16 a[16:31], a[220:223], v[120:127], v24
    s_waitcnt vmcnt(9)
    buffer_store_dwordx4 a[156:159], v1, s[20:23], s56 offen offset:3072 sc1
    v_exp_f32 v89, v89
    v_exp_f32 v90, v90
    v_exp_f32 v91, v91
    v_smfmac_f32_16x16x64_bf16 v[52:55], v[20:23], v[112:119], v24
    global_load_dwordx4 a[216:219], v1, s[38:39] offset:-2048
    v_exp_f32 v92, v92
    v_exp_f32 v93, v93
    v_smfmac_f32_16x16x64_bf16 v[52:55], v[20:23], v[120:127], v24
    global_load_dwordx4 a[220:223], v1, s[38:39] offset:-1024
    v_exp_f32 v94, v94
    v_exp_f32 v95, v95
    v_mfma_f32_32x32x16_bf16 v[112:127], a[208:211], a[176:179], v[224:239]
    s_add_u32 s33, s6, 0x20000
    v_exp_f32 v96, v96
    v_exp_f32 v97, v97
    v_exp_f32 v98, v98
    v_mfma_f32_32x32x16_bf16 v[112:127], a[212:215], a[180:183], v[112:127]
    s_and_b32 s33, s33, 0x3ffff
    v_exp_f32 v99, v99
    v_exp_f32 v100, v100
    v_exp_f32 v101, v101
    v_smfmac_f32_32x32x32_bf16 a[0:15], a[224:227], v[80:87], v24
    s_add_u32 s36, s4, s33
    v_exp_f32 v102, v102
    v_exp_f32 v103, v103
    v_exp_f32 v104, v104
    v_smfmac_f32_32x32x32_bf16 a[0:15], a[228:231], v[88:95], v24
    s_addc_u32 s37, s5, 0
    v_exp_f32 v105, v105
    v_exp_f32 v106, v106
    v_exp_f32 v107, v107
    v_smfmac_f32_16x16x64_bf16 v[48:51], v[20:23], v[80:87], v24
    global_load_dwordx4 a[200:203], v63, s[36:37] offset:-4096
    v_exp_f32 v108, v108
    v_exp_f32 v109, v109
    v_smfmac_f32_16x16x64_bf16 v[48:51], v[20:23], v[88:95], v24
    global_load_lds_dwordx4 v9, s[46:47]
    v_exp_f32 v110, v110
    v_exp_f32 v111, v111
    v_mfma_f32_32x32x16_bf16 v[80:95], a[208:211], a[184:187], v[240:255]
    s_add_u32 m0, s30, 16384
    v_exp_f32 v112, v112
    v_exp_f32 v113, v113
    v_exp_f32 v114, v114
    v_mfma_f32_32x32x16_bf16 v[80:95], a[212:215], a[188:191], v[80:95]
    s_add_u32 s46, s46, 0x10000
    v_exp_f32 v115, v115
    v_exp_f32 v116, v116
    v_exp_f32 v117, v117
    v_smfmac_f32_32x32x32_bf16 a[16:31], a[224:227], v[96:103], v24
    s_addc_u32 s47, s47, 0
    v_exp_f32 v118, v118
    v_exp_f32 v119, v119
    v_exp_f32 v120, v120
    v_smfmac_f32_32x32x32_bf16 a[16:31], a[228:231], v[104:111], v24
    s_waitcnt vmcnt(11)
    buffer_store_dwordx4 a[240:243], v1, s[20:23], s49 offen offset:0 sc1
    v_exp_f32 v121, v121
    v_exp_f32 v122, v122
    v_exp_f32 v123, v123
    v_smfmac_f32_16x16x64_bf16 v[52:55], v[20:23], v[96:103], v24
    global_load_dwordx4 a[204:207], v63, s[36:37] offset:-3072
    v_exp_f32 v124, v124
    v_exp_f32 v125, v125
    v_smfmac_f32_16x16x64_bf16 v[52:55], v[20:23], v[104:111], v24
    global_load_lds_dwordx4 v9, s[46:47]
    v_exp_f32 v126, v126
    v_exp_f32 v127, v127
    v_mfma_f32_32x32x16_bf16 v[96:111], a[208:211], a[160:163], v[128:143]
    s_add_u32 m0, s30, 20480
    v_exp_f32 v80, v80
    v_exp_f32 v81, v81
    v_exp_f32 v82, v82
    v_mfma_f32_32x32x16_bf16 v[96:111], a[212:215], a[164:167], v[96:111]
    s_xor_b32 s28, s1, 0x40000
    v_exp_f32 v83, v83
    v_exp_f32 v84, v84
    v_exp_f32 v85, v85
    v_smfmac_f32_32x32x32_bf16 a[0:15], a[232:235], v[112:119], v24
    s_add_u32 s46, s42, s28
    v_exp_f32 v86, v86
    v_exp_f32 v87, v87
    v_exp_f32 v88, v88
    v_smfmac_f32_32x32x32_bf16 a[0:15], a[236:239], v[120:127], v24
    s_addc_u32 s47, s43, 0
    buffer_store_dwordx4 a[244:247], v1, s[20:23], s49 offen offset:1024 sc1
    v_exp_f32 v89, v89
    v_exp_f32 v90, v90
    v_exp_f32 v91, v91
    v_smfmac_f32_16x16x64_bf16 v[48:51], v[20:23], v[112:119], v24
    global_load_dwordx4 a[224:227], v1, s[36:37] offset:-2048
    v_exp_f32 v92, v92
    v_exp_f32 v93, v93
    v_smfmac_f32_16x16x64_bf16 v[48:51], v[20:23], v[120:127], v24
    global_load_lds_dwordx4 v9, s[46:47]
    v_exp_f32 v94, v94
    v_exp_f32 v95, v95
    v_mfma_f32_32x32x16_bf16 v[112:127], a[208:211], a[168:171], v[144:159]
    s_add_u32 m0, s30, 24576
    v_exp_f32 v96, v96
    v_exp_f32 v97, v97
    v_exp_f32 v98, v98
    v_mfma_f32_32x32x16_bf16 v[112:127], a[212:215], a[172:175], v[112:127]
    s_add_u32 s46, s46, 0x10000
    v_exp_f32 v99, v99
    v_exp_f32 v100, v100
    v_exp_f32 v101, v101
    v_smfmac_f32_32x32x32_bf16 a[16:31], a[232:235], v[80:87], v24
    s_addc_u32 s47, s47, 0
    v_exp_f32 v102, v102
    v_exp_f32 v103, v103
    v_exp_f32 v104, v104
    v_smfmac_f32_32x32x32_bf16 a[16:31], a[236:239], v[88:95], v24
    s_waitcnt vmcnt(13)
    v_exp_f32 v105, v105
    v_exp_f32 v106, v106
    v_exp_f32 v107, v107
    v_smfmac_f32_16x16x64_bf16 v[52:55], v[20:23], v[80:87], v24
    global_load_dwordx4 a[228:231], v1, s[36:37] offset:-1024
    v_exp_f32 v108, v108
    v_exp_f32 v109, v109
    v_smfmac_f32_16x16x64_bf16 v[52:55], v[20:23], v[88:95], v24
    global_load_lds_dwordx4 v9, s[46:47]
    v_exp_f32 v110, v110
    v_exp_f32 v111, v111
    v_mfma_f32_32x32x16_bf16 v[80:95], a[192:195], a[176:179], v[224:239]
    s_add_u32 s33, s6, 0x28000
    v_exp_f32 v112, v112
    v_exp_f32 v113, v113
    v_exp_f32 v114, v114
    v_mfma_f32_32x32x16_bf16 v[80:95], a[196:199], a[180:183], v[80:95]
    s_and_b32 s33, s33, 0x3ffff
    v_exp_f32 v115, v115
    v_exp_f32 v116, v116
    v_exp_f32 v117, v117
    v_smfmac_f32_32x32x32_bf16 v[160:175], a[232:235], v[96:103], v24
    s_add_u32 s38, s4, s33
    v_exp_f32 v118, v118
    v_exp_f32 v119, v119
    v_exp_f32 v120, v120
    v_smfmac_f32_32x32x32_bf16 v[160:175], a[236:239], v[104:111], v24
    s_addc_u32 s39, s5, 0
    buffer_store_dwordx4 a[248:251], v1, s[20:23], s49 offen offset:2048 sc1
    v_exp_f32 v121, v121
    v_exp_f32 v122, v122
    v_exp_f32 v123, v123
    v_smfmac_f32_16x16x64_bf16 v[28:31], v[20:23], v[96:103], v24
    global_load_dwordx4 a[208:211], v63, s[38:39] offset:-4096
    v_exp_f32 v124, v124
    v_exp_f32 v125, v125
    v_smfmac_f32_16x16x64_bf16 v[28:31], v[20:23], v[104:111], v24
    v_exp_f32 v126, v126
    v_exp_f32 v127, v127
    v_mfma_f32_32x32x16_bf16 v[96:111], a[192:195], a[184:187], v[240:255]
    v_exp_f32 v80, v80
    v_exp_f32 v81, v81
    v_exp_f32 v82, v82
    v_mfma_f32_32x32x16_bf16 v[96:111], a[196:199], a[188:191], v[96:111]
    v_exp_f32 v83, v83
    v_exp_f32 v84, v84
    v_exp_f32 v85, v85
    v_smfmac_f32_32x32x32_bf16 v[176:191], a[232:235], v[112:119], v24
    v_exp_f32 v86, v86
    v_exp_f32 v87, v87
    v_exp_f32 v88, v88
    v_smfmac_f32_32x32x32_bf16 v[176:191], a[236:239], v[120:127], v24
    s_waitcnt vmcnt(12)
    buffer_store_dwordx4 a[252:255], v1, s[20:23], s49 offen offset:3072 sc1
    v_exp_f32 v89, v89
    v_exp_f32 v90, v90
    v_exp_f32 v91, v91
    v_smfmac_f32_16x16x64_bf16 v[32:35], v[20:23], v[112:119], v24
    global_load_dwordx4 a[212:215], v63, s[38:39] offset:-3072
    v_exp_f32 v92, v92
    v_exp_f32 v93, v93
    v_smfmac_f32_16x16x64_bf16 v[32:35], v[20:23], v[120:127], v24
    global_load_dword v45, v44, s[98:99]
    v_exp_f32 v94, v94
    v_exp_f32 v95, v95
    v_mfma_f32_32x32x16_bf16 v[112:127], a[192:195], a[160:163], v[128:143]
    v_exp_f32 v96, v96
    v_exp_f32 v97, v97
    v_exp_f32 v98, v98
    v_mfma_f32_32x32x16_bf16 v[112:127], a[196:199], a[164:167], v[112:127]
    s_add_u32 m0, s30, 28672
    v_exp_f32 v99, v99
    v_exp_f32 v100, v100
    v_exp_f32 v101, v101
    v_smfmac_f32_32x32x32_bf16 a[0:15], a[216:219], v[80:87], v24
    s_add_u32 s46, s46, 0x10000
    v_exp_f32 v102, v102
    v_exp_f32 v103, v103
    v_exp_f32 v104, v104
    v_smfmac_f32_32x32x32_bf16 a[0:15], a[220:223], v[88:95], v24
    s_addc_u32 s47, s47, 0
    v_exp_f32 v105, v105
    v_exp_f32 v106, v106
    v_exp_f32 v107, v107
    v_smfmac_f32_16x16x64_bf16 v[48:51], v[20:23], v[80:87], v24
    global_load_dwordx4 a[232:235], v1, s[38:39] offset:-2048
    v_exp_f32 v108, v108
    v_exp_f32 v109, v109
    v_smfmac_f32_16x16x64_bf16 v[48:51], v[20:23], v[88:95], v24
    global_load_lds_dwordx4 v9, s[46:47]
    v_exp_f32 v110, v110
    v_exp_f32 v111, v111
    v_mfma_f32_32x32x16_bf16 v[80:95], a[192:195], a[168:171], v[144:159]
    s_add_u32 m0, s30, 32768
    v_exp_f32 v112, v112
    v_exp_f32 v113, v113
    v_exp_f32 v114, v114
    v_mfma_f32_32x32x16_bf16 v[80:95], a[196:199], a[172:175], v[80:95]
    s_add_u32 s46, s46, 0x10000
    v_exp_f32 v115, v115
    v_exp_f32 v116, v116
    v_exp_f32 v117, v117
    v_smfmac_f32_32x32x32_bf16 a[16:31], a[216:219], v[96:103], v24
    s_addc_u32 s47, s47, 0
    v_exp_f32 v118, v118
    v_exp_f32 v119, v119
    v_exp_f32 v120, v120
    v_smfmac_f32_32x32x32_bf16 a[16:31], a[220:223], v[104:111], v24
    s_waitcnt vmcnt(13)
    v_exp_f32 v121, v121
    v_exp_f32 v122, v122
    v_exp_f32 v123, v123
    v_smfmac_f32_16x16x64_bf16 v[52:55], v[20:23], v[96:103], v24
    global_load_dwordx4 a[236:239], v1, s[38:39] offset:-1024
    v_exp_f32 v124, v124
    v_exp_f32 v125, v125
    v_smfmac_f32_16x16x64_bf16 v[52:55], v[20:23], v[104:111], v24
    global_load_lds_dwordx4 v9, s[46:47]
    v_exp_f32 v126, v126
    v_exp_f32 v127, v127
    v_mfma_f32_32x32x16_bf16 v[96:111], a[200:203], a[176:179], v[224:239]
    s_add_u32 s33, s6, 0x30000
    v_exp_f32 v80, v80
    v_exp_f32 v81, v81
    v_exp_f32 v82, v82
    v_mfma_f32_32x32x16_bf16 v[96:111], a[204:207], a[180:183], v[96:111]
    s_and_b32 s33, s33, 0x3ffff
    v_exp_f32 v83, v83
    v_exp_f32 v84, v84
    v_exp_f32 v85, v85
    v_smfmac_f32_32x32x32_bf16 v[160:175], a[216:219], v[112:119], v24
    s_add_u32 s36, s4, s33
    v_exp_f32 v86, v86
    v_exp_f32 v87, v87
    v_exp_f32 v88, v88
    v_smfmac_f32_32x32x32_bf16 v[160:175], a[220:223], v[120:127], v24
    s_addc_u32 s37, s5, 0
    v_exp_f32 v89, v89
    v_exp_f32 v90, v90
    v_exp_f32 v91, v91
    v_smfmac_f32_16x16x64_bf16 v[28:31], v[20:23], v[112:119], v24
    global_load_dwordx4 a[192:195], v63, s[36:37] offset:-4096
    v_exp_f32 v92, v92
    v_exp_f32 v93, v93
    v_smfmac_f32_16x16x64_bf16 v[28:31], v[20:23], v[120:127], v24
    v_exp_f32 v94, v94
    v_exp_f32 v95, v95
    v_mfma_f32_32x32x16_bf16 v[112:127], a[200:203], a[184:187], v[240:255]
    v_exp_f32 v96, v96
    v_exp_f32 v97, v97
    v_exp_f32 v98, v98
    v_mfma_f32_32x32x16_bf16 v[112:127], a[204:207], a[188:191], v[112:127]
    v_exp_f32 v99, v99
    v_exp_f32 v100, v100
    v_exp_f32 v101, v101
    v_smfmac_f32_32x32x32_bf16 v[176:191], a[216:219], v[80:87], v24
    v_exp_f32 v102, v102
    v_exp_f32 v103, v103
    v_exp_f32 v104, v104
    v_smfmac_f32_32x32x32_bf16 v[176:191], a[220:223], v[88:95], v24
    s_waitcnt vmcnt(11)
    v_exp_f32 v105, v105
    v_exp_f32 v106, v106
    v_exp_f32 v107, v107
    v_smfmac_f32_16x16x64_bf16 v[32:35], v[20:23], v[80:87], v24
    global_load_dwordx4 a[196:199], v63, s[36:37] offset:-3072
    v_exp_f32 v108, v108
    v_exp_f32 v109, v109
    v_smfmac_f32_16x16x64_bf16 v[32:35], v[20:23], v[88:95], v24
    v_exp_f32 v110, v110
    v_exp_f32 v111, v111
    v_mfma_f32_32x32x16_bf16 v[80:95], a[200:203], a[160:163], v[128:143]
    v_exp_f32 v112, v112
    v_exp_f32 v113, v113
    v_exp_f32 v114, v114
    v_mfma_f32_32x32x16_bf16 v[80:95], a[204:207], a[164:167], v[80:95]
    v_exp_f32 v115, v115
    v_exp_f32 v116, v116
    v_exp_f32 v117, v117
    v_smfmac_f32_32x32x32_bf16 a[0:15], a[224:227], v[96:103], v24
    v_exp_f32 v118, v118
    v_exp_f32 v119, v119
    v_exp_f32 v120, v120
    v_smfmac_f32_32x32x32_bf16 a[0:15], a[228:231], v[104:111], v24
    s_add_u32 m0, s30, 36864
    v_exp_f32 v121, v121
    v_exp_f32 v122, v122
    v_exp_f32 v123, v123
    v_smfmac_f32_16x16x64_bf16 v[48:51], v[20:23], v[96:103], v24
    buffer_load_dword v5, v19, s[20:23], 0 offen offset:128 sc1
    v_exp_f32 v124, v124
    v_exp_f32 v125, v125
    v_smfmac_f32_16x16x64_bf16 v[48:51], v[20:23], v[104:111], v24
    global_load_dwordx4 a[216:219], v1, s[36:37] offset:-2048
    v_exp_f32 v126, v126
    v_exp_f32 v127, v127
    v_mfma_f32_32x32x16_bf16 v[96:111], a[200:203], a[168:171], v[144:159]
    s_xor_b32 s28, s1, 0x80000
    v_exp_f32 v80, v80
    v_exp_f32 v81, v81
    v_exp_f32 v82, v82
    v_mfma_f32_32x32x16_bf16 v[96:111], a[204:207], a[172:175], v[96:111]
    s_add_u32 s46, s42, s28
    v_exp_f32 v83, v83
    v_exp_f32 v84, v84
    v_exp_f32 v85, v85
    v_smfmac_f32_32x32x32_bf16 a[16:31], a[224:227], v[112:119], v24
    s_addc_u32 s47, s43, 0
    v_exp_f32 v86, v86
    v_exp_f32 v87, v87
    v_exp_f32 v88, v88
    v_smfmac_f32_32x32x32_bf16 a[16:31], a[228:231], v[120:127], v24
    s_waitcnt vmcnt(9)
    v_exp_f32 v89, v89
    v_exp_f32 v90, v90
    v_exp_f32 v91, v91
    v_smfmac_f32_16x16x64_bf16 v[52:55], v[20:23], v[112:119], v24
    global_load_dwordx4 a[220:223], v1, s[36:37] offset:-1024
    v_exp_f32 v92, v92
    v_exp_f32 v93, v93
    v_smfmac_f32_16x16x64_bf16 v[52:55], v[20:23], v[120:127], v24
    buffer_store_dword v24, v25, s[20:23], s54 offen offset:256 sc1
    v_exp_f32 v94, v94
    v_exp_f32 v95, v95
    v_mov_b32 v6, v36
    v_maximum3_f32 v7, abs(v192), abs(v193), abs(v194)
    v_maximum3_f32 v8, abs(v195), abs(v196), abs(v197)
    v_maximum3_f32 v8, abs(v198), abs(v199), v8
    v_maximum3_f32 v7, abs(v200), abs(v201), v7
    v_maximum3_f32 v8, abs(v202), abs(v203), v8
    v_maximum3_f32 v7, abs(v204), abs(v205), v7
    v_maximum3_f32 v8, abs(v206), abs(v207), v8
    v_maximum3_f32 v7, v7, v8, v8
    v_maximum3_f32 v8, v7, v6, v6
    v_cmp_nlt_f32 vcc, 0xb800000, v7
    s_mov_b64 s[10:11], vcc
    v_cmp_ngt_f32 vcc, 0x7e000000, v8
    s_or_b64 vcc, vcc, s[10:11]
    s_cbranch_vccnz afa_fix0
afa_ok0:
    v_rcp_f32 v6, v6
    s_add_u32 s34, s55, 0x0
    v_pk_mul_f32 v[192:193], v[6:7], v[192:193] op_sel_hi:[0,1]
    v_pk_mul_f32 v[194:195], v[6:7], v[194:195] op_sel_hi:[0,1]
    v_pk_mul_f32 v[196:197], v[6:7], v[196:197] op_sel_hi:[0,1]
    v_pk_mul_f32 v[198:199], v[6:7], v[198:199] op_sel_hi:[0,1]
    v_pk_mul_f32 v[200:201], v[6:7], v[200:201] op_sel_hi:[0,1]
    v_pk_mul_f32 v[202:203], v[6:7], v[202:203] op_sel_hi:[0,1]
    v_pk_mul_f32 v[204:205], v[6:7], v[204:205] op_sel_hi:[0,1]
    v_pk_mul_f32 v[206:207], v[6:7], v[206:207] op_sel_hi:[0,1]
    v_cvt_pk_bf16_f32 v192, v192, v193
    v_cvt_pk_bf16_f32 v193, v194, v195
    v_cvt_pk_bf16_f32 v194, v196, v197
    v_cvt_pk_bf16_f32 v195, v198, v199
    v_cvt_pk_bf16_f32 v196, v200, v201
    v_cvt_pk_bf16_f32 v197, v202, v203
    v_cvt_pk_bf16_f32 v198, v204, v205
    v_cvt_pk_bf16_f32 v199, v206, v207
    buffer_store_dwordx4 v[192:195], v3, s[20:23], s34 offen offset:0 sc1
    buffer_store_dwordx4 v[196:199], v3, s[20:23], s34 offen offset:256 sc1
    v_mov_b32 v6, v40
    v_maximum3_f32 v7, abs(v208), abs(v209), abs(v210)
    v_maximum3_f32 v8, abs(v211), abs(v212), abs(v213)
    v_maximum3_f32 v8, abs(v214), abs(v215), v8
    v_maximum3_f32 v7, abs(v216), abs(v217), v7
    v_maximum3_f32 v8, abs(v218), abs(v219), v8
    v_maximum3_f32 v7, abs(v220), abs(v221), v7
    v_maximum3_f32 v8, abs(v222), abs(v223), v8
    v_maximum3_f32 v7, v7, v8, v8
    v_maximum3_f32 v8, v7, v6, v6
    v_cmp_nlt_f32 vcc, 0xb800000, v7
    s_mov_b64 s[10:11], vcc
    v_cmp_ngt_f32 vcc, 0x7e000000, v8
    s_or_b64 vcc, vcc, s[10:11]
    s_cbranch_vccnz afa_fix1
afa_ok1:
    v_rcp_f32 v6, v6
    s_add_u32 s34, s55, 0x10000
    v_pk_mul_f32 v[208:209], v[6:7], v[208:209] op_sel_hi:[0,1]
    v_pk_mul_f32 v[210:211], v[6:7], v[210:211] op_sel_hi:[0,1]
    v_pk_mul_f32 v[212:213], v[6:7], v[212:213] op_sel_hi:[0,1]
    v_pk_mul_f32 v[214:215], v[6:7], v[214:215] op_sel_hi:[0,1]
    v_pk_mul_f32 v[216:217], v[6:7], v[216:217] op_sel_hi:[0,1]
    v_pk_mul_f32 v[218:219], v[6:7], v[218:219] op_sel_hi:[0,1]
    v_pk_mul_f32 v[220:221], v[6:7], v[220:221] op_sel_hi:[0,1]
    v_pk_mul_f32 v[222:223], v[6:7], v[222:223] op_sel_hi:[0,1]
    v_cvt_pk_bf16_f32 v208, v208, v209
    v_cvt_pk_bf16_f32 v209, v210, v211
    v_cvt_pk_bf16_f32 v210, v212, v213
    v_cvt_pk_bf16_f32 v211, v214, v215
    v_cvt_pk_bf16_f32 v212, v216, v217
    v_cvt_pk_bf16_f32 v213, v218, v219
    v_cvt_pk_bf16_f32 v214, v220, v221
    v_cvt_pk_bf16_f32 v215, v222, v223
    buffer_store_dwordx4 v[208:211], v3, s[20:23], s34 offen offset:0 sc1
    buffer_store_dwordx4 v[212:215], v3, s[20:23], s34 offen offset:256 sc1
    v_mfma_f32_32x32x16_bf16 v[112:127], a[208:211], a[176:179], v[224:239]
    s_add_u32 s33, s6, 0x38000
    v_exp_f32 v96, v96
    v_exp_f32 v97, v97
    v_exp_f32 v98, v98
    v_mfma_f32_32x32x16_bf16 v[112:127], a[212:215], a[180:183], v[112:127]
    s_and_b32 s33, s33, 0x3ffff
    v_exp_f32 v99, v99
    v_exp_f32 v100, v100
    v_exp_f32 v101, v101
    v_smfmac_f32_32x32x32_bf16 v[160:175], a[224:227], v[80:87], v24
    s_add_u32 s38, s4, s33
    v_exp_f32 v102, v102
    v_exp_f32 v103, v103
    v_exp_f32 v104, v104
    v_smfmac_f32_32x32x32_bf16 v[160:175], a[228:231], v[88:95], v24
    s_addc_u32 s39, s5, 0
    v_exp_f32 v105, v105
    v_exp_f32 v106, v106
    v_exp_f32 v107, v107
    v_smfmac_f32_16x16x64_bf16 v[28:31], v[20:23], v[80:87], v24
    global_load_dwordx4 a[200:203], v63, s[38:39] offset:-4096
    v_exp_f32 v108, v108
    v_exp_f32 v109, v109
    v_smfmac_f32_16x16x64_bf16 v[28:31], v[20:23], v[88:95], v24
    global_load_lds_dwordx4 v9, s[46:47]
    v_exp_f32 v110, v110
    v_exp_f32 v111, v111
    v_mfma_f32_32x32x16_bf16 v[80:95], a[208:211], a[184:187], v[240:255]
    s_add_u32 m0, s30, 40960
    v_exp_f32 v112, v112
    v_exp_f32 v113, v113
    v_exp_f32 v114, v114
    v_mfma_f32_32x32x16_bf16 v[80:95], a[212:215], a[188:191], v[80:95]
    s_add_u32 s46, s46, 0x10000
    v_exp_f32 v115, v115
    v_exp_f32 v116, v116
    v_exp_f32 v117, v117
    v_smfmac_f32_32x32x32_bf16 v[176:191], a[224:227], v[96:103], v24
    s_addc_u32 s47, s47, 0
    v_exp_f32 v118, v118
    v_exp_f32 v119, v119
    v_exp_f32 v120, v120
    v_smfmac_f32_32x32x32_bf16 v[176:191], a[228:231], v[104:111], v24
    s_waitcnt vmcnt(13)
    v_exp_f32 v121, v121
    v_exp_f32 v122, v122
    v_exp_f32 v123, v123
    v_smfmac_f32_16x16x64_bf16 v[32:35], v[20:23], v[96:103], v24
    global_load_dwordx4 a[204:207], v63, s[38:39] offset:-3072
    v_exp_f32 v124, v124
    v_exp_f32 v125, v125
    v_smfmac_f32_16x16x64_bf16 v[32:35], v[20:23], v[104:111], v24
    global_load_lds_dwordx4 v9, s[46:47]
    v_exp_f32 v126, v126
    v_exp_f32 v127, v127
    v_mfma_f32_32x32x16_bf16 v[96:111], a[208:211], a[160:163], v[128:143]
    v_exp_f32 v80, v80
    v_exp_f32 v81, v81
    v_exp_f32 v82, v82
    v_mfma_f32_32x32x16_bf16 v[96:111], a[212:215], a[164:167], v[96:111]
    s_add_u32 m0, s30, 45056
    v_exp_f32 v83, v83
    v_exp_f32 v84, v84
    v_exp_f32 v85, v85
    v_smfmac_f32_32x32x32_bf16 a[0:15], a[232:235], v[112:119], v24
    s_add_u32 s46, s46, 0x10000
    v_exp_f32 v86, v86
    v_exp_f32 v87, v87
    v_exp_f32 v88, v88
    v_smfmac_f32_32x32x32_bf16 a[0:15], a[236:239], v[120:127], v24
    s_addc_u32 s47, s47, 0
    v_exp_f32 v89, v89
    v_exp_f32 v90, v90
    v_exp_f32 v91, v91
    v_smfmac_f32_16x16x64_bf16 v[48:51], v[20:23], v[112:119], v24
    global_load_dwordx4 a[224:227], v1, s[38:39] offset:-2048
    v_exp_f32 v92, v92
    v_exp_f32 v93, v93
    v_smfmac_f32_16x16x64_bf16 v[48:51], v[20:23], v[120:127], v24
    global_load_lds_dwordx4 v9, s[46:47]
    v_exp_f32 v94, v94
    v_exp_f32 v95, v95
    v_mfma_f32_32x32x16_bf16 v[112:127], a[208:211], a[168:171], v[144:159]
    s_add_u32 m0, s30, 49152
    v_exp_f32 v96, v96
    v_exp_f32 v97, v97
    v_exp_f32 v98, v98
    v_mfma_f32_32x32x16_bf16 v[112:127], a[212:215], a[172:175], v[112:127]
    s_add_u32 s46, s46, 0x10000
    v_exp_f32 v99, v99
    v_exp_f32 v100, v100
    v_exp_f32 v101, v101
    v_smfmac_f32_32x32x32_bf16 a[16:31], a[232:235], v[80:87], v24
    s_addc_u32 s47, s47, 0
    v_exp_f32 v102, v102
    v_exp_f32 v103, v103
    v_exp_f32 v104, v104
    v_smfmac_f32_32x32x32_bf16 a[16:31], a[236:239], v[88:95], v24
    s_waitcnt vmcnt(14)
    v_exp_f32 v105, v105
    v_exp_f32 v106, v106
    v_exp_f32 v107, v107
    v_smfmac_f32_16x16x64_bf16 v[52:55], v[20:23], v[80:87], v24
    global_load_dwordx4 a[228:231], v1, s[38:39] offset:-1024
    v_exp_f32 v108, v108
    v_exp_f32 v109, v109
    v_smfmac_f32_16x16x64_bf16 v[52:55], v[20:23], v[88:95], v24
    global_load_lds_dwordx4 v9, s[46:47]
    v_exp_f32 v110, v110
    v_exp_f32 v111, v111
    s_waitcnt vmcnt(15)
    v_cmp_gt_u32 vcc, 1, v5
    s_cbranch_vccnz apb1_spin
apb1_ok:
    v_mfma_f32_32x32x16_bf16 v[80:95], a[192:195], a[176:179], v[224:239]
    s_add_u32 s33, s6, 0x0
    v_exp_f32 v112, v112
    v_exp_f32 v113, v113
    v_exp_f32 v114, v114
    v_mfma_f32_32x32x16_bf16 v[80:95], a[196:199], a[180:183], v[80:95]
    s_and_b32 s33, s33, 0x3ffff
    v_exp_f32 v115, v115
    v_exp_f32 v116, v116
    v_exp_f32 v117, v117
    v_smfmac_f32_32x32x32_bf16 v[160:175], a[232:235], v[96:103], v24
    s_add_u32 s36, s4, s33
    v_exp_f32 v118, v118
    v_exp_f32 v119, v119
    v_exp_f32 v120, v120
    v_smfmac_f32_32x32x32_bf16 v[160:175], a[236:239], v[104:111], v24
    s_addc_u32 s37, s5, 0
    v_exp_f32 v121, v121
    v_exp_f32 v122, v122
    v_exp_f32 v123, v123
    v_smfmac_f32_16x16x64_bf16 v[28:31], v[20:23], v[96:103], v24
    global_load_dwordx4 a[208:211], v63, s[36:37] offset:0
    v_exp_f32 v124, v124
    v_exp_f32 v125, v125
    v_smfmac_f32_16x16x64_bf16 v[28:31], v[20:23], v[104:111], v24
    v_exp_f32 v126, v126
    v_exp_f32 v127, v127
    v_mfma_f32_32x32x16_bf16 v[96:111], a[192:195], a[184:187], v[240:255]
    v_exp_f32 v80, v80
    v_exp_f32 v81, v81
    v_exp_f32 v82, v82
    v_mfma_f32_32x32x16_bf16 v[96:111], a[196:199], a[188:191], v[96:111]
    v_exp_f32 v83, v83
    v_exp_f32 v84, v84
    v_exp_f32 v85, v85
    v_smfmac_f32_32x32x32_bf16 v[176:191], a[232:235], v[112:119], v24
    v_exp_f32 v86, v86
    v_exp_f32 v87, v87
    v_exp_f32 v88, v88
    v_smfmac_f32_32x32x32_bf16 v[176:191], a[236:239], v[120:127], v24
    s_waitcnt vmcnt(14)
    v_exp_f32 v89, v89
    v_exp_f32 v90, v90
    v_exp_f32 v91, v91
    v_smfmac_f32_16x16x64_bf16 v[32:35], v[20:23], v[112:119], v24
    global_load_dwordx4 a[212:215], v63, s[36:37] offset:1024
    v_exp_f32 v92, v92
    v_exp_f32 v93, v93
    v_smfmac_f32_16x16x64_bf16 v[32:35], v[20:23], v[120:127], v24
    v_exp_f32 v94, v94
    v_exp_f32 v95, v95
    v_mfma_f32_32x32x16_bf16 v[112:127], a[192:195], a[160:163], v[128:143]
    v_exp_f32 v96, v96
    v_exp_f32 v97, v97
    v_exp_f32 v98, v98
    v_mfma_f32_32x32x16_bf16 v[112:127], a[196:199], a[164:167], v[112:127]
    v_exp_f32 v99, v99
    v_exp_f32 v100, v100
    v_exp_f32 v101, v101
    v_smfmac_f32_32x32x32_bf16 a[0:15], a[216:219], v[80:87], v24
    v_exp_f32 v102, v102
    v_exp_f32 v103, v103
    v_exp_f32 v104, v104
    v_smfmac_f32_32x32x32_bf16 a[0:15], a[220:223], v[88:95], v24
    s_add_u32 m0, s30, 53248
    v_exp_f32 v105, v105
    v_exp_f32 v106, v106
    v_exp_f32 v107, v107
    v_smfmac_f32_16x16x64_bf16 v[48:51], v[20:23], v[80:87], v24
    global_load_dwordx4 a[232:235], v1, s[36:37] offset:2048
    v_exp_f32 v108, v108
    v_exp_f32 v109, v109
    v_smfmac_f32_16x16x64_bf16 v[48:51], v[20:23], v[88:95], v24
    s_waitcnt vmcnt(11)
    buffer_store_dword v24, v25, s[20:23], s54 offen offset:384 sc1
    v_exp_f32 v110, v110
    v_exp_f32 v111, v111
    v_mfma_f32_32x32x16_bf16 v[80:95], a[192:195], a[168:171], v[144:159]
    s_xor_b32 s28, s1, 0xc0000
    v_exp_f32 v112, v112
    v_exp_f32 v113, v113
    v_exp_f32 v114, v114
    v_mfma_f32_32x32x16_bf16 v[80:95], a[196:199], a[172:175], v[80:95]
    s_add_u32 s46, s42, s28
    v_exp_f32 v115, v115
    v_exp_f32 v116, v116
    v_exp_f32 v117, v117
    v_smfmac_f32_32x32x32_bf16 a[16:31], a[216:219], v[96:103], v24
    s_addc_u32 s47, s43, 0
    v_exp_f32 v118, v118
    v_exp_f32 v119, v119
    v_exp_f32 v120, v120
    v_smfmac_f32_32x32x32_bf16 a[16:31], a[220:223], v[104:111], v24
    s_waitcnt vmcnt(9)
    v_exp_f32 v121, v121
    v_exp_f32 v122, v122
    v_exp_f32 v123, v123
    v_smfmac_f32_16x16x64_bf16 v[52:55], v[20:23], v[96:103], v24
    global_load_dwordx4 a[236:239], v1, s[36:37] offset:3072
    v_exp_f32 v124, v124
    v_exp_f32 v125, v125
    v_smfmac_f32_16x16x64_bf16 v[52:55], v[20:23], v[104:111], v24
    global_load_lds_dwordx4 v9, s[46:47]
    v_exp_f32 v126, v126
    v_exp_f32 v127, v127
    v_mfma_f32_32x32x16_bf16 v[96:111], a[200:203], a[176:179], v[224:239]
    s_add_u32 s33, s6, 0x8000
    v_exp_f32 v80, v80
    v_exp_f32 v81, v81
    v_exp_f32 v82, v82
    v_mfma_f32_32x32x16_bf16 v[96:111], a[204:207], a[180:183], v[96:111]
    s_and_b32 s33, s33, 0x3ffff
    v_exp_f32 v83, v83
    v_exp_f32 v84, v84
    v_exp_f32 v85, v85
    v_smfmac_f32_32x32x32_bf16 v[160:175], a[216:219], v[112:119], v24
    s_add_u32 s38, s4, s33
    v_exp_f32 v86, v86
    v_exp_f32 v87, v87
    v_exp_f32 v88, v88
    v_smfmac_f32_32x32x32_bf16 v[160:175], a[220:223], v[120:127], v24
    s_addc_u32 s39, s5, 0
    v_exp_f32 v89, v89
    v_exp_f32 v90, v90
    v_exp_f32 v91, v91
    v_smfmac_f32_16x16x64_bf16 v[28:31], v[20:23], v[112:119], v24
    global_load_dwordx4 a[192:195], v63, s[38:39] offset:0
    v_exp_f32 v92, v92
    v_exp_f32 v93, v93
    v_smfmac_f32_16x16x64_bf16 v[28:31], v[20:23], v[120:127], v24
    v_exp_f32 v94, v94
    v_exp_f32 v95, v95
    v_mfma_f32_32x32x16_bf16 v[112:127], a[200:203], a[184:187], v[240:255]
    s_add_u32 m0, s30, 57344
    v_exp_f32 v96, v96
    v_exp_f32 v97, v97
    v_exp_f32 v98, v98
    v_mfma_f32_32x32x16_bf16 v[112:127], a[204:207], a[188:191], v[112:127]
    s_add_u32 s46, s46, 0x10000
    v_exp_f32 v99, v99
    v_exp_f32 v100, v100
    v_exp_f32 v101, v101
    v_smfmac_f32_32x32x32_bf16 v[176:191], a[216:219], v[80:87], v24
    s_addc_u32 s47, s47, 0
    v_exp_f32 v102, v102
    v_exp_f32 v103, v103
    v_exp_f32 v104, v104
    v_smfmac_f32_32x32x32_bf16 v[176:191], a[220:223], v[88:95], v24
hook13:
    s_cbranch_execz hook0
    s_waitcnt vmcnt(8)
    v_exp_f32 v105, v105
    v_exp_f32 v106, v106
    v_exp_f32 v107, v107
    v_smfmac_f32_16x16x64_bf16 v[32:35], v[20:23], v[80:87], v24
    global_load_dwordx4 a[196:199], v63, s[38:39] offset:1024
    v_exp_f32 v108, v108
    v_exp_f32 v109, v109
    v_smfmac_f32_16x16x64_bf16 v[32:35], v[20:23], v[88:95], v24
    global_load_lds_dwordx4 v9, s[46:47]
    v_exp_f32 v110, v110
    v_exp_f32 v111, v111
    v_mfma_f32_32x32x16_bf16 v[80:95], a[200:203], a[160:163], v[128:143]
    v_exp_f32 v112, v112
    v_exp_f32 v113, v113
    v_exp_f32 v114, v114
    v_mfma_f32_32x32x16_bf16 v[80:95], a[204:207], a[164:167], v[80:95]
    s_add_u32 m0, s30, 61440
    v_exp_f32 v115, v115
    v_exp_f32 v116, v116
    v_exp_f32 v117, v117
    v_smfmac_f32_32x32x32_bf16 a[0:15], a[224:227], v[96:103], v24
    s_add_u32 s46, s46, 0x10000
    v_exp_f32 v118, v118
    v_exp_f32 v119, v119
    v_exp_f32 v120, v120
    v_smfmac_f32_32x32x32_bf16 a[0:15], a[228:231], v[104:111], v24
    s_addc_u32 s47, s47, 0
    v_exp_f32 v121, v121
    v_exp_f32 v122, v122
    v_exp_f32 v123, v123
    v_smfmac_f32_16x16x64_bf16 v[48:51], v[20:23], v[96:103], v24
    global_load_dwordx4 a[216:219], v1, s[38:39] offset:2048
    v_exp_f32 v124, v124
    v_exp_f32 v125, v125
    v_smfmac_f32_16x16x64_bf16 v[48:51], v[20:23], v[104:111], v24
    global_load_lds_dwordx4 v9, s[46:47]
    v_exp_f32 v126, v126
    v_exp_f32 v127, v127
    v_mfma_f32_32x32x16_bf16 v[96:111], a[200:203], a[168:171], v[144:159]
    s_add_u32 m0, s30, 65536
    v_exp_f32 v80, v80
    v_exp_f32 v81, v81
    v_exp_f32 v82, v82
    v_mfma_f32_32x32x16_bf16 v[96:111], a[204:207], a[172:175], v[96:111]
    s_add_u32 s46, s46, 0x10000
    v_exp_f32 v83, v83
    v_exp_f32 v84, v84
    v_exp_f32 v85, v85
    v_smfmac_f32_32x32x32_bf16 a[16:31], a[224:227], v[112:119], v24
    s_addc_u32 s47, s47, 0
    v_exp_f32 v86, v86
    v_exp_f32 v87, v87
    v_exp_f32 v88, v88
    v_smfmac_f32_32x32x32_bf16 a[16:31], a[228:231], v[120:127], v24
    s_waitcnt vmcnt(9)
    v_exp_f32 v89, v89
    v_exp_f32 v90, v90
    v_exp_f32 v91, v91
    v_smfmac_f32_16x16x64_bf16 v[52:55], v[20:23], v[112:119], v24
    global_load_dwordx4 a[220:223], v1, s[38:39] offset:3072
    v_exp_f32 v92, v92
    v_exp_f32 v93, v93
    v_smfmac_f32_16x16x64_bf16 v[52:55], v[20:23], v[120:127], v24
    global_load_lds_dwordx4 v9, s[46:47]
    v_exp_f32 v94, v94
    v_exp_f32 v95, v95
    v_mfma_f32_32x32x16_bf16 v[112:127], a[208:211], a[176:179], v[224:239]
    s_add_u32 s33, s6, 0x10000
    v_exp_f32 v96, v96
    v_exp_f32 v97, v97
    v_exp_f32 v98, v98
    v_mfma_f32_32x32x16_bf16 v[112:127], a[212:215], a[180:183], v[112:127]
    s_and_b32 s33, s33, 0x3ffff
    v_exp_f32 v99, v99
    v_exp_f32 v100, v100
    v_exp_f32 v101, v101
    v_smfmac_f32_32x32x32_bf16 v[160:175], a[224:227], v[80:87], v24
    s_add_u32 s36, s4, s33
    v_exp_f32 v102, v102
    v_exp_f32 v103, v103
    v_exp_f32 v104, v104
    v_smfmac_f32_32x32x32_bf16 v[160:175], a[228:231], v[88:95], v24
    s_addc_u32 s37, s5, 0
    v_exp_f32 v105, v105
    v_exp_f32 v106, v106
    v_exp_f32 v107, v107
    v_smfmac_f32_16x16x64_bf16 v[28:31], v[20:23], v[80:87], v24
    global_load_dwordx4 a[200:203], v63, s[36:37] offset:0
    v_exp_f32 v108, v108
    v_exp_f32 v109, v109
    v_smfmac_f32_16x16x64_bf16 v[28:31], v[20:23], v[88:95], v24
    v_exp_f32 v110, v110
    v_exp_f32 v111, v111
    v_mfma_f32_32x32x16_bf16 v[80:95], a[208:211], a[184:187], v[240:255]
    v_exp_f32 v112, v112
    v_exp_f32 v113, v113
    v_exp_f32 v114, v114
    v_mfma_f32_32x32x16_bf16 v[80:95], a[212:215], a[188:191], v[80:95]
    v_exp_f32 v115, v115
    v_exp_f32 v116, v116
    v_exp_f32 v117, v117
    v_smfmac_f32_32x32x32_bf16 v[176:191], a[224:227], v[96:103], v24
    v_exp_f32 v118, v118
    v_exp_f32 v119, v119
    v_exp_f32 v120, v120
    v_smfmac_f32_32x32x32_bf16 v[176:191], a[228:231], v[104:111], v24
    s_waitcnt vmcnt(9)
    v_exp_f32 v121, v121
    v_exp_f32 v122, v122
    v_exp_f32 v123, v123
    v_smfmac_f32_16x16x64_bf16 v[32:35], v[20:23], v[96:103], v24
    global_load_dwordx4 a[204:207], v63, s[36:37] offset:1024
    v_exp_f32 v124, v124
    v_exp_f32 v125, v125
    v_smfmac_f32_16x16x64_bf16 v[32:35], v[20:23], v[104:111], v24
    v_exp_f32 v126, v126
    v_exp_f32 v127, v127
    v_mfma_f32_32x32x16_bf16 v[96:111], a[208:211], a[160:163], v[128:143]
    s_add_u32 m0, s30, 69632
    v_exp_f32 v80, v80
    v_exp_f32 v81, v81
    v_exp_f32 v82, v82
    v_mfma_f32_32x32x16_bf16 v[96:111], a[212:215], a[164:167], v[96:111]
    s_xor_b32 s28, s1, 0x100000
    v_exp_f32 v83, v83
    v_exp_f32 v84, v84
    v_exp_f32 v85, v85
    v_smfmac_f32_32x32x32_bf16 a[0:15], a[232:235], v[112:119], v24
    s_add_u32 s46, s42, s28
    v_exp_f32 v86, v86
    v_exp_f32 v87, v87
    v_exp_f32 v88, v88
    v_smfmac_f32_32x32x32_bf16 a[0:15], a[236:239], v[120:127], v24
    s_addc_u32 s47, s43, 0
    v_exp_f32 v89, v89
    v_exp_f32 v90, v90
    v_exp_f32 v91, v91
    v_smfmac_f32_16x16x64_bf16 v[48:51], v[20:23], v[112:119], v24
    global_load_dwordx4 a[224:227], v1, s[36:37] offset:2048
    v_exp_f32 v92, v92
    v_exp_f32 v93, v93
    v_smfmac_f32_16x16x64_bf16 v[48:51], v[20:23], v[120:127], v24
    global_load_lds_dwordx4 v9, s[46:47]
    v_exp_f32 v94, v94
    v_exp_f32 v95, v95
    v_mfma_f32_32x32x16_bf16 v[112:127], a[208:211], a[168:171], v[144:159]
    s_add_u32 m0, s30, 73728
    v_exp_f32 v96, v96
    v_exp_f32 v97, v97
    v_exp_f32 v98, v98
    v_mfma_f32_32x32x16_bf16 v[112:127], a[212:215], a[172:175], v[112:127]
    s_add_u32 s46, s46, 0x10000
    v_exp_f32 v99, v99
    v_exp_f32 v100, v100
    v_exp_f32 v101, v101
    v_smfmac_f32_32x32x32_bf16 a[16:31], a[232:235], v[80:87], v24
    s_addc_u32 s47, s47, 0
    v_exp_f32 v102, v102
    v_exp_f32 v103, v103
    v_exp_f32 v104, v104
    v_smfmac_f32_32x32x32_bf16 a[16:31], a[236:239], v[88:95], v24
    s_waitcnt vmcnt(9)
    v_exp_f32 v105, v105
    v_exp_f32 v106, v106
    v_exp_f32 v107, v107
    v_smfmac_f32_16x16x64_bf16 v[52:55], v[20:23], v[80:87], v24
    global_load_dwordx4 a[228:231], v1, s[36:37] offset:3072
    v_exp_f32 v108, v108
    v_exp_f32 v109, v109
    v_smfmac_f32_16x16x64_bf16 v[52:55], v[20:23], v[88:95], v24
    global_load_lds_dwordx4 v9, s[46:47]
    v_exp_f32 v110, v110
    v_exp_f32 v111, v111
    v_mfma_f32_32x32x16_bf16 v[80:95], a[192:195], a[176:179], v[224:239]
    s_add_u32 s33, s6, 0x18000
    v_exp_f32 v112, v112
    v_exp_f32 v113, v113
    v_exp_f32 v114, v114
    v_mfma_f32_32x32x16_bf16 v[80:95], a[196:199], a[180:183], v[80:95]
    s_and_b32 s33, s33, 0x3ffff
    v_exp_f32 v115, v115
    v_exp_f32 v116, v116
    v_exp_f32 v117, v117
    v_smfmac_f32_32x32x32_bf16 v[160:175], a[232:235], v[96:103], v24
    s_add_u32 s38, s4, s33
    v_exp_f32 v118, v118
    v_exp_f32 v119, v119
    v_exp_f32 v120, v120
    v_smfmac_f32_32x32x32_bf16 v[160:175], a[236:239], v[104:111], v24
    s_addc_u32 s39, s5, 0
    v_exp_f32 v121, v121
    v_exp_f32 v122, v122
    v_exp_f32 v123, v123
    v_smfmac_f32_16x16x64_bf16 v[28:31], v[20:23], v[96:103], v24
    global_load_dwordx4 a[208:211], v63, s[38:39] offset:0
    v_exp_f32 v124, v124
    v_exp_f32 v125, v125
    v_smfmac_f32_16x16x64_bf16 v[28:31], v[20:23], v[104:111], v24
    v_exp_f32 v126, v126
    v_exp_f32 v127, v127
    v_mfma_f32_32x32x16_bf16 v[96:111], a[192:195], a[184:187], v[240:255]
    s_add_u32 m0, s30, 77824
    v_exp_f32 v80, v80
    v_exp_f32 v81, v81
    v_exp_f32 v82, v82
    v_mfma_f32_32x32x16_bf16 v[96:111], a[196:199], a[188:191], v[96:111]
    s_add_u32 s46, s46, 0x10000
    v_exp_f32 v83, v83
    v_exp_f32 v84, v84
    v_exp_f32 v85, v85
    v_smfmac_f32_32x32x32_bf16 v[176:191], a[232:235], v[112:119], v24
    s_addc_u32 s47, s47, 0
    v_exp_f32 v86, v86
    v_exp_f32 v87, v87
    v_exp_f32 v88, v88
    v_smfmac_f32_32x32x32_bf16 v[176:191], a[236:239], v[120:127], v24
    s_waitcnt vmcnt(8)
    v_exp_f32 v89, v89
    v_exp_f32 v90, v90
    v_exp_f32 v91, v91
    v_smfmac_f32_16x16x64_bf16 v[32:35], v[20:23], v[112:119], v24
    global_load_dwordx4 a[212:215], v63, s[38:39] offset:1024
    v_exp_f32 v92, v92
    v_exp_f32 v93, v93
    v_smfmac_f32_16x16x64_bf16 v[32:35], v[20:23], v[120:127], v24
    global_load_lds_dwordx4 v9, s[46:47]
    v_exp_f32 v94, v94
    v_exp_f32 v95, v95
    v_mfma_f32_32x32x16_bf16 v[112:127], a[192:195], a[160:163], v[128:143]
    v_exp_f32 v96, v96
    v_exp_f32 v97, v97
    v_exp_f32 v98, v98
    v_mfma_f32_32x32x16_bf16 v[112:127], a[196:199], a[164:167], v[112:127]
    s_add_u32 m0, s30, 81920
    v_exp_f32 v99, v99
    v_exp_f32 v100, v100
    v_exp_f32 v101, v101
    v_smfmac_f32_32x32x32_bf16 a[0:15], a[216:219], v[80:87], v24
    s_add_u32 s46, s46, 0x10000
    v_exp_f32 v102, v102
    v_exp_f32 v103, v103
    v_exp_f32 v104, v104
    v_smfmac_f32_32x32x32_bf16 a[0:15], a[220:223], v[88:95], v24
    s_addc_u32 s47, s47, 0
    v_exp_f32 v105, v105
    v_exp_f32 v106, v106
    v_exp_f32 v107, v107
    v_smfmac_f32_16x16x64_bf16 v[48:51], v[20:23], v[80:87], v24
    global_load_dwordx4 a[232:235], v1, s[38:39] offset:2048
    v_exp_f32 v108, v108
    v_exp_f32 v109, v109
    v_smfmac_f32_16x16x64_bf16 v[48:51], v[20:23], v[88:95], v24
    global_load_lds_dwordx4 v9, s[46:47]
    v_exp_f32 v110, v110
    v_exp_f32 v111, v111
    v_mfma_f32_32x32x16_bf16 v[80:95], a[192:195], a[168:171], v[144:159]
    v_exp_f32 v112, v112
    v_exp_f32 v113, v113
    v_exp_f32 v114, v114
    v_mfma_f32_32x32x16_bf16 v[80:95], a[196:199], a[172:175], v[80:95]
    v_exp_f32 v115, v115
    v_exp_f32 v116, v116
    v_exp_f32 v117, v117
    v_smfmac_f32_32x32x32_bf16 a[16:31], a[216:219], v[96:103], v24
    s_add_u32 m0, s30, 86016
    v_exp_f32 v118, v118
    v_exp_f32 v119, v119
    v_exp_f32 v120, v120
    v_smfmac_f32_32x32x32_bf16 a[16:31], a[220:223], v[104:111], v24
    s_waitcnt vmcnt(9)
    v_exp_f32 v121, v121
    v_exp_f32 v122, v122
    v_exp_f32 v123, v123
    v_smfmac_f32_16x16x64_bf16 v[52:55], v[20:23], v[96:103], v24
    global_load_dwordx4 a[236:239], v1, s[38:39] offset:3072
    v_exp_f32 v124, v124
    v_exp_f32 v125, v125
    v_smfmac_f32_16x16x64_bf16 v[52:55], v[20:23], v[104:111], v24
    v_exp_f32 v126, v126
    v_exp_f32 v127, v127
    v_mfma_f32_32x32x16_bf16 v[96:111], a[200:203], a[176:179], v[224:239]
    s_add_u32 s33, s6, 0x20000
    v_exp_f32 v80, v80
    v_exp_f32 v81, v81
    v_exp_f32 v82, v82
    v_mfma_f32_32x32x16_bf16 v[96:111], a[204:207], a[180:183], v[96:111]
    s_and_b32 s33, s33, 0x3ffff
    v_exp_f32 v83, v83
    v_exp_f32 v84, v84
    v_exp_f32 v85, v85
    v_smfmac_f32_32x32x32_bf16 v[160:175], a[216:219], v[112:119], v24
    s_add_u32 s36, s4, s33
    v_exp_f32 v86, v86
    v_exp_f32 v87, v87
    v_exp_f32 v88, v88
    v_smfmac_f32_32x32x32_bf16 v[160:175], a[220:223], v[120:127], v24
    s_addc_u32 s37, s5, 0
    v_exp_f32 v89, v89
    v_exp_f32 v90, v90
    v_exp_f32 v91, v91
    v_smfmac_f32_16x16x64_bf16 v[28:31], v[20:23], v[112:119], v24
    global_load_dwordx4 a[192:195], v63, s[36:37] offset:0
    v_exp_f32 v92, v92
    v_exp_f32 v93, v93
    v_smfmac_f32_16x16x64_bf16 v[28:31], v[20:23], v[120:127], v24
    v_exp_f32 v94, v94
    v_exp_f32 v95, v95
    v_mfma_f32_32x32x16_bf16 v[112:127], a[200:203], a[184:187], v[240:255]
    s_xor_b32 s28, s1, 0x140000
    v_exp_f32 v96, v96
    v_exp_f32 v97, v97
    v_exp_f32 v98, v98
    v_mfma_f32_32x32x16_bf16 v[112:127], a[204:207], a[188:191], v[112:127]
    s_add_u32 s46, s42, s28
    v_exp_f32 v99, v99
    v_exp_f32 v100, v100
    v_exp_f32 v101, v101
    v_smfmac_f32_32x32x32_bf16 v[176:191], a[216:219], v[80:87], v24
    s_addc_u32 s47, s43, 0
    v_exp_f32 v102, v102
    v_exp_f32 v103, v103
    v_exp_f32 v104, v104
    v_smfmac_f32_32x32x32_bf16 v[176:191], a[220:223], v[88:95], v24
    s_waitcnt vmcnt(8)
    v_exp_f32 v105, v105
    v_exp_f32 v106, v106
    v_exp_f32 v107, v107
    v_smfmac_f32_16x16x64_bf16 v[32:35], v[20:23], v[80:87], v24
    global_load_dwordx4 a[196:199], v63, s[36:37] offset:1024
    v_exp_f32 v108, v108
    v_exp_f32 v109, v109
    v_smfmac_f32_16x16x64_bf16 v[32:35], v[20:23], v[88:95], v24
    global_load_lds_dwordx4 v9, s[46:47]
    v_exp_f32 v110, v110
    v_exp_f32 v111, v111
    v_mfma_f32_32x32x16_bf16 v[80:95], a[200:203], a[160:163], v[128:143]
    v_exp_f32 v112, v112
    v_exp_f32 v113, v113
    v_exp_f32 v114, v114
    v_mfma_f32_32x32x16_bf16 v[80:95], a[204:207], a[164:167], v[80:95]
    s_add_u32 m0, s30, 90112
    v_exp_f32 v115, v115
    v_exp_f32 v116, v116
    v_exp_f32 v117, v117
    v_smfmac_f32_32x32x32_bf16 a[0:15], a[224:227], v[96:103], v24
    s_add_u32 s46, s46, 0x10000
    v_exp_f32 v118, v118
    v_exp_f32 v119, v119
    v_exp_f32 v120, v120
    v_smfmac_f32_32x32x32_bf16 a[0:15], a[228:231], v[104:111], v24
    s_addc_u32 s47, s47, 0
    v_exp_f32 v121, v121
    v_exp_f32 v122, v122
    v_exp_f32 v123, v123
    v_smfmac_f32_16x16x64_bf16 v[48:51], v[20:23], v[96:103], v24
    global_load_dwordx4 a[216:219], v1, s[36:37] offset:2048
    v_exp_f32 v124, v124
    v_exp_f32 v125, v125
    v_smfmac_f32_16x16x64_bf16 v[48:51], v[20:23], v[104:111], v24
    global_load_lds_dwordx4 v9, s[46:47]
    v_exp_f32 v126, v126
    v_exp_f32 v127, v127
    v_mfma_f32_32x32x16_bf16 v[96:111], a[200:203], a[168:171], v[144:159]
    s_add_u32 m0, s30, 94208
    v_exp_f32 v80, v80
    v_exp_f32 v81, v81
    v_exp_f32 v82, v82
    v_mfma_f32_32x32x16_bf16 v[96:111], a[204:207], a[172:175], v[96:111]
    s_add_u32 s46, s46, 0x10000
    v_exp_f32 v83, v83
    v_exp_f32 v84, v84
    v_exp_f32 v85, v85
    v_smfmac_f32_32x32x32_bf16 a[16:31], a[224:227], v[112:119], v24
    s_addc_u32 s47, s47, 0
    v_exp_f32 v86, v86
    v_exp_f32 v87, v87
    v_exp_f32 v88, v88
    v_smfmac_f32_32x32x32_bf16 a[16:31], a[228:231], v[120:127], v24
    s_waitcnt vmcnt(9)
    v_exp_f32 v89, v89
    v_exp_f32 v90, v90
    v_exp_f32 v91, v91
    v_smfmac_f32_16x16x64_bf16 v[52:55], v[20:23], v[112:119], v24
    global_load_dwordx4 a[220:223], v1, s[36:37] offset:3072
    v_exp_f32 v92, v92
    v_exp_f32 v93, v93
    v_smfmac_f32_16x16x64_bf16 v[52:55], v[20:23], v[120:127], v24
    global_load_lds_dwordx4 v9, s[46:47]
    v_exp_f32 v94, v94
    v_exp_f32 v95, v95
    v_mfma_f32_32x32x16_bf16 v[112:127], a[208:211], a[176:179], v[224:239]
    s_add_u32 s33, s6, 0x28000
    v_exp_f32 v96, v96
    v_exp_f32 v97, v97
    v_exp_f32 v98, v98
    v_mfma_f32_32x32x16_bf16 v[112:127], a[212:215], a[180:183], v[112:127]
    s_and_b32 s33, s33, 0x3ffff
    v_exp_f32 v99, v99
    v_exp_f32 v100, v100
    v_exp_f32 v101, v101
    v_smfmac_f32_32x32x32_bf16 v[160:175], a[224:227], v[80:87], v24
    s_add_u32 s38, s4, s33
    v_exp_f32 v102, v102
    v_exp_f32 v103, v103
    v_exp_f32 v104, v104
    v_smfmac_f32_32x32x32_bf16 v[160:175], a[228:231], v[88:95], v24
    s_addc_u32 s39, s5, 0
    v_exp_f32 v105, v105
    v_exp_f32 v106, v106
    v_exp_f32 v107, v107
    v_smfmac_f32_16x16x64_bf16 v[28:31], v[20:23], v[80:87], v24
    global_load_dwordx4 a[200:203], v63, s[38:39] offset:0
    v_exp_f32 v108, v108
    v_exp_f32 v109, v109
    v_smfmac_f32_16x16x64_bf16 v[28:31], v[20:23], v[88:95], v24
    v_exp_f32 v110, v110
    v_exp_f32 v111, v111
    v_mfma_f32_32x32x16_bf16 v[80:95], a[208:211], a[184:187], v[240:255]
    s_add_u32 m0, s30, 98304
    v_exp_f32 v112, v112
    v_exp_f32 v113, v113
    v_exp_f32 v114, v114
    v_mfma_f32_32x32x16_bf16 v[80:95], a[212:215], a[188:191], v[80:95]
    s_add_u32 s46, s46, 0x10000
    v_exp_f32 v115, v115
    v_exp_f32 v116, v116
    v_exp_f32 v117, v117
    v_smfmac_f32_32x32x32_bf16 v[176:191], a[224:227], v[96:103], v24
    s_addc_u32 s47, s47, 0
    v_exp_f32 v118, v118
    v_exp_f32 v119, v119
    v_exp_f32 v120, v120
    v_smfmac_f32_32x32x32_bf16 v[176:191], a[228:231], v[104:111], v24
    s_waitcnt vmcnt(8)
    v_exp_f32 v121, v121
    v_exp_f32 v122, v122
    v_exp_f32 v123, v123
    v_smfmac_f32_16x16x64_bf16 v[32:35], v[20:23], v[96:103], v24
    global_load_dwordx4 a[204:207], v63, s[38:39] offset:1024
    v_exp_f32 v124, v124
    v_exp_f32 v125, v125
    v_smfmac_f32_16x16x64_bf16 v[32:35], v[20:23], v[104:111], v24
    global_load_lds_dwordx4 v9, s[46:47]
    v_exp_f32 v126, v126
    v_exp_f32 v127, v127
    v_mfma_f32_32x32x16_bf16 v[96:111], a[208:211], a[160:163], v[128:143]
    s_add_u32 m0, s30, 102400
    v_exp_f32 v80, v80
    v_exp_f32 v81, v81
    v_exp_f32 v82, v82
    v_mfma_f32_32x32x16_bf16 v[96:111], a[212:215], a[164:167], v[96:111]
    s_xor_b32 s28, s1, 0x180000
    v_exp_f32 v83, v83
    v_exp_f32 v84, v84
    v_exp_f32 v85, v85
    v_smfmac_f32_32x32x32_bf16 a[0:15], a[232:235], v[112:119], v24
    s_add_u32 s46, s42, s28
    v_exp_f32 v86, v86
    v_exp_f32 v87, v87
    v_exp_f32 v88, v88
    v_smfmac_f32_32x32x32_bf16 a[0:15], a[236:239], v[120:127], v24
    s_addc_u32 s47, s43, 0
    v_exp_f32 v89, v89
    v_exp_f32 v90, v90
    v_exp_f32 v91, v91
    v_smfmac_f32_16x16x64_bf16 v[48:51], v[20:23], v[112:119], v24
    global_load_dwordx4 a[224:227], v1, s[38:39] offset:2048
    v_exp_f32 v92, v92
    v_exp_f32 v93, v93
    v_smfmac_f32_16x16x64_bf16 v[48:51], v[20:23], v[120:127], v24
    global_load_lds_dwordx4 v9, s[46:47]
    v_exp_f32 v94, v94
    v_exp_f32 v95, v95
    v_mfma_f32_32x32x16_bf16 v[112:127], a[208:211], a[168:171], v[144:159]
    s_add_u32 m0, s30, 106496
    v_exp_f32 v96, v96
    v_exp_f32 v97, v97
    v_exp_f32 v98, v98
    v_mfma_f32_32x32x16_bf16 v[112:127], a[212:215], a[172:175], v[112:127]
    s_add_u32 s46, s46, 0x10000
    v_exp_f32 v99, v99
    v_exp_f32 v100, v100
    v_exp_f32 v101, v101
    v_smfmac_f32_32x32x32_bf16 a[16:31], a[232:235], v[80:87], v24
    s_addc_u32 s47, s47, 0
    v_exp_f32 v102, v102
    v_exp_f32 v103, v103
    v_exp_f32 v104, v104
    v_smfmac_f32_32x32x32_bf16 a[16:31], a[236:239], v[88:95], v24
    s_waitcnt vmcnt(10)
    v_exp_f32 v105, v105
    v_exp_f32 v106, v106
    v_exp_f32 v107, v107
    v_smfmac_f32_16x16x64_bf16 v[52:55], v[20:23], v[80:87], v24
    global_load_dwordx4 a[228:231], v1, s[38:39] offset:3072
    v_exp_f32 v108, v108
    v_exp_f32 v109, v109
    v_smfmac_f32_16x16x64_bf16 v[52:55], v[20:23], v[88:95], v24
    global_load_lds_dwordx4 v9, s[46:47]
    v_exp_f32 v110, v110
    v_exp_f32 v111, v111
    v_mfma_f32_32x32x16_bf16 v[80:95], a[192:195], a[176:179], v[224:239]
    s_add_u32 s33, s6, 0x30000
    v_exp_f32 v112, v112
    v_exp_f32 v113, v113
    v_exp_f32 v114, v114
    v_mfma_f32_32x32x16_bf16 v[80:95], a[196:199], a[180:183], v[80:95]
    s_and_b32 s33, s33, 0x3ffff
    v_exp_f32 v115, v115
    v_exp_f32 v116, v116
    v_exp_f32 v117, v117
    v_smfmac_f32_32x32x32_bf16 v[160:175], a[232:235], v[96:103], v24
    s_add_u32 s36, s4, s33
    v_exp_f32 v118, v118
    v_exp_f32 v119, v119
    v_exp_f32 v120, v120
    v_smfmac_f32_32x32x32_bf16 v[160:175], a[236:239], v[104:111], v24
    s_addc_u32 s37, s5, 0
    v_exp_f32 v121, v121
    v_exp_f32 v122, v122
    v_exp_f32 v123, v123
    v_smfmac_f32_16x16x64_bf16 v[28:31], v[20:23], v[96:103], v24
    global_load_dwordx4 a[208:211], v63, s[36:37] offset:0
    v_exp_f32 v124, v124
    v_exp_f32 v125, v125
    v_smfmac_f32_16x16x64_bf16 v[28:31], v[20:23], v[104:111], v24
    v_exp_f32 v126, v126
    v_exp_f32 v127, v127
    v_mfma_f32_32x32x16_bf16 v[96:111], a[192:195], a[184:187], v[240:255]
    s_add_u32 m0, s30, 110592
    v_exp_f32 v80, v80
    v_exp_f32 v81, v81
    v_exp_f32 v82, v82
    v_mfma_f32_32x32x16_bf16 v[96:111], a[196:199], a[188:191], v[96:111]
    s_add_u32 s46, s46, 0x10000
    v_exp_f32 v83, v83
    v_exp_f32 v84, v84
    v_exp_f32 v85, v85
    v_smfmac_f32_32x32x32_bf16 v[176:191], a[232:235], v[112:119], v24
    s_addc_u32 s47, s47, 0
    v_exp_f32 v86, v86
    v_exp_f32 v87, v87
    v_exp_f32 v88, v88
    v_smfmac_f32_32x32x32_bf16 v[176:191], a[236:239], v[120:127], v24
    s_waitcnt vmcnt(9)
    v_exp_f32 v89, v89
    v_exp_f32 v90, v90
    v_exp_f32 v91, v91
    v_smfmac_f32_16x16x64_bf16 v[32:35], v[20:23], v[112:119], v24
    global_load_dwordx4 a[212:215], v63, s[36:37] offset:1024
    v_exp_f32 v92, v92
    v_exp_f32 v93, v93
    v_smfmac_f32_16x16x64_bf16 v[32:35], v[20:23], v[120:127], v24
    global_load_lds_dwordx4 v9, s[46:47]
    v_exp_f32 v94, v94
    v_exp_f32 v95, v95
    v_mfma_f32_32x32x16_bf16 v[112:127], a[192:195], a[160:163], v[128:143]
    v_exp_f32 v96, v96
    v_exp_f32 v97, v97
    v_exp_f32 v98, v98
    v_mfma_f32_32x32x16_bf16 v[112:127], a[196:199], a[164:167], v[112:127]
    v_exp_f32 v99, v99
    v_exp_f32 v100, v100
    v_exp_f32 v101, v101
    v_smfmac_f32_32x32x32_bf16 a[0:15], a[216:219], v[80:87], v24
    v_exp_f32 v102, v102
    v_exp_f32 v103, v103
    v_exp_f32 v104, v104
    v_smfmac_f32_32x32x32_bf16 a[0:15], a[220:223], v[88:95], v24
    v_exp_f32 v105, v105
    v_exp_f32 v106, v106
    v_exp_f32 v107, v107
    v_smfmac_f32_16x16x64_bf16 v[48:51], v[20:23], v[80:87], v24
    buffer_load_dword v5, v19, s[20:23], 0 offen offset:256 sc1
    v_exp_f32 v108, v108
    v_exp_f32 v109, v109
    v_smfmac_f32_16x16x64_bf16 v[48:51], v[20:23], v[88:95], v24
    global_load_dwordx4 a[232:235], v1, s[36:37] offset:2048
    v_exp_f32 v110, v110
    v_exp_f32 v111, v111
    v_mfma_f32_32x32x16_bf16 v[80:95], a[192:195], a[168:171], v[144:159]
    s_add_u32 m0, s30, 114688
    v_exp_f32 v112, v112
    v_exp_f32 v113, v113
    v_exp_f32 v114, v114
    v_mfma_f32_32x32x16_bf16 v[80:95], a[196:199], a[172:175], v[80:95]
    s_add_u32 s46, s46, 0x10000
    v_exp_f32 v115, v115
    v_exp_f32 v116, v116
    v_exp_f32 v117, v117
    v_smfmac_f32_32x32x32_bf16 a[16:31], a[216:219], v[96:103], v24
    s_addc_u32 s47, s47, 0
    v_exp_f32 v118, v118
    v_exp_f32 v119, v119
    v_exp_f32 v120, v120
    v_smfmac_f32_32x32x32_bf16 a[16:31], a[220:223], v[104:111], v24
    s_waitcnt vmcnt(10)
    v_exp_f32 v121, v121
    v_exp_f32 v122, v122
    v_exp_f32 v123, v123
    v_smfmac_f32_16x16x64_bf16 v[52:55], v[20:23], v[96:103], v24
    global_load_dwordx4 a[236:239], v1, s[36:37] offset:3072
    v_exp_f32 v124, v124
    v_exp_f32 v125, v125
    v_smfmac_f32_16x16x64_bf16 v[52:55], v[20:23], v[104:111], v24
    global_load_lds_dwordx4 v9, s[46:47]
    v_exp_f32 v126, v126
    v_exp_f32 v127, v127
    v_mfma_f32_32x32x16_bf16 v[96:111], a[200:203], a[176:179], v[224:239]
    s_add_u32 s33, s6, 0x38000
    v_exp_f32 v80, v80
    v_exp_f32 v81, v81
    v_exp_f32 v82, v82
    v_mfma_f32_32x32x16_bf16 v[96:111], a[204:207], a[180:183], v[96:111]
    s_and_b32 s33, s33, 0x3ffff
    v_exp_f32 v83, v83
    v_exp_f32 v84, v84
    v_exp_f32 v85, v85
    v_smfmac_f32_32x32x32_bf16 v[160:175], a[216:219], v[112:119], v24
    s_add_u32 s38, s4, s33
    v_exp_f32 v86, v86
    v_exp_f32 v87, v87
    v_exp_f32 v88, v88
    v_smfmac_f32_32x32x32_bf16 v[160:175], a[220:223], v[120:127], v24
    s_addc_u32 s39, s5, 0
    v_exp_f32 v89, v89
    v_exp_f32 v90, v90
    v_exp_f32 v91, v91
    v_smfmac_f32_16x16x64_bf16 v[28:31], v[20:23], v[112:119], v24
    global_load_dwordx4 a[192:195], v63, s[38:39] offset:0
    v_exp_f32 v92, v92
    v_exp_f32 v93, v93
    v_smfmac_f32_16x16x64_bf16 v[28:31], v[20:23], v[120:127], v24
    v_exp_f32 v94, v94
    v_exp_f32 v95, v95
    v_mfma_f32_32x32x16_bf16 v[112:127], a[200:203], a[184:187], v[240:255]
    v_exp_f32 v96, v96
    v_exp_f32 v97, v97
    v_exp_f32 v98, v98
    v_mfma_f32_32x32x16_bf16 v[112:127], a[204:207], a[188:191], v[112:127]
    v_exp_f32 v99, v99
    v_exp_f32 v100, v100
    v_exp_f32 v101, v101
    v_smfmac_f32_32x32x32_bf16 v[176:191], a[216:219], v[80:87], v24
    v_exp_f32 v102, v102
    v_exp_f32 v103, v103
    v_exp_f32 v104, v104
    v_smfmac_f32_32x32x32_bf16 v[176:191], a[220:223], v[88:95], v24
    s_waitcnt vmcnt(9)
    v_exp_f32 v105, v105
    v_exp_f32 v106, v106
    v_exp_f32 v107, v107
    v_smfmac_f32_16x16x64_bf16 v[32:35], v[20:23], v[80:87], v24
    global_load_dwordx4 a[196:199], v63, s[38:39] offset:1024
    v_exp_f32 v108, v108
    v_exp_f32 v109, v109
    v_smfmac_f32_16x16x64_bf16 v[32:35], v[20:23], v[88:95], v24
    v_exp_f32 v110, v110
    v_exp_f32 v111, v111
    v_mfma_f32_32x32x16_bf16 v[80:95], a[200:203], a[160:163], v[128:143]
    s_add_u32 m0, s30, 118784
    v_exp_f32 v112, v112
    v_exp_f32 v113, v113
    v_exp_f32 v114, v114
    v_mfma_f32_32x32x16_bf16 v[80:95], a[204:207], a[164:167], v[80:95]
    s_xor_b32 s28, s1, 0x1c0000
    v_exp_f32 v115, v115
    v_exp_f32 v116, v116
    v_exp_f32 v117, v117
    v_smfmac_f32_32x32x32_bf16 a[0:15], a[224:227], v[96:103], v24
    s_add_u32 s46, s42, s28
    v_exp_f32 v118, v118
    v_exp_f32 v119, v119
    v_exp_f32 v120, v120
    v_smfmac_f32_32x32x32_bf16 a[0:15], a[228:231], v[104:111], v24
    s_addc_u32 s47, s43, 0
    v_exp_f32 v121, v121
    v_exp_f32 v122, v122
    v_exp_f32 v123, v123
    v_smfmac_f32_16x16x64_bf16 v[48:51], v[20:23], v[96:103], v24
    global_load_dwordx4 a[216:219], v1, s[38:39] offset:2048
    v_exp_f32 v124, v124
    v_exp_f32 v125, v125
    v_smfmac_f32_16x16x64_bf16 v[48:51], v[20:23], v[104:111], v24
    global_load_lds_dwordx4 v9, s[46:47]
    v_exp_f32 v126, v126
    v_exp_f32 v127, v127
    v_mfma_f32_32x32x16_bf16 v[96:111], a[200:203], a[168:171], v[144:159]
    s_add_u32 m0, s30, 122880
    v_exp_f32 v80, v80
    v_exp_f32 v81, v81
    v_exp_f32 v82, v82
    v_mfma_f32_32x32x16_bf16 v[96:111], a[204:207], a[172:175], v[96:111]
    s_add_u32 s46, s46, 0x10000
    v_exp_f32 v83, v83
    v_exp_f32 v84, v84
    v_exp_f32 v85, v85
    v_smfmac_f32_32x32x32_bf16 a[16:31], a[224:227], v[112:119], v24
    s_addc_u32 s47, s47, 0
    v_exp_f32 v86, v86
    v_exp_f32 v87, v87
    v_exp_f32 v88, v88
    v_smfmac_f32_32x32x32_bf16 a[16:31], a[228:231], v[120:127], v24
    s_waitcnt vmcnt(9)
    v_exp_f32 v89, v89
    v_exp_f32 v90, v90
    v_exp_f32 v91, v91
    v_smfmac_f32_16x16x64_bf16 v[52:55], v[20:23], v[112:119], v24
    global_load_dwordx4 a[220:223], v1, s[38:39] offset:3072
    v_exp_f32 v92, v92
    v_exp_f32 v93, v93
    v_smfmac_f32_16x16x64_bf16 v[52:55], v[20:23], v[120:127], v24
    global_load_lds_dwordx4 v9, s[46:47]
    v_exp_f32 v94, v94
    v_exp_f32 v95, v95
    s_waitcnt vmcnt(9)
    v_cmp_gt_u32 vcc, 1, v5
    s_cbranch_vccnz apb2_spin
apb2_ok:
    v_mfma_f32_32x32x16_bf16 v[112:127], a[208:211], a[176:179], v[224:239]
    s_add_u32 s33, s6, 0x2000
    v_exp_f32 v96, v96
    v_exp_f32 v97, v97
    v_exp_f32 v98, v98
    v_mfma_f32_32x32x16_bf16 v[112:127], a[212:215], a[180:183], v[112:127]
    s_and_b32 s33, s33, 0x3ffff
    v_exp_f32 v99, v99
    v_exp_f32 v100, v100
    v_exp_f32 v101, v101
    v_smfmac_f32_32x32x32_bf16 v[160:175], a[224:227], v[80:87], v24
    s_add_u32 s36, s4, s33
    v_exp_f32 v102, v102
    v_exp_f32 v103, v103
    v_exp_f32 v104, v104
    v_smfmac_f32_32x32x32_bf16 v[160:175], a[228:231], v[88:95], v24
    s_addc_u32 s37, s5, 0
    v_exp_f32 v105, v105
    v_exp_f32 v106, v106
    v_exp_f32 v107, v107
    v_smfmac_f32_16x16x64_bf16 v[28:31], v[20:23], v[80:87], v24
    global_load_dwordx4 a[200:203], v63, s[36:37] offset:-4096
    v_exp_f32 v108, v108
    v_exp_f32 v109, v109
    v_smfmac_f32_16x16x64_bf16 v[28:31], v[20:23], v[88:95], v24
    v_exp_f32 v110, v110
    v_exp_f32 v111, v111
    v_mfma_f32_32x32x16_bf16 v[80:95], a[208:211], a[184:187], v[240:255]
    s_add_u32 m0, s30, 126976
    v_exp_f32 v112, v112
    v_exp_f32 v113, v113
    v_exp_f32 v114, v114
    v_mfma_f32_32x32x16_bf16 v[80:95], a[212:215], a[188:191], v[80:95]
    s_add_u32 s46, s46, 0x10000
    v_exp_f32 v115, v115
    v_exp_f32 v116, v116
    v_exp_f32 v117, v117
    v_smfmac_f32_32x32x32_bf16 v[176:191], a[224:227], v[96:103], v24
    s_addc_u32 s47, s47, 0
    v_exp_f32 v118, v118
    v_exp_f32 v119, v119
    v_exp_f32 v120, v120
    v_smfmac_f32_32x32x32_bf16 v[176:191], a[228:231], v[104:111], v24
hook14:
    s_cbranch_execz hook3
    s_waitcnt vmcnt(8)
    v_exp_f32 v121, v121
    v_exp_f32 v122, v122
    v_exp_f32 v123, v123
    v_smfmac_f32_16x16x64_bf16 v[32:35], v[20:23], v[96:103], v24
    global_load_dwordx4 a[204:207], v63, s[36:37] offset:-3072
    v_exp_f32 v124, v124
    v_exp_f32 v125, v125
    v_smfmac_f32_16x16x64_bf16 v[32:35], v[20:23], v[104:111], v24
    global_load_lds_dwordx4 v9, s[46:47]
    v_exp_f32 v126, v126
    v_exp_f32 v127, v127
    v_mfma_f32_32x32x16_bf16 v[96:111], a[208:211], a[160:163], v[128:143]
    v_exp_f32 v80, v80
    v_exp_f32 v81, v81
    v_exp_f32 v82, v82
    v_mfma_f32_32x32x16_bf16 v[96:111], a[212:215], a[164:167], v[96:111]
    v_exp_f32 v83, v83
    v_exp_f32 v84, v84
    v_exp_f32 v85, v85
    v_smfmac_f32_32x32x32_bf16 a[0:15], a[232:235], v[112:119], v24
    v_exp_f32 v86, v86
    v_exp_f32 v87, v87
    v_exp_f32 v88, v88
    v_smfmac_f32_32x32x32_bf16 a[0:15], a[236:239], v[120:127], v24
    v_exp_f32 v89, v89
    v_exp_f32 v90, v90
    v_exp_f32 v91, v91
    v_smfmac_f32_16x16x64_bf16 v[48:51], v[20:23], v[112:119], v24
    global_load_dwordx4 a[224:227], v1, s[36:37] offset:-2048
    v_exp_f32 v92, v92
    v_exp_f32 v93, v93
    v_smfmac_f32_16x16x64_bf16 v[48:51], v[20:23], v[120:127], v24
    v_exp_f32 v94, v94
    v_exp_f32 v95, v95
    v_mfma_f32_32x32x16_bf16 v[112:127], a[208:211], a[168:171], v[144:159]
    v_exp_f32 v96, v96
    v_exp_f32 v97, v97
    v_exp_f32 v98, v98
    v_mfma_f32_32x32x16_bf16 v[112:127], a[212:215], a[172:175], v[112:127]
    v_exp_f32 v99, v99
    v_exp_f32 v100, v100
    v_exp_f32 v101, v101
    v_smfmac_f32_32x32x32_bf16 a[16:31], a[232:235], v[80:87], v24
    v_exp_f32 v102, v102
    v_exp_f32 v103, v103
    v_exp_f32 v104, v104
    v_smfmac_f32_32x32x32_bf16 a[16:31], a[236:239], v[88:95], v24
    s_waitcnt vmcnt(8)
    v_exp_f32 v105, v105
    v_exp_f32 v106, v106
    v_exp_f32 v107, v107
    v_smfmac_f32_16x16x64_bf16 v[52:55], v[20:23], v[80:87], v24
    global_load_dwordx4 a[228:231], v1, s[36:37] offset:-1024
    v_exp_f32 v108, v108
    v_exp_f32 v109, v109
    v_smfmac_f32_16x16x64_bf16 v[52:55], v[20:23], v[88:95], v24
    v_exp_f32 v110, v110
    v_exp_f32 v111, v111
    v_mfma_f32_32x32x16_bf16 v[80:95], a[192:195], a[176:179], v[224:239]
    s_add_u32 s33, s6, 0x2000
    v_exp_f32 v112, v112
    v_exp_f32 v113, v113
    v_exp_f32 v114, v114
    v_mfma_f32_32x32x16_bf16 v[80:95], a[196:199], a[180:183], v[80:95]
    s_and_b32 s33, s33, 0x3ffff
    v_exp_f32 v115, v115
    v_exp_f32 v116, v116
    v_exp_f32 v117, v117
    v_smfmac_f32_32x32x32_bf16 v[160:175], a[232:235], v[96:103], v24
    s_add_u32 s38, s4, s33
    v_exp_f32 v118, v118
    v_exp_f32 v119, v119
    v_exp_f32 v120, v120
    v_smfmac_f32_32x32x32_bf16 v[160:175], a[236:239], v[104:111], v24
    s_addc_u32 s39, s5, 0
    v_exp_f32 v121, v121
    v_exp_f32 v122, v122
    v_exp_f32 v123, v123
    v_smfmac_f32_16x16x64_bf16 v[28:31], v[20:23], v[96:103], v24
    global_load_dwordx4 a[208:211], v63, s[38:39] offset:0
    v_exp_f32 v124, v124
    v_exp_f32 v125, v125
    v_smfmac_f32_16x16x64_bf16 v[28:31], v[20:23], v[104:111], v24
    v_exp_f32 v126, v126
    v_exp_f32 v127, v127
    v_mfma_f32_32x32x16_bf16 v[96:111], a[192:195], a[184:187], v[240:255]
    v_exp_f32 v80, v80
    v_exp_f32 v81, v81
    v_exp_f32 v82, v82
    v_mfma_f32_32x32x16_bf16 v[96:111], a[196:199], a[188:191], v[96:111]
    v_exp_f32 v83, v83
    v_exp_f32 v84, v84
    v_exp_f32 v85, v85
    v_smfmac_f32_32x32x32_bf16 v[176:191], a[232:235], v[112:119], v24
    v_exp_f32 v86, v86
    v_exp_f32 v87, v87
    v_exp_f32 v88, v88
    v_smfmac_f32_32x32x32_bf16 v[176:191], a[236:239], v[120:127], v24
    s_waitcnt vmcnt(7)
    v_exp_f32 v89, v89
    v_exp_f32 v90, v90
    v_exp_f32 v91, v91
    v_smfmac_f32_16x16x64_bf16 v[32:35], v[20:23], v[112:119], v24
    global_load_dwordx4 a[212:215], v63, s[38:39] offset:1024
    v_exp_f32 v92, v92
    v_exp_f32 v93, v93
    v_smfmac_f32_16x16x64_bf16 v[32:35], v[20:23], v[120:127], v24
    v_exp_f32 v94, v94
    v_exp_f32 v95, v95
    v_mfma_f32_32x32x16_bf16 v[112:127], a[192:195], a[160:163], v[128:143]
    v_exp_f32 v96, v96
    v_exp_f32 v97, v97
    v_exp_f32 v98, v98
    v_mfma_f32_32x32x16_bf16 v[112:127], a[196:199], a[164:167], v[112:127]
    v_exp_f32 v99, v99
    v_exp_f32 v100, v100
    v_exp_f32 v101, v101
    v_smfmac_f32_32x32x32_bf16 a[0:15], a[216:219], v[80:87], v24
    v_exp_f32 v102, v102
    v_exp_f32 v103, v103
    v_exp_f32 v104, v104
    v_smfmac_f32_32x32x32_bf16 a[0:15], a[220:223], v[88:95], v24
    v_exp_f32 v105, v105
    v_exp_f32 v106, v106
    v_exp_f32 v107, v107
    v_smfmac_f32_16x16x64_bf16 v[48:51], v[20:23], v[80:87], v24
    global_load_dwordx4 a[232:235], v1, s[38:39] offset:2048
    v_exp_f32 v108, v108
    v_exp_f32 v109, v109
    v_smfmac_f32_16x16x64_bf16 v[48:51], v[20:23], v[88:95], v24
    v_exp_f32 v110, v110
    v_exp_f32 v111, v111
    v_mfma_f32_32x32x16_bf16 v[80:95], a[192:195], a[168:171], v[144:159]
    v_exp_f32 v112, v112
    v_exp_f32 v113, v113
    v_exp_f32 v114, v114
    v_mfma_f32_32x32x16_bf16 v[80:95], a[196:199], a[172:175], v[80:95]
    v_exp_f32 v115, v115
    v_exp_f32 v116, v116
    v_exp_f32 v117, v117
    v_smfmac_f32_32x32x32_bf16 a[16:31], a[216:219], v[96:103], v24
    v_exp_f32 v118, v118
    v_exp_f32 v119, v119
    v_exp_f32 v120, v120
    v_smfmac_f32_32x32x32_bf16 a[16:31], a[220:223], v[104:111], v24
    s_waitcnt vmcnt(6)
    v_exp_f32 v121, v121
    v_exp_f32 v122, v122
    v_exp_f32 v123, v123
    v_smfmac_f32_16x16x64_bf16 v[52:55], v[20:23], v[96:103], v24
    global_load_dwordx4 a[236:239], v1, s[38:39] offset:3072
    v_exp_f32 v124, v124
    v_exp_f32 v125, v125
    v_smfmac_f32_16x16x64_bf16 v[52:55], v[20:23], v[104:111], v24
    v_exp_f32 v126, v126
    v_exp_f32 v127, v127
    v_mfma_f32_32x32x16_bf16 v[96:111], a[200:203], a[176:179], v[224:239]
    s_add_u32 s33, s6, 0xa000
    v_exp_f32 v80, v80
    v_exp_f32 v81, v81
    v_exp_f32 v82, v82
    v_mfma_f32_32x32x16_bf16 v[96:111], a[204:207], a[180:183], v[96:111]
    s_and_b32 s33, s33, 0x3ffff
    v_exp_f32 v83, v83
    v_exp_f32 v84, v84
    v_exp_f32 v85, v85
    v_smfmac_f32_32x32x32_bf16 v[160:175], a[216:219], v[112:119], v24
    s_add_u32 s36, s4, s33
    v_exp_f32 v86, v86
    v_exp_f32 v87, v87
    v_exp_f32 v88, v88
    v_smfmac_f32_32x32x32_bf16 v[160:175], a[220:223], v[120:127], v24
    s_addc_u32 s37, s5, 0
    v_exp_f32 v89, v89
    v_exp_f32 v90, v90
    v_exp_f32 v91, v91
    v_smfmac_f32_16x16x64_bf16 v[28:31], v[20:23], v[112:119], v24
    global_load_dwordx4 a[192:195], v63, s[36:37] offset:-4096
    v_exp_f32 v92, v92
    v_exp_f32 v93, v93
    v_smfmac_f32_16x16x64_bf16 v[28:31], v[20:23], v[120:127], v24
    v_exp_f32 v94, v94
    v_exp_f32 v95, v95
    v_mfma_f32_32x32x16_bf16 v[112:127], a[200:203], a[184:187], v[240:255]
    v_exp_f32 v96, v96
    v_exp_f32 v97, v97
    v_exp_f32 v98, v98
    v_mfma_f32_32x32x16_bf16 v[112:127], a[204:207], a[188:191], v[112:127]
    v_exp_f32 v99, v99
    v_exp_f32 v100, v100
    v_exp_f32 v101, v101
    v_smfmac_f32_32x32x32_bf16 v[176:191], a[216:219], v[80:87], v24
    v_exp_f32 v102, v102
    v_exp_f32 v103, v103
    v_exp_f32 v104, v104
    v_smfmac_f32_32x32x32_bf16 v[176:191], a[220:223], v[88:95], v24
    s_waitcnt vmcnt(5)
    v_exp_f32 v105, v105
    v_exp_f32 v106, v106
    v_exp_f32 v107, v107
    v_smfmac_f32_16x16x64_bf16 v[32:35], v[20:23], v[80:87], v24
    global_load_dwordx4 a[196:199], v63, s[36:37] offset:-3072
    v_exp_f32 v108, v108
    v_exp_f32 v109, v109
    v_smfmac_f32_16x16x64_bf16 v[32:35], v[20:23], v[88:95], v24
    v_exp_f32 v110, v110
    v_exp_f32 v111, v111
    v_mfma_f32_32x32x16_bf16 v[80:95], a[200:203], a[160:163], v[128:143]
    v_exp_f32 v112, v112
    v_exp_f32 v113, v113
    v_exp_f32 v114, v114
    v_mfma_f32_32x32x16_bf16 v[80:95], a[204:207], a[164:167], v[80:95]
    v_exp_f32 v115, v115
    v_exp_f32 v116, v116
    v_exp_f32 v117, v117
    v_smfmac_f32_32x32x32_bf16 a[0:15], a[224:227], v[96:103], v24
    v_exp_f32 v118, v118
    v_exp_f32 v119, v119
    v_exp_f32 v120, v120
    v_smfmac_f32_32x32x32_bf16 a[0:15], a[228:231], v[104:111], v24
    v_exp_f32 v121, v121
    v_exp_f32 v122, v122
    v_exp_f32 v123, v123
    v_smfmac_f32_16x16x64_bf16 v[48:51], v[20:23], v[96:103], v24
    global_load_dwordx4 a[216:219], v1, s[36:37] offset:-2048
    v_exp_f32 v124, v124
    v_exp_f32 v125, v125
    v_smfmac_f32_16x16x64_bf16 v[48:51], v[20:23], v[104:111], v24
    v_exp_f32 v126, v126
    v_exp_f32 v127, v127
    v_mfma_f32_32x32x16_bf16 v[96:111], a[200:203], a[168:171], v[144:159]
    v_exp_f32 v80, v80
    v_exp_f32 v81, v81
    v_exp_f32 v82, v82
    v_mfma_f32_32x32x16_bf16 v[96:111], a[204:207], a[172:175], v[96:111]
    v_exp_f32 v83, v83
    v_exp_f32 v84, v84
    v_exp_f32 v85, v85
    v_smfmac_f32_32x32x32_bf16 a[16:31], a[224:227], v[112:119], v24
    v_exp_f32 v86, v86
    v_exp_f32 v87, v87
    v_exp_f32 v88, v88
    v_smfmac_f32_32x32x32_bf16 a[16:31], a[228:231], v[120:127], v24
    s_waitcnt vmcnt(5)
    v_exp_f32 v89, v89
    v_exp_f32 v90, v90
    v_exp_f32 v91, v91
    v_smfmac_f32_16x16x64_bf16 v[52:55], v[20:23], v[112:119], v24
    global_load_dwordx4 a[220:223], v1, s[36:37] offset:-1024
    v_exp_f32 v92, v92
    v_exp_f32 v93, v93
    v_smfmac_f32_16x16x64_bf16 v[52:55], v[20:23], v[120:127], v24
    v_exp_f32 v94, v94
    v_exp_f32 v95, v95
    v_mfma_f32_32x32x16_bf16 v[112:127], a[208:211], a[176:179], v[224:239]
    s_add_u32 s33, s6, 0x12000
    v_exp_f32 v96, v96
    v_exp_f32 v97, v97
    v_exp_f32 v98, v98
    v_mfma_f32_32x32x16_bf16 v[112:127], a[212:215], a[180:183], v[112:127]
    s_and_b32 s33, s33, 0x3ffff
    v_exp_f32 v99, v99
    v_exp_f32 v100, v100
    v_exp_f32 v101, v101
    v_smfmac_f32_32x32x32_bf16 v[160:175], a[224:227], v[80:87], v24
    s_add_u32 s38, s4, s33
    v_exp_f32 v102, v102
    v_exp_f32 v103, v103
    v_exp_f32 v104, v104
    v_smfmac_f32_32x32x32_bf16 v[160:175], a[228:231], v[88:95], v24
    s_addc_u32 s39, s5, 0
    v_exp_f32 v105, v105
    v_exp_f32 v106, v106
    v_exp_f32 v107, v107
    v_smfmac_f32_16x16x64_bf16 v[28:31], v[20:23], v[80:87], v24
    global_load_dwordx4 a[200:203], v63, s[38:39] offset:-4096
    v_exp_f32 v108, v108
    v_exp_f32 v109, v109
    v_smfmac_f32_16x16x64_bf16 v[28:31], v[20:23], v[88:95], v24
    v_exp_f32 v110, v110
    v_exp_f32 v111, v111
    v_mfma_f32_32x32x16_bf16 v[80:95], a[208:211], a[184:187], v[240:255]
    v_exp_f32 v112, v112
    v_exp_f32 v113, v113
    v_exp_f32 v114, v114
    v_mfma_f32_32x32x16_bf16 v[80:95], a[212:215], a[188:191], v[80:95]
    v_exp_f32 v115, v115
    v_exp_f32 v116, v116
    v_exp_f32 v117, v117
    v_smfmac_f32_32x32x32_bf16 v[176:191], a[224:227], v[96:103], v24
    v_exp_f32 v118, v118
    v_exp_f32 v119, v119
    v_exp_f32 v120, v120
    v_smfmac_f32_32x32x32_bf16 v[176:191], a[228:231], v[104:111], v24
    s_waitcnt vmcnt(5)
    v_exp_f32 v121, v121
    v_exp_f32 v122, v122
    v_exp_f32 v123, v123
    v_smfmac_f32_16x16x64_bf16 v[32:35], v[20:23], v[96:103], v24
    global_load_dwordx4 a[204:207], v63, s[38:39] offset:-3072
    v_exp_f32 v124, v124
    v_exp_f32 v125, v125
    v_smfmac_f32_16x16x64_bf16 v[32:35], v[20:23], v[104:111], v24
    v_exp_f32 v126, v126
    v_exp_f32 v127, v127
    v_mfma_f32_32x32x16_bf16 v[96:111], a[208:211], a[160:163], v[128:143]
    v_exp_f32 v80, v80
    v_exp_f32 v81, v81
    v_exp_f32 v82, v82
    v_mfma_f32_32x32x16_bf16 v[96:111], a[212:215], a[164:167], v[96:111]
    v_exp_f32 v83, v83
    v_exp_f32 v84, v84
    v_exp_f32 v85, v85
    v_smfmac_f32_32x32x32_bf16 a[0:15], a[232:235], v[112:119], v24
    v_exp_f32 v86, v86
    v_exp_f32 v87, v87
    v_exp_f32 v88, v88
    v_smfmac_f32_32x32x32_bf16 a[0:15], a[236:239], v[120:127], v24
    v_exp_f32 v89, v89
    v_exp_f32 v90, v90
    v_exp_f32 v91, v91
    v_smfmac_f32_16x16x64_bf16 v[48:51], v[20:23], v[112:119], v24
    global_load_dwordx4 a[224:227], v1, s[38:39] offset:-2048
    v_exp_f32 v92, v92
    v_exp_f32 v93, v93
    v_smfmac_f32_16x16x64_bf16 v[48:51], v[20:23], v[120:127], v24
    v_exp_f32 v94, v94
    v_exp_f32 v95, v95
    v_mfma_f32_32x32x16_bf16 v[112:127], a[208:211], a[168:171], v[144:159]
    v_exp_f32 v96, v96
    v_exp_f32 v97, v97
    v_exp_f32 v98, v98
    v_mfma_f32_32x32x16_bf16 v[112:127], a[212:215], a[172:175], v[112:127]
    v_exp_f32 v99, v99
    v_exp_f32 v100, v100
    v_exp_f32 v101, v101
    v_smfmac_f32_32x32x32_bf16 a[16:31], a[232:235], v[80:87], v24
    v_exp_f32 v102, v102
    v_exp_f32 v103, v103
    v_exp_f32 v104, v104
    v_smfmac_f32_32x32x32_bf16 a[16:31], a[236:239], v[88:95], v24
    s_waitcnt vmcnt(5)
    v_exp_f32 v105, v105
    v_exp_f32 v106, v106
    v_exp_f32 v107, v107
    v_smfmac_f32_16x16x64_bf16 v[52:55], v[20:23], v[80:87], v24
    global_load_dwordx4 a[228:231], v1, s[38:39] offset:-1024
    v_exp_f32 v108, v108
    v_exp_f32 v109, v109
    v_smfmac_f32_16x16x64_bf16 v[52:55], v[20:23], v[88:95], v24
    v_exp_f32 v110, v110
    v_exp_f32 v111, v111
    v_mfma_f32_32x32x16_bf16 v[80:95], a[192:195], a[176:179], v[224:239]
    s_add_u32 s33, s6, 0x1a000
    v_exp_f32 v112, v112
    v_exp_f32 v113, v113
    v_exp_f32 v114, v114
    v_mfma_f32_32x32x16_bf16 v[80:95], a[196:199], a[180:183], v[80:95]
    s_and_b32 s33, s33, 0x3ffff
    v_exp_f32 v115, v115
    v_exp_f32 v116, v116
    v_exp_f32 v117, v117
    v_smfmac_f32_32x32x32_bf16 v[160:175], a[232:235], v[96:103], v24
    s_add_u32 s36, s4, s33
    v_exp_f32 v118, v118
    v_exp_f32 v119, v119
    v_exp_f32 v120, v120
    v_smfmac_f32_32x32x32_bf16 v[160:175], a[236:239], v[104:111], v24
    s_addc_u32 s37, s5, 0
    v_exp_f32 v121, v121
    v_exp_f32 v122, v122
    v_exp_f32 v123, v123
    v_smfmac_f32_16x16x64_bf16 v[28:31], v[20:23], v[96:103], v24
    global_load_dwordx4 a[208:211], v63, s[36:37] offset:-4096
    v_exp_f32 v124, v124
    v_exp_f32 v125, v125
    v_smfmac_f32_16x16x64_bf16 v[28:31], v[20:23], v[104:111], v24
    v_exp_f32 v126, v126
    v_exp_f32 v127, v127
    v_mfma_f32_32x32x16_bf16 v[96:111], a[192:195], a[184:187], v[240:255]
    v_exp_f32 v80, v80
    v_exp_f32 v81, v81
    v_exp_f32 v82, v82
    v_mfma_f32_32x32x16_bf16 v[96:111], a[196:199], a[188:191], v[96:111]
    v_exp_f32 v83, v83
    v_exp_f32 v84, v84
    v_exp_f32 v85, v85
    v_smfmac_f32_32x32x32_bf16 v[176:191], a[232:235], v[112:119], v24
    v_exp_f32 v86, v86
    v_exp_f32 v87, v87
    v_exp_f32 v88, v88
    v_smfmac_f32_32x32x32_bf16 v[176:191], a[236:239], v[120:127], v24
    s_waitcnt vmcnt(5)
    v_exp_f32 v89, v89
    v_exp_f32 v90, v90
    v_exp_f32 v91, v91
    v_smfmac_f32_16x16x64_bf16 v[32:35], v[20:23], v[112:119], v24
    global_load_dwordx4 a[212:215], v63, s[36:37] offset:-3072
    v_exp_f32 v92, v92
    v_exp_f32 v93, v93
    v_smfmac_f32_16x16x64_bf16 v[32:35], v[20:23], v[120:127], v24
    v_exp_f32 v94, v94
    v_exp_f32 v95, v95
    v_mfma_f32_32x32x16_bf16 v[112:127], a[192:195], a[160:163], v[128:143]
    v_exp_f32 v96, v96
    v_exp_f32 v97, v97
    v_exp_f32 v98, v98
    v_mfma_f32_32x32x16_bf16 v[112:127], a[196:199], a[164:167], v[112:127]
    v_exp_f32 v99, v99
    v_exp_f32 v100, v100
    v_exp_f32 v101, v101
    v_smfmac_f32_32x32x32_bf16 a[0:15], a[216:219], v[80:87], v24
    v_exp_f32 v102, v102
    v_exp_f32 v103, v103
    v_exp_f32 v104, v104
    v_smfmac_f32_32x32x32_bf16 a[0:15], a[220:223], v[88:95], v24
    v_exp_f32 v105, v105
    v_exp_f32 v106, v106
    v_exp_f32 v107, v107
    v_smfmac_f32_16x16x64_bf16 v[48:51], v[20:23], v[80:87], v24
    global_load_dwordx4 a[232:235], v1, s[36:37] offset:-2048
    v_exp_f32 v108, v108
    v_exp_f32 v109, v109
    v_smfmac_f32_16x16x64_bf16 v[48:51], v[20:23], v[88:95], v24
    v_exp_f32 v110, v110
    v_exp_f32 v111, v111
    v_mfma_f32_32x32x16_bf16 v[80:95], a[192:195], a[168:171], v[144:159]
    v_exp_f32 v112, v112
    v_exp_f32 v113, v113
    v_exp_f32 v114, v114
    v_mfma_f32_32x32x16_bf16 v[80:95], a[196:199], a[172:175], v[80:95]
    v_exp_f32 v115, v115
    v_exp_f32 v116, v116
    v_exp_f32 v117, v117
    v_smfmac_f32_32x32x32_bf16 a[16:31], a[216:219], v[96:103], v24
    v_exp_f32 v118, v118
    v_exp_f32 v119, v119
    v_exp_f32 v120, v120
    v_smfmac_f32_32x32x32_bf16 a[16:31], a[220:223], v[104:111], v24
    s_waitcnt vmcnt(5)
    v_exp_f32 v121, v121
    v_exp_f32 v122, v122
    v_exp_f32 v123, v123
    v_smfmac_f32_16x16x64_bf16 v[52:55], v[20:23], v[96:103], v24
    global_load_dwordx4 a[236:239], v1, s[36:37] offset:-1024
    v_exp_f32 v124, v124
    v_exp_f32 v125, v125
    v_smfmac_f32_16x16x64_bf16 v[52:55], v[20:23], v[104:111], v24
    v_exp_f32 v126, v126
    v_exp_f32 v127, v127
    v_mfma_f32_32x32x16_bf16 v[96:111], a[200:203], a[176:179], v[224:239]
    s_add_u32 s33, s6, 0x22000
    v_exp_f32 v80, v80
    v_exp_f32 v81, v81
    v_exp_f32 v82, v82
    v_mfma_f32_32x32x16_bf16 v[96:111], a[204:207], a[180:183], v[96:111]
    s_and_b32 s33, s33, 0x3ffff
    v_exp_f32 v83, v83
    v_exp_f32 v84, v84
    v_exp_f32 v85, v85
    v_smfmac_f32_32x32x32_bf16 v[160:175], a[216:219], v[112:119], v24
    s_add_u32 s38, s4, s33
    v_exp_f32 v86, v86
    v_exp_f32 v87, v87
    v_exp_f32 v88, v88
    v_smfmac_f32_32x32x32_bf16 v[160:175], a[220:223], v[120:127], v24
    s_addc_u32 s39, s5, 0
    v_exp_f32 v89, v89
    v_exp_f32 v90, v90
    v_exp_f32 v91, v91
    v_smfmac_f32_16x16x64_bf16 v[28:31], v[20:23], v[112:119], v24
    global_load_dwordx4 a[192:195], v63, s[38:39] offset:-4096
    v_exp_f32 v92, v92
    v_exp_f32 v93, v93
    v_smfmac_f32_16x16x64_bf16 v[28:31], v[20:23], v[120:127], v24
    v_exp_f32 v94, v94
    v_exp_f32 v95, v95
    v_mfma_f32_32x32x16_bf16 v[112:127], a[200:203], a[184:187], v[240:255]
    v_exp_f32 v96, v96
    v_exp_f32 v97, v97
    v_exp_f32 v98, v98
    v_mfma_f32_32x32x16_bf16 v[112:127], a[204:207], a[188:191], v[112:127]
    v_exp_f32 v99, v99
    v_exp_f32 v100, v100
    v_exp_f32 v101, v101
    v_smfmac_f32_32x32x32_bf16 v[176:191], a[216:219], v[80:87], v24
    v_exp_f32 v102, v102
    v_exp_f32 v103, v103
    v_exp_f32 v104, v104
    v_smfmac_f32_32x32x32_bf16 v[176:191], a[220:223], v[88:95], v24
    s_waitcnt vmcnt(5)
    v_exp_f32 v105, v105
    v_exp_f32 v106, v106
    v_exp_f32 v107, v107
    v_smfmac_f32_16x16x64_bf16 v[32:35], v[20:23], v[80:87], v24
    global_load_dwordx4 a[196:199], v63, s[38:39] offset:-3072
    v_exp_f32 v108, v108
    v_exp_f32 v109, v109
    v_smfmac_f32_16x16x64_bf16 v[32:35], v[20:23], v[88:95], v24
    v_exp_f32 v110, v110
    v_exp_f32 v111, v111
    v_mfma_f32_32x32x16_bf16 v[80:95], a[200:203], a[160:163], v[128:143]
    v_exp_f32 v112, v112
    v_exp_f32 v113, v113
    v_exp_f32 v114, v114
    v_mfma_f32_32x32x16_bf16 v[80:95], a[204:207], a[164:167], v[80:95]
    v_exp_f32 v115, v115
    v_exp_f32 v116, v116
    v_exp_f32 v117, v117
    v_smfmac_f32_32x32x32_bf16 a[0:15], a[224:227], v[96:103], v24
    v_exp_f32 v118, v118
    v_exp_f32 v119, v119
    v_exp_f32 v120, v120
    v_smfmac_f32_32x32x32_bf16 a[0:15], a[228:231], v[104:111], v24
    v_exp_f32 v121, v121
    v_exp_f32 v122, v122
    v_exp_f32 v123, v123
    v_smfmac_f32_16x16x64_bf16 v[48:51], v[20:23], v[96:103], v24
    global_load_dwordx4 a[216:219], v1, s[38:39] offset:-2048
    v_exp_f32 v124, v124
    v_exp_f32 v125, v125
    v_smfmac_f32_16x16x64_bf16 v[48:51], v[20:23], v[104:111], v24
    v_exp_f32 v126, v126
    v_exp_f32 v127, v127
    v_mfma_f32_32x32x16_bf16 v[96:111], a[200:203], a[168:171], v[144:159]
    v_exp_f32 v80, v80
    v_exp_f32 v81, v81
    v_exp_f32 v82, v82
    v_mfma_f32_32x32x16_bf16 v[96:111], a[204:207], a[172:175], v[96:111]
    v_exp_f32 v83, v83
    v_exp_f32 v84, v84
    v_exp_f32 v85, v85
    v_smfmac_f32_32x32x32_bf16 a[16:31], a[224:227], v[112:119], v24
    v_exp_f32 v86, v86
    v_exp_f32 v87, v87
    v_exp_f32 v88, v88
    v_smfmac_f32_32x32x32_bf16 a[16:31], a[228:231], v[120:127], v24
    s_waitcnt vmcnt(5)
    v_exp_f32 v89, v89
    v_exp_f32 v90, v90
    v_exp_f32 v91, v91
    v_smfmac_f32_16x16x64_bf16 v[52:55], v[20:23], v[112:119], v24
    global_load_dwordx4 a[220:223], v1, s[38:39] offset:-1024
    v_exp_f32 v92, v92
    v_exp_f32 v93, v93
    v_smfmac_f32_16x16x64_bf16 v[52:55], v[20:23], v[120:127], v24
    v_exp_f32 v94, v94
    v_exp_f32 v95, v95
    v_mfma_f32_32x32x16_bf16 v[112:127], a[208:211], a[176:179], v[224:239]
    s_add_u32 s33, s6, 0x2a000
    v_exp_f32 v96, v96
    v_exp_f32 v97, v97
    v_exp_f32 v98, v98
    v_mfma_f32_32x32x16_bf16 v[112:127], a[212:215], a[180:183], v[112:127]
    s_and_b32 s33, s33, 0x3ffff
    v_exp_f32 v99, v99
    v_exp_f32 v100, v100
    v_exp_f32 v101, v101
    v_smfmac_f32_32x32x32_bf16 v[160:175], a[224:227], v[80:87], v24
    s_add_u32 s36, s4, s33
    v_exp_f32 v102, v102
    v_exp_f32 v103, v103
    v_exp_f32 v104, v104
    v_smfmac_f32_32x32x32_bf16 v[160:175], a[228:231], v[88:95], v24
    s_addc_u32 s37, s5, 0
    v_exp_f32 v105, v105
    v_exp_f32 v106, v106
    v_exp_f32 v107, v107
    v_smfmac_f32_16x16x64_bf16 v[28:31], v[20:23], v[80:87], v24
    global_load_dwordx4 a[200:203], v63, s[36:37] offset:-4096
    v_exp_f32 v108, v108
    v_exp_f32 v109, v109
    v_smfmac_f32_16x16x64_bf16 v[28:31], v[20:23], v[88:95], v24
    v_exp_f32 v110, v110
    v_exp_f32 v111, v111
att_join:
hook15:
    s_cbranch_execz hook19
    v_mfma_f32_32x32x16_bf16 v[80:95], a[208:211], a[184:187], v[240:255]
    v_exp_f32 v112, v112
    v_exp_f32 v113, v113
    v_exp_f32 v114, v114
    v_mfma_f32_32x32x16_bf16 v[80:95], a[212:215], a[188:191], v[80:95]
    v_exp_f32 v115, v115
    v_exp_f32 v116, v116
    v_exp_f32 v117, v117
    v_smfmac_f32_32x32x32_bf16 v[176:191], a[224:227], v[96:103], v24
    v_exp_f32 v118, v118
    v_exp_f32 v119, v119
    v_exp_f32 v120, v120
    v_smfmac_f32_32x32x32_bf16 v[176:191], a[228:231], v[104:111], v24
    s_waitcnt vmcnt(5)
    v_exp_f32 v121, v121
    v_exp_f32 v122, v122
    v_exp_f32 v123, v123
    v_smfmac_f32_16x16x64_bf16 v[32:35], v[20:23], v[96:103], v24
    global_load_dwordx4 a[204:207], v63, s[36:37] offset:-3072
    v_exp_f32 v124, v124
    v_exp_f32 v125, v125
    v_smfmac_f32_16x16x64_bf16 v[32:35], v[20:23], v[104:111], v24
    v_exp_f32 v126, v126
    v_exp_f32 v127, v127
    v_mfma_f32_32x32x16_bf16 v[96:111], a[208:211], a[160:163], v[128:143]
    v_exp_f32 v80, v80
    v_exp_f32 v81, v81
    v_exp_f32 v82, v82
    v_mfma_f32_32x32x16_bf16 v[96:111], a[212:215], a[164:167], v[96:111]
    v_exp_f32 v83, v83
    v_exp_f32 v84, v84
    v_exp_f32 v85, v85
    v_smfmac_f32_32x32x32_bf16 a[0:15], a[232:235], v[112:119], v24
    v_exp_f32 v86, v86
    v_exp_f32 v87, v87
    v_exp_f32 v88, v88
    v_smfmac_f32_32x32x32_bf16 a[0:15], a[236:239], v[120:127], v24
    v_exp_f32 v89, v89
    v_exp_f32 v90, v90
    v_exp_f32 v91, v91
    v_smfmac_f32_16x16x64_bf16 v[48:51], v[20:23], v[112:119], v24
    global_load_dwordx4 a[224:227], v1, s[36:37] offset:-2048
    v_exp_f32 v92, v92
    v_exp_f32 v93, v93
    v_smfmac_f32_16x16x64_bf16 v[48:51], v[20:23], v[120:127], v24
    v_exp_f32 v94, v94
    v_exp_f32 v95, v95
    v_mfma_f32_32x32x16_bf16 v[112:127], a[208:211], a[168:171], v[144:159]
    v_exp_f32 v96, v96
    v_exp_f32 v97, v97
    v_exp_f32 v98, v98
    v_mfma_f32_32x32x16_bf16 v[112:127], a[212:215], a[172:175], v[112:127]
    v_exp_f32 v99, v99
    v_exp_f32 v100, v100
    v_exp_f32 v101, v101
    v_smfmac_f32_32x32x32_bf16 a[16:31], a[232:235], v[80:87], v24
    v_exp_f32 v102, v102
    v_exp_f32 v103, v103
    v_exp_f32 v104, v104
    v_smfmac_f32_32x32x32_bf16 a[16:31], a[236:239], v[88:95], v24
    s_waitcnt vmcnt(5)
    v_exp_f32 v105, v105
    v_exp_f32 v106, v106
    v_exp_f32 v107, v107
    v_smfmac_f32_16x16x64_bf16 v[52:55], v[20:23], v[80:87], v24
    global_load_dwordx4 a[228:231], v1, s[36:37] offset:-1024
    v_exp_f32 v108, v108
    v_exp_f32 v109, v109
    v_smfmac_f32_16x16x64_bf16 v[52:55], v[20:23], v[88:95], v24
    v_exp_f32 v110, v110
    v_exp_f32 v111, v111
    v_mfma_f32_32x32x16_bf16 v[80:95], a[192:195], a[176:179], v[224:239]
    s_add_u32 s33, s6, 0x32000
    v_exp_f32 v112, v112
    v_exp_f32 v113, v113
    v_exp_f32 v114, v114
    v_mfma_f32_32x32x16_bf16 v[80:95], a[196:199], a[180:183], v[80:95]
    s_and_b32 s33, s33, 0x3ffff
    v_exp_f32 v115, v115
    v_exp_f32 v116, v116
    v_exp_f32 v117, v117
    v_smfmac_f32_32x32x32_bf16 v[160:175], a[232:235], v[96:103], v24
    s_add_u32 s38, s4, s33
    v_exp_f32 v118, v118
    v_exp_f32 v119, v119
    v_exp_f32 v120, v120
    v_smfmac_f32_32x32x32_bf16 v[160:175], a[236:239], v[104:111], v24
    s_addc_u32 s39, s5, 0
    v_exp_f32 v121, v121
    v_exp_f32 v122, v122
    v_exp_f32 v123, v123
    v_smfmac_f32_16x16x64_bf16 v[28:31], v[20:23], v[96:103], v24
    global_load_dwordx4 a[208:211], v63, s[38:39] offset:-4096
    v_exp_f32 v124, v124
    v_exp_f32 v125, v125
    v_smfmac_f32_16x16x64_bf16 v[28:31], v[20:23], v[104:111], v24
    v_exp_f32 v126, v126
    v_exp_f32 v127, v127
    v_mfma_f32_32x32x16_bf16 v[96:111], a[192:195], a[184:187], v[240:255]
    v_exp_f32 v80, v80
    v_exp_f32 v81, v81
    v_exp_f32 v82, v82
    v_mfma_f32_32x32x16_bf16 v[96:111], a[196:199], a[188:191], v[96:111]
    v_exp_f32 v83, v83
    v_exp_f32 v84, v84
    v_exp_f32 v85, v85
    v_smfmac_f32_32x32x32_bf16 v[176:191], a[232:235], v[112:119], v24
    v_exp_f32 v86, v86
    v_exp_f32 v87, v87
    v_exp_f32 v88, v88
    v_smfmac_f32_32x32x32_bf16 v[176:191], a[236:239], v[120:127], v24
    s_waitcnt vmcnt(5)
    v_exp_f32 v89, v89
    v_exp_f32 v90, v90
    v_exp_f32 v91, v91
    v_smfmac_f32_16x16x64_bf16 v[32:35], v[20:23], v[112:119], v24
    global_load_dwordx4 a[212:215], v63, s[38:39] offset:-3072
    v_exp_f32 v92, v92
    v_exp_f32 v93, v93
    v_smfmac_f32_16x16x64_bf16 v[32:35], v[20:23], v[120:127], v24
    v_exp_f32 v94, v94
    v_exp_f32 v95, v95
    v_mfma_f32_32x32x16_bf16 v[112:127], a[192:195], a[160:163], v[128:143]
    v_exp_f32 v96, v96
    v_exp_f32 v97, v97
    v_exp_f32 v98, v98
    v_mfma_f32_32x32x16_bf16 v[112:127], a[196:199], a[164:167], v[112:127]
    v_exp_f32 v99, v99
    v_exp_f32 v100, v100
    v_exp_f32 v101, v101
    v_smfmac_f32_32x32x32_bf16 a[0:15], a[216:219], v[80:87], v24
    v_exp_f32 v102, v102
    v_exp_f32 v103, v103
    v_exp_f32 v104, v104
    v_smfmac_f32_32x32x32_bf16 a[0:15], a[220:223], v[88:95], v24
    v_exp_f32 v105, v105
    v_exp_f32 v106, v106
    v_exp_f32 v107, v107
    v_smfmac_f32_16x16x64_bf16 v[48:51], v[20:23], v[80:87], v24
    global_load_dwordx4 a[232:235], v1, s[38:39] offset:-2048
    v_exp_f32 v108, v108
    v_exp_f32 v109, v109
    v_smfmac_f32_16x16x64_bf16 v[48:51], v[20:23], v[88:95], v24
    v_exp_f32 v110, v110
    v_exp_f32 v111, v111
    v_mfma_f32_32x32x16_bf16 v[80:95], a[192:195], a[168:171], v[144:159]
    v_exp_f32 v112, v112
    v_exp_f32 v113, v113
    v_exp_f32 v114, v114
    v_mfma_f32_32x32x16_bf16 v[80:95], a[196:199], a[172:175], v[80:95]
    v_exp_f32 v115, v115
    v_exp_f32 v116, v116
    v_exp_f32 v117, v117
    v_smfmac_f32_32x32x32_bf16 a[16:31], a[216:219], v[96:103], v24
    v_exp_f32 v118, v118
    v_exp_f32 v119, v119
    v_exp_f32 v120, v120
    v_smfmac_f32_32x32x32_bf16 a[16:31], a[220:223], v[104:111], v24
    s_waitcnt vmcnt(5)
    v_exp_f32 v121, v121
    v_exp_f32 v122, v122
    v_exp_f32 v123, v123
    v_smfmac_f32_16x16x64_bf16 v[52:55], v[20:23], v[96:103], v24
    buffer_load_dword v5, v46, s[20:23], 0 offen offset:384 sc1
    v_exp_f32 v124, v124
    v_exp_f32 v125, v125
    v_smfmac_f32_16x16x64_bf16 v[52:55], v[20:23], v[104:111], v24
    global_load_dwordx4 a[236:239], v1, s[38:39] offset:-1024
    v_exp_f32 v126, v126
    v_exp_f32 v127, v127
    v_mfma_f32_32x32x16_bf16 v[96:111], a[200:203], a[176:179], v[224:239]
    s_add_u32 s33, s6, 0x3a000
    v_exp_f32 v80, v80
    v_exp_f32 v81, v81
    v_exp_f32 v82, v82
    v_mfma_f32_32x32x16_bf16 v[96:111], a[204:207], a[180:183], v[96:111]
    s_and_b32 s33, s33, 0x3ffff
    v_exp_f32 v83, v83
    v_exp_f32 v84, v84
    v_exp_f32 v85, v85
    v_smfmac_f32_32x32x32_bf16 v[160:175], a[216:219], v[112:119], v24
    s_add_u32 s36, s4, s33
    v_exp_f32 v86, v86
    v_exp_f32 v87, v87
    v_exp_f32 v88, v88
    v_smfmac_f32_32x32x32_bf16 v[160:175], a[220:223], v[120:127], v24
    s_addc_u32 s37, s5, 0
    v_exp_f32 v89, v89
    v_exp_f32 v90, v90
    v_exp_f32 v91, v91
    v_smfmac_f32_16x16x64_bf16 v[28:31], v[20:23], v[112:119], v24
    global_load_dwordx4 a[192:195], v63, s[36:37] offset:-4096
    v_exp_f32 v92, v92
    v_exp_f32 v93, v93
    v_smfmac_f32_16x16x64_bf16 v[28:31], v[20:23], v[120:127], v24
    global_load_dword v45, v44, s[98:99]
    v_exp_f32 v94, v94
    v_exp_f32 v95, v95
    v_mfma_f32_32x32x16_bf16 v[112:127], a[200:203], a[184:187], v[240:255]
hook16:
    s_cbranch_execz hook20
    v_exp_f32 v96, v96
    v_exp_f32 v97, v97
    v_exp_f32 v98, v98
    v_mfma_f32_32x32x16_bf16 v[112:127], a[204:207], a[188:191], v[112:127]
    v_exp_f32 v99, v99
    v_exp_f32 v100, v100
    v_exp_f32 v101, v101
    v_smfmac_f32_32x32x32_bf16 v[176:191], a[216:219], v[80:87], v24
    v_exp_f32 v102, v102
    v_exp_f32 v103, v103
    v_exp_f32 v104, v104
    v_smfmac_f32_32x32x32_bf16 v[176:191], a[220:223], v[88:95], v24
    s_waitcnt vmcnt(7)
    v_exp_f32 v105, v105
    v_exp_f32 v106, v106
    v_exp_f32 v107, v107
    v_smfmac_f32_16x16x64_bf16 v[32:35], v[20:23], v[80:87], v24
    global_load_dwordx4 a[196:199], v63, s[36:37] offset:-3072
    v_exp_f32 v108, v108
    v_exp_f32 v109, v109
    v_smfmac_f32_16x16x64_bf16 v[32:35], v[20:23], v[88:95], v24
    v_exp_f32 v110, v110
    v_exp_f32 v111, v111
    v_mfma_f32_32x32x16_bf16 v[80:95], a[200:203], a[160:163], v[128:143]
    v_exp_f32 v112, v112
    v_exp_f32 v113, v113
    v_exp_f32 v114, v114
    v_mfma_f32_32x32x16_bf16 v[80:95], a[204:207], a[164:167], v[80:95]
    v_exp_f32 v115, v115
    v_exp_f32 v116, v116
    v_exp_f32 v117, v117
    v_smfmac_f32_32x32x32_bf16 a[0:15], a[224:227], v[96:103], v24
    v_exp_f32 v118, v118
    v_exp_f32 v119, v119
    v_exp_f32 v120, v120
    v_smfmac_f32_32x32x32_bf16 a[0:15], a[228:231], v[104:111], v24
    v_exp_f32 v121, v121
    v_exp_f32 v122, v122
    v_exp_f32 v123, v123
    v_smfmac_f32_16x16x64_bf16 v[48:51], v[20:23], v[96:103], v24
    global_load_dwordx4 a[216:219], v1, s[36:37] offset:-2048
    v_exp_f32 v124, v124
    v_exp_f32 v125, v125
    v_smfmac_f32_16x16x64_bf16 v[48:51], v[20:23], v[104:111], v24
    v_exp_f32 v126, v126
    v_exp_f32 v127, v127
    v_mfma_f32_32x32x16_bf16 v[96:111], a[200:203], a[168:171], v[144:159]
    v_exp_f32 v80, v80
    v_exp_f32 v81, v81
    v_exp_f32 v82, v82
    v_mfma_f32_32x32x16_bf16 v[96:111], a[204:207], a[172:175], v[96:111]
    v_exp_f32 v83, v83
    v_exp_f32 v84, v84
    v_exp_f32 v85, v85
    v_smfmac_f32_32x32x32_bf16 a[16:31], a[224:227], v[112:119], v24
    v_exp_f32 v86, v86
    v_exp_f32 v87, v87
    v_exp_f32 v88, v88
    v_smfmac_f32_32x32x32_bf16 a[16:31], a[228:231], v[120:127], v24
    s_waitcnt vmcnt(7)
    v_exp_f32 v89, v89
    v_exp_f32 v90, v90
    v_exp_f32 v91, v91
    v_smfmac_f32_16x16x64_bf16 v[52:55], v[20:23], v[112:119], v24
    global_load_dwordx4 a[220:223], v1, s[36:37] offset:-1024
    v_exp_f32 v92, v92
    v_exp_f32 v93, v93
    v_smfmac_f32_16x16x64_bf16 v[52:55], v[20:23], v[120:127], v24
    v_exp_f32 v94, v94
    v_exp_f32 v95, v95
    v_mfma_f32_32x32x16_bf16 v[112:127], a[208:211], a[176:179], v[224:239]
    s_add_u32 s33, s6, 0xa000
    v_exp_f32 v96, v96
    v_exp_f32 v97, v97
    v_exp_f32 v98, v98
    v_mfma_f32_32x32x16_bf16 v[112:127], a[212:215], a[180:183], v[112:127]
    s_and_b32 s33, s33, 0x3ffff
    v_exp_f32 v99, v99
    v_exp_f32 v100, v100
    v_exp_f32 v101, v101
    v_smfmac_f32_32x32x32_bf16 v[160:175], a[224:227], v[80:87], v24
    s_add_u32 s38, s4, s33
    v_exp_f32 v102, v102
    v_exp_f32 v103, v103
    v_exp_f32 v104, v104
    v_smfmac_f32_32x32x32_bf16 v[160:175], a[228:231], v[88:95], v24
    s_addc_u32 s39, s5, 0
    v_exp_f32 v105, v105
    v_exp_f32 v106, v106
    v_exp_f32 v107, v107
    v_smfmac_f32_16x16x64_bf16 v[28:31], v[20:23], v[80:87], v24
    global_load_dwordx4 a[200:203], v63, s[38:39] offset:0
    v_exp_f32 v108, v108
    v_exp_f32 v109, v109
    v_smfmac_f32_16x16x64_bf16 v[28:31], v[20:23], v[88:95], v24
    v_exp_f32 v110, v110
    v_exp_f32 v111, v111
    s_waitcnt vmcnt(7)
    v_cmp_gt_u32 vcc, 1, v5
    s_cbranch_vccnz poa_spin
poa_ok:
    v_mfma_f32_32x32x16_bf16 v[80:95], a[208:211], a[184:187], v[240:255]
    s_xor_b32 s29, s0, 0
    v_exp_f32 v112, v112
    v_exp_f32 v113, v113
    v_exp_f32 v114, v114
    v_mfma_f32_32x32x16_bf16 v[80:95], a[212:215], a[188:191], v[80:95]
    s_add_u32 s12, s60, s29
    v_exp_f32 v115, v115
    v_exp_f32 v116, v116
    v_exp_f32 v117, v117
    v_smfmac_f32_32x32x32_bf16 v[176:191], a[224:227], v[96:103], v24
    s_addc_u32 s13, s61, 0
    v_exp_f32 v118, v118
    v_exp_f32 v119, v119
    v_exp_f32 v120, v120
    v_smfmac_f32_32x32x32_bf16 v[176:191], a[228:231], v[104:111], v24
    s_waitcnt vmcnt(6)
    v_exp_f32 v121, v121
    v_exp_f32 v122, v122
    v_exp_f32 v123, v123
    v_smfmac_f32_16x16x64_bf16 v[32:35], v[20:23], v[96:103], v24
    global_load_dwordx4 a[204:207], v63, s[38:39] offset:1024
    v_exp_f32 v124, v124
    v_exp_f32 v125, v125
    v_smfmac_f32_16x16x64_bf16 v[32:35], v[20:23], v[104:111], v24
    global_load_dwordx4 a[32:35], v1, s[12:13] offset:-4096
    v_exp_f32 v126, v126
    v_exp_f32 v127, v127
    v_mfma_f32_32x32x16_bf16 v[96:111], a[208:211], a[160:163], v[128:143]
    v_exp_f32 v80, v80
    v_exp_f32 v81, v81
    v_exp_f32 v82, v82
    v_mfma_f32_32x32x16_bf16 v[96:111], a[212:215], a[164:167], v[96:111]
    v_exp_f32 v83, v83
    v_exp_f32 v84, v84
    v_exp_f32 v85, v85
    v_smfmac_f32_32x32x32_bf16 a[0:15], a[232:235], v[112:119], v24
    v_exp_f32 v86, v86
    v_exp_f32 v87, v87
    v_exp_f32 v88, v88
    v_smfmac_f32_32x32x32_bf16 a[0:15], a[236:239], v[120:127], v24
    v_exp_f32 v89, v89
    v_exp_f32 v90, v90
    v_exp_f32 v91, v91
    v_smfmac_f32_16x16x64_bf16 v[48:51], v[20:23], v[112:119], v24
    global_load_dwordx4 a[224:227], v1, s[38:39] offset:2048
    v_exp_f32 v92, v92
    v_exp_f32 v93, v93
    v_smfmac_f32_16x16x64_bf16 v[48:51], v[20:23], v[120:127], v24
    global_load_dwordx4 a[36:39], v1, s[12:13] offset:-3072
    v_exp_f32 v94, v94
    v_exp_f32 v95, v95
    v_mfma_f32_32x32x16_bf16 v[112:127], a[208:211], a[168:171], v[144:159]
    v_exp_f32 v96, v96
    v_exp_f32 v97, v97
    v_exp_f32 v98, v98
    v_mfma_f32_32x32x16_bf16 v[112:127], a[212:215], a[172:175], v[112:127]
    v_exp_f32 v99, v99
    v_exp_f32 v100, v100
    v_exp_f32 v101, v101
    v_smfmac_f32_32x32x32_bf16 a[16:31], a[232:235], v[80:87], v24
    v_exp_f32 v102, v102
    v_exp_f32 v103, v103
    v_exp_f32 v104, v104
    v_smfmac_f32_32x32x32_bf16 a[16:31], a[236:239], v[88:95], v24
    s_waitcnt vmcnt(7)
    v_exp_f32 v105, v105
    v_exp_f32 v106, v106
    v_exp_f32 v107, v107
    v_smfmac_f32_16x16x64_bf16 v[52:55], v[20:23], v[80:87], v24
    global_load_dwordx4 a[228:231], v1, s[38:39] offset:3072
    v_exp_f32 v108, v108
    v_exp_f32 v109, v109
    v_smfmac_f32_16x16x64_bf16 v[52:55], v[20:23], v[88:95], v24
    global_load_dwordx4 a[40:43], v1, s[12:13] offset:-2048
    v_exp_f32 v110, v110
    v_exp_f32 v111, v111
    v_mfma_f32_32x32x16_bf16 v[80:95], a[192:195], a[176:179], v[224:239]
    s_add_u32 s33, s6, 0x12000
    v_exp_f32 v112, v112
    v_exp_f32 v113, v113
    v_exp_f32 v114, v114
    v_mfma_f32_32x32x16_bf16 v[80:95], a[196:199], a[180:183], v[80:95]
    s_and_b32 s33, s33, 0x3ffff
    v_exp_f32 v115, v115
    v_exp_f32 v116, v116
    v_exp_f32 v117, v117
    v_smfmac_f32_32x32x32_bf16 v[160:175], a[232:235], v[96:103], v24
    s_add_u32 s36, s4, s33
    v_exp_f32 v118, v118
    v_exp_f32 v119, v119
    v_exp_f32 v120, v120
    v_smfmac_f32_32x32x32_bf16 v[160:175], a[236:239], v[104:111], v24
    s_addc_u32 s37, s5, 0
    v_exp_f32 v121, v121
    v_exp_f32 v122, v122
    v_exp_f32 v123, v123
    v_smfmac_f32_16x16x64_bf16 v[28:31], v[20:23], v[96:103], v24
    global_load_dwordx4 a[208:211], v63, s[36:37] offset:0
    v_exp_f32 v124, v124
    v_exp_f32 v125, v125
    v_smfmac_f32_16x16x64_bf16 v[28:31], v[20:23], v[104:111], v24
    global_load_dwordx4 a[44:47], v1, s[12:13] offset:-1024
    v_exp_f32 v126, v126
    v_exp_f32 v127, v127
    v_mfma_f32_32x32x16_bf16 v[96:111], a[192:195], a[184:187], v[240:255]
    v_exp_f32 v80, v80
    v_exp_f32 v81, v81
    v_exp_f32 v82, v82
    v_mfma_f32_32x32x16_bf16 v[96:111], a[196:199], a[188:191], v[96:111]
    v_exp_f32 v83, v83
    v_exp_f32 v84, v84
    v_exp_f32 v85, v85
    v_smfmac_f32_32x32x32_bf16 v[176:191], a[232:235], v[112:119], v24
    v_exp_f32 v86, v86
    v_exp_f32 v87, v87
    v_exp_f32 v88, v88
    v_smfmac_f32_32x32x32_bf16 v[176:191], a[236:239], v[120:127], v24
    s_waitcnt vmcnt(9)
    v_exp_f32 v89, v89
    v_exp_f32 v90, v90
    v_exp_f32 v91, v91
    v_smfmac_f32_16x16x64_bf16 v[32:35], v[20:23], v[112:119], v24
    global_load_dwordx4 a[212:215], v63, s[36:37] offset:1024
    v_exp_f32 v92, v92
    v_exp_f32 v93, v93
    v_smfmac_f32_16x16x64_bf16 v[32:35], v[20:23], v[120:127], v24
    global_load_dwordx4 a[48:51], v1, s[12:13] offset:0
    v_exp_f32 v94, v94
    v_exp_f32 v95, v95
    v_mfma_f32_32x32x16_bf16 v[112:127], a[192:195], a[160:163], v[128:143]
    v_exp_f32 v96, v96
    v_exp_f32 v97, v97
    v_exp_f32 v98, v98
    v_mfma_f32_32x32x16_bf16 v[112:127], a[196:199], a[164:167], v[112:127]
    v_exp_f32 v99, v99
    v_exp_f32 v100, v100
    v_exp_f32 v101, v101
    v_smfmac_f32_32x32x32_bf16 a[0:15], a[216:219], v[80:87], v24
    v_exp_f32 v102, v102
    v_exp_f32 v103, v103
    v_exp_f32 v104, v104
    v_smfmac_f32_32x32x32_bf16 a[0:15], a[220:223], v[88:95], v24
    v_exp_f32 v105, v105
    v_exp_f32 v106, v106
    v_exp_f32 v107, v107
    v_smfmac_f32_16x16x64_bf16 v[48:51], v[20:23], v[80:87], v24
    global_load_dwordx4 a[232:235], v1, s[36:37] offset:2048
    v_exp_f32 v108, v108
    v_exp_f32 v109, v109
    v_smfmac_f32_16x16x64_bf16 v[48:51], v[20:23], v[88:95], v24
    global_load_dwordx4 a[52:55], v1, s[12:13] offset:1024
    v_exp_f32 v110, v110
    v_exp_f32 v111, v111
    v_mfma_f32_32x32x16_bf16 v[80:95], a[192:195], a[168:171], v[144:159]
    v_exp_f32 v112, v112
    v_exp_f32 v113, v113
    v_exp_f32 v114, v114
    v_mfma_f32_32x32x16_bf16 v[80:95], a[196:199], a[172:175], v[80:95]
    v_exp_f32 v115, v115
    v_exp_f32 v116, v116
    v_exp_f32 v117, v117
    v_smfmac_f32_32x32x32_bf16 a[16:31], a[216:219], v[96:103], v24
    v_exp_f32 v118, v118
    v_exp_f32 v119, v119
    v_exp_f32 v120, v120
    v_smfmac_f32_32x32x32_bf16 a[16:31], a[220:223], v[104:111], v24
    s_waitcnt vmcnt(11)
    v_exp_f32 v121, v121
    v_exp_f32 v122, v122
    v_exp_f32 v123, v123
    v_smfmac_f32_16x16x64_bf16 v[52:55], v[20:23], v[96:103], v24
    global_load_dwordx4 a[236:239], v1, s[36:37] offset:3072
    v_exp_f32 v124, v124
    v_exp_f32 v125, v125
    v_smfmac_f32_16x16x64_bf16 v[52:55], v[20:23], v[104:111], v24
    global_load_dwordx4 a[56:59], v1, s[12:13] offset:2048
    v_exp_f32 v126, v126
    v_exp_f32 v127, v127
    v_mfma_f32_32x32x16_bf16 v[96:111], a[200:203], a[176:179], v[224:239]
    s_add_u32 s33, s6, 0x1a000
    v_exp_f32 v80, v80
    v_exp_f32 v81, v81
    v_exp_f32 v82, v82
    v_mfma_f32_32x32x16_bf16 v[96:111], a[204:207], a[180:183], v[96:111]
    s_and_b32 s33, s33, 0x3ffff
    v_exp_f32 v83, v83
    v_exp_f32 v84, v84
    v_exp_f32 v85, v85
    v_smfmac_f32_32x32x32_bf16 v[160:175], a[216:219], v[112:119], v24
    s_add_u32 s38, s4, s33
    v_exp_f32 v86, v86
    v_exp_f32 v87, v87
    v_exp_f32 v88, v88
    v_smfmac_f32_32x32x32_bf16 v[160:175], a[220:223], v[120:127], v24
    s_addc_u32 s39, s5, 0
    v_exp_f32 v89, v89
    v_exp_f32 v90, v90
    v_exp_f32 v91, v91
    v_smfmac_f32_16x16x64_bf16 v[28:31], v[20:23], v[112:119], v24
    global_load_dwordx4 a[192:195], v63, s[38:39] offset:0
    v_exp_f32 v92, v92
    v_exp_f32 v93, v93
    v_smfmac_f32_16x16x64_bf16 v[28:31], v[20:23], v[120:127], v24
    global_load_dwordx4 a[60:63], v1, s[12:13] offset:3072
    v_exp_f32 v94, v94
    v_exp_f32 v95, v95
    v_mfma_f32_32x32x16_bf16 v[112:127], a[200:203], a[184:187], v[240:255]
    s_xor_b32 s29, s0, 8192
    v_exp_f32 v96, v96
    v_exp_f32 v97, v97
    v_exp_f32 v98, v98
    v_mfma_f32_32x32x16_bf16 v[112:127], a[204:207], a[188:191], v[112:127]
    s_add_u32 s14, s60, s29
    v_exp_f32 v99, v99
    v_exp_f32 v100, v100
    v_exp_f32 v101, v101
    v_smfmac_f32_32x32x32_bf16 v[176:191], a[216:219], v[80:87], v24
    s_addc_u32 s15, s61, 0
    v_exp_f32 v102, v102
    v_exp_f32 v103, v103
    v_exp_f32 v104, v104
    v_smfmac_f32_32x32x32_bf16 v[176:191], a[220:223], v[88:95], v24
    s_waitcnt vmcnt(11)
    v_exp_f32 v105, v105
    v_exp_f32 v106, v106
    v_exp_f32 v107, v107
    v_smfmac_f32_16x16x64_bf16 v[32:35], v[20:23], v[80:87], v24
    global_load_dwordx4 a[196:199], v63, s[38:39] offset:1024
    v_exp_f32 v108, v108
    v_exp_f32 v109, v109
    v_smfmac_f32_16x16x64_bf16 v[32:35], v[20:23], v[88:95], v24
    global_load_dwordx4 a[64:67], v1, s[14:15] offset:-4096
    v_exp_f32 v110, v110
    v_exp_f32 v111, v111
    v_mfma_f32_32x32x16_bf16 v[80:95], a[200:203], a[160:163], v[128:143]
    v_exp_f32 v112, v112
    v_exp_f32 v113, v113
    v_exp_f32 v114, v114
    v_mfma_f32_32x32x16_bf16 v[80:95], a[204:207], a[164:167], v[80:95]
    v_exp_f32 v115, v115
    v_exp_f32 v116, v116
    v_exp_f32 v117, v117
    v_smfmac_f32_32x32x32_bf16 a[0:15], a[224:227], v[96:103], v24
    v_exp_f32 v118, v118
    v_exp_f32 v119, v119
    v_exp_f32 v120, v120
    v_smfmac_f32_32x32x32_bf16 a[0:15], a[228:231], v[104:111], v24
    v_exp_f32 v121, v121
    v_exp_f32 v122, v122
    v_exp_f32 v123, v123
    v_smfmac_f32_16x16x64_bf16 v[48:51], v[20:23], v[96:103], v24
    global_load_dwordx4 a[216:219], v1, s[38:39] offset:2048
    v_exp_f32 v124, v124
    v_exp_f32 v125, v125
    v_smfmac_f32_16x16x64_bf16 v[48:51], v[20:23], v[104:111], v24
    global_load_dwordx4 a[68:71], v1, s[14:15] offset:-3072
    v_exp_f32 v126, v126
    v_exp_f32 v127, v127
    v_mfma_f32_32x32x16_bf16 v[96:111], a[200:203], a[168:171], v[144:159]
    v_exp_f32 v80, v80
    v_exp_f32 v81, v81
    v_exp_f32 v82, v82
    v_mfma_f32_32x32x16_bf16 v[96:111], a[204:207], a[172:175], v[96:111]
    v_exp_f32 v83, v83
    v_exp_f32 v84, v84
    v_exp_f32 v85, v85
    v_smfmac_f32_32x32x32_bf16 a[16:31], a[224:227], v[112:119], v24
    v_exp_f32 v86, v86
    v_exp_f32 v87, v87
    v_exp_f32 v88, v88
    v_smfmac_f32_32x32x32_bf16 a[16:31], a[228:231], v[120:127], v24
    s_waitcnt vmcnt(11)
    v_exp_f32 v89, v89
    v_exp_f32 v90, v90
    v_exp_f32 v91, v91
    v_smfmac_f32_16x16x64_bf16 v[52:55], v[20:23], v[112:119], v24
    global_load_dwordx4 a[220:223], v1, s[38:39] offset:3072
    v_exp_f32 v92, v92
    v_exp_f32 v93, v93
    v_smfmac_f32_16x16x64_bf16 v[52:55], v[20:23], v[120:127], v24
    global_load_dwordx4 a[72:75], v1, s[14:15] offset:-2048
    v_exp_f32 v94, v94
    v_exp_f32 v95, v95
    v_mfma_f32_32x32x16_bf16 v[112:127], a[208:211], a[176:179], v[224:239]
    s_add_u32 s33, s6, 0x22000
    v_exp_f32 v96, v96
    v_exp_f32 v97, v97
    v_exp_f32 v98, v98
    v_mfma_f32_32x32x16_bf16 v[112:127], a[212:215], a[180:183], v[112:127]
    s_and_b32 s33, s33, 0x3ffff
    v_exp_f32 v99, v99
    v_exp_f32 v100, v100
    v_exp_f32 v101, v101
    v_smfmac_f32_32x32x32_bf16 v[160:175], a[224:227], v[80:87], v24
    s_add_u32 s36, s4, s33
    v_exp_f32 v102, v102
    v_exp_f32 v103, v103
    v_exp_f32 v104, v104
    v_smfmac_f32_32x32x32_bf16 v[160:175], a[228:231], v[88:95], v24
    s_addc_u32 s37, s5, 0
    v_exp_f32 v105, v105
    v_exp_f32 v106, v106
    v_exp_f32 v107, v107
    v_smfmac_f32_16x16x64_bf16 v[28:31], v[20:23], v[80:87], v24
    global_load_dwordx4 a[200:203], v63, s[36:37] offset:0
    v_exp_f32 v108, v108
    v_exp_f32 v109, v109
    v_smfmac_f32_16x16x64_bf16 v[28:31], v[20:23], v[88:95], v24
    global_load_dwordx4 a[76:79], v1, s[14:15] offset:-1024
    v_exp_f32 v110, v110
    v_exp_f32 v111, v111
    v_mfma_f32_32x32x16_bf16 v[80:95], a[208:211], a[184:187], v[240:255]
    v_exp_f32 v112, v112
    v_exp_f32 v113, v113
    v_exp_f32 v114, v114
    v_mfma_f32_32x32x16_bf16 v[80:95], a[212:215], a[188:191], v[80:95]
    v_exp_f32 v115, v115
    v_exp_f32 v116, v116
    v_exp_f32 v117, v117
    v_smfmac_f32_32x32x32_bf16 v[176:191], a[224:227], v[96:103], v24
    v_exp_f32 v118, v118
    v_exp_f32 v119, v119
    v_exp_f32 v120, v120
    v_smfmac_f32_32x32x32_bf16 v[176:191], a[228:231], v[104:111], v24
    s_waitcnt vmcnt(11)
    v_exp_f32 v121, v121
    v_exp_f32 v122, v122
    v_exp_f32 v123, v123
    v_smfmac_f32_16x16x64_bf16 v[32:35], v[20:23], v[96:103], v24
    global_load_dwordx4 a[204:207], v63, s[36:37] offset:1024
    v_exp_f32 v124, v124
    v_exp_f32 v125, v125
    v_smfmac_f32_16x16x64_bf16 v[32:35], v[20:23], v[104:111], v24
    global_load_dwordx4 a[80:83], v1, s[14:15] offset:0
    v_exp_f32 v126, v126
    v_exp_f32 v127, v127
    v_mfma_f32_32x32x16_bf16 v[96:111], a[208:211], a[160:163], v[128:143]
    v_exp_f32 v80, v80
    v_exp_f32 v81, v81
    v_exp_f32 v82, v82
    v_mfma_f32_32x32x16_bf16 v[96:111], a[212:215], a[164:167], v[96:111]
    v_exp_f32 v83, v83
    v_exp_f32 v84, v84
    v_exp_f32 v85, v85
    v_smfmac_f32_32x32x32_bf16 a[0:15], a[232:235], v[112:119], v24
    v_exp_f32 v86, v86
    v_exp_f32 v87, v87
    v_exp_f32 v88, v88
    v_smfmac_f32_32x32x32_bf16 a[0:15], a[236:239], v[120:127], v24
    v_exp_f32 v89, v89
    v_exp_f32 v90, v90
    v_exp_f32 v91, v91
    v_smfmac_f32_16x16x64_bf16 v[48:51], v[20:23], v[112:119], v24
    global_load_dwordx4 a[224:227], v1, s[36:37] offset:2048
    v_exp_f32 v92, v92
    v_exp_f32 v93, v93
    v_smfmac_f32_16x16x64_bf16 v[48:51], v[20:23], v[120:127], v24
    global_load_dwordx4 a[84:87], v1, s[14:15] offset:1024
    v_exp_f32 v94, v94
    v_exp_f32 v95, v95
    v_mfma_f32_32x32x16_bf16 v[112:127], a[208:211], a[168:171], v[144:159]
    v_exp_f32 v96, v96
    v_exp_f32 v97, v97
    v_exp_f32 v98, v98
    v_mfma_f32_32x32x16_bf16 v[112:127], a[212:215], a[172:175], v[112:127]
    v_exp_f32 v99, v99
    v_exp_f32 v100, v100
    v_exp_f32 v101, v101
    v_smfmac_f32_32x32x32_bf16 a[16:31], a[232:235], v[80:87], v24
    v_exp_f32 v102, v102
    v_exp_f32 v103, v103
    v_exp_f32 v104, v104
    v_smfmac_f32_32x32x32_bf16 a[16:31], a[236:239], v[88:95], v24
    s_waitcnt vmcnt(11)
    v_exp_f32 v105, v105
    v_exp_f32 v106, v106
    v_exp_f32 v107, v107
    v_smfmac_f32_16x16x64_bf16 v[52:55], v[20:23], v[80:87], v24
    global_load_dwordx4 a[228:231], v1, s[36:37] offset:3072
    v_exp_f32 v108, v108
    v_exp_f32 v109, v109
    v_smfmac_f32_16x16x64_bf16 v[52:55], v[20:23], v[88:95], v24
    global_load_dwordx4 a[88:91], v1, s[14:15] offset:2048
    v_exp_f32 v110, v110
    v_exp_f32 v111, v111
    v_mfma_f32_32x32x16_bf16 v[80:95], a[192:195], a[176:179], v[224:239]
    s_add_u32 s33, s6, 0x2a000
    v_exp_f32 v112, v112
    v_exp_f32 v113, v113
    v_exp_f32 v114, v114
    v_mfma_f32_32x32x16_bf16 v[80:95], a[196:199], a[180:183], v[80:95]
    s_and_b32 s33, s33, 0x3ffff
    v_exp_f32 v115, v115
    v_exp_f32 v116, v116
    v_exp_f32 v117, v117
    v_smfmac_f32_32x32x32_bf16 v[160:175], a[232:235], v[96:103], v24
    s_add_u32 s38, s4, s33
    v_exp_f32 v118, v118
    v_exp_f32 v119, v119
    v_exp_f32 v120, v120
    v_smfmac_f32_32x32x32_bf16 v[160:175], a[236:239], v[104:111], v24
    s_addc_u32 s39, s5, 0
    v_exp_f32 v121, v121
    v_exp_f32 v122, v122
    v_exp_f32 v123, v123
    v_smfmac_f32_16x16x64_bf16 v[28:31], v[20:23], v[96:103], v24
    global_load_dwordx4 a[208:211], v63, s[38:39] offset:0
    v_exp_f32 v124, v124
    v_exp_f32 v125, v125
    v_smfmac_f32_16x16x64_bf16 v[28:31], v[20:23], v[104:111], v24
    global_load_dwordx4 a[92:95], v1, s[14:15] offset:3072
    v_exp_f32 v126, v126
    v_exp_f32 v127, v127
    v_mfma_f32_32x32x16_bf16 v[96:111], a[192:195], a[184:187], v[240:255]
    s_xor_b32 s29, s0, 16384
    v_exp_f32 v80, v80
    v_exp_f32 v81, v81
    v_exp_f32 v82, v82
    v_mfma_f32_32x32x16_bf16 v[96:111], a[196:199], a[188:191], v[96:111]
    s_add_u32 s12, s60, s29
    v_exp_f32 v83, v83
    v_exp_f32 v84, v84
    v_exp_f32 v85, v85
    v_smfmac_f32_32x32x32_bf16 v[176:191], a[232:235], v[112:119], v24
    s_addc_u32 s13, s61, 0
    v_exp_f32 v86, v86
    v_exp_f32 v87, v87
    v_exp_f32 v88, v88
    v_smfmac_f32_32x32x32_bf16 v[176:191], a[236:239], v[120:127], v24
    s_waitcnt vmcnt(11)
    v_exp_f32 v89, v89
    v_exp_f32 v90, v90
    v_exp_f32 v91, v91
    v_smfmac_f32_16x16x64_bf16 v[32:35], v[20:23], v[112:119], v24
    global_load_dwordx4 a[212:215], v63, s[38:39] offset:1024
    v_exp_f32 v92, v92
    v_exp_f32 v93, v93
    v_smfmac_f32_16x16x64_bf16 v[32:35], v[20:23], v[120:127], v24
    global_load_dwordx4 a[96:99], v1, s[12:13] offset:-4096
    v_exp_f32 v94, v94
    v_exp_f32 v95, v95
    v_mfma_f32_32x32x16_bf16 v[112:127], a[192:195], a[160:163], v[128:143]
    v_exp_f32 v96, v96
    v_exp_f32 v97, v97
    v_exp_f32 v98, v98
    v_mfma_f32_32x32x16_bf16 v[112:127], a[196:199], a[164:167], v[112:127]
    v_exp_f32 v99, v99
    v_exp_f32 v100, v100
    v_exp_f32 v101, v101
    v_smfmac_f32_32x32x32_bf16 a[0:15], a[216:219], v[80:87], v24
    v_exp_f32 v102, v102
    v_exp_f32 v103, v103
    v_exp_f32 v104, v104
    v_smfmac_f32_32x32x32_bf16 a[0:15], a[220:223], v[88:95], v24
    v_exp_f32 v105, v105
    v_exp_f32 v106, v106
    v_exp_f32 v107, v107
    v_smfmac_f32_16x16x64_bf16 v[48:51], v[20:23], v[80:87], v24
    global_load_dwordx4 a[232:235], v1, s[38:39] offset:2048
    v_exp_f32 v108, v108
    v_exp_f32 v109, v109
    v_smfmac_f32_16x16x64_bf16 v[48:51], v[20:23], v[88:95], v24
    global_load_dwordx4 a[100:103], v1, s[12:13] offset:-3072
    v_exp_f32 v110, v110
    v_exp_f32 v111, v111
    v_mfma_f32_32x32x16_bf16 v[80:95], a[192:195], a[168:171], v[144:159]
    v_exp_f32 v112, v112
    v_exp_f32 v113, v113
    v_exp_f32 v114, v114
    v_mfma_f32_32x32x16_bf16 v[80:95], a[196:199], a[172:175], v[80:95]
    v_exp_f32 v115, v115
    v_exp_f32 v116, v116
    v_exp_f32 v117, v117
    v_smfmac_f32_32x32x32_bf16 a[16:31], a[216:219], v[96:103], v24
    v_exp_f32 v118, v118
    v_exp_f32 v119, v119
    v_exp_f32 v120, v120
    v_smfmac_f32_32x32x32_bf16 a[16:31], a[220:223], v[104:111], v24
    s_waitcnt vmcnt(11)
    v_exp_f32 v121, v121
    v_exp_f32 v122, v122
    v_exp_f32 v123, v123
    v_smfmac_f32_16x16x64_bf16 v[52:55], v[20:23], v[96:103], v24
    global_load_dwordx4 a[236:239], v1, s[38:39] offset:3072
    v_exp_f32 v124, v124
    v_exp_f32 v125, v125
    v_smfmac_f32_16x16x64_bf16 v[52:55], v[20:23], v[104:111], v24
    global_load_dwordx4 a[104:107], v1, s[12:13] offset:-2048
    v_exp_f32 v126, v126
    v_exp_f32 v127, v127
    v_mfma_f32_32x32x16_bf16 v[96:111], a[200:203], a[176:179], v[224:239]
    s_add_u32 s33, s6, 0x32000
    v_exp_f32 v80, v80
    v_exp_f32 v81, v81
    v_exp_f32 v82, v82
    v_mfma_f32_32x32x16_bf16 v[96:111], a[204:207], a[180:183], v[96:111]
    s_and_b32 s33, s33, 0x3ffff
    v_exp_f32 v83, v83
    v_exp_f32 v84, v84
    v_exp_f32 v85, v85
    v_smfmac_f32_32x32x32_bf16 v[160:175], a[216:219], v[112:119], v24
    s_add_u32 s36, s4, s33
    v_exp_f32 v86, v86
    v_exp_f32 v87, v87
    v_exp_f32 v88, v88
    v_smfmac_f32_32x32x32_bf16 v[160:175], a[220:223], v[120:127], v24
    s_addc_u32 s37, s5, 0
    v_exp_f32 v89, v89
    v_exp_f32 v90, v90
    v_exp_f32 v91, v91
    v_smfmac_f32_16x16x64_bf16 v[28:31], v[20:23], v[112:119], v24
    global_load_dwordx4 a[192:195], v63, s[36:37] offset:0
    v_exp_f32 v92, v92
    v_exp_f32 v93, v93
    v_smfmac_f32_16x16x64_bf16 v[28:31], v[20:23], v[120:127], v24
    global_load_dwordx4 a[108:111], v1, s[12:13] offset:-1024
    v_exp_f32 v94, v94
    v_exp_f32 v95, v95
    v_mfma_f32_32x32x16_bf16 v[112:127], a[200:203], a[184:187], v[240:255]
    v_exp_f32 v96, v96
    v_exp_f32 v97, v97
    v_exp_f32 v98, v98
    v_mfma_f32_32x32x16_bf16 v[112:127], a[204:207], a[188:191], v[112:127]
    v_exp_f32 v99, v99
    v_exp_f32 v100, v100
    v_exp_f32 v101, v101
    v_smfmac_f32_32x32x32_bf16 v[176:191], a[216:219], v[80:87], v24
    v_exp_f32 v102, v102
    v_exp_f32 v103, v103
    v_exp_f32 v104, v104
    v_smfmac_f32_32x32x32_bf16 v[176:191], a[220:223], v[88:95], v24
    s_waitcnt vmcnt(11)
    v_exp_f32 v105, v105
    v_exp_f32 v106, v106
    v_exp_f32 v107, v107
    v_smfmac_f32_16x16x64_bf16 v[32:35], v[20:23], v[80:87], v24
    global_load_dwordx4 a[196:199], v63, s[36:37] offset:1024
    v_exp_f32 v108, v108
    v_exp_f32 v109, v109
    v_smfmac_f32_16x16x64_bf16 v[32:35], v[20:23], v[88:95], v24
    global_load_dwordx4 a[112:115], v1, s[12:13] offset:0
    v_exp_f32 v110, v110
    v_exp_f32 v111, v111
    v_mfma_f32_32x32x16_bf16 v[80:95], a[200:203], a[160:163], v[128:143]
    v_exp_f32 v112, v112
    v_exp_f32 v113, v113
    v_exp_f32 v114, v114
    v_mfma_f32_32x32x16_bf16 v[80:95], a[204:207], a[164:167], v[80:95]
    v_exp_f32 v115, v115
    v_exp_f32 v116, v116
    v_exp_f32 v117, v117
    v_smfmac_f32_32x32x32_bf16 a[0:15], a[224:227], v[96:103], v24
    v_exp_f32 v118, v118
    v_exp_f32 v119, v119
    v_exp_f32 v120, v120
    v_smfmac_f32_32x32x32_bf16 a[0:15], a[228:231], v[104:111], v24
    v_exp_f32 v121, v121
    v_exp_f32 v122, v122
    v_exp_f32 v123, v123
    v_smfmac_f32_16x16x64_bf16 v[48:51], v[20:23], v[96:103], v24
    global_load_dwordx4 a[216:219], v1, s[36:37] offset:2048
    v_exp_f32 v124, v124
    v_exp_f32 v125, v125
    v_smfmac_f32_16x16x64_bf16 v[48:51], v[20:23], v[104:111], v24
    global_load_dwordx4 a[116:119], v1, s[12:13] offset:1024
    v_exp_f32 v126, v126
    v_exp_f32 v127, v127
    v_mfma_f32_32x32x16_bf16 v[96:111], a[200:203], a[168:171], v[144:159]
    v_exp_f32 v80, v80
    v_exp_f32 v81, v81
    v_exp_f32 v82, v82
    v_mfma_f32_32x32x16_bf16 v[96:111], a[204:207], a[172:175], v[96:111]
    v_exp_f32 v83, v83
    v_exp_f32 v84, v84
    v_exp_f32 v85, v85
    v_smfmac_f32_32x32x32_bf16 a[16:31], a[224:227], v[112:119], v24
    v_exp_f32 v86, v86
    v_exp_f32 v87, v87
    v_exp_f32 v88, v88
    v_smfmac_f32_32x32x32_bf16 a[16:31], a[228:231], v[120:127], v24
    s_waitcnt vmcnt(11)
    v_exp_f32 v89, v89
    v_exp_f32 v90, v90
    v_exp_f32 v91, v91
    v_smfmac_f32_16x16x64_bf16 v[52:55], v[20:23], v[112:119], v24
    global_load_dwordx4 a[220:223], v1, s[36:37] offset:3072
    v_exp_f32 v92, v92
    v_exp_f32 v93, v93
    v_smfmac_f32_16x16x64_bf16 v[52:55], v[20:23], v[120:127], v24
    global_load_dwordx4 a[120:123], v1, s[12:13] offset:2048
    v_exp_f32 v94, v94
    v_exp_f32 v95, v95
    v_mfma_f32_32x32x16_bf16 v[112:127], a[208:211], a[176:179], v[224:239]
    s_add_u32 s33, s6, 0x3a000
    v_exp_f32 v96, v96
    v_exp_f32 v97, v97
    v_exp_f32 v98, v98
    v_mfma_f32_32x32x16_bf16 v[112:127], a[212:215], a[180:183], v[112:127]
    s_and_b32 s33, s33, 0x3ffff
    v_exp_f32 v99, v99
    v_exp_f32 v100, v100
    v_exp_f32 v101, v101
    v_smfmac_f32_32x32x32_bf16 v[160:175], a[224:227], v[80:87], v24
    s_add_u32 s38, s4, s33
    v_exp_f32 v102, v102
    v_exp_f32 v103, v103
    v_exp_f32 v104, v104
    v_smfmac_f32_32x32x32_bf16 v[160:175], a[228:231], v[88:95], v24
    s_addc_u32 s39, s5, 0
    v_exp_f32 v105, v105
    v_exp_f32 v106, v106
    v_exp_f32 v107, v107
    v_smfmac_f32_16x16x64_bf16 v[28:31], v[20:23], v[80:87], v24
    global_load_dwordx4 a[200:203], v63, s[38:39] offset:0
    v_exp_f32 v108, v108
    v_exp_f32 v109, v109
    v_smfmac_f32_16x16x64_bf16 v[28:31], v[20:23], v[88:95], v24
    global_load_dwordx4 a[124:127], v1, s[12:13] offset:3072
    v_exp_f32 v110, v110
    v_exp_f32 v111, v111
    v_mfma_f32_32x32x16_bf16 v[80:95], a[208:211], a[184:187], v[240:255]
    s_xor_b32 s29, s0, 24576
    v_exp_f32 v112, v112
    v_exp_f32 v113, v113
    v_exp_f32 v114, v114
    v_mfma_f32_32x32x16_bf16 v[80:95], a[212:215], a[188:191], v[80:95]
    s_add_u32 s14, s60, s29
    v_exp_f32 v115, v115
    v_exp_f32 v116, v116
    v_exp_f32 v117, v117
    v_smfmac_f32_32x32x32_bf16 v[176:191], a[224:227], v[96:103], v24
    s_addc_u32 s15, s61, 0
    v_exp_f32 v118, v118
    v_exp_f32 v119, v119
    v_exp_f32 v120, v120
    v_smfmac_f32_32x32x32_bf16 v[176:191], a[228:231], v[104:111], v24
    s_waitcnt vmcnt(11)
    v_exp_f32 v121, v121
    v_exp_f32 v122, v122
    v_exp_f32 v123, v123
    v_smfmac_f32_16x16x64_bf16 v[32:35], v[20:23], v[96:103], v24
    global_load_dwordx4 a[204:207], v63, s[38:39] offset:1024
    v_exp_f32 v124, v124
    v_exp_f32 v125, v125
    v_smfmac_f32_16x16x64_bf16 v[32:35], v[20:23], v[104:111], v24
    global_load_dwordx4 a[128:131], v1, s[14:15] offset:-4096
    v_exp_f32 v126, v126
    v_exp_f32 v127, v127
    v_mfma_f32_32x32x16_bf16 v[96:111], a[208:211], a[160:163], v[128:143]
    v_exp_f32 v80, v80
    v_exp_f32 v81, v81
    v_exp_f32 v82, v82
    v_mfma_f32_32x32x16_bf16 v[96:111], a[212:215], a[164:167], v[96:111]
    v_exp_f32 v83, v83
    v_exp_f32 v84, v84
    v_exp_f32 v85, v85
    v_smfmac_f32_32x32x32_bf16 a[0:15], a[232:235], v[112:119], v24
    v_exp_f32 v86, v86
    v_exp_f32 v87, v87
    v_exp_f32 v88, v88
    v_smfmac_f32_32x32x32_bf16 a[0:15], a[236:239], v[120:127], v24
    v_exp_f32 v89, v89
    v_exp_f32 v90, v90
    v_exp_f32 v91, v91
    v_smfmac_f32_16x16x64_bf16 v[48:51], v[20:23], v[112:119], v24
    global_load_dwordx4 a[224:227], v1, s[38:39] offset:2048
    v_exp_f32 v92, v92
    v_exp_f32 v93, v93
    v_smfmac_f32_16x16x64_bf16 v[48:51], v[20:23], v[120:127], v24
hook17:
    s_cbranch_execz hook_end
    global_load_dwordx4 a[132:135], v1, s[14:15] offset:-3072
    v_exp_f32 v94, v94
    v_exp_f32 v95, v95
    v_mfma_f32_32x32x16_bf16 v[112:127], a[208:211], a[168:171], v[144:159]
    v_exp_f32 v96, v96
    v_exp_f32 v97, v97
    v_exp_f32 v98, v98
    v_mfma_f32_32x32x16_bf16 v[112:127], a[212:215], a[172:175], v[112:127]
    v_exp_f32 v99, v99
    v_exp_f32 v100, v100
    v_exp_f32 v101, v101
    v_smfmac_f32_32x32x32_bf16 a[16:31], a[232:235], v[80:87], v24
    v_exp_f32 v102, v102
    v_exp_f32 v103, v103
    v_exp_f32 v104, v104
    v_smfmac_f32_32x32x32_bf16 a[16:31], a[236:239], v[88:95], v24
    s_waitcnt vmcnt(11)
    v_exp_f32 v105, v105
    v_exp_f32 v106, v106
    v_exp_f32 v107, v107
    v_smfmac_f32_16x16x64_bf16 v[52:55], v[20:23], v[80:87], v24
    global_load_dwordx4 a[228:231], v1, s[38:39] offset:3072
    v_exp_f32 v108, v108
    v_exp_f32 v109, v109
    v_smfmac_f32_16x16x64_bf16 v[52:55], v[20:23], v[88:95], v24
    global_load_dwordx4 a[136:139], v1, s[14:15] offset:-2048
    v_exp_f32 v110, v110
    v_exp_f32 v111, v111
    v_mfma_f32_32x32x16_bf16 v[80:95], a[192:195], a[176:179], v[224:239]
    v_exp_f32 v112, v112
    v_exp_f32 v113, v113
    v_exp_f32 v114, v114
    v_mfma_f32_32x32x16_bf16 v[80:95], a[196:199], a[180:183], v[80:95]
    v_exp_f32 v115, v115
    v_exp_f32 v116, v116
    v_exp_f32 v117, v117
    v_smfmac_f32_32x32x32_bf16 v[160:175], a[232:235], v[96:103], v24
    v_exp_f32 v118, v118
    v_exp_f32 v119, v119
    v_exp_f32 v120, v120
    v_smfmac_f32_32x32x32_bf16 v[160:175], a[236:239], v[104:111], v24
    v_exp_f32 v121, v121
    v_exp_f32 v122, v122
    v_exp_f32 v123, v123
    v_smfmac_f32_16x16x64_bf16 v[28:31], v[20:23], v[96:103], v24
    global_load_dwordx4 a[140:143], v1, s[14:15] offset:-1024
    v_exp_f32 v124, v124
    v_exp_f32 v125, v125
    v_smfmac_f32_16x16x64_bf16 v[28:31], v[20:23], v[104:111], v24
    global_load_dwordx4 a[144:147], v1, s[14:15] offset:0
    v_exp_f32 v126, v126
    v_exp_f32 v127, v127
    v_mfma_f32_32x32x16_bf16 v[96:111], a[192:195], a[184:187], v[240:255]
    v_exp_f32 v80, v80
    v_exp_f32 v81, v81
    v_exp_f32 v82, v82
    v_mfma_f32_32x32x16_bf16 v[96:111], a[196:199], a[188:191], v[96:111]
    v_exp_f32 v83, v83
    v_exp_f32 v84, v84
    v_exp_f32 v85, v85
    v_smfmac_f32_32x32x32_bf16 v[176:191], a[232:235], v[112:119], v24
    v_exp_f32 v86, v86
    v_exp_f32 v87, v87
    v_exp_f32 v88, v88
    v_smfmac_f32_32x32x32_bf16 v[176:191], a[236:239], v[120:127], v24
    s_waitcnt vmcnt(7)
    v_exp_f32 v89, v89
    v_exp_f32 v90, v90
    v_exp_f32 v91, v91
    v_smfmac_f32_16x16x64_bf16 v[32:35], v[20:23], v[112:119], v24
    global_load_dwordx4 a[148:151], v1, s[14:15] offset:1024
    v_exp_f32 v92, v92
    v_exp_f32 v93, v93
    v_smfmac_f32_16x16x64_bf16 v[32:35], v[20:23], v[120:127], v24
    global_load_dwordx4 a[152:155], v1, s[14:15] offset:2048
    global_load_dwordx4 a[156:159], v1, s[14:15] offset:3072
    v_exp_f32 v94, v94
    v_exp_f32 v95, v95
    v_mfma_f32_32x32x16_bf16 v[112:127], a[200:203], a[176:179], v[224:239]
    v_exp_f32 v96, v96
    v_exp_f32 v97, v97
    v_exp_f32 v98, v98
    v_mfma_f32_32x32x16_bf16 v[112:127], a[204:207], a[180:183], v[112:127]
    s_xor_b32 s29, s0, 32768
    v_exp_f32 v99, v99
    v_exp_f32 v100, v100
    v_exp_f32 v101, v101
    v_smfmac_f32_32x32x32_bf16 a[0:15], a[216:219], v[80:87], v24
    s_add_u32 s12, s60, s29
    v_exp_f32 v102, v102
    v_exp_f32 v103, v103
    v_exp_f32 v104, v104
    v_smfmac_f32_32x32x32_bf16 a[0:15], a[220:223], v[88:95], v24
    s_addc_u32 s13, s61, 0
    v_exp_f32 v105, v105
    v_exp_f32 v106, v106
    v_exp_f32 v107, v107
    v_smfmac_f32_16x16x64_bf16 v[48:51], v[20:23], v[80:87], v24
    global_load_dwordx4 a[240:243], v1, s[12:13] offset:-4096
    v_exp_f32 v108, v108
    v_exp_f32 v109, v109
    v_smfmac_f32_16x16x64_bf16 v[48:51], v[20:23], v[88:95], v24
    global_load_dwordx4 a[244:247], v1, s[12:13] offset:-3072
    global_load_dwordx4 a[248:251], v1, s[12:13] offset:-2048
    v_exp_f32 v110, v110
    v_exp_f32 v111, v111
    v_mfma_f32_32x32x16_bf16 v[80:95], a[200:203], a[184:187], v[240:255]
    v_exp_f32 v112, v112
    v_exp_f32 v113, v113
    v_exp_f32 v114, v114
    v_mfma_f32_32x32x16_bf16 v[80:95], a[204:207], a[188:191], v[80:95]
    v_exp_f32 v115, v115
    v_exp_f32 v116, v116
    v_exp_f32 v117, v117
    v_smfmac_f32_32x32x32_bf16 a[16:31], a[216:219], v[96:103], v24
    v_exp_f32 v118, v118
    v_exp_f32 v119, v119
    v_exp_f32 v120, v120
    v_smfmac_f32_32x32x32_bf16 a[16:31], a[220:223], v[104:111], v24
    s_waitcnt vmcnt(9)
    v_exp_f32 v121, v121
    v_exp_f32 v122, v122
    v_exp_f32 v123, v123
    v_smfmac_f32_16x16x64_bf16 v[52:55], v[20:23], v[96:103], v24
    global_load_dwordx4 a[252:255], v1, s[12:13] offset:-1024
    v_exp_f32 v124, v124
    v_exp_f32 v125, v125
    v_smfmac_f32_16x16x64_bf16 v[52:55], v[20:23], v[104:111], v24
    global_load_dwordx4 v[36:39], v1, s[12:13] offset:0
    global_load_dwordx4 v[40:43], v1, s[12:13] offset:1024
    v_exp_f32 v126, v126
    v_exp_f32 v127, v127
    v_mfma_f32_32x32x16_bf16 v[96:111], a[192:195], a[160:163], v[128:143]
    v_exp_f32 v80, v80
    v_exp_f32 v81, v81
    v_exp_f32 v82, v82
    v_mfma_f32_32x32x16_bf16 v[96:111], a[196:199], a[164:167], v[96:111]
    s_xor_b32 s29, s0, 40960
    v_exp_f32 v83, v83
    v_exp_f32 v84, v84
    v_exp_f32 v85, v85
    v_smfmac_f32_32x32x32_bf16 a[0:15], a[224:227], v[112:119], v24
    s_add_u32 s14, s60, s29
    v_exp_f32 v86, v86
    v_exp_f32 v87, v87
    v_exp_f32 v88, v88
    v_smfmac_f32_32x32x32_bf16 a[0:15], a[228:231], v[120:127], v24
    s_addc_u32 s15, s61, 0
    v_exp_f32 v89, v89
    v_exp_f32 v90, v90
    v_exp_f32 v91, v91
    v_smfmac_f32_16x16x64_bf16 v[48:51], v[20:23], v[112:119], v24
    global_load_dwordx4 v[76:79], v1, s[12:13] offset:2048
    v_exp_f32 v92, v92
    v_exp_f32 v93, v93
    v_smfmac_f32_16x16x64_bf16 v[48:51], v[20:23], v[120:127], v24
    global_load_dwordx4 a[208:211], v1, s[12:13] offset:3072
    global_load_dwordx4 a[212:215], v1, s[14:15] offset:-4096
    v_exp_f32 v94, v94
    v_exp_f32 v95, v95
    v_mfma_f32_32x32x16_bf16 v[112:127], a[192:195], a[168:171], v[144:159]
    v_exp_f32 v96, v96
    v_exp_f32 v97, v97
    v_exp_f32 v98, v98
    v_mfma_f32_32x32x16_bf16 v[112:127], a[196:199], a[172:175], v[112:127]
    v_exp_f32 v99, v99
    v_exp_f32 v100, v100
    v_exp_f32 v101, v101
    v_smfmac_f32_32x32x32_bf16 a[16:31], a[224:227], v[80:87], v24
    ds_write_b128 v56, a[0:3] offset:0
    v_exp_f32 v102, v102
    v_exp_f32 v103, v103
    v_exp_f32 v104, v104
    v_smfmac_f32_32x32x32_bf16 a[16:31], a[228:231], v[88:95], v24
    ds_write_b128 v56, a[4:7] offset:1024
    v_exp_f32 v105, v105
    v_exp_f32 v106, v106
    v_exp_f32 v107, v107
    v_smfmac_f32_16x16x64_bf16 v[52:55], v[20:23], v[80:87], v24
    ds_write_b128 v56, a[8:11] offset:2048
    v_exp_f32 v108, v108
    v_exp_f32 v109, v109
    v_smfmac_f32_16x16x64_bf16 v[52:55], v[20:23], v[88:95], v24
    ds_write_b128 v56, a[12:15] offset:3072
    global_load_dwordx4 a[232:235], v1, s[14:15] offset:-3072
    global_load_dwordx4 a[236:239], v1, s[14:15] offset:-2048
    global_load_dwordx4 a[176:179], v1, s[14:15] offset:-1024
    v_exp_f32 v110, v110
    v_exp_f32 v111, v111
    v_mfma_f32_32x32x16_bf16 v[80:95], a[200:203], a[160:163], v[128:143]
    v_exp_f32 v112, v112
    v_exp_f32 v113, v113
    v_exp_f32 v114, v114
    v_mfma_f32_32x32x16_bf16 v[80:95], a[204:207], a[164:167], v[80:95]
    v_exp_f32 v115, v115
    v_exp_f32 v116, v116
    v_exp_f32 v117, v117
    v_smfmac_f32_32x32x32_bf16 v[160:175], a[216:219], v[96:103], v24
    ds_write_b128 v56, a[16:19] offset:4096
    v_exp_f32 v118, v118
    v_exp_f32 v119, v119
    v_exp_f32 v120, v120
    v_smfmac_f32_32x32x32_bf16 v[160:175], a[220:223], v[104:111], v24
    ds_write_b128 v56, a[20:23] offset:5120
    v_exp_f32 v121, v121
    v_exp_f32 v122, v122
    v_exp_f32 v123, v123
    v_smfmac_f32_16x16x64_bf16 v[28:31], v[20:23], v[96:103], v24
    ds_write_b128 v56, a[24:27] offset:6144
    v_exp_f32 v124, v124
    v_exp_f32 v125, v125
    v_smfmac_f32_16x16x64_bf16 v[28:31], v[20:23], v[104:111], v24
    ds_write_b128 v56, a[28:31] offset:7168
    global_load_dwordx4 a[180:183], v1, s[14:15] offset:0
    global_load_dwordx4 a[184:187], v1, s[14:15] offset:1024
    global_load_dwordx4 a[188:191], v1, s[14:15] offset:2048
    v_exp_f32 v126, v126
    v_exp_f32 v127, v127
    v_mfma_f32_32x32x16_bf16 v[96:111], a[200:203], a[168:171], v[144:159]
    ds_write2_b32 v58, v48, v52 offset1:1
    v_exp_f32 v80, v80
    v_exp_f32 v81, v81
    v_exp_f32 v82, v82
    v_mfma_f32_32x32x16_bf16 v[96:111], a[204:207], a[172:175], v[96:111]
    s_xor_b32 s29, s0, 49152
    v_exp_f32 v83, v83
    v_exp_f32 v84, v84
    v_exp_f32 v85, v85
    v_smfmac_f32_32x32x32_bf16 v[176:191], a[216:219], v[112:119], v24
    s_add_u32 s12, s60, s29
    v_exp_f32 v86, v86
    v_exp_f32 v87, v87
    v_exp_f32 v88, v88
    v_smfmac_f32_32x32x32_bf16 v[176:191], a[220:223], v[120:127], v24
    s_addc_u32 s13, s61, 0
    s_waitcnt lgkmcnt(0)
    s_barrier
    v_exp_f32 v89, v89
    v_exp_f32 v90, v90
    v_exp_f32 v91, v91
    v_smfmac_f32_16x16x64_bf16 v[32:35], v[20:23], v[112:119], v24
    ds_read_b64 v[60:61], v59
    v_exp_f32 v92, v92
    v_exp_f32 v93, v93
    v_smfmac_f32_16x16x64_bf16 v[32:35], v[20:23], v[120:127], v24
    ds_read_b128 v[192:195], v57 offset:0
    global_load_dwordx4 a[192:195], v1, s[14:15] offset:3072
    global_load_dwordx4 a[196:199], v1, s[12:13] offset:-4096
    global_load_dwordx4 a[200:203], v1, s[12:13] offset:-3072
    v_exp_f32 v94, v94
    v_exp_f32 v95, v95
    ds_read_b128 v[196:199], v57 offset:1024
    ds_read_b128 v[200:203], v57 offset:2048
    v_exp_f32 v96, v96
    v_exp_f32 v97, v97
    v_exp_f32 v98, v98
    ds_read_b128 v[204:207], v57 offset:3072
    v_exp_f32 v99, v99
    v_exp_f32 v100, v100
    v_exp_f32 v101, v101
    v_smfmac_f32_32x32x32_bf16 v[160:175], a[224:227], v[80:87], v24
    ds_read_b128 v[208:211], v57 offset:4096
    v_exp_f32 v102, v102
    v_exp_f32 v103, v103
    v_exp_f32 v104, v104
    v_smfmac_f32_32x32x32_bf16 v[160:175], a[228:231], v[88:95], v24
    ds_read_b128 v[212:215], v57 offset:5120
    v_exp_f32 v105, v105
    v_exp_f32 v106, v106
    v_exp_f32 v107, v107
    v_smfmac_f32_16x16x64_bf16 v[28:31], v[20:23], v[80:87], v24
    ds_read_b128 v[216:219], v57 offset:6144
    v_exp_f32 v108, v108
    v_exp_f32 v109, v109
    v_smfmac_f32_16x16x64_bf16 v[28:31], v[20:23], v[88:95], v24
    ds_read_b128 v[220:223], v57 offset:7168
    global_load_dwordx4 a[204:207], v1, s[12:13] offset:-2048
    global_load_dwordx4 a[216:219], v1, s[12:13] offset:-1024
    global_load_dwordx4 a[220:223], v1, s[12:13] offset:0
    v_exp_f32 v110, v110
    v_exp_f32 v111, v111
    v_smfmac_f32_32x32x32_bf16 v[176:191], a[224:227], v[96:103], v24
    v_xor_b32 v64, 0, v47
    v_xor_b32 v65, 32, v47
    v_xor_b32 v66, 64, v47
    v_xor_b32 v67, 96, v47
    v_smfmac_f32_32x32x32_bf16 v[176:191], a[228:231], v[104:111], v24
    ds_read_b64_tr_b16 v[224:225], v64 offset:4096
    ds_read_b64_tr_b16 v[226:227], v64 offset:5120
    ds_read_b64_tr_b16 v[228:229], v64 offset:8192
    ds_read_b64_tr_b16 v[230:231], v64 offset:9216
    ds_read_b64_tr_b16 v[232:233], v65 offset:4096
    ds_read_b64_tr_b16 v[234:235], v65 offset:5120
    v_smfmac_f32_16x16x64_bf16 v[32:35], v[20:23], v[96:103], v24
    ds_read_b64_tr_b16 v[236:237], v65 offset:8192
    ds_read_b64_tr_b16 v[238:239], v65 offset:9216
    v_smfmac_f32_16x16x64_bf16 v[32:35], v[20:23], v[104:111], v24
    ds_read_b64_tr_b16 v[240:241], v66 offset:4096
    ds_read_b64_tr_b16 v[242:243], v66 offset:5120
    ds_read_b64_tr_b16 v[244:245], v66 offset:8192
    ds_read_b64_tr_b16 v[246:247], v66 offset:9216
    ds_read_b64_tr_b16 v[248:249], v67 offset:4096
    ds_read_b64_tr_b16 v[250:251], v67 offset:5120
    ds_read_b64_tr_b16 v[252:253], v67 offset:8192
    ds_read_b64_tr_b16 v[254:255], v67 offset:9216
    s_waitcnt lgkmcnt(14)
    v_add_f32 v6, v28, v60
    v_pk_add_f32 v[160:161], v[160:161], v[192:193]
    v_pk_add_f32 v[162:163], v[162:163], v[194:195]
    v_pk_add_f32 v[164:165], v[164:165], v[196:197]
    v_pk_add_f32 v[166:167], v[166:167], v[198:199]
    v_pk_add_f32 v[168:169], v[168:169], v[200:201]
    v_pk_add_f32 v[170:171], v[170:171], v[202:203]
    v_pk_add_f32 v[172:173], v[172:173], v[204:205]
    v_pk_add_f32 v[174:175], v[174:175], v[206:207]
    v_maximum3_f32 v7, abs(v160), abs(v161), abs(v162)
    v_maximum3_f32 v8, abs(v163), abs(v164), abs(v165)
    v_maximum3_f32 v8, abs(v166), abs(v167), v8
    v_maximum3_f32 v7, abs(v168), abs(v169), v7
    v_maximum3_f32 v8, abs(v170), abs(v171), v8
    v_maximum3_f32 v7, abs(v172), abs(v173), v7
    v_maximum3_f32 v8, abs(v174), abs(v175), v8
    v_maximum3_f32 v7, v7, v8, v8
    v_maximum3_f32 v8, v7, v6, v6
    v_cmp_nlt_f32 vcc, 0xb800000, v7
    s_mov_b64 s[10:11], vcc
    v_cmp_ngt_f32 vcc, 0x7e000000, v8
    s_or_b64 vcc, vcc, s[10:11]
    s_cbranch_vccnz fb_fix0
fb_ok0:
    v_rcp_f32 v6, v6
    s_add_u32 s34, s53, 0x0
    v_pk_mul_f32 v[160:161], v[6:7], v[160:161] op_sel_hi:[0,1]
    v_pk_mul_f32 v[162:163], v[6:7], v[162:163] op_sel_hi:[0,1]
    v_pk_mul_f32 v[164:165], v[6:7], v[164:165] op_sel_hi:[0,1]
    v_pk_mul_f32 v[166:167], v[6:7], v[166:167] op_sel_hi:[0,1]
    v_pk_mul_f32 v[168:169], v[6:7], v[168:169] op_sel_hi:[0,1]
    v_pk_mul_f32 v[170:171], v[6:7], v[170:171] op_sel_hi:[0,1]
    v_pk_mul_f32 v[172:173], v[6:7], v[172:173] op_sel_hi:[0,1]
    v_pk_mul_f32 v[174:175], v[6:7], v[174:175] op_sel_hi:[0,1]
    v_cvt_pk_bf16_f32 v160, v160, v161
    v_cvt_pk_bf16_f32 v161, v162, v163
    v_cvt_pk_bf16_f32 v162, v164, v165
    v_cvt_pk_bf16_f32 v163, v166, v167
    v_cvt_pk_bf16_f32 v164, v168, v169
    v_cvt_pk_bf16_f32 v165, v170, v171
    v_cvt_pk_bf16_f32 v166, v172, v173
    v_cvt_pk_bf16_f32 v167, v174, v175
    buffer_store_dwordx4 v[160:163], v3, s[20:23], s34 offen offset:0 sc1
    buffer_store_dwordx4 v[164:167], v3, s[20:23], s34 offen offset:256 sc1
    v_add_f32 v6, v32, v61
    v_pk_add_f32 v[176:177], v[176:177], v[208:209]
    v_pk_add_f32 v[178:179], v[178:179], v[210:211]
    v_pk_add_f32 v[180:181], v[180:181], v[212:213]
    v_pk_add_f32 v[182:183], v[182:183], v[214:215]
    v_pk_add_f32 v[184:185], v[184:185], v[216:217]
    v_pk_add_f32 v[186:187], v[186:187], v[218:219]
    v_pk_add_f32 v[188:189], v[188:189], v[220:221]
    v_pk_add_f32 v[190:191], v[190:191], v[222:223]
    v_maximum3_f32 v7, abs(v176), abs(v177), abs(v178)
    v_maximum3_f32 v8, abs(v179), abs(v180), abs(v181)
    v_maximum3_f32 v8, abs(v182), abs(v183), v8
    v_maximum3_f32 v7, abs(v184), abs(v185), v7
    v_maximum3_f32 v8, abs(v186), abs(v187), v8
    v_maximum3_f32 v7, abs(v188), abs(v189), v7
    v_maximum3_f32 v8, abs(v190), abs(v191), v8
    v_maximum3_f32 v7, v7, v8, v8
    v_maximum3_f32 v8, v7, v6, v6
    v_cmp_nlt_f32 vcc, 0xb800000, v7
    s_mov_b64 s[10:11], vcc
    v_cmp_ngt_f32 vcc, 0x7e000000, v8
    s_or_b64 vcc, vcc, s[10:11]
    s_cbranch_vccnz fb_fix1
fb_ok1:
    v_rcp_f32 v6, v6
    s_add_u32 s34, s53, 0x10000
    v_pk_mul_f32 v[176:177], v[6:7], v[176:177] op_sel_hi:[0,1]
    v_pk_mul_f32 v[178:179], v[6:7], v[178:179] op_sel_hi:[0,1]
    v_pk_mul_f32 v[180:181], v[6:7], v[180:181] op_sel_hi:[0,1]
    v_pk_mul_f32 v[182:183], v[6:7], v[182:183] op_sel_hi:[0,1]
    v_pk_mul_f32 v[184:185], v[6:7], v[184:185] op_sel_hi:[0,1]
    v_pk_mul_f32 v[186:187], v[6:7], v[186:187] op_sel_hi:[0,1]
    v_pk_mul_f32 v[188:189], v[6:7], v[188:189] op_sel_hi:[0,1]
    v_pk_mul_f32 v[190:191], v[6:7], v[190:191] op_sel_hi:[0,1]
    v_cvt_pk_bf16_f32 v176, v176, v177
    v_cvt_pk_bf16_f32 v177, v178, v179
    v_cvt_pk_bf16_f32 v178, v180, v181
    v_cvt_pk_bf16_f32 v179, v182, v183
    v_cvt_pk_bf16_f32 v180, v184, v185
    v_cvt_pk_bf16_f32 v181, v186, v187
    v_cvt_pk_bf16_f32 v182, v188, v189
    v_cvt_pk_bf16_f32 v183, v190, v191
    buffer_store_dwordx4 v[176:179], v3, s[20:23], s34 offen offset:0 sc1
    buffer_store_dwordx4 v[180:183], v3, s[20:23], s34 offen offset:256 sc1
    s_waitcnt lgkmcnt(12)
    v_mfma_f32_16x16x32_bf16 v[80:83], v[224:227], a[32:35], 0
    ds_read_b64_tr_b16 v[192:193], v64 offset:12288
    v_add_u32 v68, 0x10000, v64
    v_mfma_f32_16x16x32_bf16 v[80:83], v[228:231], a[40:43], v[80:83]
    ds_read_b64_tr_b16 v[194:195], v64 offset:13312
    v_add_u32 v69, 0x10000, v65
    v_mfma_f32_16x16x32_bf16 v[96:99], v[224:227], a[36:39], 0
    ds_read_b64_tr_b16 v[196:197], v64 offset:16384
    v_add_u32 v70, 0x10000, v66
    v_mfma_f32_16x16x32_bf16 v[96:99], v[228:231], a[44:47], v[96:99]
    s_waitcnt lgkmcnt(11)
    ds_read_b64_tr_b16 v[198:199], v64 offset:17408
    v_add_u32 v71, 0x10000, v67
    v_mfma_f32_16x16x32_bf16 v[84:87], v[232:235], a[32:35], 0
    ds_read_b64_tr_b16 v[200:201], v65 offset:12288
    v_add_u32 v72, 0x20000, v64
    v_mfma_f32_16x16x32_bf16 v[84:87], v[236:239], a[40:43], v[84:87]
    ds_read_b64_tr_b16 v[202:203], v65 offset:13312
    v_add_u32 v73, 0x20000, v65
    v_mfma_f32_16x16x32_bf16 v[100:103], v[232:235], a[36:39], 0
    ds_read_b64_tr_b16 v[204:205], v65 offset:16384
    global_load_dwordx4 a[224:227], v1, s[12:13] offset:1024
    v_mfma_f32_16x16x32_bf16 v[100:103], v[236:239], a[44:47], v[100:103]
    s_waitcnt lgkmcnt(11)
    ds_read_b64_tr_b16 v[206:207], v65 offset:17408
    v_add_u32 v74, 0x20000, v66
    v_mfma_f32_16x16x32_bf16 v[88:91], v[240:243], a[32:35], 0
    ds_read_b64_tr_b16 v[208:209], v66 offset:12288
    v_add_u32 v75, 0x20000, v67
    v_mfma_f32_16x16x32_bf16 v[88:91], v[244:247], a[40:43], v[88:91]
    ds_read_b64_tr_b16 v[210:211], v66 offset:13312
    v_xor_b32 v12, 32, v10
    v_mfma_f32_16x16x32_bf16 v[104:107], v[240:243], a[36:39], 0
    ds_read_b64_tr_b16 v[212:213], v66 offset:16384
    global_load_dwordx4 a[228:231], v1, s[12:13] offset:2048
    v_mfma_f32_16x16x32_bf16 v[104:107], v[244:247], a[44:47], v[104:107]
    s_waitcnt lgkmcnt(11)
    ds_read_b64_tr_b16 v[214:215], v66 offset:17408
    v_xor_b32 v13, 64, v10
    v_mfma_f32_16x16x32_bf16 v[92:95], v[248:251], a[32:35], 0
    ds_read_b64_tr_b16 v[216:217], v67 offset:12288
    v_xor_b32 v14, 96, v10
    v_mfma_f32_16x16x32_bf16 v[92:95], v[252:255], a[40:43], v[92:95]
    ds_read_b64_tr_b16 v[218:219], v67 offset:13312
    v_lshrrev_b32 v6, 3, v2
    v_mfma_f32_16x16x32_bf16 v[108:111], v[248:251], a[36:39], 0
    ds_read_b64_tr_b16 v[220:221], v67 offset:16384
    global_load_dwordx4 a[0:3], v1, s[12:13] offset:3072
    v_mfma_f32_16x16x32_bf16 v[108:111], v[252:255], a[44:47], v[108:111]
    s_waitcnt lgkmcnt(11)
    ds_read_b64_tr_b16 v[222:223], v67 offset:17408
    v_and_b32 v7, 0x70, v1
    s_barrier
    v_mfma_f32_16x16x32_bf16 v[80:83], v[192:195], a[48:51], v[80:83]
    s_xor_b32 s28, s1, 0x1f0000
    ds_read_b64_tr_b16 v[224:225], v64 offset:20480
    s_add_u32 m0, s30, 0
    v_mfma_f32_16x16x32_bf16 v[80:83], v[196:199], a[56:59], v[80:83]
    s_add_u32 s46, s42, s28
    ds_read_b64_tr_b16 v[226:227], v64 offset:21504
    v_lshl_add_u32 v15, v6, 12, v7
    v_mfma_f32_16x16x32_bf16 v[96:99], v[192:195], a[52:55], v[96:99]
    s_addc_u32 s47, s43, 0
    ds_read_b64_tr_b16 v[228:229], v64 offset:24576
    global_load_lds_dwordx4 v9, s[46:47]
    v_mfma_f32_16x16x32_bf16 v[96:99], v[196:199], a[60:63], v[96:99]
    s_waitcnt lgkmcnt(11)
    ds_read_b64_tr_b16 v[230:231], v64 offset:25600
    v_lshrrev_b32 v6, 2, v2
    v_mfma_f32_16x16x32_bf16 v[84:87], v[200:203], a[48:51], v[84:87]
    ds_read_b64_tr_b16 v[232:233], v65 offset:20480
    v_and_b32 v7, 0x30, v1
    v_mfma_f32_16x16x32_bf16 v[84:87], v[204:207], a[56:59], v[84:87]
    ds_read_b64_tr_b16 v[234:235], v65 offset:21504
    v_lshl_add_u32 v16, v6, 12, v7
    v_mfma_f32_16x16x32_bf16 v[100:103], v[200:203], a[52:55], v[100:103]
    ds_read_b64_tr_b16 v[236:237], v65 offset:24576
    s_waitcnt vmcnt(4)
    buffer_store_dword v24, v25, s[20:23], s54 offen offset:512 sc1
    v_mfma_f32_16x16x32_bf16 v[100:103], v[204:207], a[60:63], v[100:103]
    s_waitcnt lgkmcnt(11)
    ds_read_b64_tr_b16 v[238:239], v65 offset:25600
    v_and_b32 v8, 7, v6
    v_mfma_f32_16x16x32_bf16 v[88:91], v[208:211], a[48:51], v[88:91]
    s_xor_b32 s28, s1, 0x0
    ds_read_b64_tr_b16 v[240:241], v66 offset:20480
    s_add_u32 m0, s30, 131072
    v_mfma_f32_16x16x32_bf16 v[88:91], v[212:215], a[56:59], v[88:91]
    s_add_u32 s46, s44, s28
    ds_read_b64_tr_b16 v[242:243], v66 offset:21504
    v_lshlrev_b32 v8, 4, v8
    v_mfma_f32_16x16x32_bf16 v[104:107], v[208:211], a[52:55], v[104:107]
    s_addc_u32 s47, s45, 0
    ds_read_b64_tr_b16 v[244:245], v66 offset:24576
    global_load_lds_dwordx4 v9, s[46:47]
    v_mfma_f32_16x16x32_bf16 v[104:107], v[212:215], a[60:63], v[104:107]
    s_waitcnt lgkmcnt(11)
    ds_read_b64_tr_b16 v[246:247], v66 offset:25600
    v_xor_b32 v7, v7, v8
    v_mfma_f32_16x16x32_bf16 v[92:95], v[216:219], a[48:51], v[92:95]
    s_xor_b32 s28, s1, 0x10000
    ds_read_b64_tr_b16 v[248:249], v67 offset:20480
    s_add_u32 m0, s30, 135168
    v_mfma_f32_16x16x32_bf16 v[92:95], v[220:223], a[56:59], v[92:95]
    s_add_u32 s46, s44, s28
    ds_read_b64_tr_b16 v[250:251], v67 offset:21504
    v_lshl_add_u32 v7, v6, 7, v7
    v_mfma_f32_16x16x32_bf16 v[108:111], v[216:219], a[52:55], v[108:111]
    s_addc_u32 s47, s45, 0
    ds_read_b64_tr_b16 v[252:253], v67 offset:24576
    global_load_lds_dwordx4 v9, s[46:47]
    v_mfma_f32_16x16x32_bf16 v[108:111], v[220:223], a[60:63], v[108:111]
    s_waitcnt lgkmcnt(11)
    ds_read_b64_tr_b16 v[254:255], v67 offset:25600
    v_and_b32 v8, 0xfffff000, v10
    v_mfma_f32_16x16x32_bf16 v[80:83], v[224:227], a[64:67], v[80:83]
    s_xor_b32 s29, s0, 57344
    ds_read_b64_tr_b16 v[192:193], v64 offset:28672
    v_add_u32 v17, v7, v8
    v_mfma_f32_16x16x32_bf16 v[80:83], v[228:231], a[72:75], v[80:83]
    s_add_u32 s14, s60, s29
    ds_read_b64_tr_b16 v[194:195], v64 offset:29696
    v_xor_b32 v18, 64, v17
    v_mfma_f32_16x16x32_bf16 v[96:99], v[224:227], a[68:71], v[96:99]
    s_addc_u32 s15, s61, 0
    ds_read_b64_tr_b16 v[196:197], v64 offset:32768
    global_load_dwordx4 a[4:7], v1, s[14:15] offset:-4096
    v_mfma_f32_16x16x32_bf16 v[96:99], v[228:231], a[76:79], v[96:99]
    s_waitcnt lgkmcnt(11)
    ds_read_b64_tr_b16 v[198:199], v64 offset:33792
    v_mfma_f32_16x16x32_bf16 v[84:87], v[232:235], a[64:67], v[84:87]
    ds_read_b64_tr_b16 v[200:201], v65 offset:28672
    v_mfma_f32_16x16x32_bf16 v[84:87], v[236:239], a[72:75], v[84:87]
    ds_read_b64_tr_b16 v[202:203], v65 offset:29696
    v_mfma_f32_16x16x32_bf16 v[100:103], v[232:235], a[68:71], v[100:103]
    ds_read_b64_tr_b16 v[204:205], v65 offset:32768
    global_load_dwordx4 a[8:11], v1, s[14:15] offset:-3072
    v_mfma_f32_16x16x32_bf16 v[100:103], v[236:239], a[76:79], v[100:103]
    s_waitcnt lgkmcnt(11)
    ds_read_b64_tr_b16 v[206:207], v65 offset:33792
    v_mfma_f32_16x16x32_bf16 v[88:91], v[240:243], a[64:67], v[88:91]
    ds_read_b64_tr_b16 v[208:209], v66 offset:28672
    v_mfma_f32_16x16x32_bf16 v[88:91], v[244:247], a[72:75], v[88:91]
    ds_read_b64_tr_b16 v[210:211], v66 offset:29696
    v_mfma_f32_16x16x32_bf16 v[104:107], v[240:243], a[68:71], v[104:107]
    ds_read_b64_tr_b16 v[212:213], v66 offset:32768
    global_load_dwordx4 a[12:15], v1, s[14:15] offset:-2048
    v_mfma_f32_16x16x32_bf16 v[104:107], v[244:247], a[76:79], v[104:107]
    s_waitcnt lgkmcnt(11)
    ds_read_b64_tr_b16 v[214:215], v66 offset:33792
    v_mfma_f32_16x16x32_bf16 v[92:95], v[248:251], a[64:67], v[92:95]
    ds_read_b64_tr_b16 v[216:217], v67 offset:28672
    v_mfma_f32_16x16x32_bf16 v[92:95], v[252:255], a[72:75], v[92:95]
    ds_read_b64_tr_b16 v[218:219], v67 offset:29696
    v_mfma_f32_16x16x32_bf16 v[108:111], v[248:251], a[68:71], v[108:111]
    ds_read_b64_tr_b16 v[220:221], v67 offset:32768
    global_load_dwordx4 a[16:19], v1, s[14:15] offset:-1024
    v_mfma_f32_16x16x32_bf16 v[108:111], v[252:255], a[76:79], v[108:111]
    s_waitcnt lgkmcnt(11)
    ds_read_b64_tr_b16 v[222:223], v67 offset:33792
    v_mfma_f32_16x16x32_bf16 v[80:83], v[192:195], a[80:83], v[80:83]
    ds_read_b64_tr_b16 v[224:225], v64 offset:36864
    v_mfma_f32_16x16x32_bf16 v[80:83], v[196:199], a[88:91], v[80:83]
    ds_read_b64_tr_b16 v[226:227], v64 offset:37888
    v_mfma_f32_16x16x32_bf16 v[96:99], v[192:195], a[84:87], v[96:99]
    ds_read_b64_tr_b16 v[228:229], v64 offset:40960
    global_load_dwordx4 a[20:23], v1, s[14:15] offset:0
    v_mfma_f32_16x16x32_bf16 v[96:99], v[196:199], a[92:95], v[96:99]
    s_waitcnt lgkmcnt(11)
    ds_read_b64_tr_b16 v[230:231], v64 offset:41984
    v_mfma_f32_16x16x32_bf16 v[84:87], v[200:203], a[80:83], v[84:87]
    ds_read_b64_tr_b16 v[232:233], v65 offset:36864
    v_mfma_f32_16x16x32_bf16 v[84:87], v[204:207], a[88:91], v[84:87]
    ds_read_b64_tr_b16 v[234:235], v65 offset:37888
    v_mfma_f32_16x16x32_bf16 v[100:103], v[200:203], a[84:87], v[100:103]
    ds_read_b64_tr_b16 v[236:237], v65 offset:40960
    global_load_dwordx4 a[24:27], v1, s[14:15] offset:1024
    v_mfma_f32_16x16x32_bf16 v[100:103], v[204:207], a[92:95], v[100:103]
    s_waitcnt lgkmcnt(11)
    ds_read_b64_tr_b16 v[238:239], v65 offset:41984
    v_mfma_f32_16x16x32_bf16 v[88:91], v[208:211], a[80:83], v[88:91]
    ds_read_b64_tr_b16 v[240:241], v66 offset:36864
    v_mfma_f32_16x16x32_bf16 v[88:91], v[212:215], a[88:91], v[88:91]
    ds_read_b64_tr_b16 v[242:243], v66 offset:37888
    v_mfma_f32_16x16x32_bf16 v[104:107], v[208:211], a[84:87], v[104:107]
    ds_read_b64_tr_b16 v[244:245], v66 offset:40960
    global_load_dwordx4 a[28:31], v1, s[14:15] offset:2048
    v_mfma_f32_16x16x32_bf16 v[104:107], v[212:215], a[92:95], v[104:107]
    s_waitcnt lgkmcnt(11)
    ds_read_b64_tr_b16 v[246:247], v66 offset:41984
    v_mfma_f32_16x16x32_bf16 v[92:95], v[216:219], a[80:83], v[92:95]
    ds_read_b64_tr_b16 v[248:249], v67 offset:36864
    v_mfma_f32_16x16x32_bf16 v[92:95], v[220:223], a[88:91], v[92:95]
    ds_read_b64_tr_b16 v[250:251], v67 offset:37888
    v_mfma_f32_16x16x32_bf16 v[108:111], v[216:219], a[84:87], v[108:111]
    ds_read_b64_tr_b16 v[252:253], v67 offset:40960
    global_load_dwordx4 a[160:163], v1, s[14:15] offset:3072
    v_mfma_f32_16x16x32_bf16 v[108:111], v[220:223], a[92:95], v[108:111]
    s_waitcnt lgkmcnt(11)
    ds_read_b64_tr_b16 v[254:255], v67 offset:41984
    s_barrier
    v_mfma_f32_16x16x32_bf16 v[80:83], v[224:227], a[96:99], v[80:83]
    s_xor_b32 s28, s1, 0x20000
    ds_read_b64_tr_b16 v[192:193], v64 offset:45056
    s_add_u32 m0, s30, 139264
    v_mfma_f32_16x16x32_bf16 v[80:83], v[228:231], a[104:107], v[80:83]
    s_add_u32 s46, s44, s28
    ds_read_b64_tr_b16 v[194:195], v64 offset:46080
    v_mfma_f32_16x16x32_bf16 v[96:99], v[224:227], a[100:103], v[96:99]
    s_addc_u32 s47, s45, 0
    ds_read_b64_tr_b16 v[196:197], v64 offset:49152
    global_load_lds_dwordx4 v9, s[46:47]
    v_mfma_f32_16x16x32_bf16 v[96:99], v[228:231], a[108:111], v[96:99]
    s_waitcnt lgkmcnt(11)
    ds_read_b64_tr_b16 v[198:199], v64 offset:50176
    v_mfma_f32_16x16x32_bf16 v[84:87], v[232:235], a[96:99], v[84:87]
    s_xor_b32 s28, s1, 0x30000
    ds_read_b64_tr_b16 v[200:201], v65 offset:45056
    s_add_u32 m0, s30, 143360
    v_mfma_f32_16x16x32_bf16 v[84:87], v[236:239], a[104:107], v[84:87]
    s_add_u32 s46, s44, s28
    ds_read_b64_tr_b16 v[202:203], v65 offset:46080
    v_mfma_f32_16x16x32_bf16 v[100:103], v[232:235], a[100:103], v[100:103]
    s_addc_u32 s47, s45, 0
    ds_read_b64_tr_b16 v[204:205], v65 offset:49152
    global_load_lds_dwordx4 v9, s[46:47]
    v_mfma_f32_16x16x32_bf16 v[100:103], v[236:239], a[108:111], v[100:103]
    s_waitcnt lgkmcnt(11)
    ds_read_b64_tr_b16 v[206:207], v65 offset:50176
    v_mfma_f32_16x16x32_bf16 v[88:91], v[240:243], a[96:99], v[88:91]
    s_xor_b32 s28, s1, 0x40000
    ds_read_b64_tr_b16 v[208:209], v66 offset:45056
    s_add_u32 m0, s30, 147456
    v_mfma_f32_16x16x32_bf16 v[88:91], v[244:247], a[104:107], v[88:91]
    s_add_u32 s46, s44, s28
    ds_read_b64_tr_b16 v[210:211], v66 offset:46080
    v_mfma_f32_16x16x32_bf16 v[104:107], v[240:243], a[100:103], v[104:107]
    s_addc_u32 s47, s45, 0
    ds_read_b64_tr_b16 v[212:213], v66 offset:49152
    global_load_lds_dwordx4 v9, s[46:47]
    v_mfma_f32_16x16x32_bf16 v[104:107], v[244:247], a[108:111], v[104:107]
hook18:
    s_cbranch_execz hook_end
    s_waitcnt lgkmcnt(11)
    ds_read_b64_tr_b16 v[214:215], v66 offset:50176
    v_mfma_f32_16x16x32_bf16 v[92:95], v[248:251], a[96:99], v[92:95]
    s_xor_b32 s28, s1, 0x50000
    ds_read_b64_tr_b16 v[216:217], v67 offset:45056
    s_add_u32 m0, s30, 151552
    v_mfma_f32_16x16x32_bf16 v[92:95], v[252:255], a[104:107], v[92:95]
    s_add_u32 s46, s44, s28
    ds_read_b64_tr_b16 v[218:219], v67 offset:46080
    v_mfma_f32_16x16x32_bf16 v[108:111], v[248:251], a[100:103], v[108:111]
    s_addc_u32 s47, s45, 0
    ds_read_b64_tr_b16 v[220:221], v67 offset:49152
    global_load_lds_dwordx4 v9, s[46:47]
    v_mfma_f32_16x16x32_bf16 v[108:111], v[252:255], a[108:111], v[108:111]
    s_waitcnt lgkmcnt(11)
    ds_read_b64_tr_b16 v[222:223], v67 offset:50176
    v_mfma_f32_16x16x32_bf16 v[80:83], v[192:195], a[112:115], v[80:83]
    s_xor_b32 s28, s1, 0x60000
    ds_read_b64_tr_b16 v[224:225], v64 offset:53248
    s_add_u32 m0, s30, 155648
    v_mfma_f32_16x16x32_bf16 v[80:83], v[196:199], a[120:123], v[80:83]
    s_add_u32 s46, s44, s28
    ds_read_b64_tr_b16 v[226:227], v64 offset:54272
    v_mfma_f32_16x16x32_bf16 v[96:99], v[192:195], a[116:119], v[96:99]
    s_addc_u32 s47, s45, 0
    ds_read_b64_tr_b16 v[228:229], v64 offset:57344
    global_load_lds_dwordx4 v9, s[46:47]
    v_mfma_f32_16x16x32_bf16 v[96:99], v[196:199], a[124:127], v[96:99]
    s_waitcnt lgkmcnt(11)
    ds_read_b64_tr_b16 v[230:231], v64 offset:58368
    v_mfma_f32_16x16x32_bf16 v[84:87], v[200:203], a[112:115], v[84:87]
    s_xor_b32 s28, s1, 0x70000
    ds_read_b64_tr_b16 v[232:233], v65 offset:53248
    s_add_u32 m0, s30, 159744
    v_mfma_f32_16x16x32_bf16 v[84:87], v[204:207], a[120:123], v[84:87]
    s_add_u32 s46, s44, s28
    ds_read_b64_tr_b16 v[234:235], v65 offset:54272
    v_mfma_f32_16x16x32_bf16 v[100:103], v[200:203], a[116:119], v[100:103]
    s_addc_u32 s47, s45, 0
    ds_read_b64_tr_b16 v[236:237], v65 offset:57344
    global_load_lds_dwordx4 v9, s[46:47]
    v_mfma_f32_16x16x32_bf16 v[100:103], v[204:207], a[124:127], v[100:103]
    s_waitcnt lgkmcnt(11)
    ds_read_b64_tr_b16 v[238:239], v65 offset:58368
    v_mfma_f32_16x16x32_bf16 v[88:91], v[208:211], a[112:115], v[88:91]
    s_xor_b32 s28, s1, 0x80000
    ds_read_b64_tr_b16 v[240:241], v66 offset:53248
    s_add_u32 m0, s30, 4096
    v_mfma_f32_16x16x32_bf16 v[88:91], v[212:215], a[120:123], v[88:91]
    s_add_u32 s46, s44, s28
    ds_read_b64_tr_b16 v[242:243], v66 offset:54272
    v_mfma_f32_16x16x32_bf16 v[104:107], v[208:211], a[116:119], v[104:107]
    s_addc_u32 s47, s45, 0
    ds_read_b64_tr_b16 v[244:245], v66 offset:57344
    global_load_lds_dwordx4 v9, s[46:47]
    v_mfma_f32_16x16x32_bf16 v[104:107], v[212:215], a[124:127], v[104:107]
    s_waitcnt lgkmcnt(11)
    ds_read_b64_tr_b16 v[246:247], v66 offset:58368
    v_mfma_f32_16x16x32_bf16 v[92:95], v[216:219], a[112:115], v[92:95]
    s_xor_b32 s28, s1, 0x90000
    ds_read_b64_tr_b16 v[248:249], v67 offset:53248
    s_add_u32 m0, s30, 8192
    v_mfma_f32_16x16x32_bf16 v[92:95], v[220:223], a[120:123], v[92:95]
    s_add_u32 s46, s44, s28
    ds_read_b64_tr_b16 v[250:251], v67 offset:54272
    v_mfma_f32_16x16x32_bf16 v[108:111], v[216:219], a[116:119], v[108:111]
    s_addc_u32 s47, s45, 0
    ds_read_b64_tr_b16 v[252:253], v67 offset:57344
    global_load_lds_dwordx4 v9, s[46:47]
    v_mfma_f32_16x16x32_bf16 v[108:111], v[220:223], a[124:127], v[108:111]
    s_waitcnt lgkmcnt(11)
    ds_read_b64_tr_b16 v[254:255], v67 offset:58368
    v_mfma_f32_16x16x32_bf16 v[80:83], v[224:227], a[128:131], v[80:83]
    s_xor_b32 s28, s1, 0xa0000
    ds_read_b64_tr_b16 v[192:193], v64 offset:61440
    s_add_u32 m0, s30, 12288
    v_mfma_f32_16x16x32_bf16 v[80:83], v[228:231], a[136:139], v[80:83]
    s_add_u32 s46, s44, s28
    ds_read_b64_tr_b16 v[194:195], v64 offset:62464
    v_mfma_f32_16x16x32_bf16 v[96:99], v[224:227], a[132:135], v[96:99]
    s_addc_u32 s47, s45, 0
    ds_read_b64_tr_b16 v[196:197], v68 offset:0
    global_load_lds_dwordx4 v9, s[46:47]
    v_mfma_f32_16x16x32_bf16 v[96:99], v[228:231], a[140:143], v[96:99]
    s_waitcnt lgkmcnt(11)
    ds_read_b64_tr_b16 v[198:199], v68 offset:1024
    v_mfma_f32_16x16x32_bf16 v[84:87], v[232:235], a[128:131], v[84:87]
    s_xor_b32 s28, s1, 0xb0000
    ds_read_b64_tr_b16 v[200:201], v65 offset:61440
    s_add_u32 m0, s30, 16384
    v_mfma_f32_16x16x32_bf16 v[84:87], v[236:239], a[136:139], v[84:87]
    s_add_u32 s46, s44, s28
    ds_read_b64_tr_b16 v[202:203], v65 offset:62464
    v_mfma_f32_16x16x32_bf16 v[100:103], v[232:235], a[132:135], v[100:103]
    s_addc_u32 s47, s45, 0
    ds_read_b64_tr_b16 v[204:205], v69 offset:0
    global_load_lds_dwordx4 v9, s[46:47]
    v_mfma_f32_16x16x32_bf16 v[100:103], v[236:239], a[140:143], v[100:103]
    s_waitcnt lgkmcnt(11)
    ds_read_b64_tr_b16 v[206:207], v69 offset:1024
    v_mfma_f32_16x16x32_bf16 v[88:91], v[240:243], a[128:131], v[88:91]
    s_xor_b32 s28, s1, 0xc0000
    ds_read_b64_tr_b16 v[208:209], v66 offset:61440
    s_add_u32 m0, s30, 20480
    v_mfma_f32_16x16x32_bf16 v[88:91], v[244:247], a[136:139], v[88:91]
    s_add_u32 s46, s44, s28
    ds_read_b64_tr_b16 v[210:211], v66 offset:62464
    v_mfma_f32_16x16x32_bf16 v[104:107], v[240:243], a[132:135], v[104:107]
    s_addc_u32 s47, s45, 0
    ds_read_b64_tr_b16 v[212:213], v70 offset:0
    global_load_lds_dwordx4 v9, s[46:47]
    v_mfma_f32_16x16x32_bf16 v[104:107], v[244:247], a[140:143], v[104:107]
    s_waitcnt lgkmcnt(11)
    ds_read_b64_tr_b16 v[214:215], v70 offset:1024
    v_mfma_f32_16x16x32_bf16 v[92:95], v[248:251], a[128:131], v[92:95]
    s_xor_b32 s28, s1, 0xd0000
    ds_read_b64_tr_b16 v[216:217], v67 offset:61440
    s_add_u32 m0, s30, 24576
    v_mfma_f32_16x16x32_bf16 v[92:95], v[252:255], a[136:139], v[92:95]
    s_add_u32 s46, s44, s28
    ds_read_b64_tr_b16 v[218:219], v67 offset:62464
    v_mfma_f32_16x16x32_bf16 v[108:111], v[248:251], a[132:135], v[108:111]
    s_addc_u32 s47, s45, 0
    ds_read_b64_tr_b16 v[220:221], v71 offset:0
    global_load_lds_dwordx4 v9, s[46:47]
    v_mfma_f32_16x16x32_bf16 v[108:111], v[252:255], a[140:143], v[108:111]
    s_waitcnt lgkmcnt(11)
    ds_read_b64_tr_b16 v[222:223], v71 offset:1024
    v_mfma_f32_16x16x32_bf16 v[80:83], v[192:195], a[144:147], v[80:83]
    s_xor_b32 s28, s1, 0xe0000
    ds_read_b64_tr_b16 v[224:225], v68 offset:4096
    s_add_u32 m0, s30, 28672
    v_mfma_f32_16x16x32_bf16 v[80:83], v[196:199], a[152:155], v[80:83]
    s_add_u32 s46, s44, s28
    ds_read_b64_tr_b16 v[226:227], v68 offset:5120
    v_mfma_f32_16x16x32_bf16 v[96:99], v[192:195], a[148:151], v[96:99]
    s_addc_u32 s47, s45, 0
    ds_read_b64_tr_b16 v[228:229], v68 offset:8192
    global_load_lds_dwordx4 v9, s[46:47]
    v_mfma_f32_16x16x32_bf16 v[96:99], v[196:199], a[156:159], v[96:99]
    s_waitcnt lgkmcnt(11)
    ds_read_b64_tr_b16 v[230:231], v68 offset:9216
    v_mfma_f32_16x16x32_bf16 v[84:87], v[200:203], a[144:147], v[84:87]
    s_xor_b32 s28, s1, 0xf0000
    ds_read_b64_tr_b16 v[232:233], v69 offset:4096
    s_add_u32 m0, s30, 32768
    v_mfma_f32_16x16x32_bf16 v[84:87], v[204:207], a[152:155], v[84:87]
    s_add_u32 s46, s44, s28
    ds_read_b64_tr_b16 v[234:235], v69 offset:5120
    v_mfma_f32_16x16x32_bf16 v[100:103], v[200:203], a[148:151], v[100:103]
    s_addc_u32 s47, s45, 0
    ds_read_b64_tr_b16 v[236:237], v69 offset:8192
    global_load_lds_dwordx4 v9, s[46:47]
    v_mfma_f32_16x16x32_bf16 v[100:103], v[204:207], a[156:159], v[100:103]
    s_waitcnt lgkmcnt(11)
    ds_read_b64_tr_b16 v[238:239], v69 offset:9216
    v_mfma_f32_16x16x32_bf16 v[88:91], v[208:211], a[144:147], v[88:91]
    ds_read_b64_tr_b16 v[240:241], v70 offset:4096
    v_mfma_f32_16x16x32_bf16 v[88:91], v[212:215], a[152:155], v[88:91]
    ds_read_b64_tr_b16 v[242:243], v70 offset:5120
    v_mfma_f32_16x16x32_bf16 v[104:107], v[208:211], a[148:151], v[104:107]
    ds_read_b64_tr_b16 v[244:245], v70 offset:8192
    v_mfma_f32_16x16x32_bf16 v[104:107], v[212:215], a[156:159], v[104:107]
    s_waitcnt lgkmcnt(11)
    ds_read_b64_tr_b16 v[246:247], v70 offset:9216
    v_mfma_f32_16x16x32_bf16 v[92:95], v[216:219], a[144:147], v[92:95]
    ds_read_b64_tr_b16 v[248:249], v71 offset:4096
    v_mfma_f32_16x16x32_bf16 v[92:95], v[220:223], a[152:155], v[92:95]
    ds_read_b64_tr_b16 v[250:251], v71 offset:5120
    v_mfma_f32_16x16x32_bf16 v[108:111], v[216:219], a[148:151], v[108:111]
    ds_read_b64_tr_b16 v[252:253], v71 offset:8192
    v_mfma_f32_16x16x32_bf16 v[108:111], v[220:223], a[156:159], v[108:111]
    s_waitcnt lgkmcnt(11)
    ds_read_b64_tr_b16 v[254:255], v71 offset:9216
    s_barrier
    v_mfma_f32_16x16x32_bf16 v[80:83], v[224:227], a[240:243], v[80:83]
    s_xor_b32 s28, s1, 0x100000
    ds_read_b64_tr_b16 v[192:193], v68 offset:12288
    s_add_u32 m0, s30, 36864
    v_mfma_f32_16x16x32_bf16 v[80:83], v[228:231], a[248:251], v[80:83]
    s_add_u32 s46, s44, s28
    ds_read_b64_tr_b16 v[194:195], v68 offset:13312
    v_mfma_f32_16x16x32_bf16 v[96:99], v[224:227], a[244:247], v[96:99]
    s_addc_u32 s47, s45, 0
    ds_read_b64_tr_b16 v[196:197], v68 offset:16384
    global_load_lds_dwordx4 v9, s[46:47]
    v_mfma_f32_16x16x32_bf16 v[96:99], v[228:231], a[252:255], v[96:99]
    s_waitcnt lgkmcnt(11)
    ds_read_b64_tr_b16 v[198:199], v68 offset:17408
    v_mfma_f32_16x16x32_bf16 v[84:87], v[232:235], a[240:243], v[84:87]
    s_xor_b32 s28, s1, 0x110000
    ds_read_b64_tr_b16 v[200:201], v69 offset:12288
    s_add_u32 m0, s30, 40960
    v_mfma_f32_16x16x32_bf16 v[84:87], v[236:239], a[248:251], v[84:87]
    s_add_u32 s46, s44, s28
    ds_read_b64_tr_b16 v[202:203], v69 offset:13312
    v_mfma_f32_16x16x32_bf16 v[100:103], v[232:235], a[244:247], v[100:103]
    s_addc_u32 s47, s45, 0
    ds_read_b64_tr_b16 v[204:205], v69 offset:16384
    global_load_lds_dwordx4 v9, s[46:47]
    v_mfma_f32_16x16x32_bf16 v[100:103], v[236:239], a[252:255], v[100:103]
    s_waitcnt lgkmcnt(11)
    ds_read_b64_tr_b16 v[206:207], v69 offset:17408
    v_mfma_f32_16x16x32_bf16 v[88:91], v[240:243], a[240:243], v[88:91]
    s_xor_b32 s28, s1, 0x120000
    ds_read_b64_tr_b16 v[208:209], v70 offset:12288
    s_add_u32 m0, s30, 45056
    v_mfma_f32_16x16x32_bf16 v[88:91], v[244:247], a[248:251], v[88:91]
    s_add_u32 s46, s44, s28
    ds_read_b64_tr_b16 v[210:211], v70 offset:13312
    v_mfma_f32_16x16x32_bf16 v[104:107], v[240:243], a[244:247], v[104:107]
    s_addc_u32 s47, s45, 0
    ds_read_b64_tr_b16 v[212:213], v70 offset:16384
    global_load_lds_dwordx4 v9, s[46:47]
    v_mfma_f32_16x16x32_bf16 v[104:107], v[244:247], a[252:255], v[104:107]
    s_waitcnt lgkmcnt(11)
    ds_read_b64_tr_b16 v[214:215], v70 offset:17408
    v_mfma_f32_16x16x32_bf16 v[92:95], v[248:251], a[240:243], v[92:95]
    s_xor_b32 s28, s1, 0x130000
    ds_read_b64_tr_b16 v[216:217], v71 offset:12288
    s_add_u32 m0, s30, 49152
    v_mfma_f32_16x16x32_bf16 v[92:95], v[252:255], a[248:251], v[92:95]
    s_add_u32 s46, s44, s28
    ds_read_b64_tr_b16 v[218:219], v71 offset:13312
    v_mfma_f32_16x16x32_bf16 v[108:111], v[248:251], a[244:247], v[108:111]
    s_addc_u32 s47, s45, 0
    ds_read_b64_tr_b16 v[220:221], v71 offset:16384
    global_load_lds_dwordx4 v9, s[46:47]
    v_mfma_f32_16x16x32_bf16 v[108:111], v[252:255], a[252:255], v[108:111]
    s_waitcnt lgkmcnt(11)
    ds_read_b64_tr_b16 v[222:223], v71 offset:17408
    v_mfma_f32_16x16x32_bf16 v[80:83], v[192:195], v[36:39], v[80:83]
    s_xor_b32 s28, s1, 0x140000
    ds_read_b64_tr_b16 v[224:225], v68 offset:20480
    s_add_u32 m0, s30, 53248
    v_mfma_f32_16x16x32_bf16 v[80:83], v[196:199], v[76:79], v[80:83]
    s_add_u32 s46, s44, s28
    ds_read_b64_tr_b16 v[226:227], v68 offset:21504
    v_mfma_f32_16x16x32_bf16 v[96:99], v[192:195], v[40:43], v[96:99]
    s_addc_u32 s47, s45, 0
    ds_read_b64_tr_b16 v[228:229], v68 offset:24576
    global_load_lds_dwordx4 v9, s[46:47]
    v_mfma_f32_16x16x32_bf16 v[96:99], v[196:199], a[208:211], v[96:99]
    s_waitcnt lgkmcnt(11)
    ds_read_b64_tr_b16 v[230:231], v68 offset:25600
    v_mfma_f32_16x16x32_bf16 v[84:87], v[200:203], v[36:39], v[84:87]
    s_xor_b32 s28, s1, 0x150000
    ds_read_b64_tr_b16 v[232:233], v69 offset:20480
    s_add_u32 m0, s30, 57344
    v_mfma_f32_16x16x32_bf16 v[84:87], v[204:207], v[76:79], v[84:87]
    s_add_u32 s46, s44, s28
    ds_read_b64_tr_b16 v[234:235], v69 offset:21504
    v_mfma_f32_16x16x32_bf16 v[100:103], v[200:203], v[40:43], v[100:103]
    s_addc_u32 s47, s45, 0
    ds_read_b64_tr_b16 v[236:237], v69 offset:24576
    global_load_lds_dwordx4 v9, s[46:47]
    v_mfma_f32_16x16x32_bf16 v[100:103], v[204:207], a[208:211], v[100:103]
    s_waitcnt lgkmcnt(11)
    ds_read_b64_tr_b16 v[238:239], v69 offset:25600
    v_mfma_f32_16x16x32_bf16 v[88:91], v[208:211], v[36:39], v[88:91]
    s_xor_b32 s28, s1, 0x160000
    ds_read_b64_tr_b16 v[240:241], v70 offset:20480
    s_add_u32 m0, s30, 61440
    v_mfma_f32_16x16x32_bf16 v[88:91], v[212:215], v[76:79], v[88:91]
    s_add_u32 s46, s44, s28
    ds_read_b64_tr_b16 v[242:243], v70 offset:21504
    v_mfma_f32_16x16x32_bf16 v[104:107], v[208:211], v[40:43], v[104:107]
    s_addc_u32 s47, s45, 0
    ds_read_b64_tr_b16 v[244:245], v70 offset:24576
    global_load_lds_dwordx4 v9, s[46:47]
    v_mfma_f32_16x16x32_bf16 v[104:107], v[212:215], a[208:211], v[104:107]
    s_waitcnt lgkmcnt(11)
    ds_read_b64_tr_b16 v[246:247], v70 offset:25600
    v_mfma_f32_16x16x32_bf16 v[92:95], v[216:219], v[36:39], v[92:95]
    ds_read_b64_tr_b16 v[248:249], v71 offset:20480
    v_mfma_f32_16x16x32_bf16 v[92:95], v[220:223], v[76:79], v[92:95]
    ds_read_b64_tr_b16 v[250:251], v71 offset:21504
    v_mfma_f32_16x16x32_bf16 v[108:111], v[216:219], v[40:43], v[108:111]
    ds_read_b64_tr_b16 v[252:253], v71 offset:24576
    buffer_load_dword v5, v62, s[20:23], 0 offen offset:512 sc1
    v_mfma_f32_16x16x32_bf16 v[108:111], v[220:223], a[208:211], v[108:111]
    s_waitcnt lgkmcnt(11)
    ds_read_b64_tr_b16 v[254:255], v71 offset:25600
    v_mfma_f32_16x16x32_bf16 v[80:83], v[224:227], a[212:215], v[80:83]
    s_xor_b32 s28, s1, 0x170000
    ds_read_b64_tr_b16 v[192:193], v68 offset:28672
    s_add_u32 m0, s30, 65536
    v_mfma_f32_16x16x32_bf16 v[80:83], v[228:231], a[236:239], v[80:83]
    s_add_u32 s46, s44, s28
    ds_read_b64_tr_b16 v[194:195], v68 offset:29696
    v_mfma_f32_16x16x32_bf16 v[96:99], v[224:227], a[232:235], v[96:99]
    s_addc_u32 s47, s45, 0
    ds_read_b64_tr_b16 v[196:197], v68 offset:32768
    global_load_lds_dwordx4 v9, s[46:47]
    v_mfma_f32_16x16x32_bf16 v[96:99], v[228:231], a[176:179], v[96:99]
    s_waitcnt lgkmcnt(11)
    ds_read_b64_tr_b16 v[198:199], v68 offset:33792
    v_mfma_f32_16x16x32_bf16 v[84:87], v[232:235], a[212:215], v[84:87]
    ds_read_b64_tr_b16 v[200:201], v69 offset:28672
    v_mfma_f32_16x16x32_bf16 v[84:87], v[236:239], a[236:239], v[84:87]
    ds_read_b64_tr_b16 v[202:203], v69 offset:29696
    v_mfma_f32_16x16x32_bf16 v[100:103], v[232:235], a[232:235], v[100:103]
    ds_read_b64_tr_b16 v[204:205], v69 offset:32768
    v_mfma_f32_16x16x32_bf16 v[100:103], v[236:239], a[176:179], v[100:103]
    s_waitcnt lgkmcnt(11)
    ds_read_b64_tr_b16 v[206:207], v69 offset:33792
    v_mfma_f32_16x16x32_bf16 v[88:91], v[240:243], a[212:215], v[88:91]
    ds_read_b64_tr_b16 v[208:209], v70 offset:28672
    v_mfma_f32_16x16x32_bf16 v[88:91], v[244:247], a[236:239], v[88:91]
    ds_read_b64_tr_b16 v[210:211], v70 offset:29696
    v_mfma_f32_16x16x32_bf16 v[104:107], v[240:243], a[232:235], v[104:107]
    ds_read_b64_tr_b16 v[212:213], v70 offset:32768
    v_mfma_f32_16x16x32_bf16 v[104:107], v[244:247], a[176:179], v[104:107]
    s_waitcnt lgkmcnt(11)
    ds_read_b64_tr_b16 v[214:215], v70 offset:33792
    v_mfma_f32_16x16x32_bf16 v[92:95], v[248:251], a[212:215], v[92:95]
    ds_read_b64_tr_b16 v[216:217], v71 offset:28672
    v_mfma_f32_16x16x32_bf16 v[92:95], v[252:255], a[236:239], v[92:95]
    ds_read_b64_tr_b16 v[218:219], v71 offset:29696
    v_mfma_f32_16x16x32_bf16 v[108:111], v[248:251], a[232:235], v[108:111]
    ds_read_b64_tr_b16 v[220:221], v71 offset:32768
    v_mfma_f32_16x16x32_bf16 v[108:111], v[252:255], a[176:179], v[108:111]
    s_waitcnt lgkmcnt(11)
    ds_read_b64_tr_b16 v[222:223], v71 offset:33792
    s_waitcnt vmcnt(31)
    s_barrier
    v_mfma_f32_16x16x32_bf16 v[80:83], v[192:195], a[180:183], v[80:83]
    s_xor_b32 s28, s1, 0x180000
    ds_read_b64_tr_b16 v[224:225], v68 offset:36864
    s_add_u32 m0, s30, 69632
    v_mfma_f32_16x16x32_bf16 v[80:83], v[196:199], a[188:191], v[80:83]
    s_add_u32 s46, s44, s28
    ds_read_b64_tr_b16 v[226:227], v68 offset:37888
    v_mfma_f32_16x16x32_bf16 v[96:99], v[192:195], a[184:187], v[96:99]
    s_addc_u32 s47, s45, 0
    ds_read_b64_tr_b16 v[228:229], v68 offset:40960
    global_load_lds_dwordx4 v9, s[46:47]
    v_mfma_f32_16x16x32_bf16 v[96:99], v[196:199], a[192:195], v[96:99]
    s_waitcnt lgkmcnt(11)
    ds_read_b64_tr_b16 v[230:231], v68 offset:41984
    v_mfma_f32_16x16x32_bf16 v[84:87], v[200:203], a[180:183], v[84:87]
    s_xor_b32 s28, s1, 0x190000
    ds_read_b64_tr_b16 v[232:233], v69 offset:36864
    s_add_u32 m0, s30, 73728
    v_mfma_f32_16x16x32_bf16 v[84:87], v[204:207], a[188:191], v[84:87]
    s_add_u32 s46, s44, s28
    ds_read_b64_tr_b16 v[234:235], v69 offset:37888
    v_mfma_f32_16x16x32_bf16 v[100:103], v[200:203], a[184:187], v[100:103]
    s_addc_u32 s47, s45, 0
    ds_read_b64_tr_b16 v[236:237], v69 offset:40960
    global_load_lds_dwordx4 v9, s[46:47]
    v_mfma_f32_16x16x32_bf16 v[100:103], v[204:207], a[192:195], v[100:103]
    s_waitcnt lgkmcnt(11)
    ds_read_b64_tr_b16 v[238:239], v69 offset:41984
    v_mfma_f32_16x16x32_bf16 v[88:91], v[208:211], a[180:183], v[88:91]
    s_xor_b32 s28, s1, 0x1a0000
    ds_read_b64_tr_b16 v[240:241], v70 offset:36864
    s_add_u32 m0, s30, 77824
    v_mfma_f32_16x16x32_bf16 v[88:91], v[212:215], a[188:191], v[88:91]
    s_add_u32 s46, s44, s28
    ds_read_b64_tr_b16 v[242:243], v70 offset:37888
    v_mfma_f32_16x16x32_bf16 v[104:107], v[208:211], a[184:187], v[104:107]
    s_addc_u32 s47, s45, 0
    ds_read_b64_tr_b16 v[244:245], v70 offset:40960
    global_load_lds_dwordx4 v9, s[46:47]
    v_mfma_f32_16x16x32_bf16 v[104:107], v[212:215], a[192:195], v[104:107]
    s_waitcnt lgkmcnt(11)
    ds_read_b64_tr_b16 v[246:247], v70 offset:41984
    v_mfma_f32_16x16x32_bf16 v[92:95], v[216:219], a[180:183], v[92:95]
    s_xor_b32 s28, s1, 0x1b0000
    ds_read_b64_tr_b16 v[248:249], v71 offset:36864
    s_add_u32 m0, s30, 81920
    v_mfma_f32_16x16x32_bf16 v[92:95], v[220:223], a[188:191], v[92:95]
    s_add_u32 s46, s44, s28
    ds_read_b64_tr_b16 v[250:251], v71 offset:37888
    v_mfma_f32_16x16x32_bf16 v[108:111], v[216:219], a[184:187], v[108:111]
    s_addc_u32 s47, s45, 0
    ds_read_b64_tr_b16 v[252:253], v71 offset:40960
    global_load_lds_dwordx4 v9, s[46:47]
    v_mfma_f32_16x16x32_bf16 v[108:111], v[220:223], a[192:195], v[108:111]
    s_waitcnt lgkmcnt(11)
    ds_read_b64_tr_b16 v[254:255], v71 offset:41984
    s_waitcnt vmcnt(5)
    v_cmp_gt_u32 vcc, 1, v5
    s_add_u32 s60, s60, 0x400000
    s_addc_u32 s61, s61, 0
    s_cbranch_vccnz g2_late
    v_mfma_f32_16x16x32_bf16 v[80:83], v[224:227], a[196:199], v[80:83]
    s_xor_b32 s28, s1, 0x1c0000
    ds_read_b64_tr_b16 v[192:193], v68 offset:45056
    s_add_u32 m0, s30, 86016
    v_mfma_f32_16x16x32_bf16 v[80:83], v[228:231], a[204:207], v[80:83]
    s_add_u32 s46, s44, s28
    ds_read_b64_tr_b16 v[194:195], v68 offset:46080
    v_mfma_f32_16x16x32_bf16 v[96:99], v[224:227], a[200:203], v[96:99]
    s_addc_u32 s47, s45, 0
    ds_read_b64_tr_b16 v[196:197], v68 offset:49152
    global_load_lds_dwordx4 v9, s[46:47]
    v_mfma_f32_16x16x32_bf16 v[96:99], v[228:231], a[216:219], v[96:99]
    s_waitcnt lgkmcnt(11)
    ds_read_b64_tr_b16 v[198:199], v68 offset:50176
    v_mfma_f32_16x16x32_bf16 v[84:87], v[232:235], a[196:199], v[84:87]
    s_xor_b32 s29, s0, 0
    ds_read_b64_tr_b16 v[200:201], v69 offset:45056
    v_mfma_f32_16x16x32_bf16 v[84:87], v[236:239], a[204:207], v[84:87]
    s_add_u32 s12, s60, s29
    ds_read_b64_tr_b16 v[202:203], v69 offset:46080
    v_mfma_f32_16x16x32_bf16 v[100:103], v[232:235], a[200:203], v[100:103]
    s_addc_u32 s13, s61, 0
    ds_read_b64_tr_b16 v[204:205], v69 offset:49152
    global_load_dwordx4 a[32:35], v1, s[12:13] offset:-4096
    v_mfma_f32_16x16x32_bf16 v[100:103], v[236:239], a[216:219], v[100:103]
    s_waitcnt lgkmcnt(11)
    ds_read_b64_tr_b16 v[206:207], v69 offset:50176
    v_mfma_f32_16x16x32_bf16 v[88:91], v[240:243], a[196:199], v[88:91]
    ds_read_b64_tr_b16 v[208:209], v70 offset:45056
    v_mfma_f32_16x16x32_bf16 v[88:91], v[244:247], a[204:207], v[88:91]
    ds_read_b64_tr_b16 v[210:211], v70 offset:46080
    v_mfma_f32_16x16x32_bf16 v[104:107], v[240:243], a[200:203], v[104:107]
    ds_read_b64_tr_b16 v[212:213], v70 offset:49152
    global_load_dwordx4 a[36:39], v1, s[12:13] offset:-3072
    v_mfma_f32_16x16x32_bf16 v[104:107], v[244:247], a[216:219], v[104:107]
    s_waitcnt lgkmcnt(11)
    ds_read_b64_tr_b16 v[214:215], v70 offset:50176
    v_mfma_f32_16x16x32_bf16 v[92:95], v[248:251], a[196:199], v[92:95]
    ds_read_b64_tr_b16 v[216:217], v71 offset:45056
    v_mfma_f32_16x16x32_bf16 v[92:95], v[252:255], a[204:207], v[92:95]
    ds_read_b64_tr_b16 v[218:219], v71 offset:46080
    v_mfma_f32_16x16x32_bf16 v[108:111], v[248:251], a[200:203], v[108:111]
    ds_read_b64_tr_b16 v[220:221], v71 offset:49152
    global_load_dwordx4 a[40:43], v1, s[12:13] offset:-2048
    v_mfma_f32_16x16x32_bf16 v[108:111], v[252:255], a[216:219], v[108:111]
    s_waitcnt lgkmcnt(11)
    ds_read_b64_tr_b16 v[222:223], v71 offset:50176
    v_mfma_f32_16x16x32_bf16 v[80:83], v[192:195], a[220:223], v[80:83]
    ds_read_b64_tr_b16 v[224:225], v68 offset:53248
    v_mfma_f32_16x16x32_bf16 v[80:83], v[196:199], a[228:231], v[80:83]
    ds_read_b64_tr_b16 v[226:227], v68 offset:54272
    v_mfma_f32_16x16x32_bf16 v[96:99], v[192:195], a[224:227], v[96:99]
    ds_read_b64_tr_b16 v[228:229], v68 offset:57344
    global_load_dwordx4 a[44:47], v1, s[12:13] offset:-1024
    v_mfma_f32_16x16x32_bf16 v[96:99], v[196:199], a[0:3], v[96:99]
    s_waitcnt lgkmcnt(11)
    ds_read_b64_tr_b16 v[230:231], v68 offset:58368
    v_mfma_f32_16x16x32_bf16 v[84:87], v[200:203], a[220:223], v[84:87]
    ds_read_b64_tr_b16 v[232:233], v69 offset:53248
    v_mfma_f32_16x16x32_bf16 v[84:87], v[204:207], a[228:231], v[84:87]
    ds_read_b64_tr_b16 v[234:235], v69 offset:54272
    v_mfma_f32_16x16x32_bf16 v[100:103], v[200:203], a[224:227], v[100:103]
    ds_read_b64_tr_b16 v[236:237], v69 offset:57344
    global_load_dwordx4 a[48:51], v1, s[12:13] offset:0
    v_mfma_f32_16x16x32_bf16 v[100:103], v[204:207], a[0:3], v[100:103]
    s_waitcnt lgkmcnt(11)
    ds_read_b64_tr_b16 v[238:239], v69 offset:58368
    v_mfma_f32_16x16x32_bf16 v[88:91], v[208:211], a[220:223], v[88:91]
    ds_read_b64_tr_b16 v[240:241], v70 offset:53248
    v_mfma_f32_16x16x32_bf16 v[88:91], v[212:215], a[228:231], v[88:91]
    ds_read_b64_tr_b16 v[242:243], v70 offset:54272
    v_mfma_f32_16x16x32_bf16 v[104:107], v[208:211], a[224:227], v[104:107]
    ds_read_b64_tr_b16 v[244:245], v70 offset:57344
    global_load_dwordx4 a[52:55], v1, s[12:13] offset:1024
    v_mfma_f32_16x16x32_bf16 v[104:107], v[212:215], a[0:3], v[104:107]
    s_waitcnt lgkmcnt(11)
    ds_read_b64_tr_b16 v[246:247], v70 offset:58368
    v_mfma_f32_16x16x32_bf16 v[92:95], v[216:219], a[220:223], v[92:95]
    ds_read_b64_tr_b16 v[248:249], v71 offset:53248
    v_mfma_f32_16x16x32_bf16 v[92:95], v[220:223], a[228:231], v[92:95]
    ds_read_b64_tr_b16 v[250:251], v71 offset:54272
    v_mfma_f32_16x16x32_bf16 v[108:111], v[216:219], a[224:227], v[108:111]
    ds_read_b64_tr_b16 v[252:253], v71 offset:57344
    global_load_dwordx4 a[56:59], v1, s[12:13] offset:2048
    v_mfma_f32_16x16x32_bf16 v[108:111], v[220:223], a[0:3], v[108:111]
    s_waitcnt lgkmcnt(11)
    ds_read_b64_tr_b16 v[254:255], v71 offset:58368
    v_mfma_f32_16x16x32_bf16 v[80:83], v[224:227], a[4:7], v[80:83]
    ds_read_b64_tr_b16 v[192:193], v68 offset:61440
    v_mfma_f32_16x16x32_bf16 v[80:83], v[228:231], a[12:15], v[80:83]
    ds_read_b64_tr_b16 v[194:195], v68 offset:62464
    v_mfma_f32_16x16x32_bf16 v[96:99], v[224:227], a[8:11], v[96:99]
    ds_read_b64_tr_b16 v[196:197], v64 offset:0
    global_load_dwordx4 a[60:63], v1, s[12:13] offset:3072
    v_mfma_f32_16x16x32_bf16 v[96:99], v[228:231], a[16:19], v[96:99]
    s_waitcnt lgkmcnt(11)
    ds_read_b64_tr_b16 v[198:199], v64 offset:1024
    v_mfma_f32_16x16x32_bf16 v[84:87], v[232:235], a[4:7], v[84:87]
    s_xor_b32 s29, s0, 8192
    ds_read_b64_tr_b16 v[200:201], v69 offset:61440
    v_mfma_f32_16x16x32_bf16 v[84:87], v[236:239], a[12:15], v[84:87]
    s_add_u32 s14, s60, s29
    ds_read_b64_tr_b16 v[202:203], v69 offset:62464
    v_mfma_f32_16x16x32_bf16 v[100:103], v[232:235], a[8:11], v[100:103]
    s_addc_u32 s15, s61, 0
    ds_read_b64_tr_b16 v[204:205], v65 offset:0
    global_load_dwordx4 a[64:67], v1, s[14:15] offset:-4096
    v_mfma_f32_16x16x32_bf16 v[100:103], v[236:239], a[16:19], v[100:103]
    s_waitcnt lgkmcnt(11)
    ds_read_b64_tr_b16 v[206:207], v65 offset:1024
    v_mfma_f32_16x16x32_bf16 v[88:91], v[240:243], a[4:7], v[88:91]
    ds_read_b64_tr_b16 v[208:209], v70 offset:61440
    v_mfma_f32_16x16x32_bf16 v[88:91], v[244:247], a[12:15], v[88:91]
    ds_read_b64_tr_b16 v[210:211], v70 offset:62464
    v_mfma_f32_16x16x32_bf16 v[104:107], v[240:243], a[8:11], v[104:107]
    ds_read_b64_tr_b16 v[212:213], v66 offset:0
    global_load_dwordx4 a[68:71], v1, s[14:15] offset:-3072
    v_mfma_f32_16x16x32_bf16 v[104:107], v[244:247], a[16:19], v[104:107]
    s_waitcnt lgkmcnt(11)
    ds_read_b64_tr_b16 v[214:215], v66 offset:1024
    v_mfma_f32_16x16x32_bf16 v[92:95], v[248:251], a[4:7], v[92:95]
    ds_read_b64_tr_b16 v[216:217], v71 offset:61440
    v_mfma_f32_16x16x32_bf16 v[92:95], v[252:255], a[12:15], v[92:95]
    ds_read_b64_tr_b16 v[218:219], v71 offset:62464
    v_mfma_f32_16x16x32_bf16 v[108:111], v[248:251], a[8:11], v[108:111]
    ds_read_b64_tr_b16 v[220:221], v67 offset:0
    global_load_dwordx4 a[72:75], v1, s[14:15] offset:-2048
    v_mfma_f32_16x16x32_bf16 v[108:111], v[252:255], a[16:19], v[108:111]
    s_waitcnt lgkmcnt(11)
    ds_read_b64_tr_b16 v[222:223], v67 offset:1024
    v_mfma_f32_16x16x32_bf16 v[80:83], v[192:195], a[20:23], v[80:83]
    ds_read_b64_tr_b16 v[224:225], v72 offset:0
    v_mfma_f32_16x16x32_bf16 v[80:83], v[196:199], a[28:31], v[80:83]
    ds_read_b64_tr_b16 v[226:227], v72 offset:1024
    v_mfma_f32_16x16x32_bf16 v[96:99], v[192:195], a[24:27], v[96:99]
    ds_read_b64_tr_b16 v[228:229], v72 offset:4096
    global_load_dwordx4 a[76:79], v1, s[14:15] offset:-1024
    v_mfma_f32_16x16x32_bf16 v[96:99], v[196:199], a[160:163], v[96:99]
    s_waitcnt lgkmcnt(11)
    ds_read_b64_tr_b16 v[230:231], v72 offset:5120
    v_mfma_f32_16x16x32_bf16 v[84:87], v[200:203], a[20:23], v[84:87]
    ds_read_b64_tr_b16 v[232:233], v73 offset:0
    v_mfma_f32_16x16x32_bf16 v[84:87], v[204:207], a[28:31], v[84:87]
    ds_read_b64_tr_b16 v[234:235], v73 offset:1024
    v_mfma_f32_16x16x32_bf16 v[100:103], v[200:203], a[24:27], v[100:103]
    ds_read_b64_tr_b16 v[236:237], v73 offset:4096
    global_load_dwordx4 a[80:83], v1, s[14:15] offset:0
    v_mfma_f32_16x16x32_bf16 v[100:103], v[204:207], a[160:163], v[100:103]
    s_waitcnt lgkmcnt(11)
    ds_read_b64_tr_b16 v[238:239], v73 offset:5120
    v_mfma_f32_16x16x32_bf16 v[88:91], v[208:211], a[20:23], v[88:91]
    ds_read_b64_tr_b16 v[240:241], v74 offset:0
    v_mfma_f32_16x16x32_bf16 v[88:91], v[212:215], a[28:31], v[88:91]
    ds_read_b64_tr_b16 v[242:243], v74 offset:1024
    v_mfma_f32_16x16x32_bf16 v[104:107], v[208:211], a[24:27], v[104:107]
    ds_read_b64_tr_b16 v[244:245], v74 offset:4096
    global_load_dwordx4 a[84:87], v1, s[14:15] offset:1024
    v_mfma_f32_16x16x32_bf16 v[104:107], v[212:215], a[160:163], v[104:107]
    s_waitcnt lgkmcnt(11)
    ds_read_b64_tr_b16 v[246:247], v74 offset:5120
    v_mfma_f32_16x16x32_bf16 v[92:95], v[216:219], a[20:23], v[92:95]
    ds_read_b64_tr_b16 v[248:249], v75 offset:0
    v_mfma_f32_16x16x32_bf16 v[92:95], v[220:223], a[28:31], v[92:95]
    ds_read_b64_tr_b16 v[250:251], v75 offset:1024
    v_mfma_f32_16x16x32_bf16 v[108:111], v[216:219], a[24:27], v[108:111]
    ds_read_b64_tr_b16 v[252:253], v75 offset:4096
    global_load_dwordx4 a[88:91], v1, s[14:15] offset:2048
    v_mfma_f32_16x16x32_bf16 v[108:111], v[220:223], a[160:163], v[108:111]
    s_waitcnt lgkmcnt(11)
    ds_read_b64_tr_b16 v[254:255], v75 offset:5120
g2_join:
    s_waitcnt vmcnt(11)
    s_barrier
    v_mfma_f32_16x16x32_bf16 v[128:131], v[224:227], a[32:35], 0
    ds_read_b64_tr_b16 v[192:193], v72 offset:8192
    v_mfma_f32_16x16x32_bf16 v[128:131], v[228:231], a[40:43], v[128:131]
hook19:
    s_cbranch_execz hook_end
    ds_read_b64_tr_b16 v[194:195], v72 offset:9216
    v_mfma_f32_16x16x32_bf16 v[144:147], v[224:227], a[36:39], 0
    ds_read_b64_tr_b16 v[196:197], v72 offset:12288
    global_load_dwordx4 a[92:95], v1, s[14:15] offset:3072
    v_mfma_f32_16x16x32_bf16 v[144:147], v[228:231], a[44:47], v[144:147]
    s_waitcnt lgkmcnt(11)
    ds_read_b64_tr_b16 v[198:199], v72 offset:13312
    v_mfma_f32_16x16x32_bf16 v[132:135], v[232:235], a[32:35], 0
    s_xor_b32 s29, s0, 16384
    ds_read_b64_tr_b16 v[200:201], v73 offset:8192
    v_mfma_f32_16x16x32_bf16 v[132:135], v[236:239], a[40:43], v[132:135]
    s_add_u32 s12, s60, s29
    ds_read_b64_tr_b16 v[202:203], v73 offset:9216
    v_mfma_f32_16x16x32_bf16 v[148:151], v[232:235], a[36:39], 0
    s_addc_u32 s13, s61, 0
    ds_read_b64_tr_b16 v[204:205], v73 offset:12288
    global_load_dwordx4 a[96:99], v1, s[12:13] offset:-4096
    v_mfma_f32_16x16x32_bf16 v[148:151], v[236:239], a[44:47], v[148:151]
    s_waitcnt lgkmcnt(11)
    ds_read_b64_tr_b16 v[206:207], v73 offset:13312
    v_mfma_f32_16x16x32_bf16 v[136:139], v[240:243], a[32:35], 0
    ds_read_b64_tr_b16 v[208:209], v74 offset:8192
    v_cvt_pk_bf16_f32 v80, v80, v81
    v_mfma_f32_16x16x32_bf16 v[136:139], v[244:247], a[40:43], v[136:139]
    ds_read_b64_tr_b16 v[210:211], v74 offset:9216
    v_cvt_pk_bf16_f32 v81, v82, v83
    v_mfma_f32_16x16x32_bf16 v[152:155], v[240:243], a[36:39], 0
    ds_read_b64_tr_b16 v[212:213], v74 offset:12288
    global_load_dwordx4 a[100:103], v1, s[12:13] offset:-3072
    v_mfma_f32_16x16x32_bf16 v[152:155], v[244:247], a[44:47], v[152:155]
    s_waitcnt lgkmcnt(11)
    ds_read_b64_tr_b16 v[214:215], v74 offset:13312
    v_cvt_pk_bf16_f32 v96, v96, v97
    v_mfma_f32_16x16x32_bf16 v[140:143], v[248:251], a[32:35], 0
    ds_read_b64_tr_b16 v[216:217], v75 offset:8192
    v_cvt_pk_bf16_f32 v97, v98, v99
    v_mfma_f32_16x16x32_bf16 v[140:143], v[252:255], a[40:43], v[140:143]
    ds_read_b64_tr_b16 v[218:219], v75 offset:9216
    v_cvt_pk_bf16_f32 v84, v84, v85
    v_mfma_f32_16x16x32_bf16 v[156:159], v[248:251], a[36:39], 0
    ds_read_b64_tr_b16 v[220:221], v75 offset:12288
    global_load_dwordx4 a[104:107], v1, s[12:13] offset:-2048
    v_mfma_f32_16x16x32_bf16 v[156:159], v[252:255], a[44:47], v[156:159]
    s_waitcnt vmcnt(11) lgkmcnt(11)
    ds_read_b64_tr_b16 v[222:223], v75 offset:13312
    v_cvt_pk_bf16_f32 v85, v86, v87
    v_mfma_f32_16x16x32_bf16 v[128:131], v[192:195], a[48:51], v[128:131]
    ds_read_b64_tr_b16 v[224:225], v72 offset:16384
    v_cvt_pk_bf16_f32 v100, v100, v101
    v_mfma_f32_16x16x32_bf16 v[128:131], v[196:199], a[56:59], v[128:131]
    ds_read_b64_tr_b16 v[226:227], v72 offset:17408
    v_cvt_pk_bf16_f32 v101, v102, v103
    v_mfma_f32_16x16x32_bf16 v[144:147], v[192:195], a[52:55], v[144:147]
    ds_read_b64_tr_b16 v[228:229], v72 offset:20480
    global_load_dwordx4 a[108:111], v1, s[12:13] offset:-1024
    v_mfma_f32_16x16x32_bf16 v[144:147], v[196:199], a[60:63], v[144:147]
    s_waitcnt lgkmcnt(11)
    ds_read_b64_tr_b16 v[230:231], v72 offset:21504
    v_cvt_pk_bf16_f32 v88, v88, v89
    v_mfma_f32_16x16x32_bf16 v[132:135], v[200:203], a[48:51], v[132:135]
    ds_read_b64_tr_b16 v[232:233], v73 offset:16384
    v_cvt_pk_bf16_f32 v89, v90, v91
    v_mfma_f32_16x16x32_bf16 v[132:135], v[204:207], a[56:59], v[132:135]
    ds_read_b64_tr_b16 v[234:235], v73 offset:17408
    v_cvt_pk_bf16_f32 v104, v104, v105
    v_mfma_f32_16x16x32_bf16 v[148:151], v[200:203], a[52:55], v[148:151]
    ds_read_b64_tr_b16 v[236:237], v73 offset:20480
    global_load_dwordx4 a[112:115], v1, s[12:13] offset:0
    v_mfma_f32_16x16x32_bf16 v[148:151], v[204:207], a[60:63], v[148:151]
    s_waitcnt lgkmcnt(11)
    ds_read_b64_tr_b16 v[238:239], v73 offset:21504
    v_cvt_pk_bf16_f32 v105, v106, v107
    v_mfma_f32_16x16x32_bf16 v[136:139], v[208:211], a[48:51], v[136:139]
    ds_read_b64_tr_b16 v[240:241], v74 offset:16384
    v_cvt_pk_bf16_f32 v92, v92, v93
    v_mfma_f32_16x16x32_bf16 v[136:139], v[212:215], a[56:59], v[136:139]
    ds_read_b64_tr_b16 v[242:243], v74 offset:17408
    v_cvt_pk_bf16_f32 v93, v94, v95
    v_mfma_f32_16x16x32_bf16 v[152:155], v[208:211], a[52:55], v[152:155]
    ds_read_b64_tr_b16 v[244:245], v74 offset:20480
    global_load_dwordx4 a[116:119], v1, s[12:13] offset:1024
    v_mfma_f32_16x16x32_bf16 v[152:155], v[212:215], a[60:63], v[152:155]
    s_waitcnt lgkmcnt(11)
    ds_read_b64_tr_b16 v[246:247], v74 offset:21504
    v_cvt_pk_bf16_f32 v108, v108, v109
    v_mfma_f32_16x16x32_bf16 v[140:143], v[216:219], a[48:51], v[140:143]
    ds_read_b64_tr_b16 v[248:249], v75 offset:16384
    v_cvt_pk_bf16_f32 v109, v110, v111
    v_mfma_f32_16x16x32_bf16 v[140:143], v[220:223], a[56:59], v[140:143]
    ds_read_b64_tr_b16 v[250:251], v75 offset:17408
    ds_write_b64 v10, v[80:81] offset:0
    v_mfma_f32_16x16x32_bf16 v[156:159], v[216:219], a[52:55], v[156:159]
    ds_read_b64_tr_b16 v[252:253], v75 offset:20480
    global_load_dwordx4 a[120:123], v1, s[12:13] offset:2048
    v_mfma_f32_16x16x32_bf16 v[156:159], v[220:223], a[60:63], v[156:159]
    s_waitcnt vmcnt(11) lgkmcnt(12)
    ds_read_b64_tr_b16 v[254:255], v75 offset:21504
    ds_write_b64 v10, v[96:97] offset:2048
    v_mfma_f32_16x16x32_bf16 v[128:131], v[224:227], a[64:67], v[128:131]
    ds_read_b64_tr_b16 v[192:193], v72 offset:24576
    v_mfma_f32_16x16x32_bf16 v[128:131], v[228:231], a[72:75], v[128:131]
    ds_read_b64_tr_b16 v[194:195], v72 offset:25600
    ds_write_b64 v12, v[84:85] offset:0
    v_mfma_f32_16x16x32_bf16 v[144:147], v[224:227], a[68:71], v[144:147]
    ds_read_b64_tr_b16 v[196:197], v72 offset:28672
    global_load_dwordx4 a[124:127], v1, s[12:13] offset:3072
    v_mfma_f32_16x16x32_bf16 v[144:147], v[228:231], a[76:79], v[144:147]
    s_waitcnt lgkmcnt(14)
    ds_read_b64_tr_b16 v[198:199], v72 offset:29696
    ds_write_b64 v12, v[100:101] offset:2048
    v_mfma_f32_16x16x32_bf16 v[132:135], v[232:235], a[64:67], v[132:135]
    s_xor_b32 s29, s0, 24576
    ds_read_b64_tr_b16 v[200:201], v73 offset:24576
    v_mfma_f32_16x16x32_bf16 v[132:135], v[236:239], a[72:75], v[132:135]
    s_add_u32 s14, s60, s29
    ds_read_b64_tr_b16 v[202:203], v73 offset:25600
    ds_write_b64 v13, v[88:89] offset:0
    v_mfma_f32_16x16x32_bf16 v[148:151], v[232:235], a[68:71], v[148:151]
    s_addc_u32 s15, s61, 0
    ds_read_b64_tr_b16 v[204:205], v73 offset:28672
    global_load_dwordx4 a[128:131], v1, s[14:15] offset:-4096
    v_mfma_f32_16x16x32_bf16 v[148:151], v[236:239], a[76:79], v[148:151]
    s_waitcnt lgkmcnt(14)
    ds_read_b64_tr_b16 v[206:207], v73 offset:29696
    ds_write_b64 v13, v[104:105] offset:2048
    v_mfma_f32_16x16x32_bf16 v[136:139], v[240:243], a[64:67], v[136:139]
    ds_read_b64_tr_b16 v[208:209], v74 offset:24576
    v_mfma_f32_16x16x32_bf16 v[136:139], v[244:247], a[72:75], v[136:139]
    ds_read_b64_tr_b16 v[210:211], v74 offset:25600
    ds_write_b64 v14, v[92:93] offset:0
    v_mfma_f32_16x16x32_bf16 v[152:155], v[240:243], a[68:71], v[152:155]
    ds_read_b64_tr_b16 v[212:213], v74 offset:28672
    global_load_dwordx4 a[132:135], v1, s[14:15] offset:-3072
    v_mfma_f32_16x16x32_bf16 v[152:155], v[244:247], a[76:79], v[152:155]
    s_waitcnt lgkmcnt(14)
    ds_read_b64_tr_b16 v[214:215], v74 offset:29696
    ds_write_b64 v14, v[108:109] offset:2048
    v_mfma_f32_16x16x32_bf16 v[140:143], v[248:251], a[64:67], v[140:143]
    ds_read_b64_tr_b16 v[216:217], v75 offset:24576
    v_mfma_f32_16x16x32_bf16 v[140:143], v[252:255], a[72:75], v[140:143]
    ds_read_b64_tr_b16 v[218:219], v75 offset:25600
    ds_read_b128 v[80:83], v0 offset:0
    v_mfma_f32_16x16x32_bf16 v[156:159], v[248:251], a[68:71], v[156:159]
    ds_read_b64_tr_b16 v[220:221], v75 offset:28672
    global_load_dwordx4 a[136:139], v1, s[14:15] offset:-2048
    v_mfma_f32_16x16x32_bf16 v[156:159], v[252:255], a[76:79], v[156:159]
    s_waitcnt vmcnt(11) lgkmcnt(14)
    ds_read_b64_tr_b16 v[222:223], v75 offset:29696
    ds_read_b128 v[84:87], v0 offset:1024
    v_mfma_f32_16x16x32_bf16 v[128:131], v[192:195], a[80:83], v[128:131]
    ds_read_b64_tr_b16 v[224:225], v64 offset:4096
    ds_read_b128 v[88:91], v0 offset:2048
    v_mfma_f32_16x16x32_bf16 v[128:131], v[196:199], a[88:91], v[128:131]
    ds_read_b64_tr_b16 v[226:227], v64 offset:5120
    ds_read_b128 v[92:95], v0 offset:3072
    v_mfma_f32_16x16x32_bf16 v[144:147], v[192:195], a[84:87], v[144:147]
    ds_read_b64_tr_b16 v[228:229], v64 offset:8192
    global_load_dwordx4 a[140:143], v1, s[14:15] offset:-1024
    v_mfma_f32_16x16x32_bf16 v[144:147], v[196:199], a[92:95], v[144:147]
    s_waitcnt lgkmcnt(14)
    ds_read_b64_tr_b16 v[230:231], v64 offset:9216
    v_mfma_f32_16x16x32_bf16 v[132:135], v[200:203], a[80:83], v[132:135]
    ds_read_b64_tr_b16 v[232:233], v65 offset:4096
    v_mfma_f32_16x16x32_bf16 v[132:135], v[204:207], a[88:91], v[132:135]
    ds_read_b64_tr_b16 v[234:235], v65 offset:5120
    v_mfma_f32_16x16x32_bf16 v[148:151], v[200:203], a[84:87], v[148:151]
    ds_read_b64_tr_b16 v[236:237], v65 offset:8192
    global_load_dwordx4 a[144:147], v1, s[14:15] offset:0
    v_mfma_f32_16x16x32_bf16 v[148:151], v[204:207], a[92:95], v[148:151]
    s_waitcnt lgkmcnt(14)
    ds_read_b64_tr_b16 v[238:239], v65 offset:9216
    v_mfma_f32_16x16x32_bf16 v[136:139], v[208:211], a[80:83], v[136:139]
    ds_read_b64_tr_b16 v[240:241], v66 offset:4096
    v_mfma_f32_16x16x32_bf16 v[136:139], v[212:215], a[88:91], v[136:139]
    ds_read_b64_tr_b16 v[242:243], v66 offset:5120
    v_mfma_f32_16x16x32_bf16 v[152:155], v[208:211], a[84:87], v[152:155]
    ds_read_b64_tr_b16 v[244:245], v66 offset:8192
    global_load_dwordx4 a[148:151], v1, s[14:15] offset:1024
    v_mfma_f32_16x16x32_bf16 v[152:155], v[212:215], a[92:95], v[152:155]
    s_waitcnt lgkmcnt(14)
    ds_read_b64_tr_b16 v[246:247], v66 offset:9216
    v_mfma_f32_16x16x32_bf16 v[140:143], v[216:219], a[80:83], v[140:143]
    ds_read_b64_tr_b16 v[248:249], v67 offset:4096
    v_mfma_f32_16x16x32_bf16 v[140:143], v[220:223], a[88:91], v[140:143]
    ds_read_b64_tr_b16 v[250:251], v67 offset:5120
    v_mfma_f32_16x16x32_bf16 v[156:159], v[216:219], a[84:87], v[156:159]
    ds_read_b64_tr_b16 v[252:253], v67 offset:8192
    global_load_dwordx4 a[152:155], v1, s[14:15] offset:2048
    v_mfma_f32_16x16x32_bf16 v[156:159], v[220:223], a[92:95], v[156:159]
    s_waitcnt vmcnt(11) lgkmcnt(11)
    ds_read_b64_tr_b16 v[254:255], v67 offset:9216
    v_mfma_f32_16x16x32_bf16 v[128:131], v[224:227], a[96:99], v[128:131]
    ds_read_b64_tr_b16 v[192:193], v64 offset:12288
    v_mfma_f32_16x16x32_bf16 v[128:131], v[228:231], a[104:107], v[128:131]
    ds_read_b64_tr_b16 v[194:195], v64 offset:13312
    v_mfma_f32_16x16x32_bf16 v[144:147], v[224:227], a[100:103], v[144:147]
    ds_read_b64_tr_b16 v[196:197], v64 offset:16384
    global_load_dwordx4 a[156:159], v1, s[14:15] offset:3072
    v_mfma_f32_16x16x32_bf16 v[144:147], v[228:231], a[108:111], v[144:147]
    s_waitcnt lgkmcnt(11)
    ds_read_b64_tr_b16 v[198:199], v64 offset:17408
    v_mfma_f32_16x16x32_bf16 v[132:135], v[232:235], a[96:99], v[132:135]
    s_xor_b32 s29, s0, 32768
    ds_read_b64_tr_b16 v[200:201], v65 offset:12288
    v_mfma_f32_16x16x32_bf16 v[132:135], v[236:239], a[104:107], v[132:135]
    s_add_u32 s12, s60, s29
    ds_read_b64_tr_b16 v[202:203], v65 offset:13312
    v_mfma_f32_16x16x32_bf16 v[148:151], v[232:235], a[100:103], v[148:151]
    s_addc_u32 s13, s61, 0
    ds_read_b64_tr_b16 v[204:205], v65 offset:16384
    global_load_dwordx4 a[240:243], v1, s[12:13] offset:-4096
    v_mfma_f32_16x16x32_bf16 v[148:151], v[236:239], a[108:111], v[148:151]
    s_waitcnt lgkmcnt(11)
    ds_read_b64_tr_b16 v[206:207], v65 offset:17408
    v_mfma_f32_16x16x32_bf16 v[136:139], v[240:243], a[96:99], v[136:139]
    ds_read_b64_tr_b16 v[208:209], v66 offset:12288
    v_mfma_f32_16x16x32_bf16 v[136:139], v[244:247], a[104:107], v[136:139]
    ds_read_b64_tr_b16 v[210:211], v66 offset:13312
    v_mfma_f32_16x16x32_bf16 v[152:155], v[240:243], a[100:103], v[152:155]
    ds_read_b64_tr_b16 v[212:213], v66 offset:16384
    global_load_dwordx4 a[244:247], v1, s[12:13] offset:-3072
    v_mfma_f32_16x16x32_bf16 v[152:155], v[244:247], a[108:111], v[152:155]
    s_waitcnt lgkmcnt(11)
    ds_read_b64_tr_b16 v[214:215], v66 offset:17408
    v_mfma_f32_16x16x32_bf16 v[140:143], v[248:251], a[96:99], v[140:143]
    ds_read_b64_tr_b16 v[216:217], v67 offset:12288
    v_mfma_f32_16x16x32_bf16 v[140:143], v[252:255], a[104:107], v[140:143]
    ds_read_b64_tr_b16 v[218:219], v67 offset:13312
    v_mfma_f32_16x16x32_bf16 v[156:159], v[248:251], a[100:103], v[156:159]
    ds_read_b64_tr_b16 v[220:221], v67 offset:16384
    global_load_dwordx4 a[248:251], v1, s[12:13] offset:-2048
    v_mfma_f32_16x16x32_bf16 v[156:159], v[252:255], a[108:111], v[156:159]
    s_waitcnt vmcnt(11) lgkmcnt(11)
    ds_read_b64_tr_b16 v[222:223], v67 offset:17408
    v_mfma_f32_16x16x32_bf16 v[128:131], v[192:195], a[112:115], v[128:131]
    ds_read_b64_tr_b16 v[224:225], v64 offset:20480
    v_mfma_f32_16x16x32_bf16 v[128:131], v[196:199], a[120:123], v[128:131]
    ds_read_b64_tr_b16 v[226:227], v64 offset:21504
    v_mfma_f32_16x16x32_bf16 v[144:147], v[192:195], a[116:119], v[144:147]
    ds_read_b64_tr_b16 v[228:229], v64 offset:24576
    global_load_dwordx4 a[252:255], v1, s[12:13] offset:-1024
    v_mfma_f32_16x16x32_bf16 v[144:147], v[196:199], a[124:127], v[144:147]
    s_waitcnt lgkmcnt(11)
    ds_read_b64_tr_b16 v[230:231], v64 offset:25600
    v_mfma_f32_16x16x32_bf16 v[132:135], v[200:203], a[112:115], v[132:135]
    ds_read_b64_tr_b16 v[232:233], v65 offset:20480
    v_mfma_f32_16x16x32_bf16 v[132:135], v[204:207], a[120:123], v[132:135]
    ds_read_b64_tr_b16 v[234:235], v65 offset:21504
    v_mfma_f32_16x16x32_bf16 v[148:151], v[200:203], a[116:119], v[148:151]
    ds_read_b64_tr_b16 v[236:237], v65 offset:24576
    global_load_dwordx4 v[36:39], v1, s[12:13] offset:0
    v_mfma_f32_16x16x32_bf16 v[148:151], v[204:207], a[124:127], v[148:151]
    s_waitcnt lgkmcnt(11)
    ds_read_b64_tr_b16 v[238:239], v65 offset:25600
    v_mfma_f32_16x16x32_bf16 v[136:139], v[208:211], a[112:115], v[136:139]
    ds_read_b64_tr_b16 v[240:241], v66 offset:20480
    v_mfma_f32_16x16x32_bf16 v[136:139], v[212:215], a[120:123], v[136:139]
    ds_read_b64_tr_b16 v[242:243], v66 offset:21504
    v_mfma_f32_16x16x32_bf16 v[152:155], v[208:211], a[116:119], v[152:155]
    ds_read_b64_tr_b16 v[244:245], v66 offset:24576
    global_load_dwordx4 v[40:43], v1, s[12:13] offset:1024
    v_mfma_f32_16x16x32_bf16 v[152:155], v[212:215], a[124:127], v[152:155]
    s_waitcnt lgkmcnt(11)
    ds_read_b64_tr_b16 v[246:247], v66 offset:25600
    v_mfma_f32_16x16x32_bf16 v[140:143], v[216:219], a[112:115], v[140:143]
    ds_read_b64_tr_b16 v[248:249], v67 offset:20480
    v_mfma_f32_16x16x32_bf16 v[140:143], v[220:223], a[120:123], v[140:143]
    ds_read_b64_tr_b16 v[250:251], v67 offset:21504
    v_mfma_f32_16x16x32_bf16 v[156:159], v[216:219], a[116:119], v[156:159]
    ds_read_b64_tr_b16 v[252:253], v67 offset:24576
    global_load_dwordx4 v[76:79], v1, s[12:13] offset:2048
    v_mfma_f32_16x16x32_bf16 v[156:159], v[220:223], a[124:127], v[156:159]
    s_waitcnt vmcnt(11) lgkmcnt(11)
    ds_read_b64_tr_b16 v[254:255], v67 offset:25600
    v_mfma_f32_16x16x32_bf16 v[128:131], v[224:227], a[128:131], v[128:131]
    ds_read_b64_tr_b16 v[192:193], v64 offset:28672
    v_mfma_f32_16x16x32_bf16 v[128:131], v[228:231], a[136:139], v[128:131]
    ds_read_b64_tr_b16 v[194:195], v64 offset:29696
    v_mfma_f32_16x16x32_bf16 v[144:147], v[224:227], a[132:135], v[144:147]
    ds_read_b64_tr_b16 v[196:197], v64 offset:32768
    global_load_dwordx4 a[208:211], v1, s[12:13] offset:3072
    v_mfma_f32_16x16x32_bf16 v[144:147], v[228:231], a[140:143], v[144:147]
    s_waitcnt lgkmcnt(11)
    ds_read_b64_tr_b16 v[198:199], v64 offset:33792
    v_mfma_f32_16x16x32_bf16 v[132:135], v[232:235], a[128:131], v[132:135]
    s_xor_b32 s29, s0, 40960
    ds_read_b64_tr_b16 v[200:201], v65 offset:28672
    v_mfma_f32_16x16x32_bf16 v[132:135], v[236:239], a[136:139], v[132:135]
    s_add_u32 s14, s60, s29
    ds_read_b64_tr_b16 v[202:203], v65 offset:29696
    v_mfma_f32_16x16x32_bf16 v[148:151], v[232:235], a[132:135], v[148:151]
    s_addc_u32 s15, s61, 0
    ds_read_b64_tr_b16 v[204:205], v65 offset:32768
    global_load_dwordx4 a[212:215], v1, s[14:15] offset:-4096
    v_mfma_f32_16x16x32_bf16 v[148:151], v[236:239], a[140:143], v[148:151]
    s_waitcnt lgkmcnt(11)
    ds_read_b64_tr_b16 v[206:207], v65 offset:33792
    v_mfma_f32_16x16x32_bf16 v[136:139], v[240:243], a[128:131], v[136:139]
    ds_read_b64_tr_b16 v[208:209], v66 offset:28672
    v_mfma_f32_16x16x32_bf16 v[136:139], v[244:247], a[136:139], v[136:139]
    ds_read_b64_tr_b16 v[210:211], v66 offset:29696
    v_mfma_f32_16x16x32_bf16 v[152:155], v[240:243], a[132:135], v[152:155]
    ds_read_b64_tr_b16 v[212:213], v66 offset:32768
    global_load_dwordx4 a[232:235], v1, s[14:15] offset:-3072
    v_mfma_f32_16x16x32_bf16 v[152:155], v[244:247], a[140:143], v[152:155]
    s_waitcnt lgkmcnt(11)
    ds_read_b64_tr_b16 v[214:215], v66 offset:33792
    v_mfma_f32_16x16x32_bf16 v[140:143], v[248:251], a[128:131], v[140:143]
    ds_read_b64_tr_b16 v[216:217], v67 offset:28672
    v_mfma_f32_16x16x32_bf16 v[140:143], v[252:255], a[136:139], v[140:143]
    ds_read_b64_tr_b16 v[218:219], v67 offset:29696
    v_mfma_f32_16x16x32_bf16 v[156:159], v[248:251], a[132:135], v[156:159]
    ds_read_b64_tr_b16 v[220:221], v67 offset:32768
    global_load_dwordx4 a[236:239], v1, s[14:15] offset:-2048
    v_mfma_f32_16x16x32_bf16 v[156:159], v[252:255], a[140:143], v[156:159]
    s_waitcnt vmcnt(11) lgkmcnt(11)
    ds_read_b64_tr_b16 v[222:223], v67 offset:33792
    v_mfma_f32_16x16x32_bf16 v[128:131], v[192:195], a[144:147], v[128:131]
    ds_read_b64_tr_b16 v[224:225], v64 offset:36864
    v_mfma_f32_16x16x32_bf16 v[128:131], v[196:199], a[152:155], v[128:131]
    ds_read_b64_tr_b16 v[226:227], v64 offset:37888
    v_mfma_f32_16x16x32_bf16 v[144:147], v[192:195], a[148:151], v[144:147]
    ds_read_b64_tr_b16 v[228:229], v64 offset:40960
    global_load_dwordx4 a[176:179], v1, s[14:15] offset:-1024
    v_mfma_f32_16x16x32_bf16 v[144:147], v[196:199], a[156:159], v[144:147]
    s_waitcnt lgkmcnt(11)
    ds_read_b64_tr_b16 v[230:231], v64 offset:41984
    v_mfma_f32_16x16x32_bf16 v[132:135], v[200:203], a[144:147], v[132:135]
    s_xor_b32 s28, s1, 0x1d0000
    ds_read_b64_tr_b16 v[232:233], v65 offset:36864
    s_add_u32 m0, s30, 90112
    v_mfma_f32_16x16x32_bf16 v[132:135], v[204:207], a[152:155], v[132:135]
    s_add_u32 s46, s44, s28
    ds_read_b64_tr_b16 v[234:235], v65 offset:37888
    v_mfma_f32_16x16x32_bf16 v[148:151], v[200:203], a[148:151], v[148:151]
    s_addc_u32 s47, s45, 0
    ds_read_b64_tr_b16 v[236:237], v65 offset:40960
    global_load_lds_dwordx4 v9, s[46:47]
    v_mfma_f32_16x16x32_bf16 v[148:151], v[204:207], a[156:159], v[148:151]
    s_waitcnt lgkmcnt(11)
    ds_read_b64_tr_b16 v[238:239], v65 offset:41984
    v_mfma_f32_16x16x32_bf16 v[136:139], v[208:211], a[144:147], v[136:139]
    s_xor_b32 s28, s1, 0x1e0000
    ds_read_b64_tr_b16 v[240:241], v66 offset:36864
    s_add_u32 m0, s30, 94208
    v_mfma_f32_16x16x32_bf16 v[136:139], v[212:215], a[152:155], v[136:139]
    s_add_u32 s46, s44, s28
    ds_read_b64_tr_b16 v[242:243], v66 offset:37888
    v_mfma_f32_16x16x32_bf16 v[152:155], v[208:211], a[148:151], v[152:155]
    s_addc_u32 s47, s45, 0
    ds_read_b64_tr_b16 v[244:245], v66 offset:40960
    global_load_lds_dwordx4 v9, s[46:47]
    v_mfma_f32_16x16x32_bf16 v[152:155], v[212:215], a[156:159], v[152:155]
    s_waitcnt lgkmcnt(11)
    ds_read_b64_tr_b16 v[246:247], v66 offset:41984
    v_mfma_f32_16x16x32_bf16 v[140:143], v[216:219], a[144:147], v[140:143]
    s_xor_b32 s28, s1, 0x1f0000
    ds_read_b64_tr_b16 v[248:249], v67 offset:36864
    s_add_u32 m0, s30, 98304
    v_mfma_f32_16x16x32_bf16 v[140:143], v[220:223], a[152:155], v[140:143]
    s_add_u32 s46, s44, s28
    ds_read_b64_tr_b16 v[250:251], v67 offset:37888
    v_mfma_f32_16x16x32_bf16 v[156:159], v[216:219], a[148:151], v[156:159]
    s_addc_u32 s47, s45, 0
    ds_read_b64_tr_b16 v[252:253], v67 offset:40960
    global_load_lds_dwordx4 v9, s[46:47]
    v_mfma_f32_16x16x32_bf16 v[156:159], v[220:223], a[156:159], v[156:159]
    s_waitcnt vmcnt(11) lgkmcnt(11)
    ds_read_b64_tr_b16 v[254:255], v67 offset:41984
    v_mfma_f32_16x16x32_bf16 v[128:131], v[224:227], a[240:243], v[128:131]
    ds_read_b64_tr_b16 v[192:193], v64 offset:45056
    v_mfma_f32_16x16x32_bf16 v[128:131], v[228:231], a[248:251], v[128:131]
    ds_read_b64_tr_b16 v[194:195], v64 offset:46080
    v_mfma_f32_16x16x32_bf16 v[144:147], v[224:227], a[244:247], v[144:147]
    ds_read_b64_tr_b16 v[196:197], v64 offset:49152
    global_load_dwordx4 a[180:183], v1, s[14:15] offset:0
    v_mfma_f32_16x16x32_bf16 v[144:147], v[228:231], a[252:255], v[144:147]
    s_waitcnt lgkmcnt(11)
    ds_read_b64_tr_b16 v[198:199], v64 offset:50176
    v_mfma_f32_16x16x32_bf16 v[132:135], v[232:235], a[240:243], v[132:135]
    ds_read_b64_tr_b16 v[200:201], v65 offset:45056
    v_mfma_f32_16x16x32_bf16 v[132:135], v[236:239], a[248:251], v[132:135]
    ds_read_b64_tr_b16 v[202:203], v65 offset:46080
    v_mfma_f32_16x16x32_bf16 v[148:151], v[232:235], a[244:247], v[148:151]
    ds_read_b64_tr_b16 v[204:205], v65 offset:49152
    global_load_dwordx4 a[184:187], v1, s[14:15] offset:1024
    v_mfma_f32_16x16x32_bf16 v[148:151], v[236:239], a[252:255], v[148:151]
    s_waitcnt lgkmcnt(11)
    ds_read_b64_tr_b16 v[206:207], v65 offset:50176
    v_mfma_f32_16x16x32_bf16 v[136:139], v[240:243], a[240:243], v[136:139]
    ds_read_b64_tr_b16 v[208:209], v66 offset:45056
    v_mfma_f32_16x16x32_bf16 v[136:139], v[244:247], a[248:251], v[136:139]
    ds_read_b64_tr_b16 v[210:211], v66 offset:46080
    v_mfma_f32_16x16x32_bf16 v[152:155], v[240:243], a[244:247], v[152:155]
    ds_read_b64_tr_b16 v[212:213], v66 offset:49152
    global_load_dwordx4 a[188:191], v1, s[14:15] offset:2048
    v_mfma_f32_16x16x32_bf16 v[152:155], v[244:247], a[252:255], v[152:155]
    s_waitcnt lgkmcnt(11)
    ds_read_b64_tr_b16 v[214:215], v66 offset:50176
    v_mfma_f32_16x16x32_bf16 v[140:143], v[248:251], a[240:243], v[140:143]
    ds_read_b64_tr_b16 v[216:217], v67 offset:45056
    v_mfma_f32_16x16x32_bf16 v[140:143], v[252:255], a[248:251], v[140:143]
    ds_read_b64_tr_b16 v[218:219], v67 offset:46080
    v_mfma_f32_16x16x32_bf16 v[156:159], v[248:251], a[244:247], v[156:159]
    ds_read_b64_tr_b16 v[220:221], v67 offset:49152
    global_load_dwordx4 a[192:195], v1, s[14:15] offset:3072
    v_mfma_f32_16x16x32_bf16 v[156:159], v[252:255], a[252:255], v[156:159]
    s_waitcnt vmcnt(11) lgkmcnt(11)
    ds_read_b64_tr_b16 v[222:223], v67 offset:50176
    v_mfma_f32_16x16x32_bf16 v[128:131], v[192:195], v[36:39], v[128:131]
    s_xor_b32 s29, s0, 49152
    ds_read_b64_tr_b16 v[224:225], v64 offset:53248
    v_mfma_f32_16x16x32_bf16 v[128:131], v[196:199], v[76:79], v[128:131]
    s_add_u32 s12, s60, s29
    ds_read_b64_tr_b16 v[226:227], v64 offset:54272
    v_mfma_f32_16x16x32_bf16 v[144:147], v[192:195], v[40:43], v[144:147]
    s_addc_u32 s13, s61, 0
    ds_read_b64_tr_b16 v[228:229], v64 offset:57344
    global_load_dwordx4 a[196:199], v1, s[12:13] offset:-4096
    v_mfma_f32_16x16x32_bf16 v[144:147], v[196:199], a[208:211], v[144:147]
    s_waitcnt lgkmcnt(11)
    ds_read_b64_tr_b16 v[230:231], v64 offset:58368
    v_mfma_f32_16x16x32_bf16 v[132:135], v[200:203], v[36:39], v[132:135]
    ds_read_b64_tr_b16 v[232:233], v65 offset:53248
    v_mfma_f32_16x16x32_bf16 v[132:135], v[204:207], v[76:79], v[132:135]
    ds_read_b64_tr_b16 v[234:235], v65 offset:54272
    v_mfma_f32_16x16x32_bf16 v[148:151], v[200:203], v[40:43], v[148:151]
    ds_read_b64_tr_b16 v[236:237], v65 offset:57344
    global_load_dwordx4 a[200:203], v1, s[12:13] offset:-3072
    v_mfma_f32_16x16x32_bf16 v[148:151], v[204:207], a[208:211], v[148:151]
    s_waitcnt lgkmcnt(11)
    ds_read_b64_tr_b16 v[238:239], v65 offset:58368
    v_mfma_f32_16x16x32_bf16 v[136:139], v[208:211], v[36:39], v[136:139]
    ds_read_b64_tr_b16 v[240:241], v66 offset:53248
    v_mfma_f32_16x16x32_bf16 v[136:139], v[212:215], v[76:79], v[136:139]
    ds_read_b64_tr_b16 v[242:243], v66 offset:54272
    v_mfma_f32_16x16x32_bf16 v[152:155], v[208:211], v[40:43], v[152:155]
    ds_read_b64_tr_b16 v[244:245], v66 offset:57344
    global_load_dwordx4 a[204:207], v1, s[12:13] offset:-2048
    v_mfma_f32_16x16x32_bf16 v[152:155], v[212:215], a[208:211], v[152:155]
    s_waitcnt lgkmcnt(11)
    ds_read_b64_tr_b16 v[246:247], v66 offset:58368
    v_mfma_f32_16x16x32_bf16 v[140:143], v[216:219], v[36:39], v[140:143]
    ds_read_b64_tr_b16 v[248:249], v67 offset:53248
    v_mfma_f32_16x16x32_bf16 v[140:143], v[220:223], v[76:79], v[140:143]
    ds_read_b64_tr_b16 v[250:251], v67 offset:54272
    v_mfma_f32_16x16x32_bf16 v[156:159], v[216:219], v[40:43], v[156:159]
    ds_read_b64_tr_b16 v[252:253], v67 offset:57344
    global_load_dwordx4 a[216:219], v1, s[12:13] offset:-1024
    v_mfma_f32_16x16x32_bf16 v[156:159], v[220:223], a[208:211], v[156:159]
    s_waitcnt vmcnt(11) lgkmcnt(11)
    ds_read_b64_tr_b16 v[254:255], v67 offset:58368
    s_waitcnt vmcnt(8)
    s_barrier
    v_mfma_f32_16x16x32_bf16 v[128:131], v[224:227], a[212:215], v[128:131]
    ds_read_b64_tr_b16 v[192:193], v64 offset:61440
    v_mfma_f32_16x16x32_bf16 v[128:131], v[228:231], a[236:239], v[128:131]
    ds_read_b64_tr_b16 v[194:195], v64 offset:62464
    v_mfma_f32_16x16x32_bf16 v[144:147], v[224:227], a[232:235], v[144:147]
    ds_read_b64_tr_b16 v[196:197], v68 offset:0
    global_load_dwordx4 a[220:223], v1, s[12:13] offset:0
    v_mfma_f32_16x16x32_bf16 v[144:147], v[228:231], a[176:179], v[144:147]
    s_waitcnt lgkmcnt(11)
    ds_read_b64_tr_b16 v[198:199], v68 offset:1024
    v_mfma_f32_16x16x32_bf16 v[132:135], v[232:235], a[212:215], v[132:135]
    ds_read_b64_tr_b16 v[200:201], v65 offset:61440
    v_mfma_f32_16x16x32_bf16 v[132:135], v[236:239], a[236:239], v[132:135]
    ds_read_b64_tr_b16 v[202:203], v65 offset:62464
    v_mfma_f32_16x16x32_bf16 v[148:151], v[232:235], a[232:235], v[148:151]
    ds_read_b64_tr_b16 v[204:205], v69 offset:0
    global_load_dwordx4 a[224:227], v1, s[12:13] offset:1024
    v_mfma_f32_16x16x32_bf16 v[148:151], v[236:239], a[176:179], v[148:151]
    s_waitcnt lgkmcnt(11)
    ds_read_b64_tr_b16 v[206:207], v69 offset:1024
    v_mfma_f32_16x16x32_bf16 v[136:139], v[240:243], a[212:215], v[136:139]
    ds_read_b64_tr_b16 v[208:209], v66 offset:61440
    v_mfma_f32_16x16x32_bf16 v[136:139], v[244:247], a[236:239], v[136:139]
    ds_read_b64_tr_b16 v[210:211], v66 offset:62464
    v_mfma_f32_16x16x32_bf16 v[152:155], v[240:243], a[232:235], v[152:155]
    ds_read_b64_tr_b16 v[212:213], v70 offset:0
    global_load_dwordx4 a[228:231], v1, s[12:13] offset:2048
    v_mfma_f32_16x16x32_bf16 v[152:155], v[244:247], a[176:179], v[152:155]
    s_waitcnt lgkmcnt(11)
    ds_read_b64_tr_b16 v[214:215], v70 offset:1024
    v_mfma_f32_16x16x32_bf16 v[140:143], v[248:251], a[212:215], v[140:143]
    ds_read_b64_tr_b16 v[216:217], v67 offset:61440
    v_mfma_f32_16x16x32_bf16 v[140:143], v[252:255], a[236:239], v[140:143]
    ds_read_b64_tr_b16 v[218:219], v67 offset:62464
    v_mfma_f32_16x16x32_bf16 v[156:159], v[248:251], a[232:235], v[156:159]
    ds_read_b64_tr_b16 v[220:221], v71 offset:0
    global_load_dwordx4 a[0:3], v1, s[12:13] offset:3072
    v_mfma_f32_16x16x32_bf16 v[156:159], v[252:255], a[176:179], v[156:159]
    s_waitcnt vmcnt(8) lgkmcnt(11)
    ds_read_b64_tr_b16 v[222:223], v71 offset:1024
    v_mfma_f32_16x16x32_bf16 v[128:131], v[192:195], a[180:183], v[128:131]
    s_xor_b32 s29, s0, 57344
    ds_read_b64_tr_b16 v[224:225], v68 offset:4096
    v_mfma_f32_16x16x32_bf16 v[128:131], v[196:199], a[188:191], v[128:131]
    s_add_u32 s14, s60, s29
    ds_read_b64_tr_b16 v[226:227], v68 offset:5120
    v_mfma_f32_16x16x32_bf16 v[144:147], v[192:195], a[184:187], v[144:147]
    s_addc_u32 s15, s61, 0
    ds_read_b64_tr_b16 v[228:229], v68 offset:8192
    global_load_dwordx4 a[4:7], v1, s[14:15] offset:-4096
    v_mfma_f32_16x16x32_bf16 v[144:147], v[196:199], a[192:195], v[144:147]
    s_waitcnt lgkmcnt(11)
    ds_read_b64_tr_b16 v[230:231], v68 offset:9216
    v_mfma_f32_16x16x32_bf16 v[132:135], v[200:203], a[180:183], v[132:135]
    ds_read_b64_tr_b16 v[232:233], v69 offset:4096
    v_mfma_f32_16x16x32_bf16 v[132:135], v[204:207], a[188:191], v[132:135]
    ds_read_b64_tr_b16 v[234:235], v69 offset:5120
    v_mfma_f32_16x16x32_bf16 v[148:151], v[200:203], a[184:187], v[148:151]
    ds_read_b64_tr_b16 v[236:237], v69 offset:8192
    global_load_dwordx4 a[8:11], v1, s[14:15] offset:-3072
    v_mfma_f32_16x16x32_bf16 v[148:151], v[204:207], a[192:195], v[148:151]
    s_waitcnt lgkmcnt(11)
    ds_read_b64_tr_b16 v[238:239], v69 offset:9216
    v_mfma_f32_16x16x32_bf16 v[136:139], v[208:211], a[180:183], v[136:139]
    ds_read_b64_tr_b16 v[240:241], v70 offset:4096
    v_mfma_f32_16x16x32_bf16 v[136:139], v[212:215], a[188:191], v[136:139]
    ds_read_b64_tr_b16 v[242:243], v70 offset:5120
    v_mfma_f32_16x16x32_bf16 v[152:155], v[208:211], a[184:187], v[152:155]
    ds_read_b64_tr_b16 v[244:245], v70 offset:8192
    global_load_dwordx4 a[12:15], v1, s[14:15] offset:-2048
    v_mfma_f32_16x16x32_bf16 v[152:155], v[212:215], a[192:195], v[152:155]
    s_waitcnt lgkmcnt(11)
    ds_read_b64_tr_b16 v[246:247], v70 offset:9216
    v_mfma_f32_16x16x32_bf16 v[140:143], v[216:219], a[180:183], v[140:143]
    ds_read_b64_tr_b16 v[248:249], v71 offset:4096
    v_mfma_f32_16x16x32_bf16 v[140:143], v[220:223], a[188:191], v[140:143]
    ds_read_b64_tr_b16 v[250:251], v71 offset:5120
    v_mfma_f32_16x16x32_bf16 v[156:159], v[216:219], a[184:187], v[156:159]
    ds_read_b64_tr_b16 v[252:253], v71 offset:8192
    global_load_dwordx4 a[16:19], v1, s[14:15] offset:-1024
    v_mfma_f32_16x16x32_bf16 v[156:159], v[220:223], a[192:195], v[156:159]
    s_waitcnt vmcnt(8) lgkmcnt(11)
    ds_read_b64_tr_b16 v[254:255], v71 offset:9216
    v_mfma_f32_16x16x32_bf16 v[128:131], v[224:227], a[196:199], v[128:131]
    ds_read_b64_tr_b16 v[192:193], v68 offset:12288
    v_mfma_f32_16x16x32_bf16 v[128:131], v[228:231], a[204:207], v[128:131]
    ds_read_b64_tr_b16 v[194:195], v68 offset:13312
    v_mfma_f32_16x16x32_bf16 v[144:147], v[224:227], a[200:203], v[144:147]
    ds_read_b64_tr_b16 v[196:197], v68 offset:16384
    global_load_dwordx4 a[20:23], v1, s[14:15] offset:0
    v_mfma_f32_16x16x32_bf16 v[144:147], v[228:231], a[216:219], v[144:147]
    s_waitcnt lgkmcnt(11)
    ds_read_b64_tr_b16 v[198:199], v68 offset:17408
    v_mfma_f32_16x16x32_bf16 v[132:135], v[232:235], a[196:199], v[132:135]
hook20:
    s_cbranch_execz hook_end
    ds_read_b64_tr_b16 v[200:201], v69 offset:12288
    v_mfma_f32_16x16x32_bf16 v[132:135], v[236:239], a[204:207], v[132:135]
    ds_read_b64_tr_b16 v[202:203], v69 offset:13312
    v_mfma_f32_16x16x32_bf16 v[148:151], v[232:235], a[200:203], v[148:151]
    ds_read_b64_tr_b16 v[204:205], v69 offset:16384
    global_load_dwordx4 a[24:27], v1, s[14:15] offset:1024
    v_mfma_f32_16x16x32_bf16 v[148:151], v[236:239], a[216:219], v[148:151]
    s_waitcnt lgkmcnt(11)
    ds_read_b64_tr_b16 v[206:207], v69 offset:17408
    v_mfma_f32_16x16x32_bf16 v[136:139], v[240:243], a[196:199], v[136:139]
    ds_read_b64_tr_b16 v[208:209], v70 offset:12288
    v_mfma_f32_16x16x32_bf16 v[136:139], v[244:247], a[204:207], v[136:139]
    ds_read_b64_tr_b16 v[210:211], v70 offset:13312
    v_mfma_f32_16x16x32_bf16 v[152:155], v[240:243], a[200:203], v[152:155]
    ds_read_b64_tr_b16 v[212:213], v70 offset:16384
    global_load_dwordx4 a[28:31], v1, s[14:15] offset:2048
    v_mfma_f32_16x16x32_bf16 v[152:155], v[244:247], a[216:219], v[152:155]
    s_waitcnt lgkmcnt(11)
    ds_read_b64_tr_b16 v[214:215], v70 offset:17408
    v_mfma_f32_16x16x32_bf16 v[140:143], v[248:251], a[196:199], v[140:143]
    ds_read_b64_tr_b16 v[216:217], v71 offset:12288
    v_mfma_f32_16x16x32_bf16 v[140:143], v[252:255], a[204:207], v[140:143]
    ds_read_b64_tr_b16 v[218:219], v71 offset:13312
    v_mfma_f32_16x16x32_bf16 v[156:159], v[248:251], a[200:203], v[156:159]
    ds_read_b64_tr_b16 v[220:221], v71 offset:16384
    global_load_dwordx4 a[160:163], v1, s[14:15] offset:3072
    v_mfma_f32_16x16x32_bf16 v[156:159], v[252:255], a[216:219], v[156:159]
    s_waitcnt vmcnt(8) lgkmcnt(11)
    ds_read_b64_tr_b16 v[222:223], v71 offset:17408
    v_mfma_f32_16x16x32_bf16 v[128:131], v[192:195], a[220:223], v[128:131]
    ds_read_b64_tr_b16 v[224:225], v68 offset:20480
    v_mfma_f32_16x16x32_bf16 v[128:131], v[196:199], a[228:231], v[128:131]
    ds_read_b64_tr_b16 v[226:227], v68 offset:21504
    v_mfma_f32_16x16x32_bf16 v[144:147], v[192:195], a[224:227], v[144:147]
    ds_read_b64_tr_b16 v[228:229], v68 offset:24576
    v_mfma_f32_16x16x32_bf16 v[144:147], v[196:199], a[0:3], v[144:147]
    s_waitcnt lgkmcnt(11)
    ds_read_b64_tr_b16 v[230:231], v68 offset:25600
    v_mfma_f32_16x16x32_bf16 v[132:135], v[200:203], a[220:223], v[132:135]
    ds_read_b64_tr_b16 v[232:233], v69 offset:20480
    v_mfma_f32_16x16x32_bf16 v[132:135], v[204:207], a[228:231], v[132:135]
    ds_read_b64_tr_b16 v[234:235], v69 offset:21504
    v_mfma_f32_16x16x32_bf16 v[148:151], v[200:203], a[224:227], v[148:151]
    ds_read_b64_tr_b16 v[236:237], v69 offset:24576
    s_add_u32 s33, s35, 0
    buffer_store_dwordx4 v[80:83], v15, s[16:19], s33 offen sc1
    v_mfma_f32_16x16x32_bf16 v[148:151], v[204:207], a[0:3], v[148:151]
    s_waitcnt lgkmcnt(11)
    ds_read_b64_tr_b16 v[238:239], v69 offset:25600
    v_mfma_f32_16x16x32_bf16 v[136:139], v[208:211], a[220:223], v[136:139]
    ds_read_b64_tr_b16 v[240:241], v70 offset:20480
    v_mfma_f32_16x16x32_bf16 v[136:139], v[212:215], a[228:231], v[136:139]
    ds_read_b64_tr_b16 v[242:243], v70 offset:21504
    v_mfma_f32_16x16x32_bf16 v[152:155], v[208:211], a[224:227], v[152:155]
    ds_read_b64_tr_b16 v[244:245], v70 offset:24576
    v_mfma_f32_16x16x32_bf16 v[152:155], v[212:215], a[0:3], v[152:155]
    s_waitcnt lgkmcnt(11)
    ds_read_b64_tr_b16 v[246:247], v70 offset:25600
    v_mfma_f32_16x16x32_bf16 v[140:143], v[216:219], a[220:223], v[140:143]
    ds_read_b64_tr_b16 v[248:249], v71 offset:20480
    v_mfma_f32_16x16x32_bf16 v[140:143], v[220:223], a[228:231], v[140:143]
    ds_read_b64_tr_b16 v[250:251], v71 offset:21504
    v_mfma_f32_16x16x32_bf16 v[156:159], v[216:219], a[224:227], v[156:159]
    ds_read_b64_tr_b16 v[252:253], v71 offset:24576
    s_add_u32 s33, s35, 32768
    buffer_store_dwordx4 v[84:87], v15, s[16:19], s33 offen sc1
    v_mfma_f32_16x16x32_bf16 v[156:159], v[220:223], a[0:3], v[156:159]
    s_waitcnt vmcnt(6) lgkmcnt(11)
    ds_read_b64_tr_b16 v[254:255], v71 offset:25600
    v_mfma_f32_16x16x32_bf16 v[128:131], v[224:227], a[4:7], v[128:131]
    ds_read_b64_tr_b16 v[192:193], v68 offset:28672
    v_mfma_f32_16x16x32_bf16 v[128:131], v[228:231], a[12:15], v[128:131]
    ds_read_b64_tr_b16 v[194:195], v68 offset:29696
    v_mfma_f32_16x16x32_bf16 v[144:147], v[224:227], a[8:11], v[144:147]
    ds_read_b64_tr_b16 v[196:197], v68 offset:32768
    v_mfma_f32_16x16x32_bf16 v[144:147], v[228:231], a[16:19], v[144:147]
    s_waitcnt lgkmcnt(11)
    ds_read_b64_tr_b16 v[198:199], v68 offset:33792
    v_mfma_f32_16x16x32_bf16 v[132:135], v[232:235], a[4:7], v[132:135]
    ds_read_b64_tr_b16 v[200:201], v69 offset:28672
    v_mfma_f32_16x16x32_bf16 v[132:135], v[236:239], a[12:15], v[132:135]
    ds_read_b64_tr_b16 v[202:203], v69 offset:29696
    v_mfma_f32_16x16x32_bf16 v[148:151], v[232:235], a[8:11], v[148:151]
    ds_read_b64_tr_b16 v[204:205], v69 offset:32768
    s_add_u32 s33, s35, 65536
    buffer_store_dwordx4 v[88:91], v15, s[16:19], s33 offen sc1
    v_mfma_f32_16x16x32_bf16 v[148:151], v[236:239], a[16:19], v[148:151]
    s_waitcnt lgkmcnt(11)
    ds_read_b64_tr_b16 v[206:207], v69 offset:33792
    v_mfma_f32_16x16x32_bf16 v[136:139], v[240:243], a[4:7], v[136:139]
    ds_read_b64_tr_b16 v[208:209], v70 offset:28672
    v_mfma_f32_16x16x32_bf16 v[136:139], v[244:247], a[12:15], v[136:139]
    ds_read_b64_tr_b16 v[210:211], v70 offset:29696
    v_mfma_f32_16x16x32_bf16 v[152:155], v[240:243], a[8:11], v[152:155]
    ds_read_b64_tr_b16 v[212:213], v70 offset:32768
    v_mfma_f32_16x16x32_bf16 v[152:155], v[244:247], a[16:19], v[152:155]
    s_waitcnt lgkmcnt(11)
    ds_read_b64_tr_b16 v[214:215], v70 offset:33792
    v_mfma_f32_16x16x32_bf16 v[140:143], v[248:251], a[4:7], v[140:143]
    ds_read_b64_tr_b16 v[216:217], v71 offset:28672
    v_mfma_f32_16x16x32_bf16 v[140:143], v[252:255], a[12:15], v[140:143]
    ds_read_b64_tr_b16 v[218:219], v71 offset:29696
    v_mfma_f32_16x16x32_bf16 v[156:159], v[248:251], a[8:11], v[156:159]
    ds_read_b64_tr_b16 v[220:221], v71 offset:32768
    s_add_u32 s33, s35, 98304
    buffer_store_dwordx4 v[92:95], v15, s[16:19], s33 offen sc1
    v_mfma_f32_16x16x32_bf16 v[156:159], v[252:255], a[16:19], v[156:159]
    s_waitcnt vmcnt(4) lgkmcnt(11)
    ds_read_b64_tr_b16 v[222:223], v71 offset:33792
    v_mfma_f32_16x16x32_bf16 v[128:131], v[192:195], a[20:23], v[128:131]
    v_mfma_f32_16x16x32_bf16 v[128:131], v[196:199], a[28:31], v[128:131]
    v_mfma_f32_16x16x32_bf16 v[144:147], v[192:195], a[24:27], v[144:147]
    v_mfma_f32_16x16x32_bf16 v[144:147], v[196:199], a[160:163], v[144:147]
    s_waitcnt lgkmcnt(8)
    v_mfma_f32_16x16x32_bf16 v[132:135], v[200:203], a[20:23], v[132:135]
    v_mfma_f32_16x16x32_bf16 v[132:135], v[204:207], a[28:31], v[132:135]
    v_mfma_f32_16x16x32_bf16 v[148:151], v[200:203], a[24:27], v[148:151]
    v_mfma_f32_16x16x32_bf16 v[148:151], v[204:207], a[160:163], v[148:151]
    s_waitcnt lgkmcnt(4)
    v_mfma_f32_16x16x32_bf16 v[136:139], v[208:211], a[20:23], v[136:139]
    v_mfma_f32_16x16x32_bf16 v[136:139], v[212:215], a[28:31], v[136:139]
    v_mfma_f32_16x16x32_bf16 v[152:155], v[208:211], a[24:27], v[152:155]
    v_mfma_f32_16x16x32_bf16 v[152:155], v[212:215], a[160:163], v[152:155]
    s_waitcnt lgkmcnt(0)
    v_mfma_f32_16x16x32_bf16 v[140:143], v[216:219], a[20:23], v[140:143]
    v_mfma_f32_16x16x32_bf16 v[140:143], v[220:223], a[28:31], v[140:143]
    v_mfma_f32_16x16x32_bf16 v[156:159], v[216:219], a[24:27], v[156:159]
    v_mfma_f32_16x16x32_bf16 v[156:159], v[220:223], a[160:163], v[156:159]
    s_nop 0
    v_cvt_pk_bf16_f32 v128, v128, v129
    v_cvt_pk_bf16_f32 v129, v130, v131
    v_cvt_pk_bf16_f32 v144, v144, v145
    v_cvt_pk_bf16_f32 v145, v146, v147
    v_cvt_pk_bf16_f32 v132, v132, v133
    v_cvt_pk_bf16_f32 v133, v134, v135
    v_cvt_pk_bf16_f32 v148, v148, v149
    v_cvt_pk_bf16_f32 v149, v150, v151
    v_cvt_pk_bf16_f32 v136, v136, v137
    v_cvt_pk_bf16_f32 v137, v138, v139
    v_cvt_pk_bf16_f32 v152, v152, v153
    v_cvt_pk_bf16_f32 v153, v154, v155
    v_cvt_pk_bf16_f32 v140, v140, v141
    v_cvt_pk_bf16_f32 v141, v142, v143
    v_cvt_pk_bf16_f32 v156, v156, v157
    v_cvt_pk_bf16_f32 v157, v158, v159
    ds_write_b64 v10, v[128:129] offset:0
    ds_write_b64 v10, v[144:145] offset:2048
    ds_write_b64 v12, v[132:133] offset:0
    ds_write_b64 v12, v[148:149] offset:2048
    ds_write_b64 v13, v[136:137] offset:0
    ds_write_b64 v13, v[152:153] offset:2048
    ds_write_b64 v14, v[140:141] offset:0
    ds_write_b64 v14, v[156:157] offset:2048
    ds_read_b128 v[128:131], v0 offset:0
    ds_read_b128 v[132:135], v0 offset:1024
    ds_read_b128 v[136:139], v0 offset:2048
    ds_read_b128 v[140:143], v0 offset:3072
    s_waitcnt lgkmcnt(3)
    s_add_u32 s33, s35, 2048
    buffer_store_dwordx4 v[128:131], v15, s[16:19], s33 offen sc1
    s_waitcnt lgkmcnt(2)
    s_add_u32 s33, s35, 34816
    buffer_store_dwordx4 v[132:135], v15, s[16:19], s33 offen sc1
    s_waitcnt lgkmcnt(1)
    s_add_u32 s33, s35, 67584
    buffer_store_dwordx4 v[136:139], v15, s[16:19], s33 offen sc1
    s_waitcnt lgkmcnt(0)
    s_add_u32 s33, s35, 100352
    buffer_store_dwordx4 v[140:143], v15, s[16:19], s33 offen sc1
fz_end:
    s_endpgm
g2_late:
    v_mfma_f32_16x16x32_bf16 v[80:83], v[224:227], a[196:199], v[80:83]
    s_xor_b32 s28, s1, 0x1c0000
    ds_read_b64_tr_b16 v[192:193], v68 offset:45056
    s_add_u32 m0, s30, 86016
    v_mfma_f32_16x16x32_bf16 v[80:83], v[228:231], a[204:207], v[80:83]
    s_add_u32 s46, s44, s28
    ds_read_b64_tr_b16 v[194:195], v68 offset:46080
    v_mfma_f32_16x16x32_bf16 v[96:99], v[224:227], a[200:203], v[96:99]
    s_addc_u32 s47, s45, 0
    ds_read_b64_tr_b16 v[196:197], v68 offset:49152
    global_load_lds_dwordx4 v9, s[46:47]
    v_mfma_f32_16x16x32_bf16 v[96:99], v[228:231], a[216:219], v[96:99]
    s_waitcnt lgkmcnt(11)
    ds_read_b64_tr_b16 v[198:199], v68 offset:50176
    v_mfma_f32_16x16x32_bf16 v[84:87], v[232:235], a[196:199], v[84:87]
    ds_read_b64_tr_b16 v[200:201], v69 offset:45056
    v_mfma_f32_16x16x32_bf16 v[84:87], v[236:239], a[204:207], v[84:87]
    ds_read_b64_tr_b16 v[202:203], v69 offset:46080
    v_mfma_f32_16x16x32_bf16 v[100:103], v[232:235], a[200:203], v[100:103]
    ds_read_b64_tr_b16 v[204:205], v69 offset:49152
    v_mfma_f32_16x16x32_bf16 v[100:103], v[236:239], a[216:219], v[100:103]
    s_waitcnt lgkmcnt(11)
    ds_read_b64_tr_b16 v[206:207], v69 offset:50176
    v_mfma_f32_16x16x32_bf16 v[88:91], v[240:243], a[196:199], v[88:91]
    ds_read_b64_tr_b16 v[208:209], v70 offset:45056
    v_mfma_f32_16x16x32_bf16 v[88:91], v[244:247], a[204:207], v[88:91]
    ds_read_b64_tr_b16 v[210:211], v70 offset:46080
    v_mfma_f32_16x16x32_bf16 v[104:107], v[240:243], a[200:203], v[104:107]
    ds_read_b64_tr_b16 v[212:213], v70 offset:49152
    v_mfma_f32_16x16x32_bf16 v[104:107], v[244:247], a[216:219], v[104:107]
    s_waitcnt lgkmcnt(11)
    ds_read_b64_tr_b16 v[214:215], v70 offset:50176
    v_mfma_f32_16x16x32_bf16 v[92:95], v[248:251], a[196:199], v[92:95]
    ds_read_b64_tr_b16 v[216:217], v71 offset:45056
    v_mfma_f32_16x16x32_bf16 v[92:95], v[252:255], a[204:207], v[92:95]
    ds_read_b64_tr_b16 v[218:219], v71 offset:46080
    v_mfma_f32_16x16x32_bf16 v[108:111], v[248:251], a[200:203], v[108:111]
    ds_read_b64_tr_b16 v[220:221], v71 offset:49152
    v_mfma_f32_16x16x32_bf16 v[108:111], v[252:255], a[216:219], v[108:111]
    s_waitcnt lgkmcnt(11)
    ds_read_b64_tr_b16 v[222:223], v71 offset:50176
    v_mfma_f32_16x16x32_bf16 v[80:83], v[192:195], a[220:223], v[80:83]
    ds_read_b64_tr_b16 v[224:225], v68 offset:53248
    v_mfma_f32_16x16x32_bf16 v[80:83], v[196:199], a[228:231], v[80:83]
    ds_read_b64_tr_b16 v[226:227], v68 offset:54272
    v_mfma_f32_16x16x32_bf16 v[96:99], v[192:195], a[224:227], v[96:99]
    ds_read_b64_tr_b16 v[228:229], v68 offset:57344
    v_mfma_f32_16x16x32_bf16 v[96:99], v[196:199], a[0:3], v[96:99]
    s_waitcnt lgkmcnt(11)
    ds_read_b64_tr_b16 v[230:231], v68 offset:58368
    v_mfma_f32_16x16x32_bf16 v[84:87], v[200:203], a[220:223], v[84:87]
    ds_read_b64_tr_b16 v[232:233], v69 offset:53248
    v_mfma_f32_16x16x32_bf16 v[84:87], v[204:207], a[228:231], v[84:87]
    ds_read_b64_tr_b16 v[234:235], v69 offset:54272
    v_mfma_f32_16x16x32_bf16 v[100:103], v[200:203], a[224:227], v[100:103]
    ds_read_b64_tr_b16 v[236:237], v69 offset:57344
    v_mfma_f32_16x16x32_bf16 v[100:103], v[204:207], a[0:3], v[100:103]
    s_waitcnt lgkmcnt(11)
    ds_read_b64_tr_b16 v[238:239], v69 offset:58368
    v_mfma_f32_16x16x32_bf16 v[88:91], v[208:211], a[220:223], v[88:91]
    ds_read_b64_tr_b16 v[240:241], v70 offset:53248
    v_mfma_f32_16x16x32_bf16 v[88:91], v[212:215], a[228:231], v[88:91]
    ds_read_b64_tr_b16 v[242:243], v70 offset:54272
    v_mfma_f32_16x16x32_bf16 v[104:107], v[208:211], a[224:227], v[104:107]
    ds_read_b64_tr_b16 v[244:245], v70 offset:57344
    v_mfma_f32_16x16x32_bf16 v[104:107], v[212:215], a[0:3], v[104:107]
    s_waitcnt lgkmcnt(11)
    ds_read_b64_tr_b16 v[246:247], v70 offset:58368
    v_mfma_f32_16x16x32_bf16 v[92:95], v[216:219], a[220:223], v[92:95]
    ds_read_b64_tr_b16 v[248:249], v71 offset:53248
    v_mfma_f32_16x16x32_bf16 v[92:95], v[220:223], a[228:231], v[92:95]
    ds_read_b64_tr_b16 v[250:251], v71 offset:54272
    v_mfma_f32_16x16x32_bf16 v[108:111], v[216:219], a[224:227], v[108:111]
    ds_read_b64_tr_b16 v[252:253], v71 offset:57344
    v_mfma_f32_16x16x32_bf16 v[108:111], v[220:223], a[0:3], v[108:111]
    s_waitcnt lgkmcnt(11)
    ds_read_b64_tr_b16 v[254:255], v71 offset:58368
    v_mfma_f32_16x16x32_bf16 v[80:83], v[224:227], a[4:7], v[80:83]
    ds_read_b64_tr_b16 v[192:193], v68 offset:61440
    v_mfma_f32_16x16x32_bf16 v[80:83], v[228:231], a[12:15], v[80:83]
    ds_read_b64_tr_b16 v[194:195], v68 offset:62464
    v_mfma_f32_16x16x32_bf16 v[96:99], v[224:227], a[8:11], v[96:99]
    ds_read_b64_tr_b16 v[196:197], v64 offset:0
    v_mfma_f32_16x16x32_bf16 v[96:99], v[228:231], a[16:19], v[96:99]
    s_waitcnt lgkmcnt(11)
    ds_read_b64_tr_b16 v[198:199], v64 offset:1024
    v_mfma_f32_16x16x32_bf16 v[84:87], v[232:235], a[4:7], v[84:87]
    ds_read_b64_tr_b16 v[200:201], v69 offset:61440
    v_mfma_f32_16x16x32_bf16 v[84:87], v[236:239], a[12:15], v[84:87]
    ds_read_b64_tr_b16 v[202:203], v69 offset:62464
    v_mfma_f32_16x16x32_bf16 v[100:103], v[232:235], a[8:11], v[100:103]
    ds_read_b64_tr_b16 v[204:205], v65 offset:0
    v_mfma_f32_16x16x32_bf16 v[100:103], v[236:239], a[16:19], v[100:103]
    s_waitcnt lgkmcnt(11)
    ds_read_b64_tr_b16 v[206:207], v65 offset:1024
    v_mfma_f32_16x16x32_bf16 v[88:91], v[240:243], a[4:7], v[88:91]
    ds_read_b64_tr_b16 v[208:209], v70 offset:61440
    v_mfma_f32_16x16x32_bf16 v[88:91], v[244:247], a[12:15], v[88:91]
    ds_read_b64_tr_b16 v[210:211], v70 offset:62464
    v_mfma_f32_16x16x32_bf16 v[104:107], v[240:243], a[8:11], v[104:107]
    ds_read_b64_tr_b16 v[212:213], v66 offset:0
    v_mfma_f32_16x16x32_bf16 v[104:107], v[244:247], a[16:19], v[104:107]
    s_waitcnt lgkmcnt(11)
    ds_read_b64_tr_b16 v[214:215], v66 offset:1024
    v_mfma_f32_16x16x32_bf16 v[92:95], v[248:251], a[4:7], v[92:95]
    ds_read_b64_tr_b16 v[216:217], v71 offset:61440
    v_mfma_f32_16x16x32_bf16 v[92:95], v[252:255], a[12:15], v[92:95]
    ds_read_b64_tr_b16 v[218:219], v71 offset:62464
    v_mfma_f32_16x16x32_bf16 v[108:111], v[248:251], a[8:11], v[108:111]
    ds_read_b64_tr_b16 v[220:221], v67 offset:0
    v_mfma_f32_16x16x32_bf16 v[108:111], v[252:255], a[16:19], v[108:111]
    s_waitcnt lgkmcnt(11)
    ds_read_b64_tr_b16 v[222:223], v67 offset:1024
    v_mfma_f32_16x16x32_bf16 v[80:83], v[192:195], a[20:23], v[80:83]
    ds_read_b64_tr_b16 v[224:225], v72 offset:0
    v_mfma_f32_16x16x32_bf16 v[80:83], v[196:199], a[28:31], v[80:83]
    ds_read_b64_tr_b16 v[226:227], v72 offset:1024
    v_mfma_f32_16x16x32_bf16 v[96:99], v[192:195], a[24:27], v[96:99]
    ds_read_b64_tr_b16 v[228:229], v72 offset:4096
    v_mfma_f32_16x16x32_bf16 v[96:99], v[196:199], a[160:163], v[96:99]
    s_waitcnt lgkmcnt(11)
    ds_read_b64_tr_b16 v[230:231], v72 offset:5120
    v_mfma_f32_16x16x32_bf16 v[84:87], v[200:203], a[20:23], v[84:87]
    ds_read_b64_tr_b16 v[232:233], v73 offset:0
    v_mfma_f32_16x16x32_bf16 v[84:87], v[204:207], a[28:31], v[84:87]
    ds_read_b64_tr_b16 v[234:235], v73 offset:1024
    v_mfma_f32_16x16x32_bf16 v[100:103], v[200:203], a[24:27], v[100:103]
    ds_read_b64_tr_b16 v[236:237], v73 offset:4096
    v_mfma_f32_16x16x32_bf16 v[100:103], v[204:207], a[160:163], v[100:103]
    s_waitcnt lgkmcnt(11)
    ds_read_b64_tr_b16 v[238:239], v73 offset:5120
    v_mfma_f32_16x16x32_bf16 v[88:91], v[208:211], a[20:23], v[88:91]
    ds_read_b64_tr_b16 v[240:241], v74 offset:0
    v_mfma_f32_16x16x32_bf16 v[88:91], v[212:215], a[28:31], v[88:91]
    ds_read_b64_tr_b16 v[242:243], v74 offset:1024
    v_mfma_f32_16x16x32_bf16 v[104:107], v[208:211], a[24:27], v[104:107]
    ds_read_b64_tr_b16 v[244:245], v74 offset:4096
    v_mfma_f32_16x16x32_bf16 v[104:107], v[212:215], a[160:163], v[104:107]
    s_waitcnt lgkmcnt(11)
    ds_read_b64_tr_b16 v[246:247], v74 offset:5120
    v_mfma_f32_16x16x32_bf16 v[92:95], v[216:219], a[20:23], v[92:95]
    ds_read_b64_tr_b16 v[248:249], v75 offset:0
    v_mfma_f32_16x16x32_bf16 v[92:95], v[220:223], a[28:31], v[92:95]
    ds_read_b64_tr_b16 v[250:251], v75 offset:1024
    v_mfma_f32_16x16x32_bf16 v[108:111], v[216:219], a[24:27], v[108:111]
    ds_read_b64_tr_b16 v[252:253], v75 offset:4096
    v_mfma_f32_16x16x32_bf16 v[108:111], v[220:223], a[160:163], v[108:111]
    s_waitcnt lgkmcnt(11)
    ds_read_b64_tr_b16 v[254:255], v75 offset:5120
    s_mov_b32 s25, 65536
pob_spin1:
    buffer_load_dword v5, v62, s[20:23], 0 offen offset:512 sc1
    s_waitcnt vmcnt(0)
    v_cmp_gt_u32 vcc, 1, v5
    s_cbranch_vccz pob_ok
    s_sleep 4
    s_sub_u32 s25, s25, 1
    s_cmp_lg_u32 s25, 0
    s_cbranch_scc1 pob_spin1
pob_ok:
    s_xor_b32 s29, s0, 0
    s_add_u32 s12, s60, s29
    s_addc_u32 s13, s61, 0
    global_load_dwordx4 a[32:35], v1, s[12:13] offset:-4096
    global_load_dwordx4 a[36:39], v1, s[12:13] offset:-3072
    global_load_dwordx4 a[40:43], v1, s[12:13] offset:-2048
    global_load_dwordx4 a[44:47], v1, s[12:13] offset:-1024
    global_load_dwordx4 a[48:51], v1, s[12:13] offset:0
    global_load_dwordx4 a[52:55], v1, s[12:13] offset:1024
    global_load_dwordx4 a[56:59], v1, s[12:13] offset:2048
    global_load_dwordx4 a[60:63], v1, s[12:13] offset:3072
    s_xor_b32 s29, s0, 8192
    s_add_u32 s14, s60, s29
    s_addc_u32 s15, s61, 0
    global_load_dwordx4 a[64:67], v1, s[14:15] offset:-4096
    global_load_dwordx4 a[68:71], v1, s[14:15] offset:-3072
    global_load_dwordx4 a[72:75], v1, s[14:15] offset:-2048
    global_load_dwordx4 a[76:79], v1, s[14:15] offset:-1024
    global_load_dwordx4 a[80:83], v1, s[14:15] offset:0
    global_load_dwordx4 a[84:87], v1, s[14:15] offset:1024
    global_load_dwordx4 a[88:91], v1, s[14:15] offset:2048
    s_branch g2_join
fz_code_end:
fb_fix1:
    s_nop 15
    s_lshl_b32 s71, s26, 1
    s_add_u32 s71, s71, 1
    s_sub_u32 s71, s71, s62
    v_accvgpr_read_b32 v112, a168
    v_accvgpr_read_b32 v113, a169
    v_accvgpr_read_b32 v114, a170
    v_accvgpr_read_b32 v115, a171
    v_accvgpr_read_b32 v116, a172
    v_accvgpr_read_b32 v117, a173
    v_accvgpr_read_b32 v118, a174
    v_accvgpr_read_b32 v119, a175
    s_mov_b32 s72, 1
    s_add_u32 s73, s63, 1
    s_getpc_b64 s[10:11]
    s_add_u32 s10, s10, att_slow-.
    s_addc_u32 s11, s11, 0
    s_swappc_b64 s[100:101], s[10:11]
    v_mov_b32 v176, v128
    v_mov_b32 v177, v129
    v_mov_b32 v178, v130
    v_mov_b32 v179, v131
    v_mov_b32 v180, v132
    v_mov_b32 v181, v133
    v_mov_b32 v182, v134
    v_mov_b32 v183, v135
    v_mov_b32 v184, v136
    v_mov_b32 v185, v137
    v_mov_b32 v186, v138
    v_mov_b32 v187, v139
    v_mov_b32 v188, v140
    v_mov_b32 v189, v141
    v_mov_b32 v190, v142
    v_mov_b32 v191, v143
    s_branch fb_ok1
fb_fix0:
    s_nop 15
    s_lshl_b32 s71, s26, 1
    s_add_u32 s71, s71, 1
    s_sub_u32 s71, s71, s62
    v_accvgpr_read_b32 v112, a160
    v_accvgpr_read_b32 v113, a161
    v_accvgpr_read_b32 v114, a162
    v_accvgpr_read_b32 v115, a163
    v_accvgpr_read_b32 v116, a164
    v_accvgpr_read_b32 v117, a165
    v_accvgpr_read_b32 v118, a166
    v_accvgpr_read_b32 v119, a167
    s_mov_b32 s72, 1
    s_add_u32 s73, s63, 0
    s_getpc_b64 s[10:11]
    s_add_u32 s10, s10, att_slow-.
    s_addc_u32 s11, s11, 0
    s_swappc_b64 s[100:101], s[10:11]
    v_mov_b32 v160, v128
    v_mov_b32 v161, v129
    v_mov_b32 v162, v130
    v_mov_b32 v163, v131
    v_mov_b32 v164, v132
    v_mov_b32 v165, v133
    v_mov_b32 v166, v134
    v_mov_b32 v167, v135
    v_mov_b32 v168, v136
    v_mov_b32 v169, v137
    v_mov_b32 v170, v138
    v_mov_b32 v171, v139
    v_mov_b32 v172, v140
    v_mov_b32 v173, v141
    v_mov_b32 v174, v142
    v_mov_b32 v175, v143
    s_branch fb_ok0
afa_fix1:
    s_nop 15
    s_mov_b32 s25, 65536
afa_w1_spin1:
    buffer_load_dword v5, v18, s[20:23], 0 offen offset:256 sc1
    s_waitcnt vmcnt(0)
    v_cmp_gt_u32 vcc, 1, v5
    s_cbranch_vccz afa_w1_ok
    s_sleep 4
    s_sub_u32 s25, s25, 1
    s_cmp_lg_u32 s25, 0
    s_cbranch_scc1 afa_w1_spin1
afa_w1_ok:
    v_accvgpr_write_b32 a32, v80
    v_accvgpr_write_b32 a33, v81
    v_accvgpr_write_b32 a34, v82
    v_accvgpr_write_b32 a35, v83
    v_accvgpr_write_b32 a36, v84
    v_accvgpr_write_b32 a37, v85
    v_accvgpr_write_b32 a38, v86
    v_accvgpr_write_b32 a39, v87
    v_accvgpr_write_b32 a40, v88
    v_accvgpr_write_b32 a41, v89
    v_accvgpr_write_b32 a42, v90
    v_accvgpr_write_b32 a43, v91
    v_accvgpr_write_b32 a44, v92
    v_accvgpr_write_b32 a45, v93
    v_accvgpr_write_b32 a46, v94
    v_accvgpr_write_b32 a47, v95
    v_accvgpr_write_b32 a48, v96
    v_accvgpr_write_b32 a49, v97
    v_accvgpr_write_b32 a50, v98
    v_accvgpr_write_b32 a51, v99
    v_accvgpr_write_b32 a52, v100
    v_accvgpr_write_b32 a53, v101
    v_accvgpr_write_b32 a54, v102
    v_accvgpr_write_b32 a55, v103
    v_accvgpr_write_b32 a56, v104
    v_accvgpr_write_b32 a57, v105
    v_accvgpr_write_b32 a58, v106
    v_accvgpr_write_b32 a59, v107
    v_accvgpr_write_b32 a60, v108
    v_accvgpr_write_b32 a61, v109
    v_accvgpr_write_b32 a62, v110
    v_accvgpr_write_b32 a63, v111
    v_accvgpr_write_b32 a64, v112
    v_accvgpr_write_b32 a65, v113
    v_accvgpr_write_b32 a66, v114
    v_accvgpr_write_b32 a67, v115
    v_accvgpr_write_b32 a68, v116
    v_accvgpr_write_b32 a69, v117
    v_accvgpr_write_b32 a70, v118
    v_accvgpr_write_b32 a71, v119
    v_accvgpr_write_b32 a72, v120
    v_accvgpr_write_b32 a73, v121
    v_accvgpr_write_b32 a74, v122
    v_accvgpr_write_b32 a75, v123
    v_accvgpr_write_b32 a76, v124
    v_accvgpr_write_b32 a77, v125
    v_accvgpr_write_b32 a78, v126
    v_accvgpr_write_b32 a79, v127
    s_mov_b32 s71, s51
    v_mov_b32 v112, v72
    v_mov_b32 v113, v73
    v_mov_b32 v114, v74
    v_mov_b32 v115, v75
    v_mov_b32 v116, v76
    v_mov_b32 v117, v77
    v_mov_b32 v118, v78
    v_mov_b32 v119, v79
    s_mov_b32 s72, 0
    s_add_u32 s73, s50, 1
    s_getpc_b64 s[10:11]
    s_add_u32 s10, s10, att_slow-.
    s_addc_u32 s11, s11, 0
    s_swappc_b64 s[100:101], s[10:11]
    v_mov_b32 v208, v128
    v_mov_b32 v209, v129
    v_mov_b32 v210, v130
    v_mov_b32 v211, v131
    v_mov_b32 v212, v132
    v_mov_b32 v213, v133
    v_mov_b32 v214, v134
    v_mov_b32 v215, v135
    v_mov_b32 v216, v136
    v_mov_b32 v217, v137
    v_mov_b32 v218, v138
    v_mov_b32 v219, v139
    v_mov_b32 v220, v140
    v_mov_b32 v221, v141
    v_mov_b32 v222, v142
    v_mov_b32 v223, v143
    v_accvgpr_read_b32 v80, a32
    v_accvgpr_read_b32 v81, a33
    v_accvgpr_read_b32 v82, a34
    v_accvgpr_read_b32 v83, a35
    v_accvgpr_read_b32 v84, a36
    v_accvgpr_read_b32 v85, a37
    v_accvgpr_read_b32 v86, a38
    v_accvgpr_read_b32 v87, a39
    v_accvgpr_read_b32 v88, a40
    v_accvgpr_read_b32 v89, a41
    v_accvgpr_read_b32 v90, a42
    v_accvgpr_read_b32 v91, a43
    v_accvgpr_read_b32 v92, a44
    v_accvgpr_read_b32 v93, a45
    v_accvgpr_read_b32 v94, a46
    v_accvgpr_read_b32 v95, a47
    v_accvgpr_read_b32 v96, a48
    v_accvgpr_read_b32 v97, a49
    v_accvgpr_read_b32 v98, a50
    v_accvgpr_read_b32 v99, a51
    v_accvgpr_read_b32 v100, a52
    v_accvgpr_read_b32 v101, a53
    v_accvgpr_read_b32 v102, a54
    v_accvgpr_read_b32 v103, a55
    v_accvgpr_read_b32 v104, a56
    v_accvgpr_read_b32 v105, a57
    v_accvgpr_read_b32 v106, a58
    v_accvgpr_read_b32 v107, a59
    v_accvgpr_read_b32 v108, a60
    v_accvgpr_read_b32 v109, a61
    v_accvgpr_read_b32 v110, a62
    v_accvgpr_read_b32 v111, a63
    v_accvgpr_read_b32 v112, a64
    v_accvgpr_read_b32 v113, a65
    v_accvgpr_read_b32 v114, a66
    v_accvgpr_read_b32 v115, a67
    v_accvgpr_read_b32 v116, a68
    v_accvgpr_read_b32 v117, a69
    v_accvgpr_read_b32 v118, a70
    v_accvgpr_read_b32 v119, a71
    v_accvgpr_read_b32 v120, a72
    v_accvgpr_read_b32 v121, a73
    v_accvgpr_read_b32 v122, a74
    v_accvgpr_read_b32 v123, a75
    v_accvgpr_read_b32 v124, a76
    v_accvgpr_read_b32 v125, a77
    v_accvgpr_read_b32 v126, a78
    v_accvgpr_read_b32 v127, a79
    v_mov_b32 v128, v16
    v_mov_b32 v129, v16
    v_mov_b64 v[130:131], v[128:129]
    v_mov_b64 v[132:133], v[128:129]
    v_mov_b64 v[134:135], v[128:129]
    v_mov_b64 v[136:137], v[128:129]
    v_mov_b64 v[138:139], v[128:129]
    v_mov_b64 v[140:141], v[128:129]
    v_mov_b64 v[142:143], v[128:129]
    v_mov_b32 v144, v17
    v_mov_b32 v145, v17
    v_mov_b64 v[146:147], v[144:145]
    v_mov_b64 v[148:149], v[144:145]
    v_mov_b64 v[150:151], v[144:145]
    v_mov_b64 v[152:153], v[144:145]
    v_mov_b64 v[154:155], v[144:145]
    v_mov_b64 v[156:157], v[144:145]
    v_mov_b64 v[158:159], v[144:145]
    s_branch afa_ok1
afa_fix0:
    s_nop 15
    s_mov_b32 s25, 65536
afa_w0_spin1:
    buffer_load_dword v5, v18, s[20:23], 0 offen offset:256 sc1
    s_waitcnt vmcnt(0)
    v_cmp_gt_u32 vcc, 1, v5
    s_cbranch_vccz afa_w0_ok
    s_sleep 4
    s_sub_u32 s25, s25, 1
    s_cmp_lg_u32 s25, 0
    s_cbranch_scc1 afa_w0_spin1
afa_w0_ok:
    v_accvgpr_write_b32 a32, v80
    v_accvgpr_write_b32 a33, v81
    v_accvgpr_write_b32 a34, v82
    v_accvgpr_write_b32 a35, v83
    v_accvgpr_write_b32 a36, v84
    v_accvgpr_write_b32 a37, v85
    v_accvgpr_write_b32 a38, v86
    v_accvgpr_write_b32 a39, v87
    v_accvgpr_write_b32 a40, v88
    v_accvgpr_write_b32 a41, v89
    v_accvgpr_write_b32 a42, v90
    v_accvgpr_write_b32 a43, v91
    v_accvgpr_write_b32 a44, v92
    v_accvgpr_write_b32 a45, v93
    v_accvgpr_write_b32 a46, v94
    v_accvgpr_write_b32 a47, v95
    v_accvgpr_write_b32 a48, v96
    v_accvgpr_write_b32 a49, v97
    v_accvgpr_write_b32 a50, v98
    v_accvgpr_write_b32 a51, v99
    v_accvgpr_write_b32 a52, v100
    v_accvgpr_write_b32 a53, v101
    v_accvgpr_write_b32 a54, v102
    v_accvgpr_write_b32 a55, v103
    v_accvgpr_write_b32 a56, v104
    v_accvgpr_write_b32 a57, v105
    v_accvgpr_write_b32 a58, v106
    v_accvgpr_write_b32 a59, v107
    v_accvgpr_write_b32 a60, v108
    v_accvgpr_write_b32 a61, v109
    v_accvgpr_write_b32 a62, v110
    v_accvgpr_write_b32 a63, v111
    v_accvgpr_write_b32 a64, v112
    v_accvgpr_write_b32 a65, v113
    v_accvgpr_write_b32 a66, v114
    v_accvgpr_write_b32 a67, v115
    v_accvgpr_write_b32 a68, v116
    v_accvgpr_write_b32 a69, v117
    v_accvgpr_write_b32 a70, v118
    v_accvgpr_write_b32 a71, v119
    v_accvgpr_write_b32 a72, v120
    v_accvgpr_write_b32 a73, v121
    v_accvgpr_write_b32 a74, v122
    v_accvgpr_write_b32 a75, v123
    v_accvgpr_write_b32 a76, v124
    v_accvgpr_write_b32 a77, v125
    v_accvgpr_write_b32 a78, v126
    v_accvgpr_write_b32 a79, v127
    s_mov_b32 s71, s51
    v_mov_b32 v112, v64
    v_mov_b32 v113, v65
    v_mov_b32 v114, v66
    v_mov_b32 v115, v67
    v_mov_b32 v116, v68
    v_mov_b32 v117, v69
    v_mov_b32 v118, v70
    v_mov_b32 v119, v71
    s_mov_b32 s72, 0
    s_add_u32 s73, s50, 0
    s_getpc_b64 s[10:11]
    s_add_u32 s10, s10, att_slow-.
    s_addc_u32 s11, s11, 0
    s_swappc_b64 s[100:101], s[10:11]
    v_mov_b32 v192, v128
    v_mov_b32 v193, v129
    v_mov_b32 v194, v130
    v_mov_b32 v195, v131
    v_mov_b32 v196, v132
    v_mov_b32 v197, v133
    v_mov_b32 v198, v134
    v_mov_b32 v199, v135
    v_mov_b32 v200, v136
    v_mov_b32 v201, v137
    v_mov_b32 v202, v138
    v_mov_b32 v203, v139
    v_mov_b32 v204, v140
    v_mov_b32 v205, v141
    v_mov_b32 v206, v142
    v_mov_b32 v207, v143
    v_accvgpr_read_b32 v80, a32
    v_accvgpr_read_b32 v81, a33
    v_accvgpr_read_b32 v82, a34
    v_accvgpr_read_b32 v83, a35
    v_accvgpr_read_b32 v84, a36
    v_accvgpr_read_b32 v85, a37
    v_accvgpr_read_b32 v86, a38
    v_accvgpr_read_b32 v87, a39
    v_accvgpr_read_b32 v88, a40
    v_accvgpr_read_b32 v89, a41
    v_accvgpr_read_b32 v90, a42
    v_accvgpr_read_b32 v91, a43
    v_accvgpr_read_b32 v92, a44
    v_accvgpr_read_b32 v93, a45
    v_accvgpr_read_b32 v94, a46
    v_accvgpr_read_b32 v95, a47
    v_accvgpr_read_b32 v96, a48
    v_accvgpr_read_b32 v97, a49
    v_accvgpr_read_b32 v98, a50
    v_accvgpr_read_b32 v99, a51
    v_accvgpr_read_b32 v100, a52
    v_accvgpr_read_b32 v101, a53
    v_accvgpr_read_b32 v102, a54
    v_accvgpr_read_b32 v103, a55
    v_accvgpr_read_b32 v104, a56
    v_accvgpr_read_b32 v105, a57
    v_accvgpr_read_b32 v106, a58
    v_accvgpr_read_b32 v107, a59
    v_accvgpr_read_b32 v108, a60
    v_accvgpr_read_b32 v109, a61
    v_accvgpr_read_b32 v110, a62
    v_accvgpr_read_b32 v111, a63
    v_accvgpr_read_b32 v112, a64
    v_accvgpr_read_b32 v113, a65
    v_accvgpr_read_b32 v114, a66
    v_accvgpr_read_b32 v115, a67
    v_accvgpr_read_b32 v116, a68
    v_accvgpr_read_b32 v117, a69
    v_accvgpr_read_b32 v118, a70
    v_accvgpr_read_b32 v119, a71
    v_accvgpr_read_b32 v120, a72
    v_accvgpr_read_b32 v121, a73
    v_accvgpr_read_b32 v122, a74
    v_accvgpr_read_b32 v123, a75
    v_accvgpr_read_b32 v124, a76
    v_accvgpr_read_b32 v125, a77
    v_accvgpr_read_b32 v126, a78
    v_accvgpr_read_b32 v127, a79
    v_mov_b32 v128, v16
    v_mov_b32 v129, v16
    v_mov_b64 v[130:131], v[128:129]
    v_mov_b64 v[132:133], v[128:129]
    v_mov_b64 v[134:135], v[128:129]
    v_mov_b64 v[136:137], v[128:129]
    v_mov_b64 v[138:139], v[128:129]
    v_mov_b64 v[140:141], v[128:129]
    v_mov_b64 v[142:143], v[128:129]
    v_mov_b32 v144, v17
    v_mov_b32 v145, v17
    v_mov_b64 v[146:147], v[144:145]
    v_mov_b64 v[148:149], v[144:145]
    v_mov_b64 v[150:151], v[144:145]
    v_mov_b64 v[152:153], v[144:145]
    v_mov_b64 v[154:155], v[144:145]
    v_mov_b64 v[156:157], v[144:145]
    v_mov_b64 v[158:159], v[144:145]
    s_branch afa_ok0
bfa_fix1:
    s_nop 15
    v_accvgpr_write_b32 a32, v80
    v_accvgpr_write_b32 a33, v81
    v_accvgpr_write_b32 a34, v82
    v_accvgpr_write_b32 a35, v83
    v_accvgpr_write_b32 a36, v84
    v_accvgpr_write_b32 a37, v85
    v_accvgpr_write_b32 a38, v86
    v_accvgpr_write_b32 a39, v87
    v_accvgpr_write_b32 a40, v88
    v_accvgpr_write_b32 a41, v89
    v_accvgpr_write_b32 a42, v90
    v_accvgpr_write_b32 a43, v91
    v_accvgpr_write_b32 a44, v92
    v_accvgpr_write_b32 a45, v93
    v_accvgpr_write_b32 a46, v94
    v_accvgpr_write_b32 a47, v95
    v_accvgpr_write_b32 a48, v96
    v_accvgpr_write_b32 a49, v97
    v_accvgpr_write_b32 a50, v98
    v_accvgpr_write_b32 a51, v99
    v_accvgpr_write_b32 a52, v100
    v_accvgpr_write_b32 a53, v101
    v_accvgpr_write_b32 a54, v102
    v_accvgpr_write_b32 a55, v103
    v_accvgpr_write_b32 a56, v104
    v_accvgpr_write_b32 a57, v105
    v_accvgpr_write_b32 a58, v106
    v_accvgpr_write_b32 a59, v107
    v_accvgpr_write_b32 a60, v108
    v_accvgpr_write_b32 a61, v109
    v_accvgpr_write_b32 a62, v110
    v_accvgpr_write_b32 a63, v111
    v_accvgpr_write_b32 a64, v112
    v_accvgpr_write_b32 a65, v113
    v_accvgpr_write_b32 a66, v114
    v_accvgpr_write_b32 a67, v115
    v_accvgpr_write_b32 a68, v116
    v_accvgpr_write_b32 a69, v117
    v_accvgpr_write_b32 a70, v118
    v_accvgpr_write_b32 a71, v119
    v_accvgpr_write_b32 a72, v120
    v_accvgpr_write_b32 a73, v121
    v_accvgpr_write_b32 a74, v122
    v_accvgpr_write_b32 a75, v123
    v_accvgpr_write_b32 a76, v124
    v_accvgpr_write_b32 a77, v125
    v_accvgpr_write_b32 a78, v126
    v_accvgpr_write_b32 a79, v127
    s_mov_b32 s71, s51
    v_mov_b32 v112, v72
    v_mov_b32 v113, v73
    v_mov_b32 v114, v74
    v_mov_b32 v115, v75
    v_mov_b32 v116, v76
    v_mov_b32 v117, v77
    v_mov_b32 v118, v78
    v_mov_b32 v119, v79
    s_mov_b32 s72, 0
    s_add_u32 s73, s50, 1
    s_getpc_b64 s[10:11]
    s_add_u32 s10, s10, att_slow-.
    s_addc_u32 s11, s11, 0
    s_swappc_b64 s[100:101], s[10:11]
    v_mov_b32 v208, v128
    v_mov_b32 v209, v129
    v_mov_b32 v210, v130
    v_mov_b32 v211, v131
    v_mov_b32 v212, v132
    v_mov_b32 v213, v133
    v_mov_b32 v214, v134
    v_mov_b32 v215, v135
    v_mov_b32 v216, v136
    v_mov_b32 v217, v137
    v_mov_b32 v218, v138
    v_mov_b32 v219, v139
    v_mov_b32 v220, v140
    v_mov_b32 v221, v141
    v_mov_b32 v222, v142
    v_mov_b32 v223, v143
    v_accvgpr_read_b32 v80, a32
    v_accvgpr_read_b32 v81, a33
    v_accvgpr_read_b32 v82, a34
    v_accvgpr_read_b32 v83, a35
    v_accvgpr_read_b32 v84, a36
    v_accvgpr_read_b32 v85, a37
    v_accvgpr_read_b32 v86, a38
    v_accvgpr_read_b32 v87, a39
    v_accvgpr_read_b32 v88, a40
    v_accvgpr_read_b32 v89, a41
    v_accvgpr_read_b32 v90, a42
    v_accvgpr_read_b32 v91, a43
    v_accvgpr_read_b32 v92, a44
    v_accvgpr_read_b32 v93, a45
    v_accvgpr_read_b32 v94, a46
    v_accvgpr_read_b32 v95, a47
    v_accvgpr_read_b32 v96, a48
    v_accvgpr_read_b32 v97, a49
    v_accvgpr_read_b32 v98, a50
    v_accvgpr_read_b32 v99, a51
    v_accvgpr_read_b32 v100, a52
    v_accvgpr_read_b32 v101, a53
    v_accvgpr_read_b32 v102, a54
    v_accvgpr_read_b32 v103, a55
    v_accvgpr_read_b32 v104, a56
    v_accvgpr_read_b32 v105, a57
    v_accvgpr_read_b32 v106, a58
    v_accvgpr_read_b32 v107, a59
    v_accvgpr_read_b32 v108, a60
    v_accvgpr_read_b32 v109, a61
    v_accvgpr_read_b32 v110, a62
    v_accvgpr_read_b32 v111, a63
    v_accvgpr_read_b32 v112, a64
    v_accvgpr_read_b32 v113, a65
    v_accvgpr_read_b32 v114, a66
    v_accvgpr_read_b32 v115, a67
    v_accvgpr_read_b32 v116, a68
    v_accvgpr_read_b32 v117, a69
    v_accvgpr_read_b32 v118, a70
    v_accvgpr_read_b32 v119, a71
    v_accvgpr_read_b32 v120, a72
    v_accvgpr_read_b32 v121, a73
    v_accvgpr_read_b32 v122, a74
    v_accvgpr_read_b32 v123, a75
    v_accvgpr_read_b32 v124, a76
    v_accvgpr_read_b32 v125, a77
    v_accvgpr_read_b32 v126, a78
    v_accvgpr_read_b32 v127, a79
    v_mov_b32 v128, v16
    v_mov_b32 v129, v16
    v_mov_b64 v[130:131], v[128:129]
    v_mov_b64 v[132:133], v[128:129]
    v_mov_b64 v[134:135], v[128:129]
    v_mov_b64 v[136:137], v[128:129]
    v_mov_b64 v[138:139], v[128:129]
    v_mov_b64 v[140:141], v[128:129]
    v_mov_b64 v[142:143], v[128:129]
    v_mov_b32 v144, v17
    v_mov_b32 v145, v17
    v_mov_b64 v[146:147], v[144:145]
    v_mov_b64 v[148:149], v[144:145]
    v_mov_b64 v[150:151], v[144:145]
    v_mov_b64 v[152:153], v[144:145]
    v_mov_b64 v[154:155], v[144:145]
    v_mov_b64 v[156:157], v[144:145]
    v_mov_b64 v[158:159], v[144:145]
    s_branch bfa_ok1
bfa_fix0:
    s_nop 15
    v_accvgpr_write_b32 a32, v80
    v_accvgpr_write_b32 a33, v81
    v_accvgpr_write_b32 a34, v82
    v_accvgpr_write_b32 a35, v83
    v_accvgpr_write_b32 a36, v84
    v_accvgpr_write_b32 a37, v85
    v_accvgpr_write_b32 a38, v86
    v_accvgpr_write_b32 a39, v87
    v_accvgpr_write_b32 a40, v88
    v_accvgpr_write_b32 a41, v89
    v_accvgpr_write_b32 a42, v90
    v_accvgpr_write_b32 a43, v91
    v_accvgpr_write_b32 a44, v92
    v_accvgpr_write_b32 a45, v93
    v_accvgpr_write_b32 a46, v94
    v_accvgpr_write_b32 a47, v95
    v_accvgpr_write_b32 a48, v96
    v_accvgpr_write_b32 a49, v97
    v_accvgpr_write_b32 a50, v98
    v_accvgpr_write_b32 a51, v99
    v_accvgpr_write_b32 a52, v100
    v_accvgpr_write_b32 a53, v101
    v_accvgpr_write_b32 a54, v102
    v_accvgpr_write_b32 a55, v103
    v_accvgpr_write_b32 a56, v104
    v_accvgpr_write_b32 a57, v105
    v_accvgpr_write_b32 a58, v106
    v_accvgpr_write_b32 a59, v107
    v_accvgpr_write_b32 a60, v108
    v_accvgpr_write_b32 a61, v109
    v_accvgpr_write_b32 a62, v110
    v_accvgpr_write_b32 a63, v111
    v_accvgpr_write_b32 a64, v112
    v_accvgpr_write_b32 a65, v113
    v_accvgpr_write_b32 a66, v114
    v_accvgpr_write_b32 a67, v115
    v_accvgpr_write_b32 a68, v116
    v_accvgpr_write_b32 a69, v117
    v_accvgpr_write_b32 a70, v118
    v_accvgpr_write_b32 a71, v119
    v_accvgpr_write_b32 a72, v120
    v_accvgpr_write_b32 a73, v121
    v_accvgpr_write_b32 a74, v122
    v_accvgpr_write_b32 a75, v123
    v_accvgpr_write_b32 a76, v124
    v_accvgpr_write_b32 a77, v125
    v_accvgpr_write_b32 a78, v126
    v_accvgpr_write_b32 a79, v127
    s_mov_b32 s71, s51
    v_mov_b32 v112, v64
    v_mov_b32 v113, v65
    v_mov_b32 v114, v66
    v_mov_b32 v115, v67
    v_mov_b32 v116, v68
    v_mov_b32 v117, v69
    v_mov_b32 v118, v70
    v_mov_b32 v119, v71
    s_mov_b32 s72, 0
    s_add_u32 s73, s50, 0
    s_getpc_b64 s[10:11]
    s_add_u32 s10, s10, att_slow-.
    s_addc_u32 s11, s11, 0
    s_swappc_b64 s[100:101], s[10:11]
    v_mov_b32 v192, v128
    v_mov_b32 v193, v129
    v_mov_b32 v194, v130
    v_mov_b32 v195, v131
    v_mov_b32 v196, v132
    v_mov_b32 v197, v133
    v_mov_b32 v198, v134
    v_mov_b32 v199, v135
    v_mov_b32 v200, v136
    v_mov_b32 v201, v137
    v_mov_b32 v202, v138
    v_mov_b32 v203, v139
    v_mov_b32 v204, v140
    v_mov_b32 v205, v141
    v_mov_b32 v206, v142
    v_mov_b32 v207, v143
    v_accvgpr_read_b32 v80, a32
    v_accvgpr_read_b32 v81, a33
    v_accvgpr_read_b32 v82, a34
    v_accvgpr_read_b32 v83, a35
    v_accvgpr_read_b32 v84, a36
    v_accvgpr_read_b32 v85, a37
    v_accvgpr_read_b32 v86, a38
    v_accvgpr_read_b32 v87, a39
    v_accvgpr_read_b32 v88, a40
    v_accvgpr_read_b32 v89, a41
    v_accvgpr_read_b32 v90, a42
    v_accvgpr_read_b32 v91, a43
    v_accvgpr_read_b32 v92, a44
    v_accvgpr_read_b32 v93, a45
    v_accvgpr_read_b32 v94, a46
    v_accvgpr_read_b32 v95, a47
    v_accvgpr_read_b32 v96, a48
    v_accvgpr_read_b32 v97, a49
    v_accvgpr_read_b32 v98, a50
    v_accvgpr_read_b32 v99, a51
    v_accvgpr_read_b32 v100, a52
    v_accvgpr_read_b32 v101, a53
    v_accvgpr_read_b32 v102, a54
    v_accvgpr_read_b32 v103, a55
    v_accvgpr_read_b32 v104, a56
    v_accvgpr_read_b32 v105, a57
    v_accvgpr_read_b32 v106, a58
    v_accvgpr_read_b32 v107, a59
    v_accvgpr_read_b32 v108, a60
    v_accvgpr_read_b32 v109, a61
    v_accvgpr_read_b32 v110, a62
    v_accvgpr_read_b32 v111, a63
    v_accvgpr_read_b32 v112, a64
    v_accvgpr_read_b32 v113, a65
    v_accvgpr_read_b32 v114, a66
    v_accvgpr_read_b32 v115, a67
    v_accvgpr_read_b32 v116, a68
    v_accvgpr_read_b32 v117, a69
    v_accvgpr_read_b32 v118, a70
    v_accvgpr_read_b32 v119, a71
    v_accvgpr_read_b32 v120, a72
    v_accvgpr_read_b32 v121, a73
    v_accvgpr_read_b32 v122, a74
    v_accvgpr_read_b32 v123, a75
    v_accvgpr_read_b32 v124, a76
    v_accvgpr_read_b32 v125, a77
    v_accvgpr_read_b32 v126, a78
    v_accvgpr_read_b32 v127, a79
    v_mov_b32 v128, v16
    v_mov_b32 v129, v16
    v_mov_b64 v[130:131], v[128:129]
    v_mov_b64 v[132:133], v[128:129]
    v_mov_b64 v[134:135], v[128:129]
    v_mov_b64 v[136:137], v[128:129]
    v_mov_b64 v[138:139], v[128:129]
    v_mov_b64 v[140:141], v[128:129]
    v_mov_b64 v[142:143], v[128:129]
    v_mov_b32 v144, v17
    v_mov_b32 v145, v17
    v_mov_b64 v[146:147], v[144:145]
    v_mov_b64 v[148:149], v[144:145]
    v_mov_b64 v[150:151], v[144:145]
    v_mov_b64 v[152:153], v[144:145]
    v_mov_b64 v[154:155], v[144:145]
    v_mov_b64 v[156:157], v[144:145]
    v_mov_b64 v[158:159], v[144:145]
    s_branch bfa_ok0
att_slow:
    s_sub_i32 s64, s73, 8
    s_max_i32 s64, s64, 0
    s_add_u32 s65, s73, 1
    s_cmp_eq_u32 s72, 0
    s_cselect_b32 s64, s64, 0
    s_cselect_b32 s65, s65, 64
    s_cselect_b32 s66, 0, 4096
    s_cselect_b32 s67, 256, -1
    s_lshl_b32 s68, s72, 23
    s_lshl_b32 s70, s71, 18
    s_add_u32 s68, s68, s70
    v_and_b32 v148, 31, v2
    v_lshrrev_b32 v149, 5, v2
    v_lshlrev_b32 v149, 4, v149
    v_sub_u32 v148, v148, v149
    v_mov_b32 v150, 0xff7fffff
    v_mov_b32 v151, 0xff7fffff
    v_mov_b64 v[128:129], 0
    v_mov_b64 v[130:131], 0
    v_mov_b64 v[132:133], 0
    v_mov_b64 v[134:135], 0
    v_mov_b64 v[136:137], 0
    v_mov_b64 v[138:139], 0
    v_mov_b64 v[140:141], 0
    v_mov_b64 v[142:143], 0
    v_mov_b64 v[144:145], 0
    v_mov_b64 v[146:147], 0
    s_mov_b32 s25, 0
att_slow_pass:
    s_mov_b32 s69, s64
att_slow_loop:
    s_lshl_b32 s70, s69, 12
    s_add_u32 s70, s70, s68
    buffer_load_dwordx4 v[96:99], v63, s[20:23], s70 offen offset:0 sc1
    buffer_load_dwordx4 v[100:103], v63, s[20:23], s70 offen offset:1024 sc1
    buffer_load_dwordx4 v[104:107], v1, s[20:23], s70 offen offset:2048 sc1
    buffer_load_dwordx4 v[108:111], v1, s[20:23], s70 offen offset:3072 sc1
    s_sub_u32 s70, s73, s69
    s_lshl_b32 s70, s70, 5
    s_add_u32 s70, s70, s66
    v_add_u32 v149, s70, v148
    s_waitcnt vmcnt(0)
    v_mfma_f32_32x32x16_bf16 v[80:95], v[96:99], v[112:115], 0
    v_mfma_f32_32x32x16_bf16 v[80:95], v[100:103], v[116:119], v[80:95]
    s_nop 15
    v_subrev_u32 v152, 0, v149
    v_cmp_gt_u32 s[10:11], s67, v152
    s_nop 1
    v_cndmask_b32 v80, v151, v80, s[10:11]
    v_subrev_u32 v152, 1, v149
    v_cmp_gt_u32 s[10:11], s67, v152
    s_nop 1
    v_cndmask_b32 v81, v151, v81, s[10:11]
    v_subrev_u32 v152, 2, v149
    v_cmp_gt_u32 s[10:11], s67, v152
    s_nop 1
    v_cndmask_b32 v82, v151, v82, s[10:11]
    v_subrev_u32 v152, 3, v149
    v_cmp_gt_u32 s[10:11], s67, v152
    s_nop 1
    v_cndmask_b32 v83, v151, v83, s[10:11]
    v_subrev_u32 v152, 8, v149
    v_cmp_gt_u32 s[10:11], s67, v152
    s_nop 1
    v_cndmask_b32 v84, v151, v84, s[10:11]
    v_subrev_u32 v152, 9, v149
    v_cmp_gt_u32 s[10:11], s67, v152
    s_nop 1
    v_cndmask_b32 v85, v151, v85, s[10:11]
    v_subrev_u32 v152, 10, v149
    v_cmp_gt_u32 s[10:11], s67, v152
    s_nop 1
    v_cndmask_b32 v86, v151, v86, s[10:11]
    v_subrev_u32 v152, 11, v149
    v_cmp_gt_u32 s[10:11], s67, v152
    s_nop 1
    v_cndmask_b32 v87, v151, v87, s[10:11]
    v_subrev_u32 v152, 4, v149
    v_cmp_gt_u32 s[10:11], s67, v152
    s_nop 1
    v_cndmask_b32 v88, v151, v88, s[10:11]
    v_subrev_u32 v152, 5, v149
    v_cmp_gt_u32 s[10:11], s67, v152
    s_nop 1
    v_cndmask_b32 v89, v151, v89, s[10:11]
    v_subrev_u32 v152, 6, v149
    v_cmp_gt_u32 s[10:11], s67, v152
    s_nop 1
    v_cndmask_b32 v90, v151, v90, s[10:11]
    v_subrev_u32 v152, 7, v149
    v_cmp_gt_u32 s[10:11], s67, v152
    s_nop 1
    v_cndmask_b32 v91, v151, v91, s[10:11]
    v_subrev_u32 v152, 12, v149
    v_cmp_gt_u32 s[10:11], s67, v152
    s_nop 1
    v_cndmask_b32 v92, v151, v92, s[10:11]
    v_subrev_u32 v152, 13, v149
    v_cmp_gt_u32 s[10:11], s67, v152
    s_nop 1
    v_cndmask_b32 v93, v151, v93, s[10:11]
    v_subrev_u32 v152, 14, v149
    v_cmp_gt_u32 s[10:11], s67, v152
    s_nop 1
    v_cndmask_b32 v94, v151, v94, s[10:11]
    v_subrev_u32 v152, 15, v149
    v_cmp_gt_u32 s[10:11], s67, v152
    s_nop 1
    v_cndmask_b32 v95, v151, v95, s[10:11]
    s_cmp_eq_u32 s25, 0
    s_cbranch_scc0 att_slow_p2
    v_max3_f32 v150, v150, v80, v81
    v_max3_f32 v150, v150, v82, v83
    v_max3_f32 v150, v150, v84, v85
    v_max3_f32 v150, v150, v86, v87
    v_max3_f32 v150, v150, v88, v89
    v_max3_f32 v150, v150, v90, v91
    v_max3_f32 v150, v150, v92, v93
    v_max3_f32 v150, v150, v94, v95
    s_branch att_slow_next
att_slow_p2:
    v_sub_f32 v80, v80, v150
    v_sub_f32 v81, v81, v150
    v_sub_f32 v82, v82, v150
    v_sub_f32 v83, v83, v150
    v_sub_f32 v84, v84, v150
    v_sub_f32 v85, v85, v150
    v_sub_f32 v86, v86, v150
    v_sub_f32 v87, v87, v150
    v_sub_f32 v88, v88, v150
    v_sub_f32 v89, v89, v150
    v_sub_f32 v90, v90, v150
    v_sub_f32 v91, v91, v150
    v_sub_f32 v92, v92, v150
    v_sub_f32 v93, v93, v150
    v_sub_f32 v94, v94, v150
    v_sub_f32 v95, v95, v150
    v_exp_f32 v80, v80
    v_exp_f32 v81, v81
    v_exp_f32 v82, v82
    v_exp_f32 v83, v83
    v_exp_f32 v84, v84
    v_exp_f32 v85, v85
    v_exp_f32 v86, v86
    v_exp_f32 v87, v87
    v_exp_f32 v88, v88
    v_exp_f32 v89, v89
    v_exp_f32 v90, v90
    v_exp_f32 v91, v91
    v_exp_f32 v92, v92
    v_exp_f32 v93, v93
    v_exp_f32 v94, v94
    v_exp_f32 v95, v95
    s_nop 1
    v_smfmac_f32_32x32x32_bf16 v[128:143], v[104:107], v[80:87], v24
    v_smfmac_f32_32x32x32_bf16 v[128:143], v[108:111], v[88:95], v24
    v_smfmac_f32_16x16x64_bf16 v[144:147], v[20:23], v[80:87], v24
    v_smfmac_f32_16x16x64_bf16 v[144:147], v[20:23], v[88:95], v24
    s_nop 15
att_slow_next:
    s_add_u32 s69, s69, 1
    s_cmp_lt_u32 s69, s65
    s_cbranch_scc1 att_slow_loop
    s_cmp_eq_u32 s25, 0
    s_cbranch_scc0 att_slow_done
    v_mov_b32 v152, v150
    s_nop 1
    v_permlane32_swap_b32 v150, v152
    v_max_f32 v150, v150, v152
    s_mov_b32 s25, 1
    s_branch att_slow_pass
att_slow_done:
    v_mov_b32 v6, v144
    s_setpc_b64 s[100:101]
.section .rodata,"a"
.p2align 6
.amdhsa_kernel concat_heads__sliding_block__softmax_full_mha__prompt_kernel
  .amdhsa_next_free_vgpr 512
  .amdhsa_next_free_sgpr 102
  .amdhsa_accum_offset 256
  .amdhsa_group_segment_fixed_size 0
  .amdhsa_kernarg_size 72
  .amdhsa_user_sgpr_count 2
  .amdhsa_user_sgpr_kernarg_segment_ptr 1
  .amdhsa_system_sgpr_workgroup_id_x 1
.end_amdhsa_kernel
```
